```python
import torch

def _softmax(x, axis=-1):
    return torch.softmax(x, dim=axis)
def _gelu(x):
    return torch.nn.functional.gelu(x, approximate="tanh")
def _silu(x):
    return torch.nn.functional.silu(x)
def _sigmoid(x):
    return torch.sigmoid(x)
def _layernorm(x, axis=-1, eps=1e-5):
    m = x.mean(dim=axis, keepdim=True)
    v = x.var(dim=axis, keepdim=True, unbiased=False)
    return (x - m) / torch.sqrt(v + eps)
def _scatter_add(tgt, idx, src, axis=0):
    return tgt.clone().index_add_(axis, idx, src)
def _segment_sum(src, seg, n):
    out = torch.zeros((n,) + src.shape[1:], dtype=src.dtype)
    return out.index_add_(0, seg, src)
def _pad(x, pw):
    flat = tuple(v for pair in reversed(pw) for v in pair)
    return torch.nn.functional.pad(x, flat)

kernel_name = 'gated_mix__compressed_kv_cla__dense_activation_relu__prompt'

def setup_inputs():

    _w = (lambda a: (lambda t: t.to(torch.bfloat16) if t.is_floating_point() else t)(torch.as_tensor(a)))
    def _A_setup():
        B, H, Sq, Sk, D, M = 1, 32, 2048, 2048, 128, 512
        Dc = 4 * D
        return {
            "x": _w((lambda *s: torch.randn(*s, dtype=torch.bfloat16) * 0.05)(B, Sq, M)),
            "c_kv": _w((lambda *s: torch.randn(*s, dtype=torch.bfloat16) * 0.8)(B, Sk, Dc)),
            "w_q": _w((lambda *s: torch.randn(*s, dtype=torch.bfloat16) * 6.4)(M, H, D) * (M ** -0.5)),
            "w_uk": _w((lambda *s: torch.randn(*s, dtype=torch.bfloat16) * 6.4)(Dc, H, D) * (Dc ** -0.5)),
            "w_uv": _w((lambda *s: torch.randn(*s, dtype=torch.bfloat16) * 0.8)(Dc, H, D) * (Dc ** -0.5)),
            "w_o": _w((lambda *s: torch.randn(*s, dtype=torch.bfloat16) * 0.8)(H, D, M) * ((H * D) ** -0.5)),
        }
    _A_in = _A_setup()

    def _B_setup():
        B, S, D, Dff = 1, 2048, 512, 1792
        return {
            "x": _w((lambda *s: torch.randn(*s, dtype=torch.bfloat16) * 0.05)(B, S, D)),
            "w1": _w((lambda *s: torch.randn(*s, dtype=torch.bfloat16) * 0.05)(D, Dff)),
            "w2": _w((lambda *s: torch.randn(*s, dtype=torch.bfloat16) * 0.05)(Dff, D)),
        }
    _B_in = _B_setup()

    return {
        "A_x": _A_in["x"],
        "A_c_kv": _A_in["c_kv"],
        "A_w_q": _A_in["w_q"],
        "A_w_uk": _A_in["w_uk"],
        "A_w_uv": _A_in["w_uv"],
        "A_w_o": _A_in["w_o"],
        "B_x": _B_in["x"],
        "B_w1": _B_in["w1"],
        "B_w2": _B_in["w2"],
        "gate_w": _w((lambda *s: torch.randn(*s, dtype=torch.bfloat16) * 0.05)(512) * 16.0),
    }

def reference(A_x, A_c_kv, A_w_q, A_w_uk, A_w_uv, A_w_o, B_x, B_w1, B_w2, gate_w):
    def _A_ref(x, c_kv, w_q, w_uk, w_uv, w_o):
        B, Sq, M = x.shape[0], x.shape[1], x.shape[2]
        Sk = c_kv.shape[1]
        H, D = w_q.shape[1], w_q.shape[2]
        q = torch.einsum("bqm,mhd->bhqd", x, w_q)
        k = torch.einsum("bkc,chd->bhkd", c_kv, w_uk)
        v = torch.einsum("bkc,chd->bhkd", c_kv, w_uv)
        scores = torch.einsum("bhqd,bhkd->bhqk", q, k) * (D ** -0.5)
        off = Sk - Sq
        qi = torch.arange(Sq)[:, None]
        kj = torch.arange(Sk)[None, :]
        cmask = kj <= (qi + off)
        scores = torch.where(cmask[None, None], scores, -1e9)
        p = _softmax(scores, axis=-1)
        ctx = torch.einsum("bhqk,bhkd->bhqd", p, v)
        return torch.einsum("bhqd,hdm->bqm", ctx, w_o)

    def _B_ref(x, w1, w2):
        h = torch.einsum("bsd,df->bsf", x, w1)
        zero = torch.zeros_like(h)
        h = torch.maximum(h, zero)
        return torch.einsum("bsf,fd->bsd", h, w2)

    x = A_x
    g = _sigmoid((x * gate_w).sum(-1, keepdims=True))
    a = _A_ref(x, A_c_kv, A_w_q, A_w_uk, A_w_uv, A_w_o)
    b = _B_ref(x, B_w1, B_w2)
    return g * a + (1 - g) * b
```

```asm
; @launch grid=(256,1,1) block=(256,1,1) lds=163840
.amdgcn_target "amdgcn-amd-amdhsa--gfx950"
.text
.p2align 12
.globl gated_mix__compressed_kv_cla__dense_activation_relu__prompt_kernel
.p2align 8
.type gated_mix__compressed_kv_cla__dense_activation_relu__prompt_kernel,@function
gated_mix__compressed_kv_cla__dense_activation_relu__prompt_kernel:
    s_getpc_b64 s[96:97]
    v_min_u32 v36, 9, v0
    v_lshlrev_b32 v36, 7, v36
    s_load_dwordx2 s[12:13], s[0:1], 24
    s_load_dwordx2 s[4:5], s[0:1], 8
    global_load_dword v37, v36, s[96:97]
    s_cmp_ge_u32 s2, 256
    s_cbranch_scc1 L_end
    v_lshrrev_b32 v39, 6, v0
    v_and_b32 v32, 63, v0
    v_readfirstlane_b32 s66, v39
    v_lshrrev_b32 v33, 4, v32
    v_lshlrev_b32 v17, 4, v32
    s_and_b32 s69, s2, 7
    s_bfe_u32 s70, s2, 0x20003
    s_lshl_b32 s64, s69, 2
    s_add_u32 s64, s64, s70
    s_lshr_b32 s65, s2, 5
    s_and_b32 s82, s65, 7
    s_add_u32 s82, s69, s82
    s_and_b32 s82, s82, 7
    s_lshl_b32 s78, s82, 19
    s_lshl_b32 s76, s66, 12
    s_lshl_b32 s71, s64, 8
    s_sub_u32 s14, 4194304, s71
    s_mov_b32 s15, 0x20000
    s_lshl_b32 s81, s82, 7
    s_mul_i32 s77, s66, 24576
    s_add_u32 s77, s77, 65536
    s_lshl_b32 s69, s65, 18
    s_lshl_b32 s72, s66, 16
    s_add_u32 s72, s69, s72
    s_mov_b32 s6, 2097152
    s_mov_b32 s7, 0x20000
    s_add_u32 s73, s72, 16384
    s_add_u32 s74, s72, 32768
    s_add_u32 s75, s72, 49152
    v_lshrrev_b32 v36, 3, v32
    v_and_b32 v38, 7, v32
    v_xor_b32 v38, v38, v33
    v_lshlrev_b32 v36, 10, v36
    v_lshl_add_u32 v15, v38, 4, v36
    v_xor_b32 v16, 64, v15
    v_add_u32 v16, 7168, v16
    s_lshr_b32 s69, s2, 3
    s_mul_i32 s69, s69, 2304
    v_min_u32 v36, 17, v0
    v_lshl_add_u32 v36, v36, 7, s69
    global_load_dword v37, v36, s[96:97]
    s_waitcnt lgkmcnt(0)
    s_add_u32 m0, s77, 0
    s_add_u32 s79, s72, s81
    buffer_load_dwordx4 v15, s[4:7], s79 offen lds
    buffer_load_dwordx4 v16, s[4:7], s79 offen offset:1024 lds
    s_add_u32 m0, s77, 2048
    s_add_u32 s79, s73, s81
    buffer_load_dwordx4 v15, s[4:7], s79 offen lds
    buffer_load_dwordx4 v16, s[4:7], s79 offen offset:1024 lds
    s_add_u32 m0, s77, 4096
    s_add_u32 s79, s74, s81
    buffer_load_dwordx4 v15, s[4:7], s79 offen lds
    buffer_load_dwordx4 v16, s[4:7], s79 offen offset:1024 lds
    s_add_u32 m0, s77, 6144
    s_add_u32 s79, s75, s81
    buffer_load_dwordx4 v15, s[4:7], s79 offen lds
    buffer_load_dwordx4 v16, s[4:7], s79 offen offset:1024 lds
    v_lshl_add_u32 v36, v39, 4, v33
    v_lshlrev_b32 v36, 13, v36
    v_lshlrev_b32 v38, 5, v33
    v_xor_b32 v38, v38, v17
    v_and_b32 v38, 255, v38
    v_add_u32 v11, v36, v38
    v_add_u32 v12, 31744, v11
    v_xor_b32 v36, 128, v11
    v_add_u32 v13, 63488, v36
    v_add_u32 v14, 95232, v36
    s_add_u32 m0, s76, 0
    s_add_u32 s12, s12, s71
    s_addc_u32 s13, s13, 0
    buffer_load_dwordx4 v11, s[12:15], s78 offen lds
    buffer_load_dwordx4 v12, s[12:15], s78 offen offset:1024 lds
    buffer_load_dwordx4 v13, s[12:15], s78 offen offset:2048 lds
    buffer_load_dwordx4 v14, s[12:15], s78 offen offset:3072 lds
    v_and_b32 v28, 15, v32
    v_lshlrev_b32 v28, 7, v28
    s_load_dwordx2 s[8:9], s[0:1], 0
    s_load_dwordx2 s[24:25], s[0:1], 16
    s_load_dwordx2 s[16:17], s[0:1], 32
    s_load_dwordx2 s[44:45], s[0:1], 40
    s_load_dwordx2 s[20:21], s[0:1], 56
    s_load_dwordx2 s[40:41], s[0:1], 64
    s_load_dwordx2 s[36:37], s[0:1], 72
    s_load_dwordx2 s[48:49], s[0:1], 80
    s_load_dwordx2 s[56:57], s[0:1], 88
    s_load_dwordx2 s[52:53], s[0:1], 96
    v_bfe_u32 v34, v32, 2, 2
    v_and_b32 v35, 3, v32
    v_bfe_u32 v36, v32, 1, 3
    v_xor_b32 v36, v36, v33
    v_lshlrev_b32 v36, 4, v36
    v_and_b32 v38, 15, v32
    v_lshl_add_u32 v36, v38, 7, v36
    v_add_u32 v9, s77, v36
    v_xor_b32 v10, 64, v9
    v_and_b32 v36, 1, v33
    v_lshl_add_u32 v36, v36, 2, v34
    v_lshlrev_b32 v36, 5, v36
    v_lshl_add_u32 v36, v35, 3, v36
    v_lshl_add_u32 v38, v33, 3, v34
    v_lshl_add_u32 v1, v38, 8, v36
    v_xor_b32 v2, 32, v1
    v_xor_b32 v3, 64, v1
    v_xor_b32 v4, 96, v1
    v_xor_b32 v5, 128, v1
    v_xor_b32 v6, 160, v1
    v_xor_b32 v7, 192, v1
    v_xor_b32 v8, 224, v1
    s_waitcnt lgkmcnt(0)
    v_mov_b32 v27, v0
    s_lshr_b32 s67, s64, 3
    s_and_b32 s68, s64, 7
    s_add_u32 s60, s52, 83886080
    s_addc_u32 s61, s53, 0
    s_lshl_b32 s69, s64, 20
    s_add_u32 s28, s52, s69
    s_addc_u32 s29, s53, 0
    s_add_u32 s32, s52, 33554432
    s_addc_u32 s33, s53, 0
    s_add_u32 s52, s52, 67108864
    s_addc_u32 s53, s53, 0
    s_mov_b32 s54, 67108864
    s_mov_b32 s55, 0x20000
    s_lshl_b32 s89, s65, 3
    s_add_u32 s89, s89, s68
    s_lshl_b32 s89, s89, 2
    s_add_u32 s89, s89, s67
    s_lshl_b32 s89, s89, 2
    s_add_u32 s89, s89, s66
    s_mul_i32 s89, s89, 6144
    s_add_u32 s90, s89, 4096
    s_mov_b32 s62, 4325376
    s_mov_b32 s63, 0x20000
    s_mov_b32 s58, 256
    s_mov_b32 s59, 0x20000
    s_mov_b32 s38, 1024
    s_mov_b32 s39, 0x20000
    s_and_b32 s87, s64, 3
    s_mul_i32 s87, s87, 0
    s_add_u32 s87, s87, s65
    s_add_u32 s87, s87, s2
    s_and_b32 s87, s87, 7
    s_lshr_b32 s96, s66, 1
    s_mul_i32 s96, s96, 1
    s_add_u32 s96, s96, s87
    s_xor_b32 s70, s71, 0
    s_add_u32 s16, s16, s70
    s_addc_u32 s17, s17, 0
    s_sub_u32 s18, 4194304, s70
    s_mov_b32 s19, 0x20000
    s_and_b32 s70, s71, 7168
    s_add_u32 s24, s24, s70
    s_addc_u32 s25, s25, 0
    s_sub_u32 s26, 4194304, s70
    s_mov_b32 s27, 0x20000
    s_mov_b32 s10, 2097152
    s_mov_b32 s11, 0x20000
    s_xor_b32 s69, s64, 2
    s_sub_u32 s69, s69, s67
    s_lshl_b32 s69, s69, 7
    s_add_u32 s20, s20, s69
    s_addc_u32 s21, s21, 0
    s_sub_u32 s22, 1835008, s69
    s_mov_b32 s23, 0x20000
    s_cmp_eq_u32 s68, 5
    s_cselect_b32 s22, 0, s22
    s_lshl_b32 s69, s65, 3
    s_sub_u32 s70, 120, s69
    s_sub_u32 s71, 7, s66
    s_add_u32 s83, s70, s71
    s_add_u32 s84, s69, s66
    s_add_u32 s85, s69, s71
    s_add_u32 s86, s70, s66
    s_lshl_b32 s70, s2, 2
    s_add_u32 s70, s70, s66
    s_lshl_b32 s92, s70, 11
    v_and_b32 v36, 1, v33
    v_lshlrev_b32 v36, 1, v36
    v_lshrrev_b32 v38, 1, v34
    v_add_lshl_u32 v38, v38, v36, 5
    v_lshl_add_u32 v38, v35, 3, v38
    v_lshl_add_u32 v35, v33, 3, v34
    v_lshl_add_u32 v23, v35, 7, v38
    v_xor_b32 v24, 32, v23
    v_xor_b32 v35, v36, v32
    v_and_b32 v35, 7, v35
    v_bfe_u32 v36, v27, 3, 3
    v_and_b32 v38, 1, v39
    v_lshl_add_u32 v36, v38, 5, v36
    v_mul_u32_u24 v36, 3584, v36
    v_lshl_add_u32 v25, v35, 4, v36
    v_xor_b32 v26, 64, v25
    v_and_b32 v36, 31, v32
    v_lshl_add_u32 v34, v38, 5, v36
    v_lshlrev_b32 v34, 1, v34
    v_lshl_add_u32 v36, v39, 5, v36
    v_lshlrev_b32 v36, 7, v36
    v_bfe_u32 v38, v32, 1, 1
    v_lshl_add_u32 v36, v38, 5, v36
    v_bfe_u32 v38, v32, 3, 1
    v_lshl_add_u32 v36, v38, 6, v36
    v_lshrrev_b32 v38, 5, v32
    v_lshl_add_u32 v22, v38, 1, v36
    v_bfe_u32 v36, v32, 1, 4
    v_lshl_add_u32 v36, v39, 4, v36
    v_bfe_u32 v30, v32, 3, 2
    v_lshl_add_u32 v30, v39, 2, v30
    v_and_b32 v38, 3, s64
    v_lshl_add_u32 v30, v38, 4, v30
    v_lshlrev_b32 v30, 13, v30
    v_and_b32 v38, 7, v32
    v_lshl_add_u32 v30, v38, 7, v30
    v_mul_u32_u24 v29, 3584, v36
    v_lshrrev_b32 v35, 2, v27
    v_lshl_add_u32 v35, s2, 6, v35
    v_mul_u32_u24 v35, 4224, v35
    v_and_b32 v38, 48, v17
    v_add_u32 v35, v35, v38
    v_lshlrev_b32 v33, 2, s2
    v_add_lshl_u32 v33, v33, v39, 2
    v_bfrev_b32 v36, 1
    v_mov_b32 v18, 0
    v_mov_b32 v19, 0
    v_cmp_eq_u32 vcc, 0, v32
    v_mov_b32 v20, 0
    v_mov_b32 v21, 0
    v_cndmask_b32 v27, v36, v32, vcc
    v_add_u32 v33, v33, v27
    v_lshlrev_b32 v36, 2, v32
    v_lshrrev_b32 v32, 3, s2
    v_lshl_add_u32 v32, v32, 2, v39
    v_lshlrev_b32 v32, 7, v32
    v_add_u32 v32, 1536, v32
    v_mov_b32 v39, 1
    s_add_u32 s81, s81, 128
    s_and_b32 s81, s81, 1023
    s_add_u32 m0, s77, 8192
    s_add_u32 s79, s72, s81
    buffer_load_dwordx4 v15, s[4:7], s79 offen lds
    buffer_load_dwordx4 v16, s[4:7], s79 offen offset:1024 lds
    s_add_u32 m0, s77, 10240
    s_add_u32 s79, s73, s81
    buffer_load_dwordx4 v15, s[4:7], s79 offen lds
    buffer_load_dwordx4 v16, s[4:7], s79 offen offset:1024 lds
    s_add_u32 m0, s77, 12288
    s_add_u32 s79, s74, s81
    buffer_load_dwordx4 v15, s[4:7], s79 offen lds
    buffer_load_dwordx4 v16, s[4:7], s79 offen offset:1024 lds
    s_add_u32 m0, s77, 14336
    s_add_u32 s79, s75, s81
    buffer_load_dwordx4 v15, s[4:7], s79 offen lds
    buffer_load_dwordx4 v16, s[4:7], s79 offen offset:1024 lds
    s_waitcnt vmcnt(12)
    ds_read_b128 a[0:3], v9
    ds_read_b128 a[16:19], v10
    ds_read_b128 a[4:7], v9 offset:2048
    ds_read_b128 a[20:23], v10 offset:2048
    ds_read_b128 a[8:11], v9 offset:4096
    ds_read_b128 a[24:27], v10 offset:4096
    ds_read_b128 a[12:15], v9 offset:6144
    ds_read_b128 a[28:31], v10 offset:6144
    s_waitcnt vmcnt(8)
    s_barrier
    ds_read_b64_tr_b16 v[232:233], v1
    ds_read_b64_tr_b16 v[234:235], v1 offset:1024
    ds_read_b64_tr_b16 v[236:237], v1 offset:8192
    ds_read_b64_tr_b16 v[238:239], v1 offset:9216
    ds_read_b64_tr_b16 v[240:241], v2
    ds_read_b64_tr_b16 v[242:243], v2 offset:1024
    ds_read_b64_tr_b16 v[244:245], v2 offset:8192
    ds_read_b64_tr_b16 v[246:247], v2 offset:9216
    s_waitcnt lgkmcnt(4)
    v_mfma_f32_16x16x32_bf16 v[40:43], v[232:235], a[0:3], 0
    s_add_u32 s78, s78, 524288
    s_and_b32 s78, s78, 4194303
    s_add_u32 m0, s76, 16384
    ds_read_b64_tr_b16 v[248:249], v3
    v_mfma_f32_16x16x32_bf16 v[40:43], v[236:239], a[16:19], v[40:43]
    buffer_load_dwordx4 v11, s[12:15], s78 offen lds
    v_mfma_f32_16x16x32_bf16 v[44:47], v[236:239], a[20:23], 0
    s_mov_b32 s30, 1048576
    ds_read_b64_tr_b16 v[250:251], v3 offset:1024
    v_mfma_f32_16x16x32_bf16 v[44:47], v[232:235], a[4:7], v[44:47]
    s_mov_b32 s31, 0x20000
    v_mfma_f32_16x16x32_bf16 v[48:51], v[232:235], a[8:11], 0
    s_mov_b32 s34, 24117248
    ds_read_b64_tr_b16 v[252:253], v3 offset:8192
    v_mfma_f32_16x16x32_bf16 v[48:51], v[236:239], a[24:27], v[48:51]
    buffer_load_dwordx4 v12, s[12:15], s78 offen offset:1024 lds
    v_mfma_f32_16x16x32_bf16 v[52:55], v[236:239], a[28:31], 0
    s_waitcnt lgkmcnt(3)
    ds_read_b64_tr_b16 v[254:255], v3 offset:9216
    v_mfma_f32_16x16x32_bf16 v[52:55], v[232:235], a[12:15], v[52:55]
    s_mov_b32 s35, 0x20000
    v_mfma_f32_16x16x32_bf16 v[56:59], v[240:243], a[0:3], 0
    s_mov_b32 s50, 2097152
    ds_read_b64_tr_b16 v[232:233], v4
    v_mfma_f32_16x16x32_bf16 v[56:59], v[244:247], a[16:19], v[56:59]
    s_waitcnt vmcnt(8)
    ds_read_b128 a[32:35], v9 offset:8192
    v_mfma_f32_16x16x32_bf16 v[60:63], v[244:247], a[20:23], 0
    s_mov_b32 s51, 0x20000
    ds_read_b64_tr_b16 v[234:235], v4 offset:1024
    v_mfma_f32_16x16x32_bf16 v[60:63], v[240:243], a[4:7], v[60:63]
    s_and_b32 s70, s64, 3
    ds_read_b128 a[48:51], v10 offset:8192
    v_mfma_f32_16x16x32_bf16 v[64:67], v[240:243], a[8:11], 0
    s_lshl_b32 s70, s70, 8
    ds_read_b64_tr_b16 v[236:237], v4 offset:8192
    v_mfma_f32_16x16x32_bf16 v[64:67], v[244:247], a[24:27], v[64:67]
    buffer_load_dwordx4 v13, s[12:15], s78 offen offset:2048 lds
    v_mfma_f32_16x16x32_bf16 v[68:71], v[244:247], a[28:31], 0
    s_waitcnt lgkmcnt(5)
    ds_read_b64_tr_b16 v[238:239], v4 offset:9216
    v_mfma_f32_16x16x32_bf16 v[68:71], v[240:243], a[12:15], v[68:71]
    buffer_load_dwordx4 v14, s[12:15], s78 offen offset:3072 lds
    v_mfma_f32_16x16x32_bf16 v[72:75], v[248:251], a[0:3], 0
    s_add_u32 s81, s81, 128
    ds_read_b64_tr_b16 v[240:241], v5
    v_mfma_f32_16x16x32_bf16 v[72:75], v[252:255], a[16:19], v[72:75]
    s_waitcnt vmcnt(8)
    ds_read_b128 a[36:39], v9 offset:10240
    v_mfma_f32_16x16x32_bf16 v[76:79], v[252:255], a[20:23], 0
    s_and_b32 s81, s81, 1023
    ds_read_b64_tr_b16 v[242:243], v5 offset:1024
    v_mfma_f32_16x16x32_bf16 v[76:79], v[248:251], a[4:7], v[76:79]
    s_add_u32 m0, s77, 16384
    ds_read_b128 a[52:55], v10 offset:10240
    v_mfma_f32_16x16x32_bf16 v[80:83], v[248:251], a[8:11], 0
    s_add_u32 s79, s72, s81
    ds_read_b64_tr_b16 v[244:245], v5 offset:8192
    v_mfma_f32_16x16x32_bf16 v[80:83], v[252:255], a[24:27], v[80:83]
    buffer_load_dwordx4 v15, s[4:7], s79 offen lds
    v_mfma_f32_16x16x32_bf16 v[84:87], v[252:255], a[28:31], 0
    s_waitcnt lgkmcnt(5)
    ds_read_b64_tr_b16 v[246:247], v5 offset:9216
    v_mfma_f32_16x16x32_bf16 v[84:87], v[248:251], a[12:15], v[84:87]
    s_mul_i32 s69, s67, 458752
    v_mfma_f32_16x16x32_bf16 v[88:91], v[232:235], a[0:3], 0
    s_add_u32 s69, s69, s70
    ds_read_b64_tr_b16 v[248:249], v6
    v_mfma_f32_16x16x32_bf16 v[88:91], v[236:239], a[16:19], v[88:91]
    s_waitcnt vmcnt(7)
    ds_read_b128 a[40:43], v9 offset:12288
    v_mfma_f32_16x16x32_bf16 v[92:95], v[236:239], a[20:23], 0
    s_add_u32 s40, s40, s69
    s_addc_u32 s41, s41, 0
    ds_read_b64_tr_b16 v[250:251], v6 offset:1024
    v_mfma_f32_16x16x32_bf16 v[92:95], v[232:235], a[4:7], v[92:95]
    s_sub_u32 s42, 1835008, s69
    ds_read_b128 a[56:59], v10 offset:12288
    v_mfma_f32_16x16x32_bf16 v[96:99], v[232:235], a[8:11], 0
    s_mov_b32 s43, 0x20000
    ds_read_b64_tr_b16 v[252:253], v6 offset:8192
    v_mfma_f32_16x16x32_bf16 v[96:99], v[236:239], a[24:27], v[96:99]
    buffer_load_dwordx4 v16, s[4:7], s79 offen offset:1024 lds
    v_mfma_f32_16x16x32_bf16 v[100:103], v[236:239], a[28:31], 0
    s_waitcnt lgkmcnt(5)
    s_add_u32 m0, s77, 18432
    s_add_u32 s79, s73, s81
    ds_read_b64_tr_b16 v[254:255], v6 offset:9216
    v_mfma_f32_16x16x32_bf16 v[100:103], v[232:235], a[12:15], v[100:103]
    buffer_load_dwordx4 v15, s[4:7], s79 offen lds
    v_mfma_f32_16x16x32_bf16 v[104:107], v[240:243], a[0:3], 0
    s_lshl_b32 s69, s67, 20
    ds_read_b64_tr_b16 v[232:233], v7
    v_mfma_f32_16x16x32_bf16 v[104:107], v[244:247], a[16:19], v[104:107]
    s_waitcnt vmcnt(7)
    ds_read_b128 a[44:47], v9 offset:14336
    v_mfma_f32_16x16x32_bf16 v[108:111], v[244:247], a[20:23], 0
    s_add_u32 s69, s69, s70
    ds_read_b64_tr_b16 v[234:235], v7 offset:1024
    v_mfma_f32_16x16x32_bf16 v[108:111], v[240:243], a[4:7], v[108:111]
    s_add_u32 s44, s44, s69
    s_addc_u32 s45, s45, 0
    ds_read_b128 a[60:63], v10 offset:14336
    v_mfma_f32_16x16x32_bf16 v[112:115], v[240:243], a[8:11], 0
    s_sub_u32 s46, 4194304, s69
    ds_read_b64_tr_b16 v[236:237], v7 offset:8192
    v_mfma_f32_16x16x32_bf16 v[112:115], v[244:247], a[24:27], v[112:115]
    buffer_load_dwordx4 v16, s[4:7], s79 offen offset:1024 lds
    v_mfma_f32_16x16x32_bf16 v[116:119], v[244:247], a[28:31], 0
    s_waitcnt lgkmcnt(5)
    s_add_u32 m0, s77, 20480
    s_add_u32 s79, s74, s81
    ds_read_b64_tr_b16 v[238:239], v7 offset:9216
    v_mfma_f32_16x16x32_bf16 v[116:119], v[240:243], a[12:15], v[116:119]
    buffer_load_dwordx4 v15, s[4:7], s79 offen lds
    v_mfma_f32_16x16x32_bf16 v[120:123], v[248:251], a[0:3], 0
    s_mov_b32 s47, 0x20000
    ds_read_b64_tr_b16 v[240:241], v8
    v_mfma_f32_16x16x32_bf16 v[120:123], v[252:255], a[16:19], v[120:123]
    s_mov_b32 s93, 0x3e0293ee
    ds_read_b64_tr_b16 v[242:243], v8 offset:1024
    v_mfma_f32_16x16x32_bf16 v[124:127], v[252:255], a[20:23], 0
    s_lshl_b32 s69, s65, 2
    ds_read_b64_tr_b16 v[244:245], v8 offset:8192
    v_mfma_f32_16x16x32_bf16 v[124:127], v[248:251], a[4:7], v[124:127]
    s_add_u32 s69, s69, s66
    ds_read_b64_tr_b16 v[246:247], v8 offset:9216
    v_mfma_f32_16x16x32_bf16 v[128:131], v[248:251], a[8:11], 0
    buffer_load_dwordx4 v16, s[4:7], s79 offen offset:1024 lds
    v_mfma_f32_16x16x32_bf16 v[128:131], v[252:255], a[24:27], v[128:131]
    s_add_u32 m0, s77, 22528
    v_mfma_f32_16x16x32_bf16 v[132:135], v[252:255], a[28:31], 0
    s_waitcnt lgkmcnt(4)
    s_add_u32 s79, s75, s81
    v_mfma_f32_16x16x32_bf16 v[132:135], v[248:251], a[12:15], v[132:135]
    buffer_load_dwordx4 v15, s[4:7], s79 offen lds
    v_mfma_f32_16x16x32_bf16 v[136:139], v[232:235], a[0:3], 0
    s_waitcnt vmcnt(7)
    v_mfma_f32_16x16x32_bf16 v[136:139], v[236:239], a[16:19], v[136:139]
    s_barrier
    v_mfma_f32_16x16x32_bf16 v[140:143], v[236:239], a[20:23], 0
    s_lshl_b32 s80, s69, 15
    ds_read_b64_tr_b16 v[248:249], v1 offset:16384
    v_mfma_f32_16x16x32_bf16 v[140:143], v[232:235], a[4:7], v[140:143]
    s_lshl_b32 s1, s67, 3
    ds_read_b64_tr_b16 v[250:251], v1 offset:17408
    v_mfma_f32_16x16x32_bf16 v[144:147], v[232:235], a[8:11], 0
    s_add_u32 s1, s1, s65
    ds_read_b64_tr_b16 v[252:253], v1 offset:24576
    v_mfma_f32_16x16x32_bf16 v[144:147], v[236:239], a[24:27], v[144:147]
    buffer_load_dwordx4 v16, s[4:7], s79 offen offset:1024 lds
    v_mfma_f32_16x16x32_bf16 v[148:151], v[236:239], a[28:31], 0
    s_waitcnt lgkmcnt(3)
    ds_read_b64_tr_b16 v[254:255], v1 offset:25600
    v_mfma_f32_16x16x32_bf16 v[148:151], v[232:235], a[12:15], v[148:151]
    s_add_u32 s78, s78, 524288
    v_mfma_f32_16x16x32_bf16 v[152:155], v[240:243], a[0:3], 0
    s_and_b32 s78, s78, 4194303
    s_add_u32 m0, s76, 32768
    ds_read_b64_tr_b16 v[232:233], v2 offset:16384
    v_mfma_f32_16x16x32_bf16 v[152:155], v[244:247], a[16:19], v[152:155]
    buffer_load_dwordx4 v11, s[12:15], s78 offen lds
    v_mfma_f32_16x16x32_bf16 v[156:159], v[244:247], a[20:23], 0
    s_lshl_b32 s1, s1, 2
    ds_read_b64_tr_b16 v[234:235], v2 offset:17408
    v_mfma_f32_16x16x32_bf16 v[156:159], v[240:243], a[4:7], v[156:159]
    s_add_u32 s1, s1, s66
    v_mfma_f32_16x16x32_bf16 v[160:163], v[240:243], a[8:11], 0
    s_add_u32 s1, s1, 64
    ds_read_b64_tr_b16 v[236:237], v2 offset:24576
    s_mov_b64 exec, 0
    s_bitcmp1_b32 s2, 5
    s_cbranch_scc1 L_hop_b
    s_cmp_eq_u32 s66, 0
    s_cbranch_scc1 L_hop0
    s_cmp_eq_u32 s66, 1
    s_cbranch_scc1 L_hop1
    s_cmp_eq_u32 s66, 2
    s_cbranch_scc1 L_hop2
    s_branch L_hop3
L_hop_b:
    s_cmp_eq_u32 s66, 0
    s_cbranch_scc1 L_hop8
    s_cmp_eq_u32 s66, 1
    s_cbranch_scc1 L_hop9
    s_cmp_eq_u32 s66, 2
    s_cbranch_scc1 L_hop10
    s_branch L_hop11
L_hop_ret:
L_hop_ret1:
    s_mov_b64 exec, -1
    v_mfma_f32_16x16x32_bf16 v[160:163], v[244:247], a[24:27], v[160:163]
    buffer_load_dwordx4 v12, s[12:15], s78 offen offset:1024 lds
    v_mfma_f32_16x16x32_bf16 v[164:167], v[244:247], a[28:31], 0
    s_waitcnt lgkmcnt(3)
    ds_read_b64_tr_b16 v[238:239], v2 offset:25600
    v_mfma_f32_16x16x32_bf16 v[164:167], v[240:243], a[12:15], v[164:167]
    s_mul_i32 s1, s1, 4224
    v_mfma_f32_16x16x32_bf16 v[40:43], v[248:251], a[32:35], v[40:43]
    s_lshl_b32 s69, s68, 2
    ds_read_b64_tr_b16 v[240:241], v3 offset:16384
    v_mfma_f32_16x16x32_bf16 v[40:43], v[252:255], a[48:51], v[40:43]
    s_add_u32 s3, s1, s69
    v_mfma_f32_16x16x32_bf16 v[44:47], v[252:255], a[52:55], v[44:47]
    s_mul_i32 s0, s64, 8448
    ds_read_b64_tr_b16 v[242:243], v3 offset:17408
    v_mfma_f32_16x16x32_bf16 v[44:47], v[248:251], a[36:39], v[44:47]
    buffer_load_dwordx4 v13, s[12:15], s78 offen offset:2048 lds
    v_mfma_f32_16x16x32_bf16 v[48:51], v[248:251], a[40:43], v[48:51]
    s_lshl_b32 s88, s66, 13
    ds_read_b64_tr_b16 v[244:245], v3 offset:24576
    v_mfma_f32_16x16x32_bf16 v[48:51], v[252:255], a[56:59], v[48:51]
    v_mfma_f32_16x16x32_bf16 v[52:55], v[252:255], a[60:63], v[52:55]
    s_waitcnt lgkmcnt(3)
    ds_read_b64_tr_b16 v[246:247], v3 offset:25600
    v_mfma_f32_16x16x32_bf16 v[52:55], v[248:251], a[44:47], v[52:55]
    buffer_load_dwordx4 v14, s[12:15], s78 offen offset:3072 lds
    v_mfma_f32_16x16x32_bf16 v[56:59], v[232:235], a[32:35], v[56:59]
    s_add_u32 s81, s81, 128
    ds_read_b64_tr_b16 v[248:249], v4 offset:16384
    v_mfma_f32_16x16x32_bf16 v[56:59], v[236:239], a[48:51], v[56:59]
    s_and_b32 s81, s81, 1023
    v_mfma_f32_16x16x32_bf16 v[60:63], v[236:239], a[52:55], v[60:63]
    s_add_u32 m0, s77, 0
    s_add_u32 s79, s72, s81
    ds_read_b64_tr_b16 v[250:251], v4 offset:17408
    v_mfma_f32_16x16x32_bf16 v[60:63], v[232:235], a[36:39], v[60:63]
    buffer_load_dwordx4 v15, s[4:7], s79 offen lds
    v_mfma_f32_16x16x32_bf16 v[64:67], v[232:235], a[40:43], v[64:67]
    ds_read_b64_tr_b16 v[252:253], v4 offset:24576
    v_mfma_f32_16x16x32_bf16 v[64:67], v[236:239], a[56:59], v[64:67]
    v_mfma_f32_16x16x32_bf16 v[68:71], v[236:239], a[60:63], v[68:71]
    s_waitcnt lgkmcnt(3)
    ds_read_b64_tr_b16 v[254:255], v4 offset:25600
    v_mfma_f32_16x16x32_bf16 v[68:71], v[232:235], a[44:47], v[68:71]
    buffer_load_dwordx4 v16, s[4:7], s79 offen offset:1024 lds
    v_mfma_f32_16x16x32_bf16 v[72:75], v[240:243], a[32:35], v[72:75]
L_hop0:
    s_cbranch_execz L_hop4
    ds_read_b64_tr_b16 v[232:233], v5 offset:16384
    v_mfma_f32_16x16x32_bf16 v[72:75], v[244:247], a[48:51], v[72:75]
    v_mfma_f32_16x16x32_bf16 v[76:79], v[244:247], a[52:55], v[76:79]
    ds_read_b64_tr_b16 v[234:235], v5 offset:17408
    v_mfma_f32_16x16x32_bf16 v[76:79], v[240:243], a[36:39], v[76:79]
    v_mfma_f32_16x16x32_bf16 v[80:83], v[240:243], a[40:43], v[80:83]
    ds_read_b64_tr_b16 v[236:237], v5 offset:24576
    v_mfma_f32_16x16x32_bf16 v[80:83], v[244:247], a[56:59], v[80:83]
    s_waitcnt vmcnt(12)
    ds_read_b128 a[64:67], v9 offset:16384
    v_mfma_f32_16x16x32_bf16 v[84:87], v[244:247], a[60:63], v[84:87]
    s_waitcnt lgkmcnt(4)
    ds_read_b64_tr_b16 v[238:239], v5 offset:25600
    v_mfma_f32_16x16x32_bf16 v[84:87], v[240:243], a[44:47], v[84:87]
    s_add_u32 m0, s77, 2048
    ds_read_b128 a[80:83], v10 offset:16384
    v_mfma_f32_16x16x32_bf16 v[88:91], v[248:251], a[32:35], v[88:91]
    s_add_u32 s79, s73, s81
    ds_read_b64_tr_b16 v[240:241], v6 offset:16384
    v_mfma_f32_16x16x32_bf16 v[88:91], v[252:255], a[48:51], v[88:91]
    buffer_load_dwordx4 v15, s[4:7], s79 offen lds
    v_mfma_f32_16x16x32_bf16 v[92:95], v[252:255], a[52:55], v[92:95]
    ds_read_b64_tr_b16 v[242:243], v6 offset:17408
    v_mfma_f32_16x16x32_bf16 v[92:95], v[248:251], a[36:39], v[92:95]
    buffer_load_dwordx4 v16, s[4:7], s79 offen offset:1024 lds
    v_mfma_f32_16x16x32_bf16 v[96:99], v[248:251], a[40:43], v[96:99]
    ds_read_b64_tr_b16 v[244:245], v6 offset:24576
    v_mfma_f32_16x16x32_bf16 v[96:99], v[252:255], a[56:59], v[96:99]
    s_waitcnt vmcnt(12)
    ds_read_b128 a[68:71], v9 offset:18432
    v_mfma_f32_16x16x32_bf16 v[100:103], v[252:255], a[60:63], v[100:103]
    s_waitcnt lgkmcnt(5)
    ds_read_b64_tr_b16 v[246:247], v6 offset:25600
    v_mfma_f32_16x16x32_bf16 v[100:103], v[248:251], a[44:47], v[100:103]
    s_add_u32 m0, s77, 4096
    ds_read_b128 a[84:87], v10 offset:18432
    v_mfma_f32_16x16x32_bf16 v[104:107], v[232:235], a[32:35], v[104:107]
    s_add_u32 s79, s74, s81
    ds_read_b64_tr_b16 v[248:249], v7 offset:16384
    v_mfma_f32_16x16x32_bf16 v[104:107], v[236:239], a[48:51], v[104:107]
    buffer_load_dwordx4 v15, s[4:7], s79 offen lds
    v_mfma_f32_16x16x32_bf16 v[108:111], v[236:239], a[52:55], v[108:111]
    ds_read_b64_tr_b16 v[250:251], v7 offset:17408
    v_mfma_f32_16x16x32_bf16 v[108:111], v[232:235], a[36:39], v[108:111]
    buffer_load_dwordx4 v16, s[4:7], s79 offen offset:1024 lds
    v_mfma_f32_16x16x32_bf16 v[112:115], v[232:235], a[40:43], v[112:115]
    ds_read_b64_tr_b16 v[252:253], v7 offset:24576
    v_mfma_f32_16x16x32_bf16 v[112:115], v[236:239], a[56:59], v[112:115]
    s_waitcnt vmcnt(12)
    ds_read_b128 a[72:75], v9 offset:20480
    v_mfma_f32_16x16x32_bf16 v[116:119], v[236:239], a[60:63], v[116:119]
    s_waitcnt lgkmcnt(5)
    ds_read_b64_tr_b16 v[254:255], v7 offset:25600
    v_mfma_f32_16x16x32_bf16 v[116:119], v[232:235], a[44:47], v[116:119]
    ds_read_b128 a[88:91], v10 offset:20480
    v_mfma_f32_16x16x32_bf16 v[120:123], v[240:243], a[32:35], v[120:123]
    ds_read_b64_tr_b16 v[232:233], v8 offset:16384
    v_mfma_f32_16x16x32_bf16 v[120:123], v[244:247], a[48:51], v[120:123]
    ds_read_b64_tr_b16 v[234:235], v8 offset:17408
    v_mfma_f32_16x16x32_bf16 v[124:127], v[244:247], a[52:55], v[124:127]
    s_add_u32 m0, s77, 6144
    ds_read_b64_tr_b16 v[236:237], v8 offset:24576
    v_mfma_f32_16x16x32_bf16 v[124:127], v[240:243], a[36:39], v[124:127]
    s_add_u32 s79, s75, s81
    ds_read_b64_tr_b16 v[238:239], v8 offset:25600
    v_mfma_f32_16x16x32_bf16 v[128:131], v[240:243], a[40:43], v[128:131]
    buffer_load_dwordx4 v15, s[4:7], s79 offen lds
    v_mfma_f32_16x16x32_bf16 v[128:131], v[244:247], a[56:59], v[128:131]
    s_waitcnt vmcnt(11)
    ds_read_b128 a[76:79], v9 offset:22528
    v_mfma_f32_16x16x32_bf16 v[132:135], v[244:247], a[60:63], v[132:135]
    s_waitcnt lgkmcnt(6)
    v_mfma_f32_16x16x32_bf16 v[132:135], v[240:243], a[44:47], v[132:135]
    ds_read_b128 a[92:95], v10 offset:22528
    v_mfma_f32_16x16x32_bf16 v[136:139], v[248:251], a[32:35], v[136:139]
    s_waitcnt vmcnt(7)
    v_mfma_f32_16x16x32_bf16 v[136:139], v[252:255], a[48:51], v[136:139]
    s_barrier
    v_mfma_f32_16x16x32_bf16 v[140:143], v[252:255], a[52:55], v[140:143]
    ds_read_b64_tr_b16 v[240:241], v1 offset:32768
    v_mfma_f32_16x16x32_bf16 v[140:143], v[248:251], a[36:39], v[140:143]
    ds_read_b64_tr_b16 v[242:243], v1 offset:33792
    v_mfma_f32_16x16x32_bf16 v[144:147], v[248:251], a[40:43], v[144:147]
    ds_read_b64_tr_b16 v[244:245], v1 offset:40960
    v_mfma_f32_16x16x32_bf16 v[144:147], v[252:255], a[56:59], v[144:147]
    buffer_load_dwordx4 v16, s[4:7], s79 offen offset:1024 lds
    v_mfma_f32_16x16x32_bf16 v[148:151], v[252:255], a[60:63], v[148:151]
    s_waitcnt lgkmcnt(5)
    ds_read_b64_tr_b16 v[246:247], v1 offset:41984
    v_mfma_f32_16x16x32_bf16 v[148:151], v[248:251], a[44:47], v[148:151]
    buffer_store_dwordx4 v[18:21], v35, s[60:63], 0 offen sc1
    v_mfma_f32_16x16x32_bf16 v[152:155], v[232:235], a[32:35], v[152:155]
    s_add_u32 s78, s78, 524288
    s_and_b32 s78, s78, 4194303
    s_add_u32 m0, s76, 49152
    ds_read_b64_tr_b16 v[248:249], v2 offset:32768
    v_mfma_f32_16x16x32_bf16 v[152:155], v[236:239], a[48:51], v[152:155]
    buffer_load_dwordx4 v11, s[12:15], s78 offen lds
    v_mfma_f32_16x16x32_bf16 v[156:159], v[236:239], a[52:55], v[156:159]
    ds_read_b64_tr_b16 v[250:251], v2 offset:33792
    v_mfma_f32_16x16x32_bf16 v[156:159], v[232:235], a[36:39], v[156:159]
    v_mfma_f32_16x16x32_bf16 v[160:163], v[232:235], a[40:43], v[160:163]
    ds_read_b64_tr_b16 v[252:253], v2 offset:40960
    v_mfma_f32_16x16x32_bf16 v[160:163], v[236:239], a[56:59], v[160:163]
    buffer_load_dwordx4 v12, s[12:15], s78 offen offset:1024 lds
    v_mfma_f32_16x16x32_bf16 v[164:167], v[236:239], a[60:63], v[164:167]
    s_waitcnt lgkmcnt(3)
    ds_read_b64_tr_b16 v[254:255], v2 offset:41984
    v_mfma_f32_16x16x32_bf16 v[164:167], v[232:235], a[44:47], v[164:167]
    v_mfma_f32_16x16x32_bf16 v[40:43], v[240:243], a[64:67], v[40:43]
    ds_read_b64_tr_b16 v[232:233], v3 offset:32768
    v_mfma_f32_16x16x32_bf16 v[40:43], v[244:247], a[80:83], v[40:43]
    buffer_load_dwordx4 v13, s[12:15], s78 offen offset:2048 lds
    v_mfma_f32_16x16x32_bf16 v[44:47], v[244:247], a[84:87], v[44:47]
    ds_read_b64_tr_b16 v[234:235], v3 offset:33792
    v_mfma_f32_16x16x32_bf16 v[44:47], v[240:243], a[68:71], v[44:47]
    v_mfma_f32_16x16x32_bf16 v[48:51], v[240:243], a[72:75], v[48:51]
    ds_read_b64_tr_b16 v[236:237], v3 offset:40960
    v_mfma_f32_16x16x32_bf16 v[48:51], v[244:247], a[88:91], v[48:51]
    buffer_load_dwordx4 v14, s[12:15], s78 offen offset:3072 lds
    v_mfma_f32_16x16x32_bf16 v[52:55], v[244:247], a[92:95], v[52:55]
    s_waitcnt lgkmcnt(3)
    ds_read_b64_tr_b16 v[238:239], v3 offset:41984
    v_mfma_f32_16x16x32_bf16 v[52:55], v[240:243], a[76:79], v[52:55]
    s_waitcnt vmcnt(11)
    ds_read_b128 a[96:99], v9
    v_mfma_f32_16x16x32_bf16 v[56:59], v[248:251], a[64:67], v[56:59]
    s_add_u32 s81, s81, 128
    ds_read_b64_tr_b16 v[240:241], v4 offset:32768
    v_mfma_f32_16x16x32_bf16 v[56:59], v[252:255], a[80:83], v[56:59]
    s_and_b32 s81, s81, 1023
    ds_read_b128 a[112:115], v10
    v_mfma_f32_16x16x32_bf16 v[60:63], v[252:255], a[84:87], v[60:63]
    s_add_u32 m0, s77, 8192
    s_add_u32 s79, s72, s81
    ds_read_b64_tr_b16 v[242:243], v4 offset:33792
    v_mfma_f32_16x16x32_bf16 v[60:63], v[248:251], a[68:71], v[60:63]
    buffer_load_dwordx4 v15, s[4:7], s79 offen lds
    v_mfma_f32_16x16x32_bf16 v[64:67], v[248:251], a[72:75], v[64:67]
    ds_read_b64_tr_b16 v[244:245], v4 offset:40960
    v_mfma_f32_16x16x32_bf16 v[64:67], v[252:255], a[88:91], v[64:67]
    v_mfma_f32_16x16x32_bf16 v[68:71], v[252:255], a[92:95], v[68:71]
    s_waitcnt lgkmcnt(5)
    ds_read_b64_tr_b16 v[246:247], v4 offset:41984
    v_mfma_f32_16x16x32_bf16 v[68:71], v[248:251], a[76:79], v[68:71]
    buffer_load_dwordx4 v16, s[4:7], s79 offen offset:1024 lds
    v_mfma_f32_16x16x32_bf16 v[72:75], v[232:235], a[64:67], v[72:75]
    ds_read_b64_tr_b16 v[248:249], v5 offset:32768
    v_mfma_f32_16x16x32_bf16 v[72:75], v[236:239], a[80:83], v[72:75]
    v_mfma_f32_16x16x32_bf16 v[76:79], v[236:239], a[84:87], v[76:79]
    ds_read_b64_tr_b16 v[250:251], v5 offset:33792
    v_mfma_f32_16x16x32_bf16 v[76:79], v[232:235], a[68:71], v[76:79]
    s_waitcnt vmcnt(11)
    ds_read_b128 a[100:103], v9 offset:2048
    v_mfma_f32_16x16x32_bf16 v[80:83], v[232:235], a[72:75], v[80:83]
    s_add_u32 m0, s77, 10240
    ds_read_b64_tr_b16 v[252:253], v5 offset:40960
    v_mfma_f32_16x16x32_bf16 v[80:83], v[236:239], a[88:91], v[80:83]
    s_add_u32 s79, s73, s81
    ds_read_b128 a[116:119], v10 offset:2048
    v_mfma_f32_16x16x32_bf16 v[84:87], v[236:239], a[92:95], v[84:87]
    s_waitcnt lgkmcnt(5)
    ds_read_b64_tr_b16 v[254:255], v5 offset:41984
    v_mfma_f32_16x16x32_bf16 v[84:87], v[232:235], a[76:79], v[84:87]
    buffer_load_dwordx4 v15, s[4:7], s79 offen lds
    v_mfma_f32_16x16x32_bf16 v[88:91], v[240:243], a[64:67], v[88:91]
    ds_read_b64_tr_b16 v[232:233], v6 offset:32768
    v_mfma_f32_16x16x32_bf16 v[88:91], v[244:247], a[80:83], v[88:91]
    buffer_load_dwordx4 v16, s[4:7], s79 offen offset:1024 lds
    v_mfma_f32_16x16x32_bf16 v[92:95], v[244:247], a[84:87], v[92:95]
    ds_read_b64_tr_b16 v[234:235], v6 offset:33792
    v_mfma_f32_16x16x32_bf16 v[92:95], v[240:243], a[68:71], v[92:95]
    s_waitcnt vmcnt(11)
    ds_read_b128 a[104:107], v9 offset:4096
    v_mfma_f32_16x16x32_bf16 v[96:99], v[240:243], a[72:75], v[96:99]
    s_add_u32 m0, s77, 12288
    ds_read_b64_tr_b16 v[236:237], v6 offset:40960
    v_mfma_f32_16x16x32_bf16 v[96:99], v[244:247], a[88:91], v[96:99]
    s_add_u32 s79, s74, s81
    ds_read_b128 a[120:123], v10 offset:4096
    v_mfma_f32_16x16x32_bf16 v[100:103], v[244:247], a[92:95], v[100:103]
    s_waitcnt lgkmcnt(5)
    ds_read_b64_tr_b16 v[238:239], v6 offset:41984
    v_mfma_f32_16x16x32_bf16 v[100:103], v[240:243], a[76:79], v[100:103]
    buffer_load_dwordx4 v15, s[4:7], s79 offen lds
    v_mfma_f32_16x16x32_bf16 v[104:107], v[248:251], a[64:67], v[104:107]
    ds_read_b64_tr_b16 v[240:241], v7 offset:32768
    v_mfma_f32_16x16x32_bf16 v[104:107], v[252:255], a[80:83], v[104:107]
    buffer_load_dwordx4 v16, s[4:7], s79 offen offset:1024 lds
    v_mfma_f32_16x16x32_bf16 v[108:111], v[252:255], a[84:87], v[108:111]
    ds_read_b64_tr_b16 v[242:243], v7 offset:33792
    v_mfma_f32_16x16x32_bf16 v[108:111], v[248:251], a[68:71], v[108:111]
    s_add_u32 m0, s77, 14336
    v_mfma_f32_16x16x32_bf16 v[112:115], v[248:251], a[72:75], v[112:115]
    s_add_u32 s79, s75, s81
    ds_read_b64_tr_b16 v[244:245], v7 offset:40960
    v_mfma_f32_16x16x32_bf16 v[112:115], v[252:255], a[88:91], v[112:115]
    buffer_load_dwordx4 v15, s[4:7], s79 offen lds
    v_mfma_f32_16x16x32_bf16 v[116:119], v[252:255], a[92:95], v[116:119]
    s_waitcnt lgkmcnt(3)
    ds_read_b64_tr_b16 v[246:247], v7 offset:41984
    v_mfma_f32_16x16x32_bf16 v[116:119], v[248:251], a[76:79], v[116:119]
    v_mfma_f32_16x16x32_bf16 v[120:123], v[232:235], a[64:67], v[120:123]
    ds_read_b64_tr_b16 v[248:249], v8 offset:32768
    v_mfma_f32_16x16x32_bf16 v[120:123], v[236:239], a[80:83], v[120:123]
    ds_read_b64_tr_b16 v[250:251], v8 offset:33792
    v_mfma_f32_16x16x32_bf16 v[124:127], v[236:239], a[84:87], v[124:127]
    ds_read_b64_tr_b16 v[252:253], v8 offset:40960
    v_mfma_f32_16x16x32_bf16 v[124:127], v[232:235], a[68:71], v[124:127]
    ds_read_b64_tr_b16 v[254:255], v8 offset:41984
    v_mfma_f32_16x16x32_bf16 v[128:131], v[232:235], a[72:75], v[128:131]
    buffer_load_dwordx4 v16, s[4:7], s79 offen offset:1024 lds
    v_mfma_f32_16x16x32_bf16 v[128:131], v[236:239], a[88:91], v[128:131]
    s_waitcnt vmcnt(13)
    ds_read_b128 a[108:111], v9 offset:6144
    v_mfma_f32_16x16x32_bf16 v[132:135], v[236:239], a[92:95], v[132:135]
    s_waitcnt lgkmcnt(5)
    v_mfma_f32_16x16x32_bf16 v[132:135], v[232:235], a[76:79], v[132:135]
    ds_read_b128 a[124:127], v10 offset:6144
    v_mfma_f32_16x16x32_bf16 v[136:139], v[240:243], a[64:67], v[136:139]
    s_waitcnt vmcnt(8)
    v_mfma_f32_16x16x32_bf16 v[136:139], v[244:247], a[80:83], v[136:139]
    s_barrier
    v_mfma_f32_16x16x32_bf16 v[140:143], v[244:247], a[84:87], v[140:143]
    s_add_u32 s78, s78, 524288
    ds_read_b64_tr_b16 v[232:233], v1 offset:49152
    v_mfma_f32_16x16x32_bf16 v[140:143], v[240:243], a[68:71], v[140:143]
    s_and_b32 s78, s78, 4194303
    ds_read_b64_tr_b16 v[234:235], v1 offset:50176
    v_mfma_f32_16x16x32_bf16 v[144:147], v[240:243], a[72:75], v[144:147]
    s_add_u32 m0, s76, 0
    ds_read_b64_tr_b16 v[236:237], v1 offset:57344
    v_mfma_f32_16x16x32_bf16 v[144:147], v[244:247], a[88:91], v[144:147]
    buffer_load_dwordx4 v11, s[12:15], s78 offen lds
    v_mfma_f32_16x16x32_bf16 v[148:151], v[244:247], a[92:95], v[148:151]
    s_waitcnt lgkmcnt(5)
    ds_read_b64_tr_b16 v[238:239], v1 offset:58368
    v_mfma_f32_16x16x32_bf16 v[148:151], v[240:243], a[76:79], v[148:151]
    buffer_load_dwordx4 v12, s[12:15], s78 offen offset:1024 lds
    v_mfma_f32_16x16x32_bf16 v[152:155], v[248:251], a[64:67], v[152:155]
    ds_read_b64_tr_b16 v[240:241], v2 offset:49152
    v_mfma_f32_16x16x32_bf16 v[152:155], v[252:255], a[80:83], v[152:155]
    buffer_load_dwordx4 v13, s[12:15], s78 offen offset:2048 lds
    v_mfma_f32_16x16x32_bf16 v[156:159], v[252:255], a[84:87], v[156:159]
    ds_read_b64_tr_b16 v[242:243], v2 offset:50176
    v_mfma_f32_16x16x32_bf16 v[156:159], v[248:251], a[68:71], v[156:159]
    v_mfma_f32_16x16x32_bf16 v[160:163], v[248:251], a[72:75], v[160:163]
    ds_read_b64_tr_b16 v[244:245], v2 offset:57344
    v_mfma_f32_16x16x32_bf16 v[160:163], v[252:255], a[88:91], v[160:163]
    buffer_load_dwordx4 v14, s[12:15], s78 offen offset:3072 lds
    v_mfma_f32_16x16x32_bf16 v[164:167], v[252:255], a[92:95], v[164:167]
    s_waitcnt lgkmcnt(3)
    ds_read_b64_tr_b16 v[246:247], v2 offset:58368
    v_mfma_f32_16x16x32_bf16 v[164:167], v[248:251], a[76:79], v[164:167]
    s_add_u32 s81, s81, 128
    s_and_b32 s81, s81, 1023
    v_mfma_f32_16x16x32_bf16 v[40:43], v[232:235], a[96:99], v[40:43]
    s_add_u32 m0, s77, 16384
    s_add_u32 s79, s72, s81
    ds_read_b64_tr_b16 v[248:249], v3 offset:49152
    v_mfma_f32_16x16x32_bf16 v[40:43], v[236:239], a[112:115], v[40:43]
    buffer_load_dwordx4 v15, s[4:7], s79 offen lds
    v_mfma_f32_16x16x32_bf16 v[44:47], v[236:239], a[116:119], v[44:47]
    ds_read_b64_tr_b16 v[250:251], v3 offset:50176
    v_mfma_f32_16x16x32_bf16 v[44:47], v[232:235], a[100:103], v[44:47]
    v_mfma_f32_16x16x32_bf16 v[48:51], v[232:235], a[104:107], v[48:51]
    ds_read_b64_tr_b16 v[252:253], v3 offset:57344
    v_mfma_f32_16x16x32_bf16 v[48:51], v[236:239], a[120:123], v[48:51]
    buffer_load_dwordx4 v16, s[4:7], s79 offen offset:1024 lds
    v_mfma_f32_16x16x32_bf16 v[52:55], v[236:239], a[124:127], v[52:55]
    s_waitcnt lgkmcnt(3)
    ds_read_b64_tr_b16 v[254:255], v3 offset:58368
    v_mfma_f32_16x16x32_bf16 v[52:55], v[232:235], a[108:111], v[52:55]
    s_waitcnt vmcnt(12)
    ds_read_b128 a[128:131], v9 offset:8192
    v_mfma_f32_16x16x32_bf16 v[56:59], v[240:243], a[96:99], v[56:59]
    ds_read_b64_tr_b16 v[232:233], v4 offset:49152
    v_mfma_f32_16x16x32_bf16 v[56:59], v[244:247], a[112:115], v[56:59]
    s_add_u32 m0, s77, 18432
    ds_read_b128 a[144:147], v10 offset:8192
    v_mfma_f32_16x16x32_bf16 v[60:63], v[244:247], a[116:119], v[60:63]
    s_add_u32 s79, s73, s81
    ds_read_b64_tr_b16 v[234:235], v4 offset:50176
    v_mfma_f32_16x16x32_bf16 v[60:63], v[240:243], a[100:103], v[60:63]
    buffer_load_dwordx4 v15, s[4:7], s79 offen lds
    v_mfma_f32_16x16x32_bf16 v[64:67], v[240:243], a[104:107], v[64:67]
    ds_read_b64_tr_b16 v[236:237], v4 offset:57344
    v_mfma_f32_16x16x32_bf16 v[64:67], v[244:247], a[120:123], v[64:67]
    v_mfma_f32_16x16x32_bf16 v[68:71], v[244:247], a[124:127], v[68:71]
    s_waitcnt lgkmcnt(5)
    ds_read_b64_tr_b16 v[238:239], v4 offset:58368
    v_mfma_f32_16x16x32_bf16 v[68:71], v[240:243], a[108:111], v[68:71]
    buffer_load_dwordx4 v16, s[4:7], s79 offen offset:1024 lds
    v_mfma_f32_16x16x32_bf16 v[72:75], v[248:251], a[96:99], v[72:75]
    ds_read_b64_tr_b16 v[240:241], v5 offset:49152
    v_mfma_f32_16x16x32_bf16 v[72:75], v[252:255], a[112:115], v[72:75]
    s_waitcnt vmcnt(12)
    ds_read_b128 a[132:135], v9 offset:10240
    v_mfma_f32_16x16x32_bf16 v[76:79], v[252:255], a[116:119], v[76:79]
    ds_read_b64_tr_b16 v[242:243], v5 offset:50176
    v_mfma_f32_16x16x32_bf16 v[76:79], v[248:251], a[100:103], v[76:79]
    s_add_u32 m0, s77, 20480
    ds_read_b128 a[148:151], v10 offset:10240
    v_mfma_f32_16x16x32_bf16 v[80:83], v[248:251], a[104:107], v[80:83]
    s_add_u32 s79, s74, s81
    ds_read_b64_tr_b16 v[244:245], v5 offset:57344
    v_mfma_f32_16x16x32_bf16 v[80:83], v[252:255], a[120:123], v[80:83]
    buffer_load_dwordx4 v15, s[4:7], s79 offen lds
    v_mfma_f32_16x16x32_bf16 v[84:87], v[252:255], a[124:127], v[84:87]
    s_waitcnt lgkmcnt(5)
    ds_read_b64_tr_b16 v[246:247], v5 offset:58368
    v_mfma_f32_16x16x32_bf16 v[84:87], v[248:251], a[108:111], v[84:87]
    v_mfma_f32_16x16x32_bf16 v[88:91], v[232:235], a[96:99], v[88:91]
    ds_read_b64_tr_b16 v[248:249], v6 offset:49152
    v_mfma_f32_16x16x32_bf16 v[88:91], v[236:239], a[112:115], v[88:91]
    s_waitcnt vmcnt(11)
    ds_read_b128 a[136:139], v9 offset:12288
    v_mfma_f32_16x16x32_bf16 v[92:95], v[236:239], a[116:119], v[92:95]
    ds_read_b64_tr_b16 v[250:251], v6 offset:50176
    v_mfma_f32_16x16x32_bf16 v[92:95], v[232:235], a[100:103], v[92:95]
    ds_read_b128 a[152:155], v10 offset:12288
    v_mfma_f32_16x16x32_bf16 v[96:99], v[232:235], a[104:107], v[96:99]
    ds_read_b64_tr_b16 v[252:253], v6 offset:57344
    v_mfma_f32_16x16x32_bf16 v[96:99], v[236:239], a[120:123], v[96:99]
    buffer_load_dwordx4 v16, s[4:7], s79 offen offset:1024 lds
    v_mfma_f32_16x16x32_bf16 v[100:103], v[236:239], a[124:127], v[100:103]
    s_waitcnt lgkmcnt(5)
    s_add_u32 m0, s77, 22528
    s_add_u32 s79, s75, s81
    ds_read_b64_tr_b16 v[254:255], v6 offset:58368
    v_mfma_f32_16x16x32_bf16 v[100:103], v[232:235], a[108:111], v[100:103]
    buffer_load_dwordx4 v15, s[4:7], s79 offen lds
    v_mfma_f32_16x16x32_bf16 v[104:107], v[240:243], a[96:99], v[104:107]
    ds_read_b64_tr_b16 v[232:233], v7 offset:49152
    v_mfma_f32_16x16x32_bf16 v[104:107], v[244:247], a[112:115], v[104:107]
    buffer_load_dwordx4 v16, s[4:7], s79 offen offset:1024 lds
    v_mfma_f32_16x16x32_bf16 v[108:111], v[244:247], a[116:119], v[108:111]
    ds_read_b64_tr_b16 v[234:235], v7 offset:50176
    v_mfma_f32_16x16x32_bf16 v[108:111], v[240:243], a[100:103], v[108:111]
    v_mfma_f32_16x16x32_bf16 v[112:115], v[240:243], a[104:107], v[112:115]
    ds_read_b64_tr_b16 v[236:237], v7 offset:57344
    v_mfma_f32_16x16x32_bf16 v[112:115], v[244:247], a[120:123], v[112:115]
    s_waitcnt vmcnt(12)
    ds_read_b128 a[140:143], v9 offset:14336
    v_mfma_f32_16x16x32_bf16 v[116:119], v[244:247], a[124:127], v[116:119]
    s_waitcnt lgkmcnt(4)
    ds_read_b64_tr_b16 v[238:239], v7 offset:58368
    v_mfma_f32_16x16x32_bf16 v[116:119], v[240:243], a[108:111], v[116:119]
    ds_read_b128 a[156:159], v10 offset:14336
    v_mfma_f32_16x16x32_bf16 v[120:123], v[248:251], a[96:99], v[120:123]
    ds_read_b64_tr_b16 v[240:241], v8 offset:49152
    v_mfma_f32_16x16x32_bf16 v[120:123], v[252:255], a[112:115], v[120:123]
    ds_read_b64_tr_b16 v[242:243], v8 offset:50176
    v_mfma_f32_16x16x32_bf16 v[124:127], v[252:255], a[116:119], v[124:127]
    ds_read_b64_tr_b16 v[244:245], v8 offset:57344
    v_mfma_f32_16x16x32_bf16 v[124:127], v[248:251], a[100:103], v[124:127]
    ds_read_b64_tr_b16 v[246:247], v8 offset:58368
    v_mfma_f32_16x16x32_bf16 v[128:131], v[248:251], a[104:107], v[128:131]
    buffer_store_dword v39, v33, s[56:59], 0 offen sc1
    v_mfma_f32_16x16x32_bf16 v[128:131], v[252:255], a[120:123], v[128:131]
    s_add_u32 s78, s78, 524288
    s_and_b32 s78, s78, 4194303
    v_mfma_f32_16x16x32_bf16 v[132:135], v[252:255], a[124:127], v[132:135]
    s_waitcnt lgkmcnt(5)
    s_add_u32 m0, s76, 16384
    v_mfma_f32_16x16x32_bf16 v[132:135], v[248:251], a[108:111], v[132:135]
    buffer_load_dwordx4 v11, s[12:15], s78 offen lds
    v_mfma_f32_16x16x32_bf16 v[136:139], v[232:235], a[96:99], v[136:139]
    s_waitcnt vmcnt(10)
    v_mfma_f32_16x16x32_bf16 v[136:139], v[236:239], a[112:115], v[136:139]
    s_barrier
    v_mfma_f32_16x16x32_bf16 v[140:143], v[236:239], a[116:119], v[140:143]
    ds_read_b64_tr_b16 v[248:249], v1
    v_mfma_f32_16x16x32_bf16 v[140:143], v[232:235], a[100:103], v[140:143]
    ds_read_b64_tr_b16 v[250:251], v1 offset:1024
    v_mfma_f32_16x16x32_bf16 v[144:147], v[232:235], a[104:107], v[144:147]
    ds_read_b64_tr_b16 v[252:253], v1 offset:8192
    v_mfma_f32_16x16x32_bf16 v[144:147], v[236:239], a[120:123], v[144:147]
    buffer_load_dwordx4 v12, s[12:15], s78 offen offset:1024 lds
    v_mfma_f32_16x16x32_bf16 v[148:151], v[236:239], a[124:127], v[148:151]
    s_waitcnt lgkmcnt(3)
    ds_read_b64_tr_b16 v[254:255], v1 offset:9216
    v_mfma_f32_16x16x32_bf16 v[148:151], v[232:235], a[108:111], v[148:151]
    buffer_load_dwordx4 v13, s[12:15], s78 offen offset:2048 lds
    v_mfma_f32_16x16x32_bf16 v[152:155], v[240:243], a[96:99], v[152:155]
    ds_read_b64_tr_b16 v[232:233], v2
    v_mfma_f32_16x16x32_bf16 v[152:155], v[244:247], a[112:115], v[152:155]
    buffer_load_dwordx4 v14, s[12:15], s78 offen offset:3072 lds
    v_mfma_f32_16x16x32_bf16 v[156:159], v[244:247], a[116:119], v[156:159]
    ds_read_b64_tr_b16 v[234:235], v2 offset:1024
    v_mfma_f32_16x16x32_bf16 v[156:159], v[240:243], a[100:103], v[156:159]
    s_add_u32 s81, s81, 128
    v_mfma_f32_16x16x32_bf16 v[160:163], v[240:243], a[104:107], v[160:163]
    s_and_b32 s81, s81, 1023
    ds_read_b64_tr_b16 v[236:237], v2 offset:8192
    v_mfma_f32_16x16x32_bf16 v[160:163], v[244:247], a[120:123], v[160:163]
    s_waitcnt vmcnt(11)
    ds_read_b128 a[160:163], v9 offset:16384
    v_mfma_f32_16x16x32_bf16 v[164:167], v[244:247], a[124:127], v[164:167]
    s_waitcnt lgkmcnt(4)
    ds_read_b64_tr_b16 v[238:239], v2 offset:9216
    v_mfma_f32_16x16x32_bf16 v[164:167], v[240:243], a[108:111], v[164:167]
    s_add_u32 m0, s77, 0
    ds_read_b128 a[176:179], v10 offset:16384
    v_mfma_f32_16x16x32_bf16 v[40:43], v[248:251], a[128:131], v[40:43]
    s_add_u32 s79, s72, s81
    ds_read_b64_tr_b16 v[240:241], v3
    v_mfma_f32_16x16x32_bf16 v[40:43], v[252:255], a[144:147], v[40:43]
    buffer_load_dwordx4 v15, s[4:7], s79 offen lds
    v_mfma_f32_16x16x32_bf16 v[44:47], v[252:255], a[148:151], v[44:47]
    ds_read_b64_tr_b16 v[242:243], v3 offset:1024
    v_mfma_f32_16x16x32_bf16 v[44:47], v[248:251], a[132:135], v[44:47]
    buffer_load_dwordx4 v16, s[4:7], s79 offen offset:1024 lds
    v_mfma_f32_16x16x32_bf16 v[48:51], v[248:251], a[136:139], v[48:51]
    ds_read_b64_tr_b16 v[244:245], v3 offset:8192
    v_mfma_f32_16x16x32_bf16 v[48:51], v[252:255], a[152:155], v[48:51]
    v_mfma_f32_16x16x32_bf16 v[52:55], v[252:255], a[156:159], v[52:55]
    s_waitcnt lgkmcnt(4)
    ds_read_b64_tr_b16 v[246:247], v3 offset:9216
    v_mfma_f32_16x16x32_bf16 v[52:55], v[248:251], a[140:143], v[52:55]
    s_waitcnt vmcnt(11)
    ds_read_b128 a[164:167], v9 offset:18432
    v_mfma_f32_16x16x32_bf16 v[56:59], v[232:235], a[128:131], v[56:59]
    ds_read_b64_tr_b16 v[248:249], v4
    v_mfma_f32_16x16x32_bf16 v[56:59], v[236:239], a[144:147], v[56:59]
    s_add_u32 m0, s77, 2048
    ds_read_b128 a[180:183], v10 offset:18432
    v_mfma_f32_16x16x32_bf16 v[60:63], v[236:239], a[148:151], v[60:63]
    s_add_u32 s79, s73, s81
    ds_read_b64_tr_b16 v[250:251], v4 offset:1024
    v_mfma_f32_16x16x32_bf16 v[60:63], v[232:235], a[132:135], v[60:63]
    buffer_load_dwordx4 v15, s[4:7], s79 offen lds
    v_mfma_f32_16x16x32_bf16 v[64:67], v[232:235], a[136:139], v[64:67]
    ds_read_b64_tr_b16 v[252:253], v4 offset:8192
    v_mfma_f32_16x16x32_bf16 v[64:67], v[236:239], a[152:155], v[64:67]
    buffer_load_dwordx4 v16, s[4:7], s79 offen offset:1024 lds
    v_mfma_f32_16x16x32_bf16 v[68:71], v[236:239], a[156:159], v[68:71]
    s_waitcnt lgkmcnt(5)
    s_add_u32 m0, s77, 4096
    s_add_u32 s79, s74, s81
    ds_read_b64_tr_b16 v[254:255], v4 offset:9216
    v_mfma_f32_16x16x32_bf16 v[68:71], v[232:235], a[140:143], v[68:71]
    buffer_load_dwordx4 v15, s[4:7], s79 offen lds
    v_mfma_f32_16x16x32_bf16 v[72:75], v[240:243], a[128:131], v[72:75]
    ds_read_b64_tr_b16 v[232:233], v5
    v_mfma_f32_16x16x32_bf16 v[72:75], v[244:247], a[144:147], v[72:75]
    v_mfma_f32_16x16x32_bf16 v[76:79], v[244:247], a[148:151], v[76:79]
    ds_read_b64_tr_b16 v[234:235], v5 offset:1024
    v_mfma_f32_16x16x32_bf16 v[76:79], v[240:243], a[132:135], v[76:79]
    buffer_load_dwordx4 v16, s[4:7], s79 offen offset:1024 lds
    v_mfma_f32_16x16x32_bf16 v[80:83], v[240:243], a[136:139], v[80:83]
    ds_read_b64_tr_b16 v[236:237], v5 offset:8192
    v_mfma_f32_16x16x32_bf16 v[80:83], v[244:247], a[152:155], v[80:83]
    s_waitcnt vmcnt(13)
    ds_read_b128 a[168:171], v9 offset:20480
    v_mfma_f32_16x16x32_bf16 v[84:87], v[244:247], a[156:159], v[84:87]
    s_waitcnt lgkmcnt(4)
    ds_read_b64_tr_b16 v[238:239], v5 offset:9216
    v_mfma_f32_16x16x32_bf16 v[84:87], v[240:243], a[140:143], v[84:87]
    ds_read_b128 a[184:187], v10 offset:20480
    v_mfma_f32_16x16x32_bf16 v[88:91], v[248:251], a[128:131], v[88:91]
    ds_read_b64_tr_b16 v[240:241], v6
    v_mfma_f32_16x16x32_bf16 v[88:91], v[252:255], a[144:147], v[88:91]
    s_waitcnt vmcnt(11)
    ds_read_b128 a[172:175], v9 offset:22528
    v_mfma_f32_16x16x32_bf16 v[92:95], v[252:255], a[148:151], v[92:95]
    ds_read_b64_tr_b16 v[242:243], v6 offset:1024
    v_mfma_f32_16x16x32_bf16 v[92:95], v[248:251], a[132:135], v[92:95]
    s_add_u32 m0, s77, 6144
    ds_read_b128 a[188:191], v10 offset:22528
    v_mfma_f32_16x16x32_bf16 v[96:99], v[248:251], a[136:139], v[96:99]
    s_add_u32 s79, s75, s81
    ds_read_b64_tr_b16 v[244:245], v6 offset:8192
    v_mfma_f32_16x16x32_bf16 v[96:99], v[252:255], a[152:155], v[96:99]
    buffer_load_dwordx4 v15, s[4:7], s79 offen lds
    v_mfma_f32_16x16x32_bf16 v[100:103], v[252:255], a[156:159], v[100:103]
    s_waitcnt lgkmcnt(6)
    ds_read_b64_tr_b16 v[246:247], v6 offset:9216
    v_mfma_f32_16x16x32_bf16 v[100:103], v[248:251], a[140:143], v[100:103]
    buffer_load_dwordx4 v16, s[4:7], s79 offen offset:1024 lds
    v_mfma_f32_16x16x32_bf16 v[104:107], v[232:235], a[128:131], v[104:107]
    s_add_u32 s78, s78, 524288
    s_and_b32 s78, s78, 4194303
    s_add_u32 m0, s76, 32768
    ds_read_b64_tr_b16 v[248:249], v7
    v_mfma_f32_16x16x32_bf16 v[104:107], v[236:239], a[144:147], v[104:107]
    buffer_load_dwordx4 v11, s[12:15], s78 offen lds
    v_mfma_f32_16x16x32_bf16 v[108:111], v[236:239], a[148:151], v[108:111]
    ds_read_b64_tr_b16 v[250:251], v7 offset:1024
    v_mfma_f32_16x16x32_bf16 v[108:111], v[232:235], a[132:135], v[108:111]
    v_mfma_f32_16x16x32_bf16 v[112:115], v[232:235], a[136:139], v[112:115]
    ds_read_b64_tr_b16 v[252:253], v7 offset:8192
    v_mfma_f32_16x16x32_bf16 v[112:115], v[236:239], a[152:155], v[112:115]
    v_mfma_f32_16x16x32_bf16 v[116:119], v[236:239], a[156:159], v[116:119]
    s_waitcnt lgkmcnt(3)
    ds_read_b64_tr_b16 v[254:255], v7 offset:9216
    v_mfma_f32_16x16x32_bf16 v[116:119], v[232:235], a[140:143], v[116:119]
    buffer_load_dwordx4 v12, s[12:15], s78 offen offset:1024 lds
    v_mfma_f32_16x16x32_bf16 v[120:123], v[240:243], a[128:131], v[120:123]
    ds_read_b64_tr_b16 v[232:233], v8
    v_mfma_f32_16x16x32_bf16 v[120:123], v[244:247], a[144:147], v[120:123]
    ds_read_b64_tr_b16 v[234:235], v8 offset:1024
    v_mfma_f32_16x16x32_bf16 v[124:127], v[244:247], a[148:151], v[124:127]
    ds_read_b64_tr_b16 v[236:237], v8 offset:8192
    v_mfma_f32_16x16x32_bf16 v[124:127], v[240:243], a[132:135], v[124:127]
    ds_read_b64_tr_b16 v[238:239], v8 offset:9216
    v_mfma_f32_16x16x32_bf16 v[128:131], v[240:243], a[136:139], v[128:131]
    buffer_load_dwordx4 v13, s[12:15], s78 offen offset:2048 lds
    v_mfma_f32_16x16x32_bf16 v[128:131], v[244:247], a[152:155], v[128:131]
    v_mfma_f32_16x16x32_bf16 v[132:135], v[244:247], a[156:159], v[132:135]
    s_waitcnt lgkmcnt(4)
    v_mfma_f32_16x16x32_bf16 v[132:135], v[240:243], a[140:143], v[132:135]
    buffer_load_dwordx4 v14, s[12:15], s78 offen offset:3072 lds
    v_mfma_f32_16x16x32_bf16 v[136:139], v[248:251], a[128:131], v[136:139]
    s_waitcnt vmcnt(12)
    v_mfma_f32_16x16x32_bf16 v[136:139], v[252:255], a[144:147], v[136:139]
    s_waitcnt lgkmcnt(0)
    s_barrier
    v_mfma_f32_16x16x32_bf16 v[140:143], v[252:255], a[148:151], v[140:143]
    s_add_u32 s81, s81, 128
    ds_read_b64_tr_b16 v[240:241], v1 offset:16384
    v_mfma_f32_16x16x32_bf16 v[140:143], v[248:251], a[132:135], v[140:143]
    s_and_b32 s81, s81, 1023
    ds_read_b64_tr_b16 v[242:243], v1 offset:17408
    v_mfma_f32_16x16x32_bf16 v[144:147], v[248:251], a[136:139], v[144:147]
    s_add_u32 m0, s77, 8192
    s_add_u32 s79, s72, s81
    ds_read_b64_tr_b16 v[244:245], v1 offset:24576
    v_mfma_f32_16x16x32_bf16 v[144:147], v[252:255], a[152:155], v[144:147]
    buffer_load_dwordx4 v15, s[4:7], s79 offen lds
    v_mfma_f32_16x16x32_bf16 v[148:151], v[252:255], a[156:159], v[148:151]
    s_waitcnt lgkmcnt(3)
    ds_read_b64_tr_b16 v[246:247], v1 offset:25600
    v_mfma_f32_16x16x32_bf16 v[148:151], v[248:251], a[140:143], v[148:151]
    v_mfma_f32_16x16x32_bf16 v[152:155], v[232:235], a[128:131], v[152:155]
    ds_read_b64_tr_b16 v[248:249], v2 offset:16384
    v_mfma_f32_16x16x32_bf16 v[152:155], v[236:239], a[144:147], v[152:155]
    buffer_load_dwordx4 v16, s[4:7], s79 offen offset:1024 lds
    v_mfma_f32_16x16x32_bf16 v[156:159], v[236:239], a[148:151], v[156:159]
    ds_read_b64_tr_b16 v[250:251], v2 offset:17408
    v_mfma_f32_16x16x32_bf16 v[156:159], v[232:235], a[132:135], v[156:159]
    s_waitcnt vmcnt(12)
    ds_read_b128 a[192:195], v9
    v_mfma_f32_16x16x32_bf16 v[160:163], v[232:235], a[136:139], v[160:163]
    s_add_u32 m0, s77, 10240
    ds_read_b64_tr_b16 v[252:253], v2 offset:24576
    v_mfma_f32_16x16x32_bf16 v[160:163], v[236:239], a[152:155], v[160:163]
L_hop1:
    s_cbranch_execz L_hop5
    s_add_u32 s79, s73, s81
    ds_read_b128 a[208:211], v10
    v_mfma_f32_16x16x32_bf16 v[164:167], v[236:239], a[156:159], v[164:167]
    s_waitcnt lgkmcnt(5)
    ds_read_b64_tr_b16 v[254:255], v2 offset:25600
    v_mfma_f32_16x16x32_bf16 v[164:167], v[232:235], a[140:143], v[164:167]
    buffer_load_dwordx4 v15, s[4:7], s79 offen lds
    v_mfma_f32_16x16x32_bf16 v[40:43], v[240:243], a[160:163], v[40:43]
    ds_read_b64_tr_b16 v[232:233], v3 offset:16384
    v_mfma_f32_16x16x32_bf16 v[40:43], v[244:247], a[176:179], v[40:43]
    v_mfma_f32_16x16x32_bf16 v[44:47], v[244:247], a[180:183], v[44:47]
    ds_read_b64_tr_b16 v[234:235], v3 offset:17408
    v_mfma_f32_16x16x32_bf16 v[44:47], v[240:243], a[164:167], v[44:47]
    buffer_load_dwordx4 v16, s[4:7], s79 offen offset:1024 lds
    v_mfma_f32_16x16x32_bf16 v[48:51], v[240:243], a[168:171], v[48:51]
    ds_read_b64_tr_b16 v[236:237], v3 offset:24576
    v_mfma_f32_16x16x32_bf16 v[48:51], v[244:247], a[184:187], v[48:51]
    s_waitcnt vmcnt(12)
    ds_read_b128 a[196:199], v9 offset:2048
    v_mfma_f32_16x16x32_bf16 v[52:55], v[244:247], a[188:191], v[52:55]
    s_waitcnt lgkmcnt(4)
    ds_read_b64_tr_b16 v[238:239], v3 offset:25600
    v_mfma_f32_16x16x32_bf16 v[52:55], v[240:243], a[172:175], v[52:55]
    s_add_u32 m0, s77, 12288
    ds_read_b128 a[212:215], v10 offset:2048
    v_mfma_f32_16x16x32_bf16 v[56:59], v[248:251], a[160:163], v[56:59]
    s_add_u32 s79, s74, s81
    ds_read_b64_tr_b16 v[240:241], v4 offset:16384
    v_mfma_f32_16x16x32_bf16 v[56:59], v[252:255], a[176:179], v[56:59]
    buffer_load_dwordx4 v15, s[4:7], s79 offen lds
    v_mfma_f32_16x16x32_bf16 v[60:63], v[252:255], a[180:183], v[60:63]
    ds_read_b64_tr_b16 v[242:243], v4 offset:17408
    v_mfma_f32_16x16x32_bf16 v[60:63], v[248:251], a[164:167], v[60:63]
    s_waitcnt vmcnt(11)
    ds_read_b128 a[200:203], v9 offset:4096
    v_mfma_f32_16x16x32_bf16 v[64:67], v[248:251], a[168:171], v[64:67]
    ds_read_b64_tr_b16 v[244:245], v4 offset:24576
    v_mfma_f32_16x16x32_bf16 v[64:67], v[252:255], a[184:187], v[64:67]
    ds_read_b128 a[216:219], v10 offset:4096
    v_mfma_f32_16x16x32_bf16 v[68:71], v[252:255], a[188:191], v[68:71]
    s_waitcnt lgkmcnt(6)
    ds_read_b64_tr_b16 v[246:247], v4 offset:25600
    v_mfma_f32_16x16x32_bf16 v[68:71], v[248:251], a[172:175], v[68:71]
    buffer_load_dwordx4 v16, s[4:7], s79 offen offset:1024 lds
    v_mfma_f32_16x16x32_bf16 v[72:75], v[232:235], a[160:163], v[72:75]
    s_add_u32 m0, s77, 14336
    s_add_u32 s79, s75, s81
    ds_read_b64_tr_b16 v[248:249], v5 offset:16384
    v_mfma_f32_16x16x32_bf16 v[72:75], v[236:239], a[176:179], v[72:75]
    buffer_load_dwordx4 v15, s[4:7], s79 offen lds
    v_mfma_f32_16x16x32_bf16 v[76:79], v[236:239], a[180:183], v[76:79]
    ds_read_b64_tr_b16 v[250:251], v5 offset:17408
    v_mfma_f32_16x16x32_bf16 v[76:79], v[232:235], a[164:167], v[76:79]
    v_mfma_f32_16x16x32_bf16 v[80:83], v[232:235], a[168:171], v[80:83]
    ds_read_b64_tr_b16 v[252:253], v5 offset:24576
    v_mfma_f32_16x16x32_bf16 v[80:83], v[236:239], a[184:187], v[80:83]
    buffer_load_dwordx4 v16, s[4:7], s79 offen offset:1024 lds
    v_mfma_f32_16x16x32_bf16 v[84:87], v[236:239], a[188:191], v[84:87]
    s_waitcnt lgkmcnt(3)
    ds_read_b64_tr_b16 v[254:255], v5 offset:25600
    v_mfma_f32_16x16x32_bf16 v[84:87], v[232:235], a[172:175], v[84:87]
    s_waitcnt vmcnt(12)
    ds_read_b128 a[204:207], v9 offset:6144
    v_mfma_f32_16x16x32_bf16 v[88:91], v[240:243], a[160:163], v[88:91]
    s_add_u32 s78, s78, 524288
    ds_read_b64_tr_b16 v[232:233], v6 offset:16384
    v_mfma_f32_16x16x32_bf16 v[88:91], v[244:247], a[176:179], v[88:91]
    s_and_b32 s78, s78, 4194303
    ds_read_b128 a[220:223], v10 offset:6144
    v_mfma_f32_16x16x32_bf16 v[92:95], v[244:247], a[180:183], v[92:95]
    s_add_u32 m0, s76, 49152
    ds_read_b64_tr_b16 v[234:235], v6 offset:17408
    v_mfma_f32_16x16x32_bf16 v[92:95], v[240:243], a[164:167], v[92:95]
    buffer_load_dwordx4 v11, s[12:15], s78 offen lds
    v_mfma_f32_16x16x32_bf16 v[96:99], v[240:243], a[168:171], v[96:99]
    ds_read_b64_tr_b16 v[236:237], v6 offset:24576
    v_mfma_f32_16x16x32_bf16 v[96:99], v[244:247], a[184:187], v[96:99]
    buffer_load_dwordx4 v12, s[12:15], s78 offen offset:1024 lds
    v_mfma_f32_16x16x32_bf16 v[100:103], v[244:247], a[188:191], v[100:103]
    s_waitcnt lgkmcnt(5)
    ds_read_b64_tr_b16 v[238:239], v6 offset:25600
    v_mfma_f32_16x16x32_bf16 v[100:103], v[240:243], a[172:175], v[100:103]
    v_mfma_f32_16x16x32_bf16 v[104:107], v[248:251], a[160:163], v[104:107]
    ds_read_b64_tr_b16 v[240:241], v7 offset:16384
    v_mfma_f32_16x16x32_bf16 v[104:107], v[252:255], a[176:179], v[104:107]
    v_mfma_f32_16x16x32_bf16 v[108:111], v[252:255], a[180:183], v[108:111]
    ds_read_b64_tr_b16 v[242:243], v7 offset:17408
    v_mfma_f32_16x16x32_bf16 v[108:111], v[248:251], a[164:167], v[108:111]
    buffer_load_dwordx4 v13, s[12:15], s78 offen offset:2048 lds
    v_mfma_f32_16x16x32_bf16 v[112:115], v[248:251], a[168:171], v[112:115]
    ds_read_b64_tr_b16 v[244:245], v7 offset:24576
    v_mfma_f32_16x16x32_bf16 v[112:115], v[252:255], a[184:187], v[112:115]
    v_mfma_f32_16x16x32_bf16 v[116:119], v[252:255], a[188:191], v[116:119]
    s_waitcnt lgkmcnt(3)
    ds_read_b64_tr_b16 v[246:247], v7 offset:25600
    v_mfma_f32_16x16x32_bf16 v[116:119], v[248:251], a[172:175], v[116:119]
    buffer_load_dwordx4 v14, s[12:15], s78 offen offset:3072 lds
    v_mfma_f32_16x16x32_bf16 v[120:123], v[232:235], a[160:163], v[120:123]
    ds_read_b64_tr_b16 v[248:249], v8 offset:16384
    v_mfma_f32_16x16x32_bf16 v[120:123], v[236:239], a[176:179], v[120:123]
    ds_read_b64_tr_b16 v[250:251], v8 offset:17408
    v_mfma_f32_16x16x32_bf16 v[124:127], v[236:239], a[180:183], v[124:127]
    ds_read_b64_tr_b16 v[252:253], v8 offset:24576
    v_mfma_f32_16x16x32_bf16 v[124:127], v[232:235], a[164:167], v[124:127]
    s_getpc_b64 s[100:101]
    ds_read_b64_tr_b16 v[254:255], v8 offset:25600
    v_mfma_f32_16x16x32_bf16 v[128:131], v[232:235], a[168:171], v[128:131]
    global_load_dword v37, v32, s[100:101]
    v_mfma_f32_16x16x32_bf16 v[128:131], v[236:239], a[184:187], v[128:131]
    s_add_u32 s78, s78, 524288
    s_and_b32 s78, s78, 4194303
    v_mfma_f32_16x16x32_bf16 v[132:135], v[236:239], a[188:191], v[132:135]
    s_waitcnt lgkmcnt(4)
    s_add_u32 m0, s76, 0
    v_mfma_f32_16x16x32_bf16 v[132:135], v[232:235], a[172:175], v[132:135]
    buffer_load_dwordx4 v11, s[16:19], s78 offen nt lds
    v_mfma_f32_16x16x32_bf16 v[136:139], v[240:243], a[160:163], v[136:139]
    s_waitcnt vmcnt(14)
    v_mfma_f32_16x16x32_bf16 v[136:139], v[244:247], a[176:179], v[136:139]
    s_waitcnt lgkmcnt(0)
    s_barrier
    v_mfma_f32_16x16x32_bf16 v[140:143], v[244:247], a[180:183], v[140:143]
    ds_read_b64_tr_b16 v[232:233], v1 offset:32768
    v_mfma_f32_16x16x32_bf16 v[140:143], v[240:243], a[164:167], v[140:143]
    ds_read_b64_tr_b16 v[234:235], v1 offset:33792
    v_mfma_f32_16x16x32_bf16 v[144:147], v[240:243], a[168:171], v[144:147]
    ds_read_b64_tr_b16 v[236:237], v1 offset:40960
    v_mfma_f32_16x16x32_bf16 v[144:147], v[244:247], a[184:187], v[144:147]
    s_waitcnt vmcnt(12)
    ds_read_b128 a[224:227], v9 offset:8192
    v_mfma_f32_16x16x32_bf16 v[148:151], v[244:247], a[188:191], v[148:151]
    s_waitcnt lgkmcnt(4)
    ds_read_b64_tr_b16 v[238:239], v1 offset:41984
    v_mfma_f32_16x16x32_bf16 v[148:151], v[240:243], a[172:175], v[148:151]
    ds_read_b128 a[240:243], v10 offset:8192
    v_mfma_f32_16x16x32_bf16 v[152:155], v[248:251], a[160:163], v[152:155]
    ds_read_b64_tr_b16 v[240:241], v2 offset:32768
    v_mfma_f32_16x16x32_bf16 v[152:155], v[252:255], a[176:179], v[152:155]
    buffer_load_dwordx4 v12, s[16:19], s78 offen offset:1024 nt lds
    v_mfma_f32_16x16x32_bf16 v[156:159], v[252:255], a[180:183], v[156:159]
    ds_read_b64_tr_b16 v[242:243], v2 offset:33792
    v_mfma_f32_16x16x32_bf16 v[156:159], v[248:251], a[164:167], v[156:159]
    s_waitcnt vmcnt(11)
    ds_read_b128 a[228:231], v9 offset:10240
    v_mfma_f32_16x16x32_bf16 v[160:163], v[248:251], a[168:171], v[160:163]
    ds_read_b64_tr_b16 v[244:245], v2 offset:40960
    v_mfma_f32_16x16x32_bf16 v[160:163], v[252:255], a[184:187], v[160:163]
    ds_read_b128 a[244:247], v10 offset:10240
    v_mfma_f32_16x16x32_bf16 v[164:167], v[252:255], a[188:191], v[164:167]
    s_waitcnt lgkmcnt(6)
    ds_read_b64_tr_b16 v[246:247], v2 offset:41984
    v_mfma_f32_16x16x32_bf16 v[164:167], v[248:251], a[172:175], v[164:167]
    buffer_load_dwordx4 v13, s[16:19], s78 offen offset:2048 nt lds
    v_mfma_f32_16x16x32_bf16 v[40:43], v[232:235], a[192:195], v[40:43]
    ds_read_b64_tr_b16 v[248:249], v3 offset:32768
    v_mfma_f32_16x16x32_bf16 v[40:43], v[236:239], a[208:211], v[40:43]
    buffer_load_dwordx4 v14, s[16:19], s78 offen offset:3072 nt lds
    v_mfma_f32_16x16x32_bf16 v[44:47], v[236:239], a[212:215], v[44:47]
    ds_read_b64_tr_b16 v[250:251], v3 offset:33792
    v_mfma_f32_16x16x32_bf16 v[44:47], v[232:235], a[196:199], v[44:47]
    buffer_load_dword v37, v28, s[8:11], s92 offen
    v_mfma_f32_16x16x32_bf16 v[48:51], v[232:235], a[200:203], v[48:51]
    s_and_b32 s96, s96, 7
    s_lshl_b32 s97, s96, 7
    ds_read_b64_tr_b16 v[252:253], v3 offset:40960
    v_mfma_f32_16x16x32_bf16 v[48:51], v[236:239], a[216:219], v[48:51]
    buffer_load_ushort v18, v34, s[36:39], s97 offen
    v_mfma_f32_16x16x32_bf16 v[52:55], v[236:239], a[220:223], v[52:55]
    s_waitcnt lgkmcnt(3)
    ds_read_b64_tr_b16 v[254:255], v3 offset:41984
    v_mfma_f32_16x16x32_bf16 v[52:55], v[232:235], a[204:207], v[52:55]
    s_waitcnt vmcnt(13)
    ds_read_b128 a[232:235], v9 offset:12288
    v_mfma_f32_16x16x32_bf16 v[56:59], v[240:243], a[192:195], v[56:59]
    s_add_u32 s96, s96, 2
    ds_read_b64_tr_b16 v[232:233], v4 offset:32768
    v_mfma_f32_16x16x32_bf16 v[56:59], v[244:247], a[208:211], v[56:59]
    s_and_b32 s96, s96, 7
    ds_read_b128 a[248:251], v10 offset:12288
    v_mfma_f32_16x16x32_bf16 v[60:63], v[244:247], a[212:215], v[60:63]
    s_lshl_b32 s97, s96, 7
    ds_read_b64_tr_b16 v[234:235], v4 offset:33792
    v_mfma_f32_16x16x32_bf16 v[60:63], v[240:243], a[196:199], v[60:63]
    buffer_load_ushort v19, v34, s[36:39], s97 offen
    v_mfma_f32_16x16x32_bf16 v[64:67], v[240:243], a[200:203], v[64:67]
    s_add_u32 s96, s96, 2
    ds_read_b64_tr_b16 v[236:237], v4 offset:40960
    v_mfma_f32_16x16x32_bf16 v[64:67], v[244:247], a[216:219], v[64:67]
    s_waitcnt vmcnt(12)
    ds_read_b128 a[236:239], v9 offset:14336
    v_mfma_f32_16x16x32_bf16 v[68:71], v[244:247], a[220:223], v[68:71]
    s_waitcnt lgkmcnt(6)
    ds_read_b64_tr_b16 v[238:239], v4 offset:41984
    v_mfma_f32_16x16x32_bf16 v[68:71], v[240:243], a[204:207], v[68:71]
    s_and_b32 s96, s96, 7
    ds_read_b128 a[252:255], v10 offset:14336
    v_mfma_f32_16x16x32_bf16 v[72:75], v[248:251], a[192:195], v[72:75]
    s_lshl_b32 s97, s96, 7
    ds_read_b64_tr_b16 v[240:241], v5 offset:32768
    v_mfma_f32_16x16x32_bf16 v[72:75], v[252:255], a[208:211], v[72:75]
    buffer_load_ushort v20, v34, s[36:39], s97 offen
    v_mfma_f32_16x16x32_bf16 v[76:79], v[252:255], a[212:215], v[76:79]
    s_add_u32 s96, s96, 2
    s_and_b32 s96, s96, 7
    s_lshl_b32 s97, s96, 7
    ds_read_b64_tr_b16 v[242:243], v5 offset:33792
    v_mfma_f32_16x16x32_bf16 v[76:79], v[248:251], a[196:199], v[76:79]
    buffer_load_ushort v21, v34, s[36:39], s97 offen
    v_mfma_f32_16x16x32_bf16 v[80:83], v[248:251], a[200:203], v[80:83]
    s_lshl_b32 s72, s83, 14
    ds_read_b64_tr_b16 v[244:245], v5 offset:40960
    v_mfma_f32_16x16x32_bf16 v[80:83], v[252:255], a[216:219], v[80:83]
    s_lshl_b32 s73, s84, 14
    v_mfma_f32_16x16x32_bf16 v[84:87], v[252:255], a[220:223], v[84:87]
    s_waitcnt lgkmcnt(4)
    ds_read_b64_tr_b16 v[246:247], v5 offset:41984
    v_mfma_f32_16x16x32_bf16 v[84:87], v[248:251], a[204:207], v[84:87]
    s_lshl_b32 s74, s85, 14
    v_mfma_f32_16x16x32_bf16 v[88:91], v[232:235], a[192:195], v[88:91]
    s_lshl_b32 s75, s86, 14
    ds_read_b64_tr_b16 v[248:249], v6 offset:32768
    v_mfma_f32_16x16x32_bf16 v[88:91], v[236:239], a[208:211], v[88:91]
    s_mov_b32 s38, s30
    v_mfma_f32_16x16x32_bf16 v[92:95], v[236:239], a[212:215], v[92:95]
    s_and_b32 s7, s64, 0
    ds_read_b64_tr_b16 v[250:251], v6 offset:33792
    v_mfma_f32_16x16x32_bf16 v[92:95], v[232:235], a[196:199], v[92:95]
    s_lshl_b32 s7, s7, 21
    v_mfma_f32_16x16x32_bf16 v[96:99], v[232:235], a[200:203], v[96:99]
    s_sub_u32 s36, s28, s7
    s_subb_u32 s37, s29, 0
    ds_read_b64_tr_b16 v[252:253], v6 offset:40960
    v_mfma_f32_16x16x32_bf16 v[96:99], v[236:239], a[216:219], v[96:99]
    s_add_u32 s36, s36, 0
    s_addc_u32 s37, s37, 0
    v_mfma_f32_16x16x32_bf16 v[100:103], v[236:239], a[220:223], v[100:103]
    s_waitcnt lgkmcnt(3)
    ds_read_b64_tr_b16 v[254:255], v6 offset:41984
    v_mfma_f32_16x16x32_bf16 v[100:103], v[232:235], a[204:207], v[100:103]
    s_lshl_b32 s69, s67, 7
    v_mfma_f32_16x16x32_bf16 v[104:107], v[240:243], a[192:195], v[104:107]
    s_add_u32 s83, s83, s69
    ds_read_b64_tr_b16 v[232:233], v7 offset:32768
    v_mfma_f32_16x16x32_bf16 v[104:107], v[244:247], a[208:211], v[104:107]
    s_mul_i32 s83, s83, 47104
    v_mfma_f32_16x16x32_bf16 v[108:111], v[244:247], a[212:215], v[108:111]
    s_add_u32 s84, s84, s69
    ds_read_b64_tr_b16 v[234:235], v7 offset:33792
    v_mfma_f32_16x16x32_bf16 v[108:111], v[240:243], a[196:199], v[108:111]
    s_add_u32 s78, s78, 524288
    v_mfma_f32_16x16x32_bf16 v[112:115], v[240:243], a[200:203], v[112:115]
    s_and_b32 s78, s78, 4194303
    ds_read_b64_tr_b16 v[236:237], v7 offset:40960
    v_mfma_f32_16x16x32_bf16 v[112:115], v[244:247], a[216:219], v[112:115]
    s_add_u32 m0, s76, 16384
    v_mfma_f32_16x16x32_bf16 v[116:119], v[244:247], a[220:223], v[116:119]
    s_waitcnt lgkmcnt(3)
    ds_read_b64_tr_b16 v[238:239], v7 offset:41984
    v_mfma_f32_16x16x32_bf16 v[116:119], v[240:243], a[204:207], v[116:119]
    buffer_load_dwordx4 v11, s[16:19], s78 offen lds
    v_mfma_f32_16x16x32_bf16 v[120:123], v[248:251], a[192:195], v[120:123]
    s_mul_i32 s84, s84, 47104
    ds_read_b64_tr_b16 v[240:241], v8 offset:32768
    v_mfma_f32_16x16x32_bf16 v[120:123], v[252:255], a[208:211], v[120:123]
    s_add_u32 s85, s85, s69
    ds_read_b64_tr_b16 v[242:243], v8 offset:33792
    v_mfma_f32_16x16x32_bf16 v[124:127], v[252:255], a[212:215], v[124:127]
    s_mul_i32 s85, s85, 47104
    ds_read_b64_tr_b16 v[244:245], v8 offset:40960
    v_mfma_f32_16x16x32_bf16 v[124:127], v[248:251], a[196:199], v[124:127]
    s_add_u32 s86, s86, s69
    ds_read_b64_tr_b16 v[246:247], v8 offset:41984
    v_mfma_f32_16x16x32_bf16 v[128:131], v[248:251], a[200:203], v[128:131]
    buffer_load_dwordx4 v12, s[16:19], s78 offen offset:1024 lds
    v_mfma_f32_16x16x32_bf16 v[128:131], v[252:255], a[216:219], v[128:131]
    s_mul_i32 s86, s86, 47104
    v_mfma_f32_16x16x32_bf16 v[132:135], v[252:255], a[220:223], v[132:135]
    s_waitcnt lgkmcnt(4)
    v_mfma_f32_16x16x32_bf16 v[132:135], v[248:251], a[204:207], v[132:135]
    buffer_load_dwordx4 v13, s[16:19], s78 offen offset:2048 lds
    v_mfma_f32_16x16x32_bf16 v[136:139], v[232:235], a[192:195], v[136:139]
    s_waitcnt vmcnt(13)
    v_mfma_f32_16x16x32_bf16 v[136:139], v[236:239], a[208:211], v[136:139]
    s_waitcnt lgkmcnt(0)
    s_barrier
    v_mfma_f32_16x16x32_bf16 v[140:143], v[236:239], a[212:215], v[140:143]
    ds_read_b64_tr_b16 v[248:249], v1 offset:49152
    v_mfma_f32_16x16x32_bf16 v[140:143], v[232:235], a[196:199], v[140:143]
    ds_read_b64_tr_b16 v[250:251], v1 offset:50176
    v_mfma_f32_16x16x32_bf16 v[144:147], v[232:235], a[200:203], v[144:147]
    ds_read_b64_tr_b16 v[252:253], v1 offset:57344
    v_mfma_f32_16x16x32_bf16 v[144:147], v[236:239], a[216:219], v[144:147]
    buffer_load_dwordx4 v14, s[16:19], s78 offen offset:3072 lds
    v_mfma_f32_16x16x32_bf16 v[148:151], v[236:239], a[220:223], v[148:151]
    s_waitcnt lgkmcnt(3)
    ds_read_b64_tr_b16 v[254:255], v1 offset:58368
    v_mfma_f32_16x16x32_bf16 v[148:151], v[232:235], a[204:207], v[148:151]
    s_add_u32 s78, s78, 524288
    v_mfma_f32_16x16x32_bf16 v[152:155], v[240:243], a[192:195], v[152:155]
    s_and_b32 s78, s78, 4194303
    s_add_u32 m0, s76, 32768
    ds_read_b64_tr_b16 v[232:233], v2 offset:49152
    v_mfma_f32_16x16x32_bf16 v[152:155], v[244:247], a[208:211], v[152:155]
    buffer_load_dwordx4 v11, s[16:19], s78 offen lds
    v_mfma_f32_16x16x32_bf16 v[156:159], v[244:247], a[212:215], v[156:159]
    ds_read_b64_tr_b16 v[234:235], v2 offset:50176
    v_mfma_f32_16x16x32_bf16 v[156:159], v[240:243], a[196:199], v[156:159]
    v_mfma_f32_16x16x32_bf16 v[160:163], v[240:243], a[200:203], v[160:163]
    ds_read_b64_tr_b16 v[236:237], v2 offset:57344
    v_mfma_f32_16x16x32_bf16 v[160:163], v[244:247], a[216:219], v[160:163]
    v_mfma_f32_16x16x32_bf16 v[164:167], v[244:247], a[220:223], v[164:167]
    s_waitcnt lgkmcnt(3)
    ds_read_b64_tr_b16 v[238:239], v2 offset:58368
    v_mfma_f32_16x16x32_bf16 v[164:167], v[240:243], a[204:207], v[164:167]
    buffer_load_dwordx4 v12, s[16:19], s78 offen offset:1024 lds
    v_mfma_f32_16x16x32_bf16 v[40:43], v[248:251], a[224:227], v[40:43]
    ds_read_b64_tr_b16 v[240:241], v3 offset:49152
    v_mfma_f32_16x16x32_bf16 v[40:43], v[252:255], a[240:243], v[40:43]
    v_mfma_f32_16x16x32_bf16 v[44:47], v[252:255], a[244:247], v[44:47]
    ds_read_b64_tr_b16 v[242:243], v3 offset:50176
    v_mfma_f32_16x16x32_bf16 v[44:47], v[248:251], a[228:231], v[44:47]
    buffer_load_dwordx4 v13, s[16:19], s78 offen offset:2048 lds
    v_mfma_f32_16x16x32_bf16 v[48:51], v[248:251], a[232:235], v[48:51]
    ds_read_b64_tr_b16 v[244:245], v3 offset:57344
    v_mfma_f32_16x16x32_bf16 v[48:51], v[252:255], a[248:251], v[48:51]
    v_mfma_f32_16x16x32_bf16 v[52:55], v[252:255], a[252:255], v[52:55]
    s_waitcnt lgkmcnt(3)
    ds_read_b64_tr_b16 v[246:247], v3 offset:58368
    v_mul_f32 v40, s93, v40
    v_mfma_f32_16x16x32_bf16 v[52:55], v[248:251], a[236:239], v[52:55]
    buffer_load_dwordx4 v14, s[16:19], s78 offen offset:3072 lds
    v_mfma_f32_16x16x32_bf16 v[56:59], v[232:235], a[224:227], v[56:59]
    ds_read_b64_tr_b16 v[248:249], v4 offset:49152
    v_mul_f32 v41, s93, v41
    v_mfma_f32_16x16x32_bf16 v[56:59], v[236:239], a[240:243], v[56:59]
    v_mul_f32 v42, s93, v42
    v_mul_f32 v43, s93, v43
    v_mfma_f32_16x16x32_bf16 v[60:63], v[236:239], a[244:247], v[60:63]
    ds_read_b64_tr_b16 v[250:251], v4 offset:50176
    v_cvt_pk_bf16_f32 v168, v40, v41
    v_mfma_f32_16x16x32_bf16 v[60:63], v[232:235], a[228:231], v[60:63]
    v_cvt_pk_bf16_f32 v169, v42, v43
    v_mul_f32 v44, s93, v44
    v_mul_f32 v45, s93, v45
    v_mfma_f32_16x16x32_bf16 v[64:67], v[232:235], a[232:235], v[64:67]
    s_lshl_b32 s97, s87, 19
    ds_read_b64_tr_b16 v[252:253], v4 offset:57344
    v_mul_f32 v46, s93, v46
    v_mul_f32 v47, s93, v47
    v_mfma_f32_16x16x32_bf16 v[64:67], v[236:239], a[248:251], v[64:67]
    buffer_load_dword v37, v30, s[24:27], s97 offen
    v_cvt_pk_bf16_f32 v184, v44, v45
    v_mfma_f32_16x16x32_bf16 v[68:71], v[236:239], a[252:255], v[68:71]
    s_waitcnt lgkmcnt(3)
    s_mul_i32 s97, s87, 229376
    ds_read_b64_tr_b16 v[254:255], v4 offset:58368
    v_cvt_pk_bf16_f32 v185, v46, v47
    v_mfma_f32_16x16x32_bf16 v[68:71], v[232:235], a[236:239], v[68:71]
    buffer_load_dword v37, v29, s[20:23], s97 offen
    v_mul_f32 v48, s93, v48
    v_mfma_f32_16x16x32_bf16 v[72:75], v[240:243], a[224:227], v[72:75]
    ds_read_b64_tr_b16 v[232:233], v5 offset:49152
    v_mul_f32 v49, s93, v49
    v_mul_f32 v50, s93, v50
    v_mfma_f32_16x16x32_bf16 v[72:75], v[244:247], a[240:243], v[72:75]
    v_mul_f32 v51, s93, v51
    v_cvt_pk_bf16_f32 v200, v48, v49
    v_cvt_pk_bf16_f32 v201, v50, v51
    v_mfma_f32_16x16x32_bf16 v[76:79], v[244:247], a[244:247], v[76:79]
    ds_read_b64_tr_b16 v[234:235], v5 offset:50176
    v_mul_f32 v52, s93, v52
    v_mul_f32 v53, s93, v53
    v_mfma_f32_16x16x32_bf16 v[76:79], v[240:243], a[228:231], v[76:79]
    v_mul_f32 v54, s93, v54
    v_mul_f32 v55, s93, v55
    v_cvt_pk_bf16_f32 v216, v52, v53
    v_mfma_f32_16x16x32_bf16 v[80:83], v[240:243], a[232:235], v[80:83]
    ds_read_b64_tr_b16 v[236:237], v5 offset:57344
    v_cvt_pk_bf16_f32 v217, v54, v55
    v_mul_f32 v56, s93, v56
    v_mfma_f32_16x16x32_bf16 v[80:83], v[244:247], a[248:251], v[80:83]
    v_mul_f32 v57, s93, v57
    v_mul_f32 v58, s93, v58
    v_mul_f32 v59, s93, v59
    v_mfma_f32_16x16x32_bf16 v[84:87], v[244:247], a[252:255], v[84:87]
    s_waitcnt lgkmcnt(3)
    ds_read_b64_tr_b16 v[238:239], v5 offset:58368
    v_cvt_pk_bf16_f32 v170, v56, v57
    v_cvt_pk_bf16_f32 v171, v58, v59
    v_mfma_f32_16x16x32_bf16 v[84:87], v[240:243], a[236:239], v[84:87]
    v_mul_f32 v60, s93, v60
    v_mul_f32 v61, s93, v61
    v_mul_f32 v62, s93, v62
    v_mfma_f32_16x16x32_bf16 v[88:91], v[248:251], a[224:227], v[88:91]
    ds_read_b64_tr_b16 v[240:241], v6 offset:49152
    v_mul_f32 v63, s93, v63
    v_cvt_pk_bf16_f32 v186, v60, v61
    v_mfma_f32_16x16x32_bf16 v[88:91], v[252:255], a[240:243], v[88:91]
    v_cvt_pk_bf16_f32 v187, v62, v63
    v_mul_f32 v64, s93, v64
    v_mfma_f32_16x16x32_bf16 v[92:95], v[252:255], a[244:247], v[92:95]
    ds_read_b64_tr_b16 v[242:243], v6 offset:50176
    v_mul_f32 v65, s93, v65
    v_mfma_f32_16x16x32_bf16 v[92:95], v[248:251], a[228:231], v[92:95]
    v_mul_f32 v66, s93, v66
    v_mul_f32 v67, s93, v67
    v_mfma_f32_16x16x32_bf16 v[96:99], v[248:251], a[232:235], v[96:99]
    ds_read_b64_tr_b16 v[244:245], v6 offset:57344
    v_cvt_pk_bf16_f32 v202, v64, v65
    v_mfma_f32_16x16x32_bf16 v[96:99], v[252:255], a[248:251], v[96:99]
    v_cvt_pk_bf16_f32 v203, v66, v67
    v_mul_f32 v68, s93, v68
    v_mul_f32 v69, s93, v69
    v_mfma_f32_16x16x32_bf16 v[100:103], v[252:255], a[252:255], v[100:103]
    s_waitcnt lgkmcnt(3)
    ds_read_b64_tr_b16 v[246:247], v6 offset:58368
    v_mul_f32 v70, s93, v70
    v_mul_f32 v71, s93, v71
    v_mfma_f32_16x16x32_bf16 v[100:103], v[248:251], a[236:239], v[100:103]
    v_cvt_pk_bf16_f32 v218, v68, v69
    v_cvt_pk_bf16_f32 v219, v70, v71
    v_mfma_f32_16x16x32_bf16 v[104:107], v[232:235], a[224:227], v[104:107]
    ds_read_b64_tr_b16 v[248:249], v7 offset:49152
    v_mul_f32 v72, s93, v72
    v_mfma_f32_16x16x32_bf16 v[104:107], v[236:239], a[240:243], v[104:107]
    v_mul_f32 v73, s93, v73
    v_mul_f32 v74, s93, v74
    v_mfma_f32_16x16x32_bf16 v[108:111], v[236:239], a[244:247], v[108:111]
    ds_read_b64_tr_b16 v[250:251], v7 offset:50176
    v_mul_f32 v75, s93, v75
    v_mfma_f32_16x16x32_bf16 v[108:111], v[232:235], a[228:231], v[108:111]
    v_cvt_pk_bf16_f32 v172, v72, v73
    v_cvt_pk_bf16_f32 v173, v74, v75
    v_mfma_f32_16x16x32_bf16 v[112:115], v[232:235], a[232:235], v[112:115]
    ds_read_b64_tr_b16 v[252:253], v7 offset:57344
    v_mul_f32 v76, s93, v76
    v_mfma_f32_16x16x32_bf16 v[112:115], v[236:239], a[248:251], v[112:115]
    v_mul_f32 v77, s93, v77
    v_mul_f32 v78, s93, v78
    v_mfma_f32_16x16x32_bf16 v[116:119], v[236:239], a[252:255], v[116:119]
    s_waitcnt lgkmcnt(3)
    ds_read_b64_tr_b16 v[254:255], v7 offset:58368
    v_mul_f32 v79, s93, v79
    v_mfma_f32_16x16x32_bf16 v[116:119], v[232:235], a[236:239], v[116:119]
    v_cvt_pk_bf16_f32 v188, v76, v77
    v_cvt_pk_bf16_f32 v189, v78, v79
    v_mfma_f32_16x16x32_bf16 v[120:123], v[240:243], a[224:227], v[120:123]
    ds_read_b64_tr_b16 v[232:233], v8 offset:49152
    v_mul_f32 v80, s93, v80
    v_mfma_f32_16x16x32_bf16 v[120:123], v[244:247], a[240:243], v[120:123]
    ds_read_b64_tr_b16 v[234:235], v8 offset:50176
    v_mul_f32 v81, s93, v81
    v_mfma_f32_16x16x32_bf16 v[124:127], v[244:247], a[244:247], v[124:127]
    ds_read_b64_tr_b16 v[236:237], v8 offset:57344
    v_mul_f32 v82, s93, v82
    v_mfma_f32_16x16x32_bf16 v[124:127], v[240:243], a[228:231], v[124:127]
    ds_read_b64_tr_b16 v[238:239], v8 offset:58368
    v_mul_f32 v83, s93, v83
    v_mfma_f32_16x16x32_bf16 v[128:131], v[240:243], a[232:235], v[128:131]
    v_cvt_pk_bf16_f32 v204, v80, v81
    v_cvt_pk_bf16_f32 v205, v82, v83
    v_mul_f32 v84, s93, v84
    v_mfma_f32_16x16x32_bf16 v[128:131], v[244:247], a[248:251], v[128:131]
    v_mul_f32 v85, s93, v85
    v_mul_f32 v86, s93, v86
    v_mul_f32 v87, s93, v87
    v_mfma_f32_16x16x32_bf16 v[132:135], v[244:247], a[252:255], v[132:135]
    s_waitcnt lgkmcnt(4)
    v_cvt_pk_bf16_f32 v220, v84, v85
    v_cvt_pk_bf16_f32 v221, v86, v87
    v_mfma_f32_16x16x32_bf16 v[132:135], v[240:243], a[236:239], v[132:135]
    v_mul_f32 v88, s93, v88
    v_mul_f32 v89, s93, v89
    v_mfma_f32_16x16x32_bf16 v[136:139], v[248:251], a[224:227], v[136:139]
    s_waitcnt vmcnt(6)
    v_mul_f32 v90, s93, v90
    v_mul_f32 v91, s93, v91
    v_mfma_f32_16x16x32_bf16 v[136:139], v[252:255], a[240:243], v[136:139]
    s_waitcnt lgkmcnt(0)
    s_barrier
    v_cvt_pk_bf16_f32 v174, v88, v89
    v_mfma_f32_16x16x32_bf16 v[140:143], v[252:255], a[244:247], v[140:143]
    ds_read_b64_tr_b16 v[240:241], v1
    v_cvt_pk_bf16_f32 v175, v90, v91
    v_mfma_f32_16x16x32_bf16 v[140:143], v[248:251], a[228:231], v[140:143]
    ds_read_b64_tr_b16 v[242:243], v1 offset:1024
    v_mul_f32 v92, s93, v92
    v_mfma_f32_16x16x32_bf16 v[144:147], v[248:251], a[232:235], v[144:147]
    ds_read_b64_tr_b16 v[244:245], v1 offset:8192
    v_mul_f32 v93, s93, v93
    v_mfma_f32_16x16x32_bf16 v[144:147], v[252:255], a[248:251], v[144:147]
    v_mul_f32 v94, s93, v94
    v_mul_f32 v95, s93, v95
    v_mfma_f32_16x16x32_bf16 v[148:151], v[252:255], a[252:255], v[148:151]
    s_waitcnt lgkmcnt(3)
    ds_read_b64_tr_b16 v[246:247], v1 offset:9216
    v_cvt_pk_bf16_f32 v190, v92, v93
    v_mfma_f32_16x16x32_bf16 v[148:151], v[248:251], a[236:239], v[148:151]
    v_cvt_pk_bf16_f32 v191, v94, v95
    v_mul_f32 v96, s93, v96
    v_mul_f32 v97, s93, v97
    v_mfma_f32_16x16x32_bf16 v[152:155], v[232:235], a[224:227], v[152:155]
    ds_read_b64_tr_b16 v[248:249], v2
    v_mul_f32 v98, s93, v98
    v_mul_f32 v99, s93, v99
    v_mfma_f32_16x16x32_bf16 v[152:155], v[236:239], a[240:243], v[152:155]
    v_cvt_pk_bf16_f32 v206, v96, v97
    v_cvt_pk_bf16_f32 v207, v98, v99
    v_mfma_f32_16x16x32_bf16 v[156:159], v[236:239], a[244:247], v[156:159]
    ds_read_b64_tr_b16 v[250:251], v2 offset:1024
    v_mul_f32 v100, s93, v100
    v_mfma_f32_16x16x32_bf16 v[156:159], v[232:235], a[228:231], v[156:159]
    v_mul_f32 v101, s93, v101
    v_mul_f32 v102, s93, v102
    v_mfma_f32_16x16x32_bf16 v[160:163], v[232:235], a[232:235], v[160:163]
    ds_read_b64_tr_b16 v[252:253], v2 offset:8192
    v_mul_f32 v103, s93, v103
    v_mfma_f32_16x16x32_bf16 v[160:163], v[236:239], a[248:251], v[160:163]
    v_cvt_pk_bf16_f32 v222, v100, v101
    v_cvt_pk_bf16_f32 v223, v102, v103
    v_mul_f32 v104, s93, v104
    v_mfma_f32_16x16x32_bf16 v[164:167], v[236:239], a[252:255], v[164:167]
    s_waitcnt lgkmcnt(3)
    ds_read_b64_tr_b16 v[254:255], v2 offset:9216
    v_mul_f32 v105, s93, v105
    v_mul_f32 v106, s93, v106
    v_mfma_f32_16x16x32_bf16 v[164:167], v[232:235], a[236:239], v[164:167]
    v_mul_f32 v107, s93, v107
    v_cvt_pk_bf16_f32 v176, v104, v105
    v_cvt_pk_bf16_f32 v177, v106, v107
    v_mfma_f32_16x16x32_bf16 v[40:43], a[0:3], v[240:243], 0
    ds_read_b64_tr_b16 v[232:233], v3
    v_mul_f32 v108, s93, v108
    v_mfma_f32_16x16x32_bf16 v[40:43], a[16:19], v[244:247], v[40:43]
    v_mul_f32 v109, s93, v109
    v_mul_f32 v110, s93, v110
    v_mfma_f32_16x16x32_bf16 v[44:47], a[20:23], v[244:247], 0
    ds_read_b64_tr_b16 v[234:235], v3 offset:1024
    v_mul_f32 v111, s93, v111
    v_mfma_f32_16x16x32_bf16 v[44:47], a[4:7], v[240:243], v[44:47]
    v_cvt_pk_bf16_f32 v192, v108, v109
    v_cvt_pk_bf16_f32 v193, v110, v111
    v_mfma_f32_16x16x32_bf16 v[48:51], a[8:11], v[240:243], 0
    ds_read_b64_tr_b16 v[236:237], v3 offset:8192
    v_mul_f32 v112, s93, v112
    v_mfma_f32_16x16x32_bf16 v[48:51], a[24:27], v[244:247], v[48:51]
    v_mul_f32 v113, s93, v113
    v_mul_f32 v114, s93, v114
    v_mfma_f32_16x16x32_bf16 v[52:55], a[28:31], v[244:247], 0
    s_waitcnt lgkmcnt(3)
    ds_read_b64_tr_b16 v[238:239], v3 offset:9216
    v_mul_f32 v115, s93, v115
    v_mfma_f32_16x16x32_bf16 v[52:55], a[12:15], v[240:243], v[52:55]
    v_cvt_pk_bf16_f32 v208, v112, v113
    v_cvt_pk_bf16_f32 v209, v114, v115
    v_mfma_f32_16x16x32_bf16 v[56:59], a[0:3], v[248:251], 0
    ds_read_b64_tr_b16 v[240:241], v4
    v_mul_f32 v116, s93, v116
    v_mfma_f32_16x16x32_bf16 v[56:59], a[16:19], v[252:255], v[56:59]
    v_mul_f32 v117, s93, v117
    v_mul_f32 v118, s93, v118
    v_mfma_f32_16x16x32_bf16 v[60:63], a[20:23], v[252:255], 0
    ds_read_b64_tr_b16 v[242:243], v4 offset:1024
    v_mul_f32 v119, s93, v119
    v_mfma_f32_16x16x32_bf16 v[60:63], a[4:7], v[248:251], v[60:63]
    v_cvt_pk_bf16_f32 v224, v116, v117
    v_cvt_pk_bf16_f32 v225, v118, v119
    v_mfma_f32_16x16x32_bf16 v[64:67], a[8:11], v[248:251], 0
    ds_read_b64_tr_b16 v[244:245], v4 offset:8192
    v_mul_f32 v120, s93, v120
    v_mfma_f32_16x16x32_bf16 v[64:67], a[24:27], v[252:255], v[64:67]
    v_mul_f32 v121, s93, v121
    v_mul_f32 v122, s93, v122
    v_mfma_f32_16x16x32_bf16 v[68:71], a[28:31], v[252:255], 0
    s_waitcnt lgkmcnt(3)
    ds_read_b64_tr_b16 v[246:247], v4 offset:9216
    v_mul_f32 v123, s93, v123
    v_mfma_f32_16x16x32_bf16 v[68:71], a[12:15], v[248:251], v[68:71]
    v_cvt_pk_bf16_f32 v178, v120, v121
    v_cvt_pk_bf16_f32 v179, v122, v123
    v_mul_f32 v124, s93, v124
    v_mfma_f32_16x16x32_bf16 v[72:75], a[0:3], v[232:235], 0
    ds_read_b64_tr_b16 v[248:249], v5
    v_mul_f32 v125, s93, v125
    v_mul_f32 v126, s93, v126
    v_mfma_f32_16x16x32_bf16 v[72:75], a[16:19], v[236:239], v[72:75]
    v_mul_f32 v127, s93, v127
    v_cvt_pk_bf16_f32 v194, v124, v125
    v_cvt_pk_bf16_f32 v195, v126, v127
    v_mfma_f32_16x16x32_bf16 v[76:79], a[20:23], v[236:239], 0
    ds_read_b64_tr_b16 v[250:251], v5 offset:1024
    v_mul_f32 v128, s93, v128
    v_mfma_f32_16x16x32_bf16 v[76:79], a[4:7], v[232:235], v[76:79]
L_hop2:
    s_cbranch_execz L_hop6
    v_mul_f32 v129, s93, v129
    v_mul_f32 v130, s93, v130
    v_mfma_f32_16x16x32_bf16 v[80:83], a[8:11], v[232:235], 0
    ds_read_b64_tr_b16 v[252:253], v5 offset:8192
    v_mul_f32 v131, s93, v131
    v_mfma_f32_16x16x32_bf16 v[80:83], a[24:27], v[236:239], v[80:83]
    v_cvt_pk_bf16_f32 v210, v128, v129
    v_cvt_pk_bf16_f32 v211, v130, v131
    v_mfma_f32_16x16x32_bf16 v[84:87], a[28:31], v[236:239], 0
    s_waitcnt lgkmcnt(3)
    ds_read_b64_tr_b16 v[254:255], v5 offset:9216
    v_mul_f32 v132, s93, v132
    v_mfma_f32_16x16x32_bf16 v[84:87], a[12:15], v[232:235], v[84:87]
    v_mul_f32 v133, s93, v133
    v_mul_f32 v134, s93, v134
    v_mfma_f32_16x16x32_bf16 v[88:91], a[0:3], v[240:243], 0
    ds_read_b64_tr_b16 v[232:233], v6
    v_mul_f32 v135, s93, v135
    v_mfma_f32_16x16x32_bf16 v[88:91], a[16:19], v[244:247], v[88:91]
    v_cvt_pk_bf16_f32 v226, v132, v133
    v_cvt_pk_bf16_f32 v227, v134, v135
    v_mfma_f32_16x16x32_bf16 v[92:95], a[20:23], v[244:247], 0
    ds_read_b64_tr_b16 v[234:235], v6 offset:1024
    v_mul_f32 v136, s93, v136
    v_mfma_f32_16x16x32_bf16 v[92:95], a[4:7], v[240:243], v[92:95]
    v_mul_f32 v137, s93, v137
    v_mul_f32 v138, s93, v138
    v_mfma_f32_16x16x32_bf16 v[96:99], a[8:11], v[240:243], 0
    ds_read_b64_tr_b16 v[236:237], v6 offset:8192
    v_mul_f32 v139, s93, v139
    v_mfma_f32_16x16x32_bf16 v[96:99], a[24:27], v[244:247], v[96:99]
    v_cvt_pk_bf16_f32 v180, v136, v137
    v_cvt_pk_bf16_f32 v181, v138, v139
    v_mul_f32 v140, s93, v140
    v_mfma_f32_16x16x32_bf16 v[100:103], a[28:31], v[244:247], 0
    s_waitcnt lgkmcnt(3)
    ds_read_b64_tr_b16 v[238:239], v6 offset:9216
    v_mul_f32 v141, s93, v141
    v_mul_f32 v142, s93, v142
    v_mfma_f32_16x16x32_bf16 v[100:103], a[12:15], v[240:243], v[100:103]
    v_mul_f32 v143, s93, v143
    v_cvt_pk_bf16_f32 v196, v140, v141
    v_cvt_pk_bf16_f32 v197, v142, v143
    v_mfma_f32_16x16x32_bf16 v[104:107], a[0:3], v[248:251], 0
    ds_read_b64_tr_b16 v[240:241], v7
    v_mul_f32 v144, s93, v144
    v_mfma_f32_16x16x32_bf16 v[104:107], a[16:19], v[252:255], v[104:107]
    v_mul_f32 v145, s93, v145
    v_mul_f32 v146, s93, v146
    v_mfma_f32_16x16x32_bf16 v[108:111], a[20:23], v[252:255], 0
    ds_read_b64_tr_b16 v[242:243], v7 offset:1024
    v_mul_f32 v147, s93, v147
    v_mfma_f32_16x16x32_bf16 v[108:111], a[4:7], v[248:251], v[108:111]
    s_add_u32 s78, s78, 524288
    v_cvt_pk_bf16_f32 v212, v144, v145
    v_cvt_pk_bf16_f32 v213, v146, v147
    v_mfma_f32_16x16x32_bf16 v[112:115], a[8:11], v[248:251], 0
    s_and_b32 s78, s78, 4194303
    ds_read_b64_tr_b16 v[244:245], v7 offset:8192
    v_mul_f32 v148, s93, v148
    v_mfma_f32_16x16x32_bf16 v[112:115], a[24:27], v[252:255], v[112:115]
    s_add_u32 m0, s76, 49152
    v_mul_f32 v149, s93, v149
    v_mul_f32 v150, s93, v150
    v_mfma_f32_16x16x32_bf16 v[116:119], a[28:31], v[252:255], 0
    s_waitcnt lgkmcnt(3)
    ds_read_b64_tr_b16 v[246:247], v7 offset:9216
    v_mul_f32 v151, s93, v151
    v_mfma_f32_16x16x32_bf16 v[116:119], a[12:15], v[248:251], v[116:119]
    buffer_load_dwordx4 v11, s[16:19], s78 offen lds
    v_mfma_f32_16x16x32_bf16 v[120:123], a[0:3], v[232:235], 0
    ds_read_b64_tr_b16 v[248:249], v8
    v_cvt_pk_bf16_f32 v228, v148, v149
    v_mfma_f32_16x16x32_bf16 v[120:123], a[16:19], v[236:239], v[120:123]
    v_cvt_pk_bf16_f32 v229, v150, v151
    v_mul_f32 v152, s93, v152
    v_mul_f32 v153, s93, v153
    v_mfma_f32_16x16x32_bf16 v[124:127], a[20:23], v[236:239], 0
    ds_read_b64_tr_b16 v[250:251], v8 offset:1024
    v_mul_f32 v154, s93, v154
    v_mul_f32 v155, s93, v155
    v_mfma_f32_16x16x32_bf16 v[124:127], a[4:7], v[232:235], v[124:127]
    buffer_load_dwordx4 v12, s[16:19], s78 offen offset:1024 lds
    v_cvt_pk_bf16_f32 v182, v152, v153
    v_mfma_f32_16x16x32_bf16 v[128:131], a[8:11], v[232:235], 0
    ds_read_b64_tr_b16 v[252:253], v8 offset:8192
    v_cvt_pk_bf16_f32 v183, v154, v155
    v_mul_f32 v156, s93, v156
    v_mfma_f32_16x16x32_bf16 v[128:131], a[24:27], v[236:239], v[128:131]
    v_mul_f32 v157, s93, v157
    v_mul_f32 v158, s93, v158
    v_mul_f32 v159, s93, v159
    v_mfma_f32_16x16x32_bf16 v[132:135], a[28:31], v[236:239], 0
    s_waitcnt lgkmcnt(3)
    ds_read_b64_tr_b16 v[254:255], v8 offset:9216
    v_cvt_pk_bf16_f32 v198, v156, v157
    v_cvt_pk_bf16_f32 v199, v158, v159
    v_mfma_f32_16x16x32_bf16 v[132:135], a[12:15], v[232:235], v[132:135]
    buffer_load_dwordx4 v13, s[16:19], s78 offen offset:2048 lds
    v_mfma_f32_16x16x32_bf16 v[136:139], a[0:3], v[240:243], 0
    ds_read_b64_tr_b16 v[232:233], v1 offset:16384
    v_mul_f32 v160, s93, v160
    v_mfma_f32_16x16x32_bf16 v[136:139], a[16:19], v[244:247], v[136:139]
    v_mul_f32 v161, s93, v161
    v_mul_f32 v162, s93, v162
    v_mfma_f32_16x16x32_bf16 v[140:143], a[20:23], v[244:247], 0
    s_add_u32 s71, s80, 0
    ds_read_b64_tr_b16 v[234:235], v1 offset:17408
    v_mul_f32 v163, s93, v163
    v_mfma_f32_16x16x32_bf16 v[140:143], a[4:7], v[240:243], v[140:143]
    buffer_store_dwordx4 v[168:171], v17, s[28:31], s71 offen sc1
    v_mfma_f32_16x16x32_bf16 v[144:147], a[8:11], v[240:243], 0
    ds_read_b64_tr_b16 v[236:237], v1 offset:24576
    v_cvt_pk_bf16_f32 v214, v160, v161
    v_mfma_f32_16x16x32_bf16 v[144:147], a[24:27], v[244:247], v[144:147]
    buffer_load_dwordx4 v14, s[16:19], s78 offen offset:3072 lds
    v_mfma_f32_16x16x32_bf16 v[148:151], a[28:31], v[244:247], 0
    s_waitcnt lgkmcnt(3)
    ds_read_b64_tr_b16 v[238:239], v1 offset:25600
    v_cvt_pk_bf16_f32 v215, v162, v163
    v_mul_f32 v164, s93, v164
    v_mfma_f32_16x16x32_bf16 v[148:151], a[12:15], v[240:243], v[148:151]
    s_lshl_b32 s81, s87, 7
    v_mul_f32 v165, s93, v165
    v_mul_f32 v166, s93, v166
    v_mul_f32 v167, s93, v167
    v_mfma_f32_16x16x32_bf16 v[152:155], a[0:3], v[248:251], 0
    s_add_u32 m0, s77, 16384
    s_add_u32 s79, s72, s81
    ds_read_b64_tr_b16 v[240:241], v2 offset:16384
    v_cvt_pk_bf16_f32 v230, v164, v165
    v_mfma_f32_16x16x32_bf16 v[152:155], a[16:19], v[252:255], v[152:155]
    buffer_load_dwordx4 v15, s[8:11], s79 offen lds
    v_cvt_pk_bf16_f32 v231, v166, v167
    v_mfma_f32_16x16x32_bf16 v[156:159], a[20:23], v[252:255], 0
    ds_read_b64_tr_b16 v[242:243], v2 offset:17408
    v_mfma_f32_16x16x32_bf16 v[156:159], a[4:7], v[248:251], v[156:159]
    v_mfma_f32_16x16x32_bf16 v[160:163], a[8:11], v[248:251], 0
    ds_read_b64_tr_b16 v[244:245], v2 offset:24576
    v_mfma_f32_16x16x32_bf16 v[160:163], a[24:27], v[252:255], v[160:163]
    buffer_load_dwordx4 v16, s[8:11], s79 offen offset:1024 lds
    v_mfma_f32_16x16x32_bf16 v[164:167], a[28:31], v[252:255], 0
    s_waitcnt lgkmcnt(3)
    ds_read_b64_tr_b16 v[246:247], v2 offset:25600
    v_mfma_f32_16x16x32_bf16 v[164:167], a[12:15], v[248:251], v[164:167]
    v_mfma_f32_16x16x32_bf16 v[40:43], a[32:35], v[232:235], v[40:43]
    ds_read_b64_tr_b16 v[248:249], v3 offset:16384
    v_mfma_f32_16x16x32_bf16 v[40:43], a[48:51], v[236:239], v[40:43]
    s_add_u32 m0, s77, 18432
    v_mfma_f32_16x16x32_bf16 v[44:47], a[52:55], v[236:239], v[44:47]
    s_add_u32 s79, s73, s81
    ds_read_b64_tr_b16 v[250:251], v3 offset:17408
    v_mfma_f32_16x16x32_bf16 v[44:47], a[36:39], v[232:235], v[44:47]
    buffer_load_dwordx4 v15, s[8:11], s79 offen lds
    v_mfma_f32_16x16x32_bf16 v[48:51], a[40:43], v[232:235], v[48:51]
    ds_read_b64_tr_b16 v[252:253], v3 offset:24576
    v_mfma_f32_16x16x32_bf16 v[48:51], a[56:59], v[236:239], v[48:51]
    v_mfma_f32_16x16x32_bf16 v[52:55], a[60:63], v[236:239], v[52:55]
    s_waitcnt lgkmcnt(3)
    ds_read_b64_tr_b16 v[254:255], v3 offset:25600
    v_mfma_f32_16x16x32_bf16 v[52:55], a[44:47], v[232:235], v[52:55]
    buffer_load_dwordx4 v16, s[8:11], s79 offen offset:1024 lds
    v_mfma_f32_16x16x32_bf16 v[56:59], a[32:35], v[240:243], v[56:59]
    ds_read_b64_tr_b16 v[232:233], v4 offset:16384
    v_mfma_f32_16x16x32_bf16 v[56:59], a[48:51], v[244:247], v[56:59]
    v_mfma_f32_16x16x32_bf16 v[60:63], a[52:55], v[244:247], v[60:63]
    ds_read_b64_tr_b16 v[234:235], v4 offset:17408
    v_mfma_f32_16x16x32_bf16 v[60:63], a[36:39], v[240:243], v[60:63]
    s_add_u32 m0, s77, 20480
    v_mfma_f32_16x16x32_bf16 v[64:67], a[40:43], v[240:243], v[64:67]
    s_add_u32 s79, s74, s81
    ds_read_b64_tr_b16 v[236:237], v4 offset:24576
    v_mfma_f32_16x16x32_bf16 v[64:67], a[56:59], v[244:247], v[64:67]
    buffer_store_dwordx4 v[172:175], v17, s[28:31], s71 offen offset:1024 sc1
    v_mfma_f32_16x16x32_bf16 v[68:71], a[60:63], v[244:247], v[68:71]
    s_waitcnt lgkmcnt(3)
    ds_read_b64_tr_b16 v[238:239], v4 offset:25600
    v_mfma_f32_16x16x32_bf16 v[68:71], a[44:47], v[240:243], v[68:71]
    buffer_load_dwordx4 v15, s[8:11], s79 offen lds
    v_mfma_f32_16x16x32_bf16 v[72:75], a[32:35], v[248:251], v[72:75]
    ds_read_b64_tr_b16 v[240:241], v5 offset:16384
    v_mfma_f32_16x16x32_bf16 v[72:75], a[48:51], v[252:255], v[72:75]
    buffer_load_dwordx4 v16, s[8:11], s79 offen offset:1024 lds
    v_mfma_f32_16x16x32_bf16 v[76:79], a[52:55], v[252:255], v[76:79]
    ds_read_b64_tr_b16 v[242:243], v5 offset:17408
    v_mfma_f32_16x16x32_bf16 v[76:79], a[36:39], v[248:251], v[76:79]
    s_add_u32 m0, s77, 22528
    v_mfma_f32_16x16x32_bf16 v[80:83], a[40:43], v[248:251], v[80:83]
    s_add_u32 s79, s75, s81
    ds_read_b64_tr_b16 v[244:245], v5 offset:24576
    v_mfma_f32_16x16x32_bf16 v[80:83], a[56:59], v[252:255], v[80:83]
    buffer_load_dwordx4 v15, s[8:11], s79 offen lds
    v_mfma_f32_16x16x32_bf16 v[84:87], a[60:63], v[252:255], v[84:87]
    s_waitcnt lgkmcnt(3)
    ds_read_b64_tr_b16 v[246:247], v5 offset:25600
    v_mfma_f32_16x16x32_bf16 v[84:87], a[44:47], v[248:251], v[84:87]
    v_mfma_f32_16x16x32_bf16 v[88:91], a[32:35], v[232:235], v[88:91]
    ds_read_b64_tr_b16 v[248:249], v6 offset:16384
    v_mfma_f32_16x16x32_bf16 v[88:91], a[48:51], v[236:239], v[88:91]
    v_mfma_f32_16x16x32_bf16 v[92:95], a[52:55], v[236:239], v[92:95]
    ds_read_b64_tr_b16 v[250:251], v6 offset:17408
    v_mfma_f32_16x16x32_bf16 v[92:95], a[36:39], v[232:235], v[92:95]
    buffer_load_dwordx4 v16, s[8:11], s79 offen offset:1024 lds
    v_mfma_f32_16x16x32_bf16 v[96:99], a[40:43], v[232:235], v[96:99]
    ds_read_b64_tr_b16 v[252:253], v6 offset:24576
    v_mfma_f32_16x16x32_bf16 v[96:99], a[56:59], v[236:239], v[96:99]
    v_mfma_f32_16x16x32_bf16 v[100:103], a[60:63], v[236:239], v[100:103]
    s_waitcnt lgkmcnt(3)
    ds_read_b64_tr_b16 v[254:255], v6 offset:25600
    v_mfma_f32_16x16x32_bf16 v[100:103], a[44:47], v[232:235], v[100:103]
    v_mfma_f32_16x16x32_bf16 v[104:107], a[32:35], v[240:243], v[104:107]
    ds_read_b64_tr_b16 v[232:233], v7 offset:16384
    v_mfma_f32_16x16x32_bf16 v[104:107], a[48:51], v[244:247], v[104:107]
    v_mfma_f32_16x16x32_bf16 v[108:111], a[52:55], v[244:247], v[108:111]
    ds_read_b64_tr_b16 v[234:235], v7 offset:17408
    v_mfma_f32_16x16x32_bf16 v[108:111], a[36:39], v[240:243], v[108:111]
    v_mfma_f32_16x16x32_bf16 v[112:115], a[40:43], v[240:243], v[112:115]
    ds_read_b64_tr_b16 v[236:237], v7 offset:24576
    v_mfma_f32_16x16x32_bf16 v[112:115], a[56:59], v[244:247], v[112:115]
    v_mfma_f32_16x16x32_bf16 v[116:119], a[60:63], v[244:247], v[116:119]
    s_waitcnt lgkmcnt(3)
    ds_read_b64_tr_b16 v[238:239], v7 offset:25600
    v_mfma_f32_16x16x32_bf16 v[116:119], a[44:47], v[240:243], v[116:119]
    v_mfma_f32_16x16x32_bf16 v[120:123], a[32:35], v[248:251], v[120:123]
    ds_read_b64_tr_b16 v[240:241], v8 offset:16384
    v_mfma_f32_16x16x32_bf16 v[120:123], a[48:51], v[252:255], v[120:123]
    ds_read_b64_tr_b16 v[242:243], v8 offset:17408
    v_mfma_f32_16x16x32_bf16 v[124:127], a[52:55], v[252:255], v[124:127]
    ds_read_b64_tr_b16 v[244:245], v8 offset:24576
    v_mfma_f32_16x16x32_bf16 v[124:127], a[36:39], v[248:251], v[124:127]
    ds_read_b64_tr_b16 v[246:247], v8 offset:25600
    v_mfma_f32_16x16x32_bf16 v[128:131], a[40:43], v[248:251], v[128:131]
    buffer_store_dwordx4 v[176:179], v17, s[28:31], s71 offen offset:2048 sc1
    v_mfma_f32_16x16x32_bf16 v[128:131], a[56:59], v[252:255], v[128:131]
    v_mfma_f32_16x16x32_bf16 v[132:135], a[60:63], v[252:255], v[132:135]
    s_waitcnt lgkmcnt(4)
    v_mfma_f32_16x16x32_bf16 v[132:135], a[44:47], v[248:251], v[132:135]
    v_mfma_f32_16x16x32_bf16 v[136:139], a[32:35], v[232:235], v[136:139]
    s_waitcnt vmcnt(10)
    v_mfma_f32_16x16x32_bf16 v[136:139], a[48:51], v[236:239], v[136:139]
    s_waitcnt lgkmcnt(0)
    s_barrier
    v_mfma_f32_16x16x32_bf16 v[140:143], a[52:55], v[236:239], v[140:143]
    s_add_u32 s78, s78, 524288
    ds_read_b64_tr_b16 v[248:249], v1 offset:32768
    v_mfma_f32_16x16x32_bf16 v[140:143], a[36:39], v[232:235], v[140:143]
    s_and_b32 s78, s78, 4194303
    ds_read_b64_tr_b16 v[250:251], v1 offset:33792
    v_mfma_f32_16x16x32_bf16 v[144:147], a[40:43], v[232:235], v[144:147]
    s_add_u32 m0, s76, 0
    ds_read_b64_tr_b16 v[252:253], v1 offset:40960
    v_mfma_f32_16x16x32_bf16 v[144:147], a[56:59], v[236:239], v[144:147]
    buffer_load_dwordx4 v11, s[16:19], s78 offen lds
    v_mfma_f32_16x16x32_bf16 v[148:151], a[60:63], v[236:239], v[148:151]
    s_waitcnt lgkmcnt(3)
    ds_read_b64_tr_b16 v[254:255], v1 offset:41984
    v_mfma_f32_16x16x32_bf16 v[148:151], a[44:47], v[232:235], v[148:151]
    v_mfma_f32_16x16x32_bf16 v[152:155], a[32:35], v[240:243], v[152:155]
    ds_read_b64_tr_b16 v[232:233], v2 offset:32768
    v_mfma_f32_16x16x32_bf16 v[152:155], a[48:51], v[244:247], v[152:155]
    v_mfma_f32_16x16x32_bf16 v[156:159], a[52:55], v[244:247], v[156:159]
    ds_read_b64_tr_b16 v[234:235], v2 offset:33792
    v_mfma_f32_16x16x32_bf16 v[156:159], a[36:39], v[240:243], v[156:159]
    buffer_load_dwordx4 v12, s[16:19], s78 offen offset:1024 lds
    v_mfma_f32_16x16x32_bf16 v[160:163], a[40:43], v[240:243], v[160:163]
    ds_read_b64_tr_b16 v[236:237], v2 offset:40960
    v_mfma_f32_16x16x32_bf16 v[160:163], a[56:59], v[244:247], v[160:163]
    v_mfma_f32_16x16x32_bf16 v[164:167], a[60:63], v[244:247], v[164:167]
    s_waitcnt lgkmcnt(3)
    ds_read_b64_tr_b16 v[238:239], v2 offset:41984
    v_mfma_f32_16x16x32_bf16 v[164:167], a[44:47], v[240:243], v[164:167]
    v_mfma_f32_16x16x32_bf16 v[40:43], a[64:67], v[248:251], v[40:43]
    ds_read_b64_tr_b16 v[240:241], v3 offset:32768
    v_xor_b32 v28, 64, v23
    v_mfma_f32_16x16x32_bf16 v[40:43], a[80:83], v[252:255], v[40:43]
    s_cmp_eq_u32 s68, 5
    s_cselect_b32 s4, 0x80000000, 0
    v_xor_b32 v29, 96, v23
    v_mfma_f32_16x16x32_bf16 v[44:47], a[84:87], v[252:255], v[44:47]
    ds_read_b64_tr_b16 v[242:243], v3 offset:33792
    v_mfma_f32_16x16x32_bf16 v[44:47], a[68:71], v[248:251], v[44:47]
    buffer_store_dwordx4 v[180:183], v17, s[28:31], s71 offen offset:3072 sc1
    v_mfma_f32_16x16x32_bf16 v[48:51], a[72:75], v[248:251], v[48:51]
    ds_read_b64_tr_b16 v[244:245], v3 offset:40960
    v_or_b32 v33, s4, v17
    v_mfma_f32_16x16x32_bf16 v[48:51], a[88:91], v[252:255], v[48:51]
    buffer_load_dwordx4 v13, s[16:19], s78 offen offset:2048 lds
    v_mfma_f32_16x16x32_bf16 v[52:55], a[92:95], v[252:255], v[52:55]
    s_waitcnt lgkmcnt(3)
    ds_read_b64_tr_b16 v[246:247], v3 offset:41984
    v_lshrrev_b32 v34, 8, v17
    v_mfma_f32_16x16x32_bf16 v[52:55], a[76:79], v[248:251], v[52:55]
    v_min_u32 v34, 1, v34
    v_lshl_add_u32 v34, v34, 30, v33
    v_mfma_f32_16x16x32_bf16 v[56:59], a[64:67], v[232:235], v[56:59]
    ds_read_b64_tr_b16 v[248:249], v4 offset:32768
    v_xor_b32 v34, 0x80000000, v34
    v_mfma_f32_16x16x32_bf16 v[56:59], a[80:83], v[236:239], v[56:59]
    buffer_load_dwordx4 v14, s[16:19], s78 offen offset:3072 lds
    v_mfma_f32_16x16x32_bf16 v[60:63], a[84:87], v[236:239], v[60:63]
    ds_read_b64_tr_b16 v[250:251], v4 offset:33792
    v_mfma_f32_16x16x32_bf16 v[60:63], a[68:71], v[232:235], v[60:63]
    v_mfma_f32_16x16x32_bf16 v[64:67], a[72:75], v[232:235], v[64:67]
    ds_read_b64_tr_b16 v[252:253], v4 offset:40960
    v_mfma_f32_16x16x32_bf16 v[64:67], a[88:91], v[236:239], v[64:67]
    s_add_u32 s78, s78, 524288
    v_mfma_f32_16x16x32_bf16 v[68:71], a[92:95], v[236:239], v[68:71]
    s_waitcnt lgkmcnt(3)
    ds_read_b64_tr_b16 v[254:255], v4 offset:41984
    v_mfma_f32_16x16x32_bf16 v[68:71], a[76:79], v[232:235], v[68:71]
    s_and_b32 s78, s78, 4194303
    v_mfma_f32_16x16x32_bf16 v[72:75], a[64:67], v[240:243], v[72:75]
    s_add_u32 m0, s76, 16384
    ds_read_b64_tr_b16 v[232:233], v5 offset:32768
    v_mfma_f32_16x16x32_bf16 v[72:75], a[80:83], v[244:247], v[72:75]
    buffer_load_dwordx4 v11, s[16:19], s78 offen lds
    v_mfma_f32_16x16x32_bf16 v[76:79], a[84:87], v[244:247], v[76:79]
    ds_read_b64_tr_b16 v[234:235], v5 offset:33792
    v_mfma_f32_16x16x32_bf16 v[76:79], a[68:71], v[240:243], v[76:79]
    v_mfma_f32_16x16x32_bf16 v[80:83], a[72:75], v[240:243], v[80:83]
    ds_read_b64_tr_b16 v[236:237], v5 offset:40960
    v_mfma_f32_16x16x32_bf16 v[80:83], a[88:91], v[244:247], v[80:83]
    v_mfma_f32_16x16x32_bf16 v[84:87], a[92:95], v[244:247], v[84:87]
    s_waitcnt lgkmcnt(3)
    ds_read_b64_tr_b16 v[238:239], v5 offset:41984
    v_mfma_f32_16x16x32_bf16 v[84:87], a[76:79], v[240:243], v[84:87]
    s_waitcnt vmcnt(14)
    ds_read_b128 a[0:3], v9 offset:16384
    v_mfma_f32_16x16x32_bf16 v[88:91], a[64:67], v[248:251], v[88:91]
    ds_read_b64_tr_b16 v[240:241], v6 offset:32768
    v_mfma_f32_16x16x32_bf16 v[88:91], a[80:83], v[252:255], v[88:91]
    ds_read_b128 a[16:19], v10 offset:16384
    v_mfma_f32_16x16x32_bf16 v[92:95], a[84:87], v[252:255], v[92:95]
    ds_read_b64_tr_b16 v[242:243], v6 offset:33792
    v_mfma_f32_16x16x32_bf16 v[92:95], a[68:71], v[248:251], v[92:95]
    buffer_load_dwordx4 v12, s[16:19], s78 offen offset:1024 lds
    v_mfma_f32_16x16x32_bf16 v[96:99], a[72:75], v[248:251], v[96:99]
    ds_read_b64_tr_b16 v[244:245], v6 offset:40960
    v_mfma_f32_16x16x32_bf16 v[96:99], a[88:91], v[252:255], v[96:99]
    s_add_u32 s71, s80, 4096
    v_mfma_f32_16x16x32_bf16 v[100:103], a[92:95], v[252:255], v[100:103]
    s_waitcnt lgkmcnt(5)
    ds_read_b64_tr_b16 v[246:247], v6 offset:41984
    v_mfma_f32_16x16x32_bf16 v[100:103], a[76:79], v[248:251], v[100:103]
    buffer_store_dwordx4 v[184:187], v17, s[28:31], s71 offen sc1
    v_mfma_f32_16x16x32_bf16 v[104:107], a[64:67], v[232:235], v[104:107]
    ds_read_b64_tr_b16 v[248:249], v7 offset:32768
    v_mfma_f32_16x16x32_bf16 v[104:107], a[80:83], v[236:239], v[104:107]
    s_waitcnt vmcnt(14)
    ds_read_b128 a[4:7], v9 offset:18432
    v_mfma_f32_16x16x32_bf16 v[108:111], a[84:87], v[236:239], v[108:111]
    ds_read_b64_tr_b16 v[250:251], v7 offset:33792
    v_mfma_f32_16x16x32_bf16 v[108:111], a[68:71], v[232:235], v[108:111]
    ds_read_b128 a[20:23], v10 offset:18432
    v_mfma_f32_16x16x32_bf16 v[112:115], a[72:75], v[232:235], v[112:115]
    ds_read_b64_tr_b16 v[252:253], v7 offset:40960
    v_mfma_f32_16x16x32_bf16 v[112:115], a[88:91], v[236:239], v[112:115]
    buffer_load_dwordx4 v13, s[16:19], s78 offen offset:2048 lds
    v_mfma_f32_16x16x32_bf16 v[116:119], a[92:95], v[236:239], v[116:119]
    s_waitcnt lgkmcnt(5)
    ds_read_b64_tr_b16 v[254:255], v7 offset:41984
    v_mfma_f32_16x16x32_bf16 v[116:119], a[76:79], v[232:235], v[116:119]
    v_mfma_f32_16x16x32_bf16 v[120:123], a[64:67], v[240:243], v[120:123]
    ds_read_b64_tr_b16 v[232:233], v8 offset:32768
    v_mfma_f32_16x16x32_bf16 v[120:123], a[80:83], v[244:247], v[120:123]
    buffer_load_dwordx4 v14, s[16:19], s78 offen offset:3072 lds
    v_mfma_f32_16x16x32_bf16 v[124:127], a[84:87], v[244:247], v[124:127]
    ds_read_b64_tr_b16 v[234:235], v8 offset:33792
    v_mfma_f32_16x16x32_bf16 v[124:127], a[68:71], v[240:243], v[124:127]
    s_waitcnt vmcnt(13)
    ds_read_b128 a[8:11], v9 offset:20480
    v_mfma_f32_16x16x32_bf16 v[128:131], a[72:75], v[240:243], v[128:131]
    s_add_u32 s81, s81, 128
    ds_read_b64_tr_b16 v[236:237], v8 offset:40960
    v_mfma_f32_16x16x32_bf16 v[128:131], a[88:91], v[244:247], v[128:131]
    s_and_b32 s81, s81, 1023
    ds_read_b128 a[24:27], v10 offset:20480
    v_mfma_f32_16x16x32_bf16 v[132:135], a[92:95], v[244:247], v[132:135]
    s_waitcnt lgkmcnt(5)
    ds_read_b64_tr_b16 v[238:239], v8 offset:41984
    v_mfma_f32_16x16x32_bf16 v[132:135], a[76:79], v[240:243], v[132:135]
    s_add_u32 m0, s77, 0
    v_mfma_f32_16x16x32_bf16 v[136:139], a[64:67], v[248:251], v[136:139]
    s_add_u32 s79, s72, s81
    ds_read_b64_tr_b16 v[240:241], v1 offset:49152
    v_mfma_f32_16x16x32_bf16 v[136:139], a[80:83], v[252:255], v[136:139]
    buffer_load_dwordx4 v15, s[8:11], s79 offen lds
    v_mfma_f32_16x16x32_bf16 v[140:143], a[84:87], v[252:255], v[140:143]
    ds_read_b64_tr_b16 v[242:243], v1 offset:50176
    v_mfma_f32_16x16x32_bf16 v[140:143], a[68:71], v[248:251], v[140:143]
    v_mfma_f32_16x16x32_bf16 v[144:147], a[72:75], v[248:251], v[144:147]
    ds_read_b64_tr_b16 v[244:245], v1 offset:57344
    v_mfma_f32_16x16x32_bf16 v[144:147], a[88:91], v[252:255], v[144:147]
    s_waitcnt vmcnt(12)
    ds_read_b128 a[12:15], v9 offset:22528
    v_mfma_f32_16x16x32_bf16 v[148:151], a[92:95], v[252:255], v[148:151]
    s_waitcnt lgkmcnt(4)
    ds_read_b64_tr_b16 v[246:247], v1 offset:58368
    v_mfma_f32_16x16x32_bf16 v[148:151], a[76:79], v[248:251], v[148:151]
    ds_read_b128 a[28:31], v10 offset:22528
    v_mfma_f32_16x16x32_bf16 v[152:155], a[64:67], v[232:235], v[152:155]
    ds_read_b64_tr_b16 v[248:249], v2 offset:49152
    v_mfma_f32_16x16x32_bf16 v[152:155], a[80:83], v[236:239], v[152:155]
    buffer_store_dwordx4 v[188:191], v17, s[28:31], s71 offen offset:1024 sc1
    v_mfma_f32_16x16x32_bf16 v[156:159], a[84:87], v[236:239], v[156:159]
    ds_read_b64_tr_b16 v[250:251], v2 offset:50176
    v_mfma_f32_16x16x32_bf16 v[156:159], a[68:71], v[232:235], v[156:159]
    buffer_load_dwordx4 v16, s[8:11], s79 offen offset:1024 lds
    v_mfma_f32_16x16x32_bf16 v[160:163], a[72:75], v[232:235], v[160:163]
    s_add_u32 m0, s77, 2048
    ds_read_b64_tr_b16 v[252:253], v2 offset:57344
    v_mfma_f32_16x16x32_bf16 v[160:163], a[88:91], v[236:239], v[160:163]
    s_add_u32 s79, s73, s81
    v_mfma_f32_16x16x32_bf16 v[164:167], a[92:95], v[236:239], v[164:167]
    s_waitcnt lgkmcnt(4)
    ds_read_b64_tr_b16 v[254:255], v2 offset:58368
    v_mfma_f32_16x16x32_bf16 v[164:167], a[76:79], v[232:235], v[164:167]
    buffer_load_dwordx4 v15, s[8:11], s79 offen lds
    v_mfma_f32_16x16x32_bf16 v[40:43], a[96:99], v[240:243], v[40:43]
    s_lshl_b32 s5, s64, 8
    ds_read_b64_tr_b16 v[232:233], v3 offset:49152
    v_mfma_f32_16x16x32_bf16 v[40:43], a[112:115], v[244:247], v[40:43]
    s_and_b32 s6, s5, 7168
    v_mfma_f32_16x16x32_bf16 v[44:47], a[116:119], v[244:247], v[44:47]
    s_sub_u32 s24, s24, s6
    s_subb_u32 s25, s25, 0
    ds_read_b64_tr_b16 v[234:235], v3 offset:50176
    v_mfma_f32_16x16x32_bf16 v[44:47], a[100:103], v[240:243], v[44:47]
    s_add_u32 s24, s24, s5
    s_addc_u32 s25, s25, 0
    v_mfma_f32_16x16x32_bf16 v[48:51], a[104:107], v[240:243], v[48:51]
    s_sub_u32 s26, 4194304, s5
    ds_read_b64_tr_b16 v[236:237], v3 offset:57344
    v_mfma_f32_16x16x32_bf16 v[48:51], a[120:123], v[244:247], v[48:51]
    v_mfma_f32_16x16x32_bf16 v[52:55], a[124:127], v[244:247], v[52:55]
    s_waitcnt lgkmcnt(3)
    ds_read_b64_tr_b16 v[238:239], v3 offset:58368
    v_mfma_f32_16x16x32_bf16 v[52:55], a[108:111], v[240:243], v[52:55]
    buffer_load_dwordx4 v16, s[8:11], s79 offen offset:1024 lds
    v_mfma_f32_16x16x32_bf16 v[56:59], a[96:99], v[248:251], v[56:59]
    ds_read_b64_tr_b16 v[240:241], v4 offset:49152
    v_mfma_f32_16x16x32_bf16 v[56:59], a[112:115], v[252:255], v[56:59]
    v_mfma_f32_16x16x32_bf16 v[60:63], a[116:119], v[252:255], v[60:63]
    ds_read_b64_tr_b16 v[242:243], v4 offset:50176
    v_mfma_f32_16x16x32_bf16 v[60:63], a[100:103], v[248:251], v[60:63]
    v_mfma_f32_16x16x32_bf16 v[64:67], a[104:107], v[248:251], v[64:67]
    s_add_u32 m0, s77, 4096
    ds_read_b64_tr_b16 v[244:245], v4 offset:57344
    v_mfma_f32_16x16x32_bf16 v[64:67], a[120:123], v[252:255], v[64:67]
    s_add_u32 s79, s74, s81
    v_mfma_f32_16x16x32_bf16 v[68:71], a[124:127], v[252:255], v[68:71]
    s_waitcnt lgkmcnt(3)
    ds_read_b64_tr_b16 v[246:247], v4 offset:58368
    v_mfma_f32_16x16x32_bf16 v[68:71], a[108:111], v[248:251], v[68:71]
    buffer_load_dwordx4 v15, s[8:11], s79 offen lds
    v_mfma_f32_16x16x32_bf16 v[72:75], a[96:99], v[232:235], v[72:75]
    ds_read_b64_tr_b16 v[248:249], v5 offset:49152
    v_mfma_f32_16x16x32_bf16 v[72:75], a[112:115], v[236:239], v[72:75]
    v_mfma_f32_16x16x32_bf16 v[76:79], a[116:119], v[236:239], v[76:79]
    ds_read_b64_tr_b16 v[250:251], v5 offset:50176
    v_mfma_f32_16x16x32_bf16 v[76:79], a[100:103], v[232:235], v[76:79]
    v_mfma_f32_16x16x32_bf16 v[80:83], a[104:107], v[232:235], v[80:83]
    ds_read_b64_tr_b16 v[252:253], v5 offset:57344
    v_mfma_f32_16x16x32_bf16 v[80:83], a[120:123], v[236:239], v[80:83]
    buffer_store_dwordx4 v[192:195], v17, s[28:31], s71 offen offset:2048 sc1
    v_mfma_f32_16x16x32_bf16 v[84:87], a[124:127], v[236:239], v[84:87]
    s_waitcnt lgkmcnt(3)
    ds_read_b64_tr_b16 v[254:255], v5 offset:58368
    v_mfma_f32_16x16x32_bf16 v[84:87], a[108:111], v[232:235], v[84:87]
    buffer_load_dwordx4 v16, s[8:11], s79 offen offset:1024 lds
    v_mfma_f32_16x16x32_bf16 v[88:91], a[96:99], v[240:243], v[88:91]
    ds_read_b64_tr_b16 v[232:233], v6 offset:49152
    v_mfma_f32_16x16x32_bf16 v[88:91], a[112:115], v[244:247], v[88:91]
    v_mfma_f32_16x16x32_bf16 v[92:95], a[116:119], v[244:247], v[92:95]
    ds_read_b64_tr_b16 v[234:235], v6 offset:50176
    v_mfma_f32_16x16x32_bf16 v[92:95], a[100:103], v[240:243], v[92:95]
    s_add_u32 m0, s77, 6144
    v_mfma_f32_16x16x32_bf16 v[96:99], a[104:107], v[240:243], v[96:99]
    s_add_u32 s79, s75, s81
    ds_read_b64_tr_b16 v[236:237], v6 offset:57344
    v_mfma_f32_16x16x32_bf16 v[96:99], a[120:123], v[244:247], v[96:99]
    buffer_load_dwordx4 v15, s[8:11], s79 offen lds
    v_mfma_f32_16x16x32_bf16 v[100:103], a[124:127], v[244:247], v[100:103]
    s_waitcnt lgkmcnt(3)
    ds_read_b64_tr_b16 v[238:239], v6 offset:58368
    v_mfma_f32_16x16x32_bf16 v[100:103], a[108:111], v[240:243], v[100:103]
    v_mfma_f32_16x16x32_bf16 v[104:107], a[96:99], v[248:251], v[104:107]
    ds_read_b64_tr_b16 v[240:241], v7 offset:49152
    v_mfma_f32_16x16x32_bf16 v[104:107], a[112:115], v[252:255], v[104:107]
    v_mfma_f32_16x16x32_bf16 v[108:111], a[116:119], v[252:255], v[108:111]
    ds_read_b64_tr_b16 v[242:243], v7 offset:50176
    v_mfma_f32_16x16x32_bf16 v[108:111], a[100:103], v[248:251], v[108:111]
    v_mfma_f32_16x16x32_bf16 v[112:115], a[104:107], v[248:251], v[112:115]
    ds_read_b64_tr_b16 v[244:245], v7 offset:57344
    v_mfma_f32_16x16x32_bf16 v[112:115], a[120:123], v[252:255], v[112:115]
    buffer_load_dwordx4 v16, s[8:11], s79 offen offset:1024 lds
    v_mfma_f32_16x16x32_bf16 v[116:119], a[124:127], v[252:255], v[116:119]
    s_waitcnt lgkmcnt(3)
    ds_read_b64_tr_b16 v[246:247], v7 offset:58368
    v_mfma_f32_16x16x32_bf16 v[116:119], a[108:111], v[248:251], v[116:119]
    v_mfma_f32_16x16x32_bf16 v[120:123], a[96:99], v[232:235], v[120:123]
    ds_read_b64_tr_b16 v[248:249], v8 offset:49152
    v_mfma_f32_16x16x32_bf16 v[120:123], a[112:115], v[236:239], v[120:123]
    ds_read_b64_tr_b16 v[250:251], v8 offset:50176
    v_mfma_f32_16x16x32_bf16 v[124:127], a[116:119], v[236:239], v[124:127]
    ds_read_b64_tr_b16 v[252:253], v8 offset:57344
    v_mfma_f32_16x16x32_bf16 v[124:127], a[100:103], v[232:235], v[124:127]
    ds_read_b64_tr_b16 v[254:255], v8 offset:58368
    v_mfma_f32_16x16x32_bf16 v[128:131], a[104:107], v[232:235], v[128:131]
    v_mfma_f32_16x16x32_bf16 v[128:131], a[120:123], v[236:239], v[128:131]
    buffer_load_dword v38, v36, s[56:59], 0 offen sc1
    v_mfma_f32_16x16x32_bf16 v[132:135], a[124:127], v[236:239], v[132:135]
    s_waitcnt lgkmcnt(4)
    v_mfma_f32_16x16x32_bf16 v[132:135], a[108:111], v[232:235], v[132:135]
    buffer_store_dwordx4 v[196:199], v17, s[28:31], s71 offen offset:3072 sc1
    v_mfma_f32_16x16x32_bf16 v[136:139], a[96:99], v[240:243], v[136:139]
    s_waitcnt vmcnt(12)
    v_mfma_f32_16x16x32_bf16 v[136:139], a[112:115], v[244:247], v[136:139]
    s_waitcnt lgkmcnt(0)
    s_barrier
    v_mfma_f32_16x16x32_bf16 v[140:143], a[116:119], v[244:247], v[140:143]
    ds_read_b64_tr_b16 v[232:233], v1
    v_mfma_f32_16x16x32_bf16 v[140:143], a[100:103], v[240:243], v[140:143]
    ds_read_b64_tr_b16 v[234:235], v1 offset:1024
    v_mfma_f32_16x16x32_bf16 v[144:147], a[104:107], v[240:243], v[144:147]
    s_getpc_b64 s[100:101]
    ds_read_b64_tr_b16 v[236:237], v1 offset:8192
    v_mfma_f32_16x16x32_bf16 v[144:147], a[120:123], v[244:247], v[144:147]
    global_load_dword v37, v32, s[100:101]
    v_mfma_f32_16x16x32_bf16 v[148:151], a[124:127], v[244:247], v[148:151]
    s_waitcnt lgkmcnt(3)
    s_add_u32 s78, s78, 524288
    s_and_b32 s78, s78, 4194303
    s_add_u32 m0, s76, 32768
    ds_read_b64_tr_b16 v[238:239], v1 offset:9216
    v_mfma_f32_16x16x32_bf16 v[148:151], a[108:111], v[240:243], v[148:151]
    buffer_load_dwordx4 v11, s[16:19], s78 offen lds
    v_mfma_f32_16x16x32_bf16 v[152:155], a[96:99], v[248:251], v[152:155]
    ds_read_b64_tr_b16 v[240:241], v2
    v_mfma_f32_16x16x32_bf16 v[152:155], a[112:115], v[252:255], v[152:155]
    v_mfma_f32_16x16x32_bf16 v[156:159], a[116:119], v[252:255], v[156:159]
    ds_read_b64_tr_b16 v[242:243], v2 offset:1024
    v_mfma_f32_16x16x32_bf16 v[156:159], a[100:103], v[248:251], v[156:159]
    buffer_load_dwordx4 v12, s[16:19], s78 offen offset:1024 lds
    v_mfma_f32_16x16x32_bf16 v[160:163], a[104:107], v[248:251], v[160:163]
    ds_read_b64_tr_b16 v[244:245], v2 offset:8192
    v_mfma_f32_16x16x32_bf16 v[160:163], a[120:123], v[252:255], v[160:163]
    v_mfma_f32_16x16x32_bf16 v[164:167], a[124:127], v[252:255], v[164:167]
    s_waitcnt lgkmcnt(3)
    ds_read_b64_tr_b16 v[246:247], v2 offset:9216
    v_mfma_f32_16x16x32_bf16 v[164:167], a[108:111], v[248:251], v[164:167]
    v_mfma_f32_16x16x32_bf16 v[40:43], a[128:131], v[232:235], v[40:43]
    ds_read_b64_tr_b16 v[248:249], v3
    v_mfma_f32_16x16x32_bf16 v[40:43], a[144:147], v[236:239], v[40:43]
    v_mfma_f32_16x16x32_bf16 v[44:47], a[148:151], v[236:239], v[44:47]
    ds_read_b64_tr_b16 v[250:251], v3 offset:1024
    v_mfma_f32_16x16x32_bf16 v[44:47], a[132:135], v[232:235], v[44:47]
    buffer_load_dwordx4 v13, s[16:19], s78 offen offset:2048 lds
    v_mfma_f32_16x16x32_bf16 v[48:51], a[136:139], v[232:235], v[48:51]
    ds_read_b64_tr_b16 v[252:253], v3 offset:8192
    v_mfma_f32_16x16x32_bf16 v[48:51], a[152:155], v[236:239], v[48:51]
    v_mfma_f32_16x16x32_bf16 v[52:55], a[156:159], v[236:239], v[52:55]
    s_waitcnt lgkmcnt(3)
    ds_read_b64_tr_b16 v[254:255], v3 offset:9216
    v_mfma_f32_16x16x32_bf16 v[52:55], a[140:143], v[232:235], v[52:55]
L_hop3:
    s_cbranch_execz L_hop7
    v_mfma_f32_16x16x32_bf16 v[56:59], a[128:131], v[240:243], v[56:59]
    ds_read_b64_tr_b16 v[232:233], v4
    v_mfma_f32_16x16x32_bf16 v[56:59], a[144:147], v[244:247], v[56:59]
    buffer_load_dwordx4 v14, s[16:19], s78 offen offset:3072 lds
    v_mfma_f32_16x16x32_bf16 v[60:63], a[148:151], v[244:247], v[60:63]
    s_add_u32 s71, s80, 8192
    ds_read_b64_tr_b16 v[234:235], v4 offset:1024
    v_mfma_f32_16x16x32_bf16 v[60:63], a[132:135], v[240:243], v[60:63]
    buffer_store_dwordx4 v[200:203], v17, s[28:31], s71 offen sc1
    v_mfma_f32_16x16x32_bf16 v[64:67], a[136:139], v[240:243], v[64:67]
    ds_read_b64_tr_b16 v[236:237], v4 offset:8192
    v_mfma_f32_16x16x32_bf16 v[64:67], a[152:155], v[244:247], v[64:67]
    s_add_u32 s78, s78, 524288
    v_mfma_f32_16x16x32_bf16 v[68:71], a[156:159], v[244:247], v[68:71]
    s_waitcnt lgkmcnt(3)
    ds_read_b64_tr_b16 v[238:239], v4 offset:9216
    v_mfma_f32_16x16x32_bf16 v[68:71], a[140:143], v[240:243], v[68:71]
    s_and_b32 s78, s78, 4194303
    v_mfma_f32_16x16x32_bf16 v[72:75], a[128:131], v[248:251], v[72:75]
    s_add_u32 m0, s76, 49152
    ds_read_b64_tr_b16 v[240:241], v5
    v_mfma_f32_16x16x32_bf16 v[72:75], a[144:147], v[252:255], v[72:75]
    buffer_load_dwordx4 v11, s[16:19], s78 offen lds
    v_mfma_f32_16x16x32_bf16 v[76:79], a[148:151], v[252:255], v[76:79]
    ds_read_b64_tr_b16 v[242:243], v5 offset:1024
    v_mfma_f32_16x16x32_bf16 v[76:79], a[132:135], v[248:251], v[76:79]
    v_mfma_f32_16x16x32_bf16 v[80:83], a[136:139], v[248:251], v[80:83]
    ds_read_b64_tr_b16 v[244:245], v5 offset:8192
    v_mfma_f32_16x16x32_bf16 v[80:83], a[152:155], v[252:255], v[80:83]
    s_waitcnt vmcnt(16)
    ds_read_b128 a[32:35], v9
    v_mfma_f32_16x16x32_bf16 v[84:87], a[156:159], v[252:255], v[84:87]
    s_waitcnt lgkmcnt(4)
    ds_read_b64_tr_b16 v[246:247], v5 offset:9216
    v_mfma_f32_16x16x32_bf16 v[84:87], a[140:143], v[248:251], v[84:87]
    ds_read_b128 a[48:51], v10
    v_mfma_f32_16x16x32_bf16 v[88:91], a[128:131], v[232:235], v[88:91]
    ds_read_b64_tr_b16 v[248:249], v6
    v_mfma_f32_16x16x32_bf16 v[88:91], a[144:147], v[236:239], v[88:91]
    buffer_load_dwordx4 v12, s[16:19], s78 offen offset:1024 lds
    v_mfma_f32_16x16x32_bf16 v[92:95], a[148:151], v[236:239], v[92:95]
    ds_read_b64_tr_b16 v[250:251], v6 offset:1024
    v_mfma_f32_16x16x32_bf16 v[92:95], a[132:135], v[232:235], v[92:95]
    v_mfma_f32_16x16x32_bf16 v[96:99], a[136:139], v[232:235], v[96:99]
    ds_read_b64_tr_b16 v[252:253], v6 offset:8192
    v_mfma_f32_16x16x32_bf16 v[96:99], a[152:155], v[236:239], v[96:99]
    v_mfma_f32_16x16x32_bf16 v[100:103], a[156:159], v[236:239], v[100:103]
    s_waitcnt lgkmcnt(4)
    ds_read_b64_tr_b16 v[254:255], v6 offset:9216
    v_mfma_f32_16x16x32_bf16 v[100:103], a[140:143], v[232:235], v[100:103]
    v_mfma_f32_16x16x32_bf16 v[104:107], a[128:131], v[240:243], v[104:107]
    ds_read_b64_tr_b16 v[232:233], v7
    v_mfma_f32_16x16x32_bf16 v[104:107], a[144:147], v[244:247], v[104:107]
    s_waitcnt vmcnt(15)
    ds_read_b128 a[36:39], v9 offset:2048
    v_mfma_f32_16x16x32_bf16 v[108:111], a[148:151], v[244:247], v[108:111]
    ds_read_b64_tr_b16 v[234:235], v7 offset:1024
    v_mfma_f32_16x16x32_bf16 v[108:111], a[132:135], v[240:243], v[108:111]
    ds_read_b128 a[52:55], v10 offset:2048
    v_mfma_f32_16x16x32_bf16 v[112:115], a[136:139], v[240:243], v[112:115]
    ds_read_b64_tr_b16 v[236:237], v7 offset:8192
    v_mfma_f32_16x16x32_bf16 v[112:115], a[152:155], v[244:247], v[112:115]
    buffer_store_dwordx4 v[204:207], v17, s[28:31], s71 offen offset:1024 sc1
    v_mfma_f32_16x16x32_bf16 v[116:119], a[156:159], v[244:247], v[116:119]
    s_waitcnt lgkmcnt(5)
    ds_read_b64_tr_b16 v[238:239], v7 offset:9216
    v_mfma_f32_16x16x32_bf16 v[116:119], a[140:143], v[240:243], v[116:119]
    buffer_load_dwordx4 v13, s[16:19], s78 offen offset:2048 lds
    v_mfma_f32_16x16x32_bf16 v[120:123], a[128:131], v[248:251], v[120:123]
    ds_read_b64_tr_b16 v[240:241], v8
    v_mfma_f32_16x16x32_bf16 v[120:123], a[144:147], v[252:255], v[120:123]
    buffer_load_dwordx4 v14, s[16:19], s78 offen offset:3072 lds
    v_mfma_f32_16x16x32_bf16 v[124:127], a[148:151], v[252:255], v[124:127]
    ds_read_b64_tr_b16 v[242:243], v8 offset:1024
    v_mfma_f32_16x16x32_bf16 v[124:127], a[132:135], v[248:251], v[124:127]
    v_mfma_f32_16x16x32_bf16 v[128:131], a[136:139], v[248:251], v[128:131]
    ds_read_b64_tr_b16 v[244:245], v8 offset:8192
    v_mfma_f32_16x16x32_bf16 v[128:131], a[152:155], v[252:255], v[128:131]
    v_mfma_f32_16x16x32_bf16 v[132:135], a[156:159], v[252:255], v[132:135]
    s_waitcnt lgkmcnt(3)
    ds_read_b64_tr_b16 v[246:247], v8 offset:9216
    v_mfma_f32_16x16x32_bf16 v[132:135], a[140:143], v[248:251], v[132:135]
    v_mfma_f32_16x16x32_bf16 v[136:139], a[128:131], v[232:235], v[136:139]
    s_add_u32 s81, s81, 128
    ds_read_b64_tr_b16 v[248:249], v1 offset:16384
    v_mfma_f32_16x16x32_bf16 v[136:139], a[144:147], v[236:239], v[136:139]
    s_waitcnt vmcnt(15)
    ds_read_b128 a[40:43], v9 offset:4096
    v_mfma_f32_16x16x32_bf16 v[140:143], a[148:151], v[236:239], v[140:143]
    s_and_b32 s81, s81, 1023
    ds_read_b64_tr_b16 v[250:251], v1 offset:17408
    v_mfma_f32_16x16x32_bf16 v[140:143], a[132:135], v[232:235], v[140:143]
    s_add_u32 m0, s77, 8192
    ds_read_b128 a[56:59], v10 offset:4096
    v_mfma_f32_16x16x32_bf16 v[144:147], a[136:139], v[232:235], v[144:147]
    s_add_u32 s79, s72, s81
    ds_read_b64_tr_b16 v[252:253], v1 offset:24576
    v_mfma_f32_16x16x32_bf16 v[144:147], a[152:155], v[236:239], v[144:147]
    buffer_load_dwordx4 v15, s[8:11], s79 offen lds
    v_mfma_f32_16x16x32_bf16 v[148:151], a[156:159], v[236:239], v[148:151]
    s_waitcnt lgkmcnt(5)
    ds_read_b64_tr_b16 v[254:255], v1 offset:25600
    v_mfma_f32_16x16x32_bf16 v[148:151], a[140:143], v[232:235], v[148:151]
    buffer_load_dwordx4 v16, s[8:11], s79 offen offset:1024 lds
    v_mfma_f32_16x16x32_bf16 v[152:155], a[128:131], v[240:243], v[152:155]
    ds_read_b64_tr_b16 v[232:233], v2 offset:16384
    v_mfma_f32_16x16x32_bf16 v[152:155], a[144:147], v[244:247], v[152:155]
    v_mfma_f32_16x16x32_bf16 v[156:159], a[148:151], v[244:247], v[156:159]
    ds_read_b64_tr_b16 v[234:235], v2 offset:17408
    v_mfma_f32_16x16x32_bf16 v[156:159], a[132:135], v[240:243], v[156:159]
    v_mfma_f32_16x16x32_bf16 v[160:163], a[136:139], v[240:243], v[160:163]
    ds_read_b64_tr_b16 v[236:237], v2 offset:24576
    v_mfma_f32_16x16x32_bf16 v[160:163], a[152:155], v[244:247], v[160:163]
    v_mfma_f32_16x16x32_bf16 v[164:167], a[156:159], v[244:247], v[164:167]
    s_waitcnt lgkmcnt(3)
    ds_read_b64_tr_b16 v[238:239], v2 offset:25600
    v_mfma_f32_16x16x32_bf16 v[164:167], a[140:143], v[240:243], v[164:167]
    buffer_store_dwordx4 v[208:211], v17, s[28:31], s71 offen offset:2048 sc1
    v_mfma_f32_16x16x32_bf16 v[40:43], a[160:163], v[248:251], v[40:43]
    ds_read_b64_tr_b16 v[240:241], v3 offset:16384
    v_mfma_f32_16x16x32_bf16 v[40:43], a[176:179], v[252:255], v[40:43]
    s_waitcnt vmcnt(16)
    ds_read_b128 a[44:47], v9 offset:6144
    v_mfma_f32_16x16x32_bf16 v[44:47], a[180:183], v[252:255], v[44:47]
    ds_read_b64_tr_b16 v[242:243], v3 offset:17408
    v_mfma_f32_16x16x32_bf16 v[44:47], a[164:167], v[248:251], v[44:47]
    s_add_u32 m0, s77, 10240
    ds_read_b128 a[60:63], v10 offset:6144
    v_mfma_f32_16x16x32_bf16 v[48:51], a[168:171], v[248:251], v[48:51]
    s_add_u32 s79, s73, s81
    ds_read_b64_tr_b16 v[244:245], v3 offset:24576
    v_mfma_f32_16x16x32_bf16 v[48:51], a[184:187], v[252:255], v[48:51]
    buffer_load_dwordx4 v15, s[8:11], s79 offen lds
    v_mfma_f32_16x16x32_bf16 v[52:55], a[188:191], v[252:255], v[52:55]
    s_waitcnt lgkmcnt(5)
    ds_read_b64_tr_b16 v[246:247], v3 offset:25600
    v_mfma_f32_16x16x32_bf16 v[52:55], a[172:175], v[248:251], v[52:55]
    buffer_load_dwordx4 v16, s[8:11], s79 offen offset:1024 lds
    v_mfma_f32_16x16x32_bf16 v[56:59], a[160:163], v[232:235], v[56:59]
    ds_read_b64_tr_b16 v[248:249], v4 offset:16384
    v_mfma_f32_16x16x32_bf16 v[56:59], a[176:179], v[236:239], v[56:59]
    v_mfma_f32_16x16x32_bf16 v[60:63], a[180:183], v[236:239], v[60:63]
    ds_read_b64_tr_b16 v[250:251], v4 offset:17408
    v_mfma_f32_16x16x32_bf16 v[60:63], a[164:167], v[232:235], v[60:63]
    v_mfma_f32_16x16x32_bf16 v[64:67], a[168:171], v[232:235], v[64:67]
    s_add_u32 m0, s77, 12288
    ds_read_b64_tr_b16 v[252:253], v4 offset:24576
    v_mfma_f32_16x16x32_bf16 v[64:67], a[184:187], v[236:239], v[64:67]
    s_add_u32 s79, s74, s81
    v_mfma_f32_16x16x32_bf16 v[68:71], a[188:191], v[236:239], v[68:71]
    s_waitcnt lgkmcnt(3)
    ds_read_b64_tr_b16 v[254:255], v4 offset:25600
    v_mfma_f32_16x16x32_bf16 v[68:71], a[172:175], v[232:235], v[68:71]
    buffer_load_dwordx4 v15, s[8:11], s79 offen lds
    v_mfma_f32_16x16x32_bf16 v[72:75], a[160:163], v[240:243], v[72:75]
    s_waitcnt vmcnt(18)
    ds_read_b64_tr_b16 v[232:233], v5 offset:16384
    v_cmp_eq_u32 vcc, 0, v38
    v_mfma_f32_16x16x32_bf16 v[72:75], a[176:179], v[244:247], v[72:75]
    v_mfma_f32_16x16x32_bf16 v[76:79], a[180:183], v[244:247], v[76:79]
    s_cbranch_vccnz L_spin_z
L_spin_z_ret:
    ds_read_b64_tr_b16 v[234:235], v5 offset:17408
    v_mfma_f32_16x16x32_bf16 v[76:79], a[164:167], v[240:243], v[76:79]
    v_mfma_f32_16x16x32_bf16 v[80:83], a[168:171], v[240:243], v[80:83]
    ds_read_b64_tr_b16 v[236:237], v5 offset:24576
    v_bfe_u32 v38, v17, 8, 1
    v_mfma_f32_16x16x32_bf16 v[80:83], a[184:187], v[244:247], v[80:83]
    v_mul_u32_u24 v38, 4224, v38
    v_and_b32 v36, 63, v36
    v_mfma_f32_16x16x32_bf16 v[84:87], a[188:191], v[244:247], v[84:87]
    s_waitcnt lgkmcnt(3)
    ds_read_b64_tr_b16 v[238:239], v5 offset:25600
    v_add_u32 v36, v36, v38
    v_mfma_f32_16x16x32_bf16 v[84:87], a[172:175], v[240:243], v[84:87]
    buffer_load_dwordx4 v16, s[8:11], s79 offen offset:1024 lds
    v_mfma_f32_16x16x32_bf16 v[88:91], a[160:163], v[248:251], v[88:91]
    ds_read_b64_tr_b16 v[240:241], v6 offset:16384
    v_mfma_f32_16x16x32_bf16 v[88:91], a[176:179], v[252:255], v[88:91]
    v_mfma_f32_16x16x32_bf16 v[92:95], a[180:183], v[252:255], v[92:95]
    s_add_u32 m0, s77, 14336
    ds_read_b64_tr_b16 v[242:243], v6 offset:17408
    v_mfma_f32_16x16x32_bf16 v[92:95], a[164:167], v[248:251], v[92:95]
    buffer_store_dwordx4 v[212:215], v17, s[28:31], s71 offen offset:3072 sc1
    v_mfma_f32_16x16x32_bf16 v[96:99], a[168:171], v[248:251], v[96:99]
    s_add_u32 s79, s75, s81
    ds_read_b64_tr_b16 v[244:245], v6 offset:24576
    v_mfma_f32_16x16x32_bf16 v[96:99], a[184:187], v[252:255], v[96:99]
    buffer_load_dwordx4 v15, s[8:11], s79 offen lds
    v_mfma_f32_16x16x32_bf16 v[100:103], a[188:191], v[252:255], v[100:103]
    s_waitcnt lgkmcnt(3)
    ds_read_b64_tr_b16 v[246:247], v6 offset:25600
    v_mfma_f32_16x16x32_bf16 v[100:103], a[172:175], v[248:251], v[100:103]
    v_mfma_f32_16x16x32_bf16 v[104:107], a[160:163], v[232:235], v[104:107]
    ds_read_b64_tr_b16 v[248:249], v7 offset:16384
    v_mfma_f32_16x16x32_bf16 v[104:107], a[176:179], v[236:239], v[104:107]
    v_mfma_f32_16x16x32_bf16 v[108:111], a[180:183], v[236:239], v[108:111]
    ds_read_b64_tr_b16 v[250:251], v7 offset:17408
    v_mfma_f32_16x16x32_bf16 v[108:111], a[164:167], v[232:235], v[108:111]
    v_mfma_f32_16x16x32_bf16 v[112:115], a[168:171], v[232:235], v[112:115]
    ds_read_b64_tr_b16 v[252:253], v7 offset:24576
    v_mfma_f32_16x16x32_bf16 v[112:115], a[184:187], v[236:239], v[112:115]
    buffer_load_dwordx4 v16, s[8:11], s79 offen offset:1024 lds
    v_mfma_f32_16x16x32_bf16 v[116:119], a[188:191], v[236:239], v[116:119]
    s_waitcnt lgkmcnt(3)
    ds_read_b64_tr_b16 v[254:255], v7 offset:25600
    v_mfma_f32_16x16x32_bf16 v[116:119], a[172:175], v[232:235], v[116:119]
    v_mfma_f32_16x16x32_bf16 v[120:123], a[160:163], v[240:243], v[120:123]
    ds_read_b64_tr_b16 v[232:233], v8 offset:16384
    v_mfma_f32_16x16x32_bf16 v[120:123], a[176:179], v[244:247], v[120:123]
    ds_read_b64_tr_b16 v[234:235], v8 offset:17408
    v_mfma_f32_16x16x32_bf16 v[124:127], a[180:183], v[244:247], v[124:127]
    ds_read_b64_tr_b16 v[236:237], v8 offset:24576
    v_mfma_f32_16x16x32_bf16 v[124:127], a[164:167], v[240:243], v[124:127]
    ds_read_b64_tr_b16 v[238:239], v8 offset:25600
    v_mfma_f32_16x16x32_bf16 v[128:131], a[168:171], v[240:243], v[128:131]
    v_mfma_f32_16x16x32_bf16 v[128:131], a[184:187], v[244:247], v[128:131]
    v_mfma_f32_16x16x32_bf16 v[132:135], a[188:191], v[244:247], v[132:135]
    s_waitcnt lgkmcnt(4)
    v_mfma_f32_16x16x32_bf16 v[132:135], a[172:175], v[240:243], v[132:135]
    v_mfma_f32_16x16x32_bf16 v[136:139], a[160:163], v[248:251], v[136:139]
    s_waitcnt vmcnt(10)
    v_mfma_f32_16x16x32_bf16 v[136:139], a[176:179], v[252:255], v[136:139]
    s_waitcnt lgkmcnt(0)
    s_barrier
    v_mfma_f32_16x16x32_bf16 v[140:143], a[180:183], v[252:255], v[140:143]
    s_lshl_b32 s78, s87, 19
    ds_read_b64_tr_b16 v[240:241], v1 offset:32768
    v_mfma_f32_16x16x32_bf16 v[140:143], a[164:167], v[248:251], v[140:143]
    s_add_u32 m0, s76, 0
    ds_read_b64_tr_b16 v[242:243], v1 offset:33792
    v_mfma_f32_16x16x32_bf16 v[144:147], a[168:171], v[248:251], v[144:147]
    s_add_u32 s71, s80, 12288
    ds_read_b64_tr_b16 v[244:245], v1 offset:40960
    v_mfma_f32_16x16x32_bf16 v[144:147], a[184:187], v[252:255], v[144:147]
    buffer_store_dwordx4 v[216:219], v17, s[28:31], s71 offen sc1
    v_mfma_f32_16x16x32_bf16 v[148:151], a[188:191], v[252:255], v[148:151]
    s_waitcnt lgkmcnt(3)
    ds_read_b64_tr_b16 v[246:247], v1 offset:41984
    v_mfma_f32_16x16x32_bf16 v[148:151], a[172:175], v[248:251], v[148:151]
    buffer_load_dwordx4 v11, s[24:27], s78 offen lds
    v_mfma_f32_16x16x32_bf16 v[152:155], a[160:163], v[232:235], v[152:155]
    ds_read_b64_tr_b16 v[248:249], v2 offset:32768
    v_mfma_f32_16x16x32_bf16 v[152:155], a[176:179], v[236:239], v[152:155]
    v_mfma_f32_16x16x32_bf16 v[156:159], a[180:183], v[236:239], v[156:159]
    ds_read_b64_tr_b16 v[250:251], v2 offset:33792
    v_mfma_f32_16x16x32_bf16 v[156:159], a[164:167], v[232:235], v[156:159]
    buffer_load_dwordx4 v12, s[24:27], s78 offen offset:1024 lds
    v_mfma_f32_16x16x32_bf16 v[160:163], a[168:171], v[232:235], v[160:163]
    ds_read_b64_tr_b16 v[252:253], v2 offset:40960
    v_mfma_f32_16x16x32_bf16 v[160:163], a[184:187], v[236:239], v[160:163]
    v_mfma_f32_16x16x32_bf16 v[164:167], a[188:191], v[236:239], v[164:167]
    s_waitcnt lgkmcnt(3)
    ds_read_b64_tr_b16 v[254:255], v2 offset:41984
    v_mfma_f32_16x16x32_bf16 v[164:167], a[172:175], v[232:235], v[164:167]
    v_mfma_f32_16x16x32_bf16 v[40:43], a[192:195], v[240:243], v[40:43]
    ds_read_b64_tr_b16 v[232:233], v3 offset:32768
    v_mfma_f32_16x16x32_bf16 v[40:43], a[208:211], v[244:247], v[40:43]
    v_mfma_f32_16x16x32_bf16 v[44:47], a[212:215], v[244:247], v[44:47]
    ds_read_b64_tr_b16 v[234:235], v3 offset:33792
    v_mfma_f32_16x16x32_bf16 v[44:47], a[196:199], v[240:243], v[44:47]
    buffer_load_dwordx4 v13, s[24:27], s78 offen offset:2048 lds
    v_mfma_f32_16x16x32_bf16 v[48:51], a[200:203], v[240:243], v[48:51]
    ds_read_b64_tr_b16 v[236:237], v3 offset:40960
    v_mfma_f32_16x16x32_bf16 v[48:51], a[216:219], v[244:247], v[48:51]
    v_mfma_f32_16x16x32_bf16 v[52:55], a[220:223], v[244:247], v[52:55]
    s_waitcnt lgkmcnt(3)
    ds_read_b64_tr_b16 v[238:239], v3 offset:41984
    v_mfma_f32_16x16x32_bf16 v[52:55], a[204:207], v[240:243], v[52:55]
    v_mfma_f32_16x16x32_bf16 v[56:59], a[192:195], v[248:251], v[56:59]
    ds_read_b64_tr_b16 v[240:241], v4 offset:32768
    v_mfma_f32_16x16x32_bf16 v[56:59], a[208:211], v[252:255], v[56:59]
    buffer_load_dwordx4 v14, s[24:27], s78 offen offset:3072 lds
    v_mfma_f32_16x16x32_bf16 v[60:63], a[212:215], v[252:255], v[60:63]
    ds_read_b64_tr_b16 v[242:243], v4 offset:33792
    v_mfma_f32_16x16x32_bf16 v[60:63], a[196:199], v[248:251], v[60:63]
    v_mfma_f32_16x16x32_bf16 v[64:67], a[200:203], v[248:251], v[64:67]
    ds_read_b64_tr_b16 v[244:245], v4 offset:40960
    v_mfma_f32_16x16x32_bf16 v[64:67], a[216:219], v[252:255], v[64:67]
    v_mfma_f32_16x16x32_bf16 v[68:71], a[220:223], v[252:255], v[68:71]
    s_waitcnt lgkmcnt(3)
    ds_read_b64_tr_b16 v[246:247], v4 offset:41984
    v_mfma_f32_16x16x32_bf16 v[68:71], a[204:207], v[248:251], v[68:71]
    v_mfma_f32_16x16x32_bf16 v[72:75], a[192:195], v[232:235], v[72:75]
    ds_read_b64_tr_b16 v[248:249], v5 offset:32768
    v_mfma_f32_16x16x32_bf16 v[72:75], a[208:211], v[236:239], v[72:75]
    buffer_store_dwordx4 v[220:223], v17, s[28:31], s71 offen offset:1024 sc1
    v_mfma_f32_16x16x32_bf16 v[76:79], a[212:215], v[236:239], v[76:79]
    s_add_u32 s78, s78, 524288
    ds_read_b64_tr_b16 v[250:251], v5 offset:33792
    v_mfma_f32_16x16x32_bf16 v[76:79], a[196:199], v[232:235], v[76:79]
    s_waitcnt vmcnt(14)
    ds_read_b128 a[64:67], v9 offset:8192
    v_mfma_f32_16x16x32_bf16 v[80:83], a[200:203], v[232:235], v[80:83]
    s_and_b32 s78, s78, 4194303
    ds_read_b64_tr_b16 v[252:253], v5 offset:40960
    v_mfma_f32_16x16x32_bf16 v[80:83], a[216:219], v[236:239], v[80:83]
    s_add_u32 m0, s76, 16384
    ds_read_b128 a[80:83], v10 offset:8192
    v_mfma_f32_16x16x32_bf16 v[84:87], a[220:223], v[236:239], v[84:87]
    s_waitcnt lgkmcnt(5)
    ds_read_b64_tr_b16 v[254:255], v5 offset:41984
    v_mfma_f32_16x16x32_bf16 v[84:87], a[204:207], v[232:235], v[84:87]
    buffer_load_dwordx4 v11, s[24:27], s78 offen lds
    v_mfma_f32_16x16x32_bf16 v[88:91], a[192:195], v[240:243], v[88:91]
    ds_read_b64_tr_b16 v[232:233], v6 offset:32768
    v_mfma_f32_16x16x32_bf16 v[88:91], a[208:211], v[244:247], v[88:91]
    buffer_load_dwordx4 v12, s[24:27], s78 offen offset:1024 lds
    v_mfma_f32_16x16x32_bf16 v[92:95], a[212:215], v[244:247], v[92:95]
    ds_read_b64_tr_b16 v[234:235], v6 offset:33792
    v_mfma_f32_16x16x32_bf16 v[92:95], a[196:199], v[240:243], v[92:95]
    v_mfma_f32_16x16x32_bf16 v[96:99], a[200:203], v[240:243], v[96:99]
    ds_read_b64_tr_b16 v[236:237], v6 offset:40960
    v_mfma_f32_16x16x32_bf16 v[96:99], a[216:219], v[244:247], v[96:99]
    v_mfma_f32_16x16x32_bf16 v[100:103], a[220:223], v[244:247], v[100:103]
    s_waitcnt lgkmcnt(3)
    ds_read_b64_tr_b16 v[238:239], v6 offset:41984
    v_mfma_f32_16x16x32_bf16 v[100:103], a[204:207], v[240:243], v[100:103]
    v_mfma_f32_16x16x32_bf16 v[104:107], a[192:195], v[248:251], v[104:107]
    ds_read_b64_tr_b16 v[240:241], v7 offset:32768
    v_mfma_f32_16x16x32_bf16 v[104:107], a[208:211], v[252:255], v[104:107]
    s_waitcnt vmcnt(13)
    ds_read_b128 a[68:71], v9 offset:10240
    v_mfma_f32_16x16x32_bf16 v[108:111], a[212:215], v[252:255], v[108:111]
    ds_read_b64_tr_b16 v[242:243], v7 offset:33792
    v_mfma_f32_16x16x32_bf16 v[108:111], a[196:199], v[248:251], v[108:111]
    ds_read_b128 a[84:87], v10 offset:10240
    v_mfma_f32_16x16x32_bf16 v[112:115], a[200:203], v[248:251], v[112:115]
    ds_read_b64_tr_b16 v[244:245], v7 offset:40960
    v_mfma_f32_16x16x32_bf16 v[112:115], a[216:219], v[252:255], v[112:115]
    buffer_load_dwordx4 v13, s[24:27], s78 offen offset:2048 lds
    v_mfma_f32_16x16x32_bf16 v[116:119], a[220:223], v[252:255], v[116:119]
    s_waitcnt lgkmcnt(5)
    ds_read_b64_tr_b16 v[246:247], v7 offset:41984
    v_mfma_f32_16x16x32_bf16 v[116:119], a[204:207], v[248:251], v[116:119]
    v_mfma_f32_16x16x32_bf16 v[120:123], a[192:195], v[232:235], v[120:123]
    ds_read_b64_tr_b16 v[248:249], v8 offset:32768
    v_mfma_f32_16x16x32_bf16 v[120:123], a[208:211], v[236:239], v[120:123]
    buffer_load_dwordx4 v14, s[24:27], s78 offen offset:3072 lds
    v_mfma_f32_16x16x32_bf16 v[124:127], a[212:215], v[236:239], v[124:127]
    ds_read_b64_tr_b16 v[250:251], v8 offset:33792
    v_mfma_f32_16x16x32_bf16 v[124:127], a[196:199], v[232:235], v[124:127]
    buffer_store_dwordx4 v[224:227], v17, s[28:31], s71 offen offset:2048 sc1
    v_mfma_f32_16x16x32_bf16 v[128:131], a[200:203], v[232:235], v[128:131]
    ds_read_b64_tr_b16 v[252:253], v8 offset:40960
    v_mfma_f32_16x16x32_bf16 v[128:131], a[216:219], v[236:239], v[128:131]
    v_mfma_f32_16x16x32_bf16 v[132:135], a[220:223], v[236:239], v[132:135]
    s_waitcnt lgkmcnt(3)
    ds_read_b64_tr_b16 v[254:255], v8 offset:41984
    v_mfma_f32_16x16x32_bf16 v[132:135], a[204:207], v[232:235], v[132:135]
    v_mfma_f32_16x16x32_bf16 v[136:139], a[192:195], v[240:243], v[136:139]
    s_add_u32 s81, s81, 128
    ds_read_b64_tr_b16 v[232:233], v1 offset:49152
    v_mfma_f32_16x16x32_bf16 v[136:139], a[208:211], v[244:247], v[136:139]
    s_waitcnt vmcnt(14)
    ds_read_b128 a[72:75], v9 offset:12288
    v_mfma_f32_16x16x32_bf16 v[140:143], a[212:215], v[244:247], v[140:143]
    s_and_b32 s81, s81, 1023
    ds_read_b64_tr_b16 v[234:235], v1 offset:50176
    v_mfma_f32_16x16x32_bf16 v[140:143], a[196:199], v[240:243], v[140:143]
    s_add_u32 m0, s77, 16384
    ds_read_b128 a[88:91], v10 offset:12288
    v_mfma_f32_16x16x32_bf16 v[144:147], a[200:203], v[240:243], v[144:147]
    s_add_u32 s79, s72, s81
    ds_read_b64_tr_b16 v[236:237], v1 offset:57344
    v_mfma_f32_16x16x32_bf16 v[144:147], a[216:219], v[244:247], v[144:147]
    buffer_load_dwordx4 v15, s[8:11], s79 offen lds
    v_mfma_f32_16x16x32_bf16 v[148:151], a[220:223], v[244:247], v[148:151]
    s_waitcnt lgkmcnt(5)
    ds_read_b64_tr_b16 v[238:239], v1 offset:58368
    v_mfma_f32_16x16x32_bf16 v[148:151], a[204:207], v[240:243], v[148:151]
    buffer_load_dwordx4 v16, s[8:11], s79 offen offset:1024 lds
    v_mfma_f32_16x16x32_bf16 v[152:155], a[192:195], v[248:251], v[152:155]
    ds_read_b64_tr_b16 v[240:241], v2 offset:49152
    v_mfma_f32_16x16x32_bf16 v[152:155], a[208:211], v[252:255], v[152:155]
    v_mfma_f32_16x16x32_bf16 v[156:159], a[212:215], v[252:255], v[156:159]
    ds_read_b64_tr_b16 v[242:243], v2 offset:50176
    v_mfma_f32_16x16x32_bf16 v[156:159], a[196:199], v[248:251], v[156:159]
    v_mfma_f32_16x16x32_bf16 v[160:163], a[200:203], v[248:251], v[160:163]
    ds_read_b64_tr_b16 v[244:245], v2 offset:57344
    v_mfma_f32_16x16x32_bf16 v[160:163], a[216:219], v[252:255], v[160:163]
    v_mfma_f32_16x16x32_bf16 v[164:167], a[220:223], v[252:255], v[164:167]
    s_waitcnt lgkmcnt(3)
    ds_read_b64_tr_b16 v[246:247], v2 offset:58368
    v_mfma_f32_16x16x32_bf16 v[164:167], a[204:207], v[248:251], v[164:167]
    s_waitcnt vmcnt(13)
    ds_read_b128 a[76:79], v9 offset:14336
    v_mfma_f32_16x16x32_bf16 v[40:43], a[224:227], v[232:235], v[40:43]
    ds_read_b64_tr_b16 v[248:249], v3 offset:49152
    v_mfma_f32_16x16x32_bf16 v[40:43], a[240:243], v[236:239], v[40:43]
    s_add_u32 m0, s77, 18432
    ds_read_b128 a[92:95], v10 offset:14336
    v_mfma_f32_16x16x32_bf16 v[44:47], a[244:247], v[236:239], v[44:47]
    s_add_u32 s79, s73, s81
    ds_read_b64_tr_b16 v[250:251], v3 offset:50176
    v_mfma_f32_16x16x32_bf16 v[44:47], a[228:231], v[232:235], v[44:47]
    buffer_load_dwordx4 v15, s[8:11], s79 offen lds
    v_mfma_f32_16x16x32_bf16 v[48:51], a[232:235], v[232:235], v[48:51]
    ds_read_b64_tr_b16 v[252:253], v3 offset:57344
    v_mfma_f32_16x16x32_bf16 v[48:51], a[248:251], v[236:239], v[48:51]
    v_mfma_f32_16x16x32_bf16 v[52:55], a[252:255], v[236:239], v[52:55]
    s_waitcnt lgkmcnt(5)
    ds_read_b64_tr_b16 v[254:255], v3 offset:58368
    v_max3_f32 v31, abs(v40), abs(v41), 0
    v_mfma_f32_16x16x32_bf16 v[52:55], a[236:239], v[232:235], v[52:55]
    buffer_store_dwordx4 v[228:231], v17, s[28:31], s71 offen offset:3072 sc1
    v_mfma_f32_16x16x32_bf16 v[56:59], a[224:227], v[240:243], v[56:59]
    ds_read_b64_tr_b16 v[232:233], v4 offset:49152
    v_max3_f32 v31, abs(v42), abs(v43), v31
    v_mfma_f32_16x16x32_bf16 v[56:59], a[240:243], v[244:247], v[56:59]
    buffer_load_dwordx4 v16, s[8:11], s79 offen offset:1024 lds
    v_mfma_f32_16x16x32_bf16 v[60:63], a[244:247], v[244:247], v[60:63]
    ds_read_b64_tr_b16 v[234:235], v4 offset:50176
    v_cvt_pk_bf16_f32 v168, v40, v41
    v_mfma_f32_16x16x32_bf16 v[60:63], a[228:231], v[240:243], v[60:63]
    v_cvt_pk_bf16_f32 v169, v42, v43
    v_max3_f32 v31, abs(v44), abs(v45), v31
    v_max3_f32 v31, abs(v46), abs(v47), v31
    v_mfma_f32_16x16x32_bf16 v[64:67], a[232:235], v[240:243], v[64:67]
    s_add_u32 m0, s77, 20480
    ds_read_b64_tr_b16 v[236:237], v4 offset:57344
    v_cvt_pk_bf16_f32 v170, v44, v45
    v_cvt_pk_bf16_f32 v171, v46, v47
    v_mfma_f32_16x16x32_bf16 v[64:67], a[248:251], v[244:247], v[64:67]
    s_add_u32 s79, s74, s81
    v_max3_f32 v31, abs(v48), abs(v49), v31
    v_max3_f32 v31, abs(v50), abs(v51), v31
    v_cvt_pk_bf16_f32 v172, v48, v49
    v_mfma_f32_16x16x32_bf16 v[68:71], a[252:255], v[244:247], v[68:71]
    s_waitcnt lgkmcnt(3)
    ds_read_b64_tr_b16 v[238:239], v4 offset:58368
    v_cvt_pk_bf16_f32 v173, v50, v51
    v_max3_f32 v31, abs(v52), abs(v53), v31
    v_mfma_f32_16x16x32_bf16 v[68:71], a[236:239], v[240:243], v[68:71]
    buffer_load_dwordx4 v15, s[8:11], s79 offen lds
    v_max3_f32 v31, abs(v54), abs(v55), v31
    v_mfma_f32_16x16x32_bf16 v[72:75], a[224:227], v[248:251], v[72:75]
    ds_read_b64_tr_b16 v[240:241], v5 offset:49152
    v_cvt_pk_bf16_f32 v174, v52, v53
    v_cvt_pk_bf16_f32 v175, v54, v55
    v_mfma_f32_16x16x32_bf16 v[72:75], a[240:243], v[252:255], v[72:75]
    v_max3_f32 v31, abs(v56), abs(v57), v31
    v_max3_f32 v31, abs(v58), abs(v59), v31
    v_mfma_f32_16x16x32_bf16 v[76:79], a[244:247], v[252:255], v[76:79]
    ds_read_b64_tr_b16 v[242:243], v5 offset:50176
    v_cvt_pk_bf16_f32 v176, v56, v57
    v_mfma_f32_16x16x32_bf16 v[76:79], a[228:231], v[248:251], v[76:79]
    v_cvt_pk_bf16_f32 v177, v58, v59
    v_max3_f32 v31, abs(v60), abs(v61), v31
    v_mfma_f32_16x16x32_bf16 v[80:83], a[232:235], v[248:251], v[80:83]
    ds_read_b64_tr_b16 v[244:245], v5 offset:57344
    v_max3_f32 v31, abs(v62), abs(v63), v31
    v_mfma_f32_16x16x32_bf16 v[80:83], a[248:251], v[252:255], v[80:83]
    v_cvt_pk_bf16_f32 v178, v60, v61
    v_cvt_pk_bf16_f32 v179, v62, v63
    v_mfma_f32_16x16x32_bf16 v[84:87], a[252:255], v[252:255], v[84:87]
    s_waitcnt lgkmcnt(3)
    ds_read_b64_tr_b16 v[246:247], v5 offset:58368
    v_max3_f32 v31, abs(v64), abs(v65), v31
    v_mfma_f32_16x16x32_bf16 v[84:87], a[236:239], v[248:251], v[84:87]
    buffer_load_dwordx4 v16, s[8:11], s79 offen offset:1024 lds
    v_mfma_f32_16x16x32_bf16 v[88:91], a[224:227], v[232:235], v[88:91]
    ds_read_b64_tr_b16 v[248:249], v6 offset:49152
    v_max3_f32 v31, abs(v66), abs(v67), v31
    v_mfma_f32_16x16x32_bf16 v[88:91], a[240:243], v[236:239], v[88:91]
    v_cvt_pk_bf16_f32 v180, v64, v65
    v_cvt_pk_bf16_f32 v181, v66, v67
    v_mfma_f32_16x16x32_bf16 v[92:95], a[244:247], v[236:239], v[92:95]
    ds_read_b64_tr_b16 v[250:251], v6 offset:50176
    v_max3_f32 v31, abs(v68), abs(v69), v31
    v_mfma_f32_16x16x32_bf16 v[92:95], a[228:231], v[232:235], v[92:95]
    s_add_u32 m0, s77, 22528
    v_max3_f32 v31, abs(v70), abs(v71), v31
    v_cvt_pk_bf16_f32 v182, v68, v69
    v_mfma_f32_16x16x32_bf16 v[96:99], a[232:235], v[232:235], v[96:99]
    s_add_u32 s79, s75, s81
    ds_read_b64_tr_b16 v[252:253], v6 offset:57344
    v_cvt_pk_bf16_f32 v183, v70, v71
    v_mfma_f32_16x16x32_bf16 v[96:99], a[248:251], v[236:239], v[96:99]
    buffer_load_dwordx4 v15, s[8:11], s79 offen lds
    v_mfma_f32_16x16x32_bf16 v[100:103], a[252:255], v[236:239], v[100:103]
    s_waitcnt lgkmcnt(3)
    ds_read_b64_tr_b16 v[254:255], v6 offset:58368
    v_max3_f32 v31, abs(v72), abs(v73), v31
    v_mfma_f32_16x16x32_bf16 v[100:103], a[236:239], v[232:235], v[100:103]
    v_max3_f32 v31, abs(v74), abs(v75), v31
    v_cvt_pk_bf16_f32 v184, v72, v73
    v_mfma_f32_16x16x32_bf16 v[104:107], a[224:227], v[240:243], v[104:107]
    ds_read_b64_tr_b16 v[232:233], v7 offset:49152
    v_cvt_pk_bf16_f32 v185, v74, v75
    v_max3_f32 v31, abs(v76), abs(v77), v31
    v_mfma_f32_16x16x32_bf16 v[104:107], a[240:243], v[244:247], v[104:107]
    v_max3_f32 v31, abs(v78), abs(v79), v31
    v_cvt_pk_bf16_f32 v186, v76, v77
    v_cvt_pk_bf16_f32 v187, v78, v79
    v_mfma_f32_16x16x32_bf16 v[108:111], a[244:247], v[244:247], v[108:111]
    ds_read_b64_tr_b16 v[234:235], v7 offset:50176
    v_max3_f32 v31, abs(v80), abs(v81), v31
    v_mfma_f32_16x16x32_bf16 v[108:111], a[228:231], v[240:243], v[108:111]
    v_max3_f32 v31, abs(v82), abs(v83), v31
    v_cvt_pk_bf16_f32 v188, v80, v81
    v_mfma_f32_16x16x32_bf16 v[112:115], a[232:235], v[240:243], v[112:115]
    ds_read_b64_tr_b16 v[236:237], v7 offset:57344
    v_cvt_pk_bf16_f32 v189, v82, v83
    v_mfma_f32_16x16x32_bf16 v[112:115], a[248:251], v[244:247], v[112:115]
    buffer_load_dwordx4 v16, s[8:11], s79 offen offset:1024 lds
    v_mfma_f32_16x16x32_bf16 v[116:119], a[252:255], v[244:247], v[116:119]
    s_waitcnt lgkmcnt(3)
    ds_read_b64_tr_b16 v[238:239], v7 offset:58368
    v_max3_f32 v31, abs(v84), abs(v85), v31
    v_mfma_f32_16x16x32_bf16 v[116:119], a[236:239], v[240:243], v[116:119]
    v_max3_f32 v31, abs(v86), abs(v87), v31
    v_cvt_pk_bf16_f32 v190, v84, v85
    v_mfma_f32_16x16x32_bf16 v[120:123], a[224:227], v[248:251], v[120:123]
    ds_read_b64_tr_b16 v[240:241], v8 offset:49152
    v_cvt_pk_bf16_f32 v191, v86, v87
    v_mfma_f32_16x16x32_bf16 v[120:123], a[240:243], v[252:255], v[120:123]
    ds_read_b64_tr_b16 v[242:243], v8 offset:50176
    v_max3_f32 v31, abs(v88), abs(v89), v31
    v_mfma_f32_16x16x32_bf16 v[124:127], a[244:247], v[252:255], v[124:127]
    ds_read_b64_tr_b16 v[244:245], v8 offset:57344
    v_max3_f32 v31, abs(v90), abs(v91), v31
    v_mfma_f32_16x16x32_bf16 v[124:127], a[228:231], v[248:251], v[124:127]
    ds_read_b64_tr_b16 v[246:247], v8 offset:58368
    v_cvt_pk_bf16_f32 v192, v88, v89
    v_mfma_f32_16x16x32_bf16 v[128:131], a[232:235], v[248:251], v[128:131]
    v_cvt_pk_bf16_f32 v193, v90, v91
    v_max3_f32 v31, abs(v92), abs(v93), v31
    v_max3_f32 v31, abs(v94), abs(v95), v31
    v_mfma_f32_16x16x32_bf16 v[128:131], a[248:251], v[252:255], v[128:131]
    v_cvt_pk_bf16_f32 v194, v92, v93
    v_cvt_pk_bf16_f32 v195, v94, v95
    v_mfma_f32_16x16x32_bf16 v[132:135], a[252:255], v[252:255], v[132:135]
    s_waitcnt lgkmcnt(4)
    v_max3_f32 v31, abs(v96), abs(v97), v31
    v_max3_f32 v31, abs(v98), abs(v99), v31
    v_mfma_f32_16x16x32_bf16 v[132:135], a[236:239], v[248:251], v[132:135]
    v_cvt_pk_bf16_f32 v196, v96, v97
    v_cvt_pk_bf16_f32 v197, v98, v99
    v_mfma_f32_16x16x32_bf16 v[136:139], a[224:227], v[232:235], v[136:139]
L_hop4:
    s_cbranch_execz L_hop_ret
    s_waitcnt vmcnt(10)
    v_max3_f32 v31, abs(v100), abs(v101), v31
    v_max3_f32 v31, abs(v102), abs(v103), v31
    v_mfma_f32_16x16x32_bf16 v[136:139], a[240:243], v[236:239], v[136:139]
    s_waitcnt lgkmcnt(0)
    s_barrier
    v_cvt_pk_bf16_f32 v198, v100, v101
    v_mfma_f32_16x16x32_bf16 v[140:143], a[244:247], v[236:239], v[140:143]
    s_add_u32 s78, s78, 524288
    ds_read_b64_tr_b16 v[248:249], v1
    v_cvt_pk_bf16_f32 v199, v102, v103
    v_mfma_f32_16x16x32_bf16 v[140:143], a[228:231], v[232:235], v[140:143]
    s_and_b32 s78, s78, 4194303
    ds_read_b64_tr_b16 v[250:251], v1 offset:1024
    v_max3_f32 v31, abs(v104), abs(v105), v31
    v_mfma_f32_16x16x32_bf16 v[144:147], a[232:235], v[232:235], v[144:147]
    s_add_u32 m0, s76, 32768
    ds_read_b64_tr_b16 v[252:253], v1 offset:8192
    v_max3_f32 v31, abs(v106), abs(v107), v31
    v_mfma_f32_16x16x32_bf16 v[144:147], a[248:251], v[236:239], v[144:147]
    buffer_load_dwordx4 v11, s[24:27], s78 offen lds
    v_mfma_f32_16x16x32_bf16 v[148:151], a[252:255], v[236:239], v[148:151]
    s_waitcnt lgkmcnt(3)
    ds_read_b64_tr_b16 v[254:255], v1 offset:9216
    v_cvt_pk_bf16_f32 v200, v104, v105
    v_mfma_f32_16x16x32_bf16 v[148:151], a[236:239], v[232:235], v[148:151]
    v_cvt_pk_bf16_f32 v201, v106, v107
    v_max3_f32 v31, abs(v108), abs(v109), v31
    v_mfma_f32_16x16x32_bf16 v[152:155], a[224:227], v[240:243], v[152:155]
    ds_read_b64_tr_b16 v[232:233], v2
    v_max3_f32 v31, abs(v110), abs(v111), v31
    v_mfma_f32_16x16x32_bf16 v[152:155], a[240:243], v[244:247], v[152:155]
    v_cvt_pk_bf16_f32 v202, v108, v109
    v_cvt_pk_bf16_f32 v203, v110, v111
    v_mfma_f32_16x16x32_bf16 v[156:159], a[244:247], v[244:247], v[156:159]
    ds_read_b64_tr_b16 v[234:235], v2 offset:1024
    v_max3_f32 v31, abs(v112), abs(v113), v31
    v_mfma_f32_16x16x32_bf16 v[156:159], a[228:231], v[240:243], v[156:159]
    buffer_load_dwordx4 v12, s[24:27], s78 offen offset:1024 lds
    v_mfma_f32_16x16x32_bf16 v[160:163], a[232:235], v[240:243], v[160:163]
    ds_read_b64_tr_b16 v[236:237], v2 offset:8192
    v_max3_f32 v31, abs(v114), abs(v115), v31
    v_mfma_f32_16x16x32_bf16 v[160:163], a[248:251], v[244:247], v[160:163]
    v_cvt_pk_bf16_f32 v204, v112, v113
    v_cvt_pk_bf16_f32 v205, v114, v115
    v_mfma_f32_16x16x32_bf16 v[164:167], a[252:255], v[244:247], v[164:167]
    s_waitcnt lgkmcnt(3)
    ds_read_b64_tr_b16 v[238:239], v2 offset:9216
    v_max3_f32 v31, abs(v116), abs(v117), v31
    v_mfma_f32_16x16x32_bf16 v[164:167], a[236:239], v[240:243], v[164:167]
    v_max3_f32 v31, abs(v118), abs(v119), v31
    v_cvt_pk_bf16_f32 v206, v116, v117
    v_mfma_f32_16x16x32_bf16 v[40:43], v[248:251], a[0:3], 0
    s_lshl_b32 s19, s65, 3
    ds_read_b64_tr_b16 v[240:241], v3
    v_cvt_pk_bf16_f32 v207, v118, v119
    v_mfma_f32_16x16x32_bf16 v[40:43], v[252:255], a[16:19], v[40:43]
    s_add_u32 s19, s19, s68
    v_max3_f32 v31, abs(v120), abs(v121), v31
    v_max3_f32 v31, abs(v122), abs(v123), v31
    v_mfma_f32_16x16x32_bf16 v[44:47], v[252:255], a[20:23], 0
    s_lshl_b32 s19, s19, 2
    ds_read_b64_tr_b16 v[242:243], v3 offset:1024
    v_cvt_pk_bf16_f32 v208, v120, v121
    v_mfma_f32_16x16x32_bf16 v[44:47], v[248:251], a[4:7], v[44:47]
    buffer_load_dwordx4 v13, s[24:27], s78 offen offset:2048 lds
    v_mfma_f32_16x16x32_bf16 v[48:51], v[248:251], a[8:11], 0
    s_add_u32 s17, s19, s66
    ds_read_b64_tr_b16 v[244:245], v3 offset:8192
    v_cvt_pk_bf16_f32 v209, v122, v123
    v_max3_f32 v31, abs(v124), abs(v125), v31
    v_mfma_f32_16x16x32_bf16 v[48:51], v[252:255], a[24:27], v[48:51]
    s_add_u32 s17, s17, 448
    v_max3_f32 v31, abs(v126), abs(v127), v31
    v_cvt_pk_bf16_f32 v210, v124, v125
    v_cvt_pk_bf16_f32 v211, v126, v127
    v_mfma_f32_16x16x32_bf16 v[52:55], v[252:255], a[28:31], 0
    s_waitcnt lgkmcnt(3)
    ds_read_b64_tr_b16 v[246:247], v3 offset:9216
    v_max3_f32 v31, abs(v128), abs(v129), v31
    v_mfma_f32_16x16x32_bf16 v[52:55], v[248:251], a[12:15], v[52:55]
    s_mul_i32 s17, s17, 4224
    v_max3_f32 v31, abs(v130), abs(v131), v31
    v_cvt_pk_bf16_f32 v212, v128, v129
    v_mfma_f32_16x16x32_bf16 v[56:59], v[232:235], a[0:3], 0
    s_lshl_b32 s18, s67, 2
    ds_read_b64_tr_b16 v[248:249], v4
    v_cvt_pk_bf16_f32 v213, v130, v131
    v_mfma_f32_16x16x32_bf16 v[56:59], v[236:239], a[16:19], v[56:59]
    buffer_load_dwordx4 v14, s[24:27], s78 offen offset:3072 lds
    v_mfma_f32_16x16x32_bf16 v[60:63], v[236:239], a[20:23], 0
    s_add_u32 s18, s18, s17
    ds_read_b64_tr_b16 v[250:251], v4 offset:1024
    v_max3_f32 v31, abs(v132), abs(v133), v31
    v_mfma_f32_16x16x32_bf16 v[60:63], v[232:235], a[4:7], v[60:63]
    s_xor_b32 s12, s67, 0
    v_max3_f32 v31, abs(v134), abs(v135), v31
    v_cvt_pk_bf16_f32 v214, v132, v133
    v_mfma_f32_16x16x32_bf16 v[64:67], v[232:235], a[8:11], 0
    s_add_u32 s12, s12, s19
    ds_read_b64_tr_b16 v[252:253], v4 offset:8192
    v_cvt_pk_bf16_f32 v215, v134, v135
    v_mfma_f32_16x16x32_bf16 v[64:67], v[236:239], a[24:27], v[64:67]
    s_add_u32 s78, s78, 524288
    v_max3_f32 v31, abs(v136), abs(v137), v31
    v_max3_f32 v31, abs(v138), abs(v139), v31
    v_mfma_f32_16x16x32_bf16 v[68:71], v[236:239], a[28:31], 0
    s_waitcnt lgkmcnt(3)
    ds_read_b64_tr_b16 v[254:255], v4 offset:9216
    v_cvt_pk_bf16_f32 v216, v136, v137
    v_mfma_f32_16x16x32_bf16 v[68:71], v[232:235], a[12:15], v[68:71]
    s_and_b32 s78, s78, 4194303
    v_cvt_pk_bf16_f32 v217, v138, v139
    v_max3_f32 v31, abs(v140), abs(v141), v31
    v_mfma_f32_16x16x32_bf16 v[72:75], v[240:243], a[0:3], 0
    s_add_u32 m0, s76, 49152
    ds_read_b64_tr_b16 v[232:233], v5
    v_max3_f32 v31, abs(v142), abs(v143), v31
    v_mfma_f32_16x16x32_bf16 v[72:75], v[244:247], a[16:19], v[72:75]
    buffer_load_dwordx4 v11, s[24:27], s78 offen lds
    v_mfma_f32_16x16x32_bf16 v[76:79], v[244:247], a[20:23], 0
    s_add_u32 s71, s80, 16384
    ds_read_b64_tr_b16 v[234:235], v5 offset:1024
    v_cvt_pk_bf16_f32 v218, v140, v141
    v_mfma_f32_16x16x32_bf16 v[76:79], v[240:243], a[4:7], v[76:79]
    buffer_store_dwordx4 v[168:171], v17, s[36:39], s71 offen sc1
    v_mfma_f32_16x16x32_bf16 v[80:83], v[240:243], a[8:11], 0
    s_lshl_b32 s12, s12, 2
    ds_read_b64_tr_b16 v[236:237], v5 offset:8192
    v_cvt_pk_bf16_f32 v219, v142, v143
    v_max3_f32 v31, abs(v144), abs(v145), v31
    v_mfma_f32_16x16x32_bf16 v[80:83], v[244:247], a[24:27], v[80:83]
    s_waitcnt vmcnt(13)
    ds_read_b128 a[96:99], v9 offset:16384
    v_max3_f32 v31, abs(v146), abs(v147), v31
    v_cvt_pk_bf16_f32 v220, v144, v145
    v_mfma_f32_16x16x32_bf16 v[84:87], v[244:247], a[28:31], 0
    s_waitcnt lgkmcnt(4)
    ds_read_b64_tr_b16 v[238:239], v5 offset:9216
    v_cvt_pk_bf16_f32 v221, v146, v147
    v_max3_f32 v31, abs(v148), abs(v149), v31
    v_mfma_f32_16x16x32_bf16 v[84:87], v[240:243], a[12:15], v[84:87]
    s_add_u32 s12, s12, s66
    ds_read_b128 a[112:115], v10 offset:16384
    v_max3_f32 v31, abs(v150), abs(v151), v31
    v_cvt_pk_bf16_f32 v222, v148, v149
    v_mfma_f32_16x16x32_bf16 v[88:91], v[248:251], a[0:3], 0
    s_mul_i32 s12, s12, 6144
    ds_read_b64_tr_b16 v[240:241], v6
    v_cvt_pk_bf16_f32 v223, v150, v151
    v_mfma_f32_16x16x32_bf16 v[88:91], v[252:255], a[16:19], v[88:91]
    buffer_load_dwordx4 v12, s[24:27], s78 offen offset:1024 lds
    v_mfma_f32_16x16x32_bf16 v[92:95], v[252:255], a[20:23], 0
    s_xor_b32 s13, s67, 1
    ds_read_b64_tr_b16 v[242:243], v6 offset:1024
    v_max3_f32 v31, abs(v152), abs(v153), v31
    v_mfma_f32_16x16x32_bf16 v[92:95], v[248:251], a[4:7], v[92:95]
    s_add_u32 s13, s13, s19
    v_max3_f32 v31, abs(v154), abs(v155), v31
    v_cvt_pk_bf16_f32 v224, v152, v153
    v_mfma_f32_16x16x32_bf16 v[96:99], v[248:251], a[8:11], 0
    s_lshl_b32 s13, s13, 2
    ds_read_b64_tr_b16 v[244:245], v6 offset:8192
    v_cvt_pk_bf16_f32 v225, v154, v155
    v_max3_f32 v31, abs(v156), abs(v157), v31
    v_mfma_f32_16x16x32_bf16 v[96:99], v[252:255], a[24:27], v[96:99]
    s_add_u32 s13, s13, s66
    v_max3_f32 v31, abs(v158), abs(v159), v31
    v_cvt_pk_bf16_f32 v226, v156, v157
    v_cvt_pk_bf16_f32 v227, v158, v159
    v_mfma_f32_16x16x32_bf16 v[100:103], v[252:255], a[28:31], 0
    s_waitcnt lgkmcnt(4)
    ds_read_b64_tr_b16 v[246:247], v6 offset:9216
    v_max3_f32 v31, abs(v160), abs(v161), v31
    v_mfma_f32_16x16x32_bf16 v[100:103], v[248:251], a[12:15], v[100:103]
    s_mul_i32 s13, s13, 6144
    v_max3_f32 v31, abs(v162), abs(v163), v31
    v_cvt_pk_bf16_f32 v228, v160, v161
    v_mfma_f32_16x16x32_bf16 v[104:107], v[232:235], a[0:3], 0
    s_xor_b32 s14, s67, 2
    ds_read_b64_tr_b16 v[248:249], v7
    v_cvt_pk_bf16_f32 v229, v162, v163
    v_mfma_f32_16x16x32_bf16 v[104:107], v[236:239], a[16:19], v[104:107]
    buffer_load_dwordx4 v13, s[24:27], s78 offen offset:2048 lds
    v_mfma_f32_16x16x32_bf16 v[108:111], v[236:239], a[20:23], 0
    s_add_u32 s14, s14, s19
    ds_read_b64_tr_b16 v[250:251], v7 offset:1024
    v_max3_f32 v31, abs(v164), abs(v165), v31
    v_mfma_f32_16x16x32_bf16 v[108:111], v[232:235], a[4:7], v[108:111]
    s_lshl_b32 s14, s14, 2
    v_max3_f32 v31, abs(v166), abs(v167), v31
    v_cvt_pk_bf16_f32 v230, v164, v165
    v_mfma_f32_16x16x32_bf16 v[112:115], v[232:235], a[8:11], 0
    s_add_u32 s14, s14, s66
    ds_read_b64_tr_b16 v[252:253], v7 offset:8192
    v_cvt_pk_bf16_f32 v231, v166, v167
    v_mfma_f32_16x16x32_bf16 v[112:115], v[236:239], a[24:27], v[112:115]
    buffer_store_dwordx4 v[172:175], v17, s[36:39], s71 offen offset:1024 sc1
    v_mfma_f32_16x16x32_bf16 v[116:119], v[236:239], a[28:31], 0
    s_waitcnt lgkmcnt(3)
    ds_read_b64_tr_b16 v[254:255], v7 offset:9216
    v_mov_b32 v30, 0x5d800000
    v_mfma_f32_16x16x32_bf16 v[116:119], v[232:235], a[12:15], v[116:119]
    s_waitcnt vmcnt(13)
    ds_read_b128 a[100:103], v9 offset:18432
    v_cmp_nle_f32 s[6:7], v31, v30
    v_mfma_f32_16x16x32_bf16 v[120:123], v[240:243], a[0:3], 0
    s_mul_i32 s14, s14, 6144
    ds_read_b64_tr_b16 v[232:233], v8
    v_cmp_neq_f32 s[4:5], 0, v31
    v_mfma_f32_16x16x32_bf16 v[120:123], v[244:247], a[16:19], v[120:123]
    s_add_u32 s14, s14, 2048
    ds_read_b128 a[116:119], v10 offset:18432
    v_cmp_le_f32 vcc, 0x26800000, v31
    v_mfma_f32_16x16x32_bf16 v[124:127], v[244:247], a[20:23], 0
    s_xor_b32 s15, s67, 3
    ds_read_b64_tr_b16 v[234:235], v8 offset:1024
    v_mfma_f32_16x16x32_bf16 v[124:127], v[240:243], a[4:7], v[124:127]
    buffer_load_dwordx4 v14, s[24:27], s78 offen offset:3072 lds
    v_mfma_f32_16x16x32_bf16 v[128:131], v[240:243], a[8:11], 0
    s_add_u32 s15, s15, s19
    ds_read_b64_tr_b16 v[236:237], v8 offset:8192
    v_mfma_f32_16x16x32_bf16 v[128:131], v[244:247], a[24:27], v[128:131]
    s_lshl_b32 s15, s15, 2
    v_mfma_f32_16x16x32_bf16 v[132:135], v[244:247], a[28:31], 0
    s_waitcnt lgkmcnt(5)
    ds_read_b64_tr_b16 v[238:239], v8 offset:9216
    v_mfma_f32_16x16x32_bf16 v[132:135], v[240:243], a[12:15], v[132:135]
    s_add_u32 s15, s15, s66
    v_mfma_f32_16x16x32_bf16 v[136:139], v[248:251], a[0:3], 0
    s_add_u32 s81, s81, 128
    ds_read_b64_tr_b16 v[240:241], v1 offset:16384
    v_mfma_f32_16x16x32_bf16 v[136:139], v[252:255], a[16:19], v[136:139]
    s_waitcnt vmcnt(12)
    ds_read_b128 a[104:107], v9 offset:20480
    v_mfma_f32_16x16x32_bf16 v[140:143], v[252:255], a[20:23], 0
    s_and_b32 s81, s81, 1023
    ds_read_b64_tr_b16 v[242:243], v1 offset:17408
    v_mfma_f32_16x16x32_bf16 v[140:143], v[248:251], a[4:7], v[140:143]
    s_add_u32 m0, s77, 0
    ds_read_b128 a[120:123], v10 offset:20480
    v_mfma_f32_16x16x32_bf16 v[144:147], v[248:251], a[8:11], 0
    s_add_u32 s79, s72, s81
    ds_read_b64_tr_b16 v[244:245], v1 offset:24576
    v_mfma_f32_16x16x32_bf16 v[144:147], v[252:255], a[24:27], v[144:147]
    buffer_load_dwordx4 v15, s[8:11], s79 offen lds
    v_mfma_f32_16x16x32_bf16 v[148:151], v[252:255], a[28:31], 0
    s_waitcnt lgkmcnt(5)
    ds_read_b64_tr_b16 v[246:247], v1 offset:25600
    v_mfma_f32_16x16x32_bf16 v[148:151], v[248:251], a[12:15], v[148:151]
    buffer_store_dwordx4 v[176:179], v17, s[36:39], s71 offen offset:2048 sc1
    v_mfma_f32_16x16x32_bf16 v[152:155], v[232:235], a[0:3], 0
    s_mul_i32 s15, s15, 6144
    ds_read_b64_tr_b16 v[248:249], v2 offset:16384
    v_mfma_f32_16x16x32_bf16 v[152:155], v[236:239], a[16:19], v[152:155]
    buffer_load_dwordx4 v16, s[8:11], s79 offen offset:1024 lds
    v_mfma_f32_16x16x32_bf16 v[156:159], v[236:239], a[20:23], 0
    s_add_u32 s15, s15, 4096
    ds_read_b64_tr_b16 v[250:251], v2 offset:17408
    v_mfma_f32_16x16x32_bf16 v[156:159], v[232:235], a[4:7], v[156:159]
    s_add_u32 s16, s12, 4096
    v_mfma_f32_16x16x32_bf16 v[160:163], v[232:235], a[8:11], 0
    s_lshl_b32 s19, s67, 3
    ds_read_b64_tr_b16 v[252:253], v2 offset:24576
    v_mfma_f32_16x16x32_bf16 v[160:163], v[236:239], a[24:27], v[160:163]
    s_add_u32 s19, s19, s65
    v_mfma_f32_16x16x32_bf16 v[164:167], v[236:239], a[28:31], 0
    s_waitcnt lgkmcnt(3)
    ds_read_b64_tr_b16 v[254:255], v2 offset:25600
    v_mfma_f32_16x16x32_bf16 v[164:167], v[232:235], a[12:15], v[164:167]
    s_waitcnt vmcnt(13)
    ds_read_b128 a[108:111], v9 offset:22528
    v_mfma_f32_16x16x32_bf16 v[40:43], v[240:243], a[32:35], v[40:43]
    s_lshl_b32 s19, s19, 2
    ds_read_b64_tr_b16 v[232:233], v3 offset:16384
    v_mfma_f32_16x16x32_bf16 v[40:43], v[244:247], a[48:51], v[40:43]
    s_add_u32 m0, s77, 2048
    ds_read_b128 a[124:127], v10 offset:22528
    v_mfma_f32_16x16x32_bf16 v[44:47], v[244:247], a[52:55], v[44:47]
    s_add_u32 s79, s73, s81
    ds_read_b64_tr_b16 v[234:235], v3 offset:17408
    v_mfma_f32_16x16x32_bf16 v[44:47], v[240:243], a[36:39], v[44:47]
    buffer_load_dwordx4 v15, s[8:11], s79 offen lds
    v_mfma_f32_16x16x32_bf16 v[48:51], v[240:243], a[40:43], v[48:51]
    s_add_u32 s19, s19, s66
    ds_read_b64_tr_b16 v[236:237], v3 offset:24576
    v_mfma_f32_16x16x32_bf16 v[48:51], v[244:247], a[56:59], v[48:51]
    s_lshl_b32 s19, s19, 8
    v_mfma_f32_16x16x32_bf16 v[52:55], v[244:247], a[60:63], v[52:55]
    s_waitcnt lgkmcnt(5)
    ds_read_b64_tr_b16 v[238:239], v3 offset:25600
    v_mfma_f32_16x16x32_bf16 v[52:55], v[240:243], a[44:47], v[52:55]
    buffer_load_dwordx4 v16, s[8:11], s79 offen offset:1024 lds
    v_mfma_f32_16x16x32_bf16 v[56:59], v[248:251], a[32:35], v[56:59]
    s_add_u32 s19, s19, 8388608
    ds_read_b64_tr_b16 v[240:241], v4 offset:16384
    v_mfma_f32_16x16x32_bf16 v[56:59], v[252:255], a[48:51], v[56:59]
    buffer_store_dwordx4 v[180:183], v17, s[36:39], s71 offen offset:3072 sc1
    v_mfma_f32_16x16x32_bf16 v[60:63], v[252:255], a[52:55], v[60:63]
    s_cmp_lg_u64 s[4:5], 0
    s_cselect_b32 s93, 2, 1
    ds_read_b64_tr_b16 v[242:243], v4 offset:17408
    v_mfma_f32_16x16x32_bf16 v[60:63], v[248:251], a[36:39], v[60:63]
    s_cmp_eq_u64 vcc, 0
    s_cselect_b32 s93, s93, 1
    v_mfma_f32_16x16x32_bf16 v[64:67], v[248:251], a[40:43], v[64:67]
    s_add_u32 m0, s77, 4096
    ds_read_b64_tr_b16 v[244:245], v4 offset:24576
    v_mfma_f32_16x16x32_bf16 v[64:67], v[252:255], a[56:59], v[64:67]
    s_add_u32 s79, s74, s81
    v_mfma_f32_16x16x32_bf16 v[68:71], v[252:255], a[60:63], v[68:71]
    s_waitcnt lgkmcnt(3)
    ds_read_b64_tr_b16 v[246:247], v4 offset:25600
    v_mfma_f32_16x16x32_bf16 v[68:71], v[248:251], a[44:47], v[68:71]
    buffer_load_dwordx4 v15, s[8:11], s79 offen lds
    v_mfma_f32_16x16x32_bf16 v[72:75], v[232:235], a[32:35], v[72:75]
    s_cmp_lg_u64 s[6:7], 0
    s_cselect_b32 s93, 2, s93
    ds_read_b64_tr_b16 v[248:249], v5 offset:16384
    v_mfma_f32_16x16x32_bf16 v[72:75], v[236:239], a[48:51], v[72:75]
    v_mov_b32 v31, s93
    v_mfma_f32_16x16x32_bf16 v[76:79], v[236:239], a[52:55], v[76:79]
    ds_read_b64_tr_b16 v[250:251], v5 offset:17408
    v_mfma_f32_16x16x32_bf16 v[76:79], v[232:235], a[36:39], v[76:79]
    v_mfma_f32_16x16x32_bf16 v[80:83], v[232:235], a[40:43], v[80:83]
    ds_read_b64_tr_b16 v[252:253], v5 offset:24576
    v_mfma_f32_16x16x32_bf16 v[80:83], v[236:239], a[56:59], v[80:83]
    v_mfma_f32_16x16x32_bf16 v[84:87], v[236:239], a[60:63], v[84:87]
    s_waitcnt lgkmcnt(3)
    ds_read_b64_tr_b16 v[254:255], v5 offset:25600
    v_mfma_f32_16x16x32_bf16 v[84:87], v[232:235], a[44:47], v[84:87]
    buffer_load_dwordx4 v16, s[8:11], s79 offen offset:1024 lds
    v_mfma_f32_16x16x32_bf16 v[88:91], v[240:243], a[32:35], v[88:91]
    ds_read_b64_tr_b16 v[232:233], v6 offset:16384
    v_mfma_f32_16x16x32_bf16 v[88:91], v[244:247], a[48:51], v[88:91]
    s_add_u32 m0, s77, 6144
    v_mfma_f32_16x16x32_bf16 v[92:95], v[244:247], a[52:55], v[92:95]
    s_add_u32 s71, s80, 20480
    ds_read_b64_tr_b16 v[234:235], v6 offset:17408
    v_mfma_f32_16x16x32_bf16 v[92:95], v[240:243], a[36:39], v[92:95]
    buffer_store_dwordx4 v[184:187], v17, s[36:39], s71 offen sc1
    v_mfma_f32_16x16x32_bf16 v[96:99], v[240:243], a[40:43], v[96:99]
    s_add_u32 s79, s75, s81
    ds_read_b64_tr_b16 v[236:237], v6 offset:24576
    v_mfma_f32_16x16x32_bf16 v[96:99], v[244:247], a[56:59], v[96:99]
    buffer_load_dwordx4 v15, s[8:11], s79 offen lds
    v_mfma_f32_16x16x32_bf16 v[100:103], v[244:247], a[60:63], v[100:103]
    s_waitcnt lgkmcnt(3)
    ds_read_b64_tr_b16 v[238:239], v6 offset:25600
    v_mfma_f32_16x16x32_bf16 v[100:103], v[240:243], a[44:47], v[100:103]
    v_mfma_f32_16x16x32_bf16 v[104:107], v[248:251], a[32:35], v[104:107]
    ds_read_b64_tr_b16 v[240:241], v7 offset:16384
    v_mfma_f32_16x16x32_bf16 v[104:107], v[252:255], a[48:51], v[104:107]
    v_mfma_f32_16x16x32_bf16 v[108:111], v[252:255], a[52:55], v[108:111]
    ds_read_b64_tr_b16 v[242:243], v7 offset:17408
    v_mfma_f32_16x16x32_bf16 v[108:111], v[248:251], a[36:39], v[108:111]
    v_mfma_f32_16x16x32_bf16 v[112:115], v[248:251], a[40:43], v[112:115]
    ds_read_b64_tr_b16 v[244:245], v7 offset:24576
    v_mfma_f32_16x16x32_bf16 v[112:115], v[252:255], a[56:59], v[112:115]
    buffer_load_dwordx4 v16, s[8:11], s79 offen offset:1024 lds
    v_mfma_f32_16x16x32_bf16 v[116:119], v[252:255], a[60:63], v[116:119]
    s_waitcnt lgkmcnt(3)
    ds_read_b64_tr_b16 v[246:247], v7 offset:25600
    v_mfma_f32_16x16x32_bf16 v[116:119], v[248:251], a[44:47], v[116:119]
    v_mfma_f32_16x16x32_bf16 v[120:123], v[232:235], a[32:35], v[120:123]
    ds_read_b64_tr_b16 v[248:249], v8 offset:16384
    v_mfma_f32_16x16x32_bf16 v[120:123], v[236:239], a[48:51], v[120:123]
    ds_read_b64_tr_b16 v[250:251], v8 offset:17408
    v_mfma_f32_16x16x32_bf16 v[124:127], v[236:239], a[52:55], v[124:127]
    ds_read_b64_tr_b16 v[252:253], v8 offset:24576
    v_mfma_f32_16x16x32_bf16 v[124:127], v[232:235], a[36:39], v[124:127]
    s_getpc_b64 s[100:101]
    ds_read_b64_tr_b16 v[254:255], v8 offset:25600
    v_mfma_f32_16x16x32_bf16 v[128:131], v[232:235], a[40:43], v[128:131]
    buffer_store_dwordx4 v[188:191], v17, s[36:39], s71 offen offset:1024 sc1
    v_mfma_f32_16x16x32_bf16 v[128:131], v[236:239], a[56:59], v[128:131]
    global_load_dword v37, v32, s[100:101]
    v_mfma_f32_16x16x32_bf16 v[132:135], v[236:239], a[60:63], v[132:135]
    s_waitcnt lgkmcnt(4)
    v_mfma_f32_16x16x32_bf16 v[132:135], v[232:235], a[44:47], v[132:135]
    s_add_u32 s96, s96, 2
    v_mfma_f32_16x16x32_bf16 v[136:139], v[240:243], a[32:35], v[136:139]
    s_waitcnt vmcnt(13)
    v_mfma_f32_16x16x32_bf16 v[136:139], v[244:247], a[48:51], v[136:139]
    s_waitcnt lgkmcnt(0)
    s_barrier
    v_mfma_f32_16x16x32_bf16 v[140:143], v[244:247], a[52:55], v[140:143]
    s_and_b32 s96, s96, 7
    ds_read_b64_tr_b16 v[232:233], v1 offset:32768
    v_mfma_f32_16x16x32_bf16 v[140:143], v[240:243], a[36:39], v[140:143]
    s_mul_i32 s97, s96, 229376
    ds_read_b64_tr_b16 v[234:235], v1 offset:33792
    v_mfma_f32_16x16x32_bf16 v[144:147], v[240:243], a[40:43], v[144:147]
    s_add_u32 m0, s76, 0
    ds_read_b64_tr_b16 v[236:237], v1 offset:40960
    v_mfma_f32_16x16x32_bf16 v[144:147], v[244:247], a[56:59], v[144:147]
    buffer_load_dwordx4 v25, s[20:23], s97 offen lds
    v_mfma_f32_16x16x32_bf16 v[148:151], v[244:247], a[60:63], v[148:151]
    s_waitcnt lgkmcnt(3)
    ds_read_b64_tr_b16 v[238:239], v1 offset:41984
    v_mfma_f32_16x16x32_bf16 v[148:151], v[240:243], a[44:47], v[148:151]
    v_mfma_f32_16x16x32_bf16 v[152:155], v[248:251], a[32:35], v[152:155]
    ds_read_b64_tr_b16 v[240:241], v2 offset:32768
    v_mfma_f32_16x16x32_bf16 v[152:155], v[252:255], a[48:51], v[152:155]
    v_mfma_f32_16x16x32_bf16 v[156:159], v[252:255], a[52:55], v[156:159]
    s_add_u32 s97, s97, 27648
    ds_read_b64_tr_b16 v[242:243], v2 offset:33792
    v_mfma_f32_16x16x32_bf16 v[156:159], v[248:251], a[36:39], v[156:159]
    buffer_load_dwordx4 v26, s[20:23], s97 offen offset:1024 lds
    v_mfma_f32_16x16x32_bf16 v[160:163], v[248:251], a[40:43], v[160:163]
    ds_read_b64_tr_b16 v[244:245], v2 offset:40960
    v_mfma_f32_16x16x32_bf16 v[160:163], v[252:255], a[56:59], v[160:163]
    v_mfma_f32_16x16x32_bf16 v[164:167], v[252:255], a[60:63], v[164:167]
    s_waitcnt lgkmcnt(3)
    ds_read_b64_tr_b16 v[246:247], v2 offset:41984
    v_mfma_f32_16x16x32_bf16 v[164:167], v[248:251], a[44:47], v[164:167]
    buffer_store_dwordx4 v[192:195], v17, s[36:39], s71 offen offset:2048 sc1
    v_mfma_f32_16x16x32_bf16 v[40:43], v[232:235], a[64:67], v[40:43]
    s_cmp_eq_u32 s68, 5
    s_cselect_b64 s[6:7], -1, 0
    ds_read_b64_tr_b16 v[248:249], v3 offset:32768
    v_mfma_f32_16x16x32_bf16 v[40:43], v[236:239], a[80:83], v[40:43]
    v_mfma_f32_16x16x32_bf16 v[44:47], v[236:239], a[84:87], v[44:47]
    s_add_u32 s97, s97, 27648
    ds_read_b64_tr_b16 v[250:251], v3 offset:33792
    v_mfma_f32_16x16x32_bf16 v[44:47], v[232:235], a[68:71], v[44:47]
    buffer_load_dwordx4 v25, s[20:23], s97 offen offset:2048 lds
    v_mfma_f32_16x16x32_bf16 v[48:51], v[232:235], a[72:75], v[48:51]
    ds_read_b64_tr_b16 v[252:253], v3 offset:40960
    v_mfma_f32_16x16x32_bf16 v[48:51], v[236:239], a[88:91], v[48:51]
    v_mfma_f32_16x16x32_bf16 v[52:55], v[236:239], a[92:95], v[52:55]
    s_waitcnt lgkmcnt(3)
    ds_read_b64_tr_b16 v[254:255], v3 offset:41984
    v_mfma_f32_16x16x32_bf16 v[52:55], v[232:235], a[76:79], v[52:55]
    v_mfma_f32_16x16x32_bf16 v[56:59], v[240:243], a[64:67], v[56:59]
    s_add_u32 s97, s97, 27648
    ds_read_b64_tr_b16 v[232:233], v4 offset:32768
    v_mfma_f32_16x16x32_bf16 v[56:59], v[244:247], a[80:83], v[56:59]
    buffer_load_dwordx4 v26, s[20:23], s97 offen offset:3072 lds
    v_mfma_f32_16x16x32_bf16 v[60:63], v[244:247], a[84:87], v[60:63]
    ds_read_b64_tr_b16 v[234:235], v4 offset:33792
    v_mfma_f32_16x16x32_bf16 v[60:63], v[240:243], a[68:71], v[60:63]
    v_mfma_f32_16x16x32_bf16 v[64:67], v[240:243], a[72:75], v[64:67]
    ds_read_b64_tr_b16 v[236:237], v4 offset:40960
    v_mfma_f32_16x16x32_bf16 v[64:67], v[244:247], a[88:91], v[64:67]
    v_mfma_f32_16x16x32_bf16 v[68:71], v[244:247], a[92:95], v[68:71]
    s_waitcnt lgkmcnt(3)
    ds_read_b64_tr_b16 v[238:239], v4 offset:41984
    v_mfma_f32_16x16x32_bf16 v[68:71], v[240:243], a[76:79], v[68:71]
    v_mfma_f32_16x16x32_bf16 v[72:75], v[248:251], a[64:67], v[72:75]
    s_add_u32 s96, s96, 2
    ds_read_b64_tr_b16 v[240:241], v5 offset:32768
    v_mfma_f32_16x16x32_bf16 v[72:75], v[252:255], a[80:83], v[72:75]
    buffer_store_dwordx4 v[196:199], v17, s[36:39], s71 offen offset:3072 sc1
    v_mfma_f32_16x16x32_bf16 v[76:79], v[252:255], a[84:87], v[76:79]
    s_and_b32 s96, s96, 7
    ds_read_b64_tr_b16 v[242:243], v5 offset:33792
    v_mfma_f32_16x16x32_bf16 v[76:79], v[248:251], a[68:71], v[76:79]
    s_waitcnt vmcnt(16)
    ds_read_b128 a[128:131], v9
    v_mfma_f32_16x16x32_bf16 v[80:83], v[248:251], a[72:75], v[80:83]
    s_mul_i32 s97, s96, 229376
    ds_read_b64_tr_b16 v[244:245], v5 offset:40960
    v_mfma_f32_16x16x32_bf16 v[80:83], v[252:255], a[88:91], v[80:83]
    s_add_u32 m0, s76, 16384
    ds_read_b128 a[144:147], v10
    v_mfma_f32_16x16x32_bf16 v[84:87], v[252:255], a[92:95], v[84:87]
    s_waitcnt lgkmcnt(5)
    ds_read_b64_tr_b16 v[246:247], v5 offset:41984
    v_mfma_f32_16x16x32_bf16 v[84:87], v[248:251], a[76:79], v[84:87]
    buffer_load_dwordx4 v25, s[20:23], s97 offen lds
    v_mfma_f32_16x16x32_bf16 v[88:91], v[232:235], a[64:67], v[88:91]
    s_add_u32 s97, s97, 27648
    ds_read_b64_tr_b16 v[248:249], v6 offset:32768
    v_mfma_f32_16x16x32_bf16 v[88:91], v[236:239], a[80:83], v[88:91]
    buffer_load_dwordx4 v26, s[20:23], s97 offen offset:1024 lds
    v_mfma_f32_16x16x32_bf16 v[92:95], v[236:239], a[84:87], v[92:95]
    ds_read_b64_tr_b16 v[250:251], v6 offset:33792
    v_mfma_f32_16x16x32_bf16 v[92:95], v[232:235], a[68:71], v[92:95]
    v_mfma_f32_16x16x32_bf16 v[96:99], v[232:235], a[72:75], v[96:99]
    ds_read_b64_tr_b16 v[252:253], v6 offset:40960
    v_mfma_f32_16x16x32_bf16 v[96:99], v[236:239], a[88:91], v[96:99]
    v_mfma_f32_16x16x32_bf16 v[100:103], v[236:239], a[92:95], v[100:103]
    s_waitcnt lgkmcnt(3)
    ds_read_b64_tr_b16 v[254:255], v6 offset:41984
    v_mfma_f32_16x16x32_bf16 v[100:103], v[232:235], a[76:79], v[100:103]
    v_mfma_f32_16x16x32_bf16 v[104:107], v[240:243], a[64:67], v[104:107]
    s_add_u32 s97, s97, 27648
    ds_read_b64_tr_b16 v[232:233], v7 offset:32768
    v_mfma_f32_16x16x32_bf16 v[104:107], v[244:247], a[80:83], v[104:107]
    buffer_load_dwordx4 v25, s[20:23], s97 offen offset:2048 lds
    v_mfma_f32_16x16x32_bf16 v[108:111], v[244:247], a[84:87], v[108:111]
    s_add_u32 s71, s80, 24576
    ds_read_b64_tr_b16 v[234:235], v7 offset:33792
    v_mfma_f32_16x16x32_bf16 v[108:111], v[240:243], a[68:71], v[108:111]
    buffer_store_dwordx4 v[200:203], v17, s[36:39], s71 offen sc1
    v_mfma_f32_16x16x32_bf16 v[112:115], v[240:243], a[72:75], v[112:115]
    ds_read_b64_tr_b16 v[236:237], v7 offset:40960
    v_mfma_f32_16x16x32_bf16 v[112:115], v[244:247], a[88:91], v[112:115]
    s_waitcnt vmcnt(18)
    ds_read_b128 a[132:135], v9 offset:2048
    v_mfma_f32_16x16x32_bf16 v[116:119], v[244:247], a[92:95], v[116:119]
    s_waitcnt lgkmcnt(4)
    ds_read_b64_tr_b16 v[238:239], v7 offset:41984
    v_mfma_f32_16x16x32_bf16 v[116:119], v[240:243], a[76:79], v[116:119]
    ds_read_b128 a[148:151], v10 offset:2048
    v_mfma_f32_16x16x32_bf16 v[120:123], v[248:251], a[64:67], v[120:123]
    s_add_u32 s97, s97, 27648
    ds_read_b64_tr_b16 v[240:241], v8 offset:32768
    v_mfma_f32_16x16x32_bf16 v[120:123], v[252:255], a[80:83], v[120:123]
    buffer_load_dwordx4 v26, s[20:23], s97 offen offset:3072 lds
    v_mfma_f32_16x16x32_bf16 v[124:127], v[252:255], a[84:87], v[124:127]
    ds_read_b64_tr_b16 v[242:243], v8 offset:33792
    v_mfma_f32_16x16x32_bf16 v[124:127], v[248:251], a[68:71], v[124:127]
    v_mfma_f32_16x16x32_bf16 v[128:131], v[248:251], a[72:75], v[128:131]
    ds_read_b64_tr_b16 v[244:245], v8 offset:40960
    v_mfma_f32_16x16x32_bf16 v[128:131], v[252:255], a[88:91], v[128:131]
    v_mfma_f32_16x16x32_bf16 v[132:135], v[252:255], a[92:95], v[132:135]
    s_waitcnt lgkmcnt(4)
    ds_read_b64_tr_b16 v[246:247], v8 offset:41984
    v_mfma_f32_16x16x32_bf16 v[132:135], v[248:251], a[76:79], v[132:135]
    v_mfma_f32_16x16x32_bf16 v[136:139], v[232:235], a[64:67], v[136:139]
    s_add_u32 s81, s81, 128
    ds_read_b64_tr_b16 v[248:249], v1 offset:49152
    v_mfma_f32_16x16x32_bf16 v[136:139], v[236:239], a[80:83], v[136:139]
    s_waitcnt vmcnt(16)
    ds_read_b128 a[136:139], v9 offset:4096
    v_mfma_f32_16x16x32_bf16 v[140:143], v[236:239], a[84:87], v[140:143]
    s_and_b32 s81, s81, 1023
    ds_read_b64_tr_b16 v[250:251], v1 offset:50176
    v_mfma_f32_16x16x32_bf16 v[140:143], v[232:235], a[68:71], v[140:143]
    s_add_u32 m0, s77, 8192
    ds_read_b128 a[152:155], v10 offset:4096
    v_mfma_f32_16x16x32_bf16 v[144:147], v[232:235], a[72:75], v[144:147]
    s_add_u32 s79, s72, s81
    ds_read_b64_tr_b16 v[252:253], v1 offset:57344
    v_mfma_f32_16x16x32_bf16 v[144:147], v[236:239], a[88:91], v[144:147]
    buffer_store_dwordx4 v[204:207], v17, s[36:39], s71 offen offset:1024 sc1
    v_mfma_f32_16x16x32_bf16 v[148:151], v[236:239], a[92:95], v[148:151]
    s_waitcnt lgkmcnt(5)
    ds_read_b64_tr_b16 v[254:255], v1 offset:58368
    v_mfma_f32_16x16x32_bf16 v[148:151], v[232:235], a[76:79], v[148:151]
    buffer_load_dwordx4 v15, s[8:11], s79 offen lds
    v_mfma_f32_16x16x32_bf16 v[152:155], v[240:243], a[64:67], v[152:155]
    ds_read_b64_tr_b16 v[232:233], v2 offset:49152
    v_mfma_f32_16x16x32_bf16 v[152:155], v[244:247], a[80:83], v[152:155]
    buffer_load_dwordx4 v16, s[8:11], s79 offen offset:1024 lds
    v_mfma_f32_16x16x32_bf16 v[156:159], v[244:247], a[84:87], v[156:159]
    ds_read_b64_tr_b16 v[234:235], v2 offset:50176
    v_mfma_f32_16x16x32_bf16 v[156:159], v[240:243], a[68:71], v[156:159]
    v_mfma_f32_16x16x32_bf16 v[160:163], v[240:243], a[72:75], v[160:163]
    ds_read_b64_tr_b16 v[236:237], v2 offset:57344
    v_mfma_f32_16x16x32_bf16 v[160:163], v[244:247], a[88:91], v[160:163]
L_hop5:
    s_cbranch_execz L_hop_ret
    v_mfma_f32_16x16x32_bf16 v[164:167], v[244:247], a[92:95], v[164:167]
    s_waitcnt lgkmcnt(3)
    ds_read_b64_tr_b16 v[238:239], v2 offset:58368
    v_mfma_f32_16x16x32_bf16 v[164:167], v[240:243], a[76:79], v[164:167]
    s_waitcnt vmcnt(16)
    ds_read_b128 a[140:143], v9 offset:6144
    v_mfma_f32_16x16x32_bf16 v[40:43], v[248:251], a[96:99], v[40:43]
    ds_read_b64_tr_b16 v[240:241], v3 offset:49152
    v_mfma_f32_16x16x32_bf16 v[40:43], v[252:255], a[112:115], v[40:43]
    s_add_u32 m0, s77, 10240
    ds_read_b128 a[156:159], v10 offset:6144
    v_mfma_f32_16x16x32_bf16 v[44:47], v[252:255], a[116:119], v[44:47]
    s_add_u32 s79, s73, s81
    ds_read_b64_tr_b16 v[242:243], v3 offset:50176
    v_mfma_f32_16x16x32_bf16 v[44:47], v[248:251], a[100:103], v[44:47]
    buffer_load_dwordx4 v15, s[8:11], s79 offen lds
    v_mfma_f32_16x16x32_bf16 v[48:51], v[248:251], a[104:107], v[48:51]
    ds_read_b64_tr_b16 v[244:245], v3 offset:57344
    v_mfma_f32_16x16x32_bf16 v[48:51], v[252:255], a[120:123], v[48:51]
    v_mfma_f32_16x16x32_bf16 v[52:55], v[252:255], a[124:127], v[52:55]
    s_waitcnt lgkmcnt(5)
    ds_read_b64_tr_b16 v[246:247], v3 offset:58368
    v_mfma_f32_16x16x32_bf16 v[52:55], v[248:251], a[108:111], v[52:55]
    buffer_store_dwordx4 v[208:211], v17, s[36:39], s71 offen offset:2048 sc1
    v_mfma_f32_16x16x32_bf16 v[56:59], v[232:235], a[96:99], v[56:59]
    ds_read_b64_tr_b16 v[248:249], v4 offset:49152
    v_mfma_f32_16x16x32_bf16 v[56:59], v[236:239], a[112:115], v[56:59]
    buffer_load_dwordx4 v16, s[8:11], s79 offen offset:1024 lds
    v_mfma_f32_16x16x32_bf16 v[60:63], v[236:239], a[116:119], v[60:63]
    ds_read_b64_tr_b16 v[250:251], v4 offset:50176
    v_mfma_f32_16x16x32_bf16 v[60:63], v[232:235], a[100:103], v[60:63]
    v_mfma_f32_16x16x32_bf16 v[64:67], v[232:235], a[104:107], v[64:67]
    s_add_u32 m0, s77, 12288
    ds_read_b64_tr_b16 v[252:253], v4 offset:57344
    v_mfma_f32_16x16x32_bf16 v[64:67], v[236:239], a[120:123], v[64:67]
    s_add_u32 s79, s74, s81
    v_mfma_f32_16x16x32_bf16 v[68:71], v[236:239], a[124:127], v[68:71]
    s_waitcnt lgkmcnt(3)
    ds_read_b64_tr_b16 v[254:255], v4 offset:58368
    v_mfma_f32_16x16x32_bf16 v[68:71], v[232:235], a[108:111], v[68:71]
    buffer_load_dwordx4 v15, s[8:11], s79 offen lds
    v_mfma_f32_16x16x32_bf16 v[72:75], v[240:243], a[96:99], v[72:75]
    ds_read_b64_tr_b16 v[232:233], v5 offset:49152
    v_mfma_f32_16x16x32_bf16 v[72:75], v[244:247], a[112:115], v[72:75]
    v_mfma_f32_16x16x32_bf16 v[76:79], v[244:247], a[116:119], v[76:79]
    ds_read_b64_tr_b16 v[234:235], v5 offset:50176
    v_mfma_f32_16x16x32_bf16 v[76:79], v[240:243], a[100:103], v[76:79]
    v_mfma_f32_16x16x32_bf16 v[80:83], v[240:243], a[104:107], v[80:83]
    ds_read_b64_tr_b16 v[236:237], v5 offset:57344
    v_mfma_f32_16x16x32_bf16 v[80:83], v[244:247], a[120:123], v[80:83]
    v_mfma_f32_16x16x32_bf16 v[84:87], v[244:247], a[124:127], v[84:87]
    s_waitcnt lgkmcnt(3)
    ds_read_b64_tr_b16 v[238:239], v5 offset:58368
    v_mfma_f32_16x16x32_bf16 v[84:87], v[240:243], a[108:111], v[84:87]
    buffer_load_dwordx4 v16, s[8:11], s79 offen offset:1024 lds
    v_mfma_f32_16x16x32_bf16 v[88:91], v[248:251], a[96:99], v[88:91]
    ds_read_b64_tr_b16 v[240:241], v6 offset:49152
    v_mfma_f32_16x16x32_bf16 v[88:91], v[252:255], a[112:115], v[88:91]
    buffer_store_dwordx4 v[212:215], v17, s[36:39], s71 offen offset:3072 sc1
    v_mfma_f32_16x16x32_bf16 v[92:95], v[252:255], a[116:119], v[92:95]
    ds_read_b64_tr_b16 v[242:243], v6 offset:50176
    v_mfma_f32_16x16x32_bf16 v[92:95], v[248:251], a[100:103], v[92:95]
    s_add_u32 m0, s77, 14336
    v_mfma_f32_16x16x32_bf16 v[96:99], v[248:251], a[104:107], v[96:99]
    s_add_u32 s79, s75, s81
    ds_read_b64_tr_b16 v[244:245], v6 offset:57344
    v_mfma_f32_16x16x32_bf16 v[96:99], v[252:255], a[120:123], v[96:99]
    buffer_load_dwordx4 v15, s[8:11], s79 offen lds
    v_mfma_f32_16x16x32_bf16 v[100:103], v[252:255], a[124:127], v[100:103]
    s_waitcnt lgkmcnt(3)
    ds_read_b64_tr_b16 v[246:247], v6 offset:58368
    v_mfma_f32_16x16x32_bf16 v[100:103], v[248:251], a[108:111], v[100:103]
    v_mfma_f32_16x16x32_bf16 v[104:107], v[232:235], a[96:99], v[104:107]
    ds_read_b64_tr_b16 v[248:249], v7 offset:49152
    v_mfma_f32_16x16x32_bf16 v[104:107], v[236:239], a[112:115], v[104:107]
    v_mfma_f32_16x16x32_bf16 v[108:111], v[236:239], a[116:119], v[108:111]
    ds_read_b64_tr_b16 v[250:251], v7 offset:50176
    v_mfma_f32_16x16x32_bf16 v[108:111], v[232:235], a[100:103], v[108:111]
    v_mfma_f32_16x16x32_bf16 v[112:115], v[232:235], a[104:107], v[112:115]
    ds_read_b64_tr_b16 v[252:253], v7 offset:57344
    v_mfma_f32_16x16x32_bf16 v[112:115], v[236:239], a[120:123], v[112:115]
    buffer_load_dwordx4 v16, s[8:11], s79 offen offset:1024 lds
    v_mfma_f32_16x16x32_bf16 v[116:119], v[236:239], a[124:127], v[116:119]
    s_waitcnt lgkmcnt(3)
    ds_read_b64_tr_b16 v[254:255], v7 offset:58368
    v_mfma_f32_16x16x32_bf16 v[116:119], v[232:235], a[108:111], v[116:119]
    v_mfma_f32_16x16x32_bf16 v[120:123], v[240:243], a[96:99], v[120:123]
    ds_read_b64_tr_b16 v[232:233], v8 offset:49152
    v_mfma_f32_16x16x32_bf16 v[120:123], v[244:247], a[112:115], v[120:123]
    ds_read_b64_tr_b16 v[234:235], v8 offset:50176
    v_mfma_f32_16x16x32_bf16 v[124:127], v[244:247], a[116:119], v[124:127]
    ds_read_b64_tr_b16 v[236:237], v8 offset:57344
    v_mfma_f32_16x16x32_bf16 v[124:127], v[240:243], a[100:103], v[124:127]
    s_add_u32 s71, s80, 28672
    ds_read_b64_tr_b16 v[238:239], v8 offset:58368
    v_mfma_f32_16x16x32_bf16 v[128:131], v[240:243], a[104:107], v[128:131]
    buffer_store_dwordx4 v[216:219], v17, s[36:39], s71 offen sc1
    v_mfma_f32_16x16x32_bf16 v[128:131], v[244:247], a[120:123], v[128:131]
    v_mfma_f32_16x16x32_bf16 v[132:135], v[244:247], a[124:127], v[132:135]
    s_waitcnt lgkmcnt(4)
    s_waitcnt vmcnt(12)
    s_mov_b64 exec, s[6:7]
    ds_write_b16 v22, v18
    ds_write_b16 v22, v19 offset:16384
    s_mov_b64 exec, -1
    v_mfma_f32_16x16x32_bf16 v[132:135], v[240:243], a[108:111], v[132:135]
    s_add_u32 s96, s96, 2
    v_mfma_f32_16x16x32_bf16 v[136:139], v[248:251], a[96:99], v[136:139]
    v_mfma_f32_16x16x32_bf16 v[136:139], v[252:255], a[112:115], v[136:139]
    s_waitcnt lgkmcnt(0)
    s_barrier
    v_mfma_f32_16x16x32_bf16 v[140:143], v[252:255], a[116:119], v[140:143]
    s_and_b32 s96, s96, 7
    ds_read_b64_tr_b16 v[240:241], v23
    v_mfma_f32_16x16x32_bf16 v[140:143], v[248:251], a[100:103], v[140:143]
    s_mul_i32 s97, s96, 229376
    ds_read_b64_tr_b16 v[242:243], v23 offset:512
    v_mfma_f32_16x16x32_bf16 v[144:147], v[248:251], a[104:107], v[144:147]
    s_add_u32 m0, s76, 32768
    ds_read_b64_tr_b16 v[244:245], v23 offset:4096
    v_mfma_f32_16x16x32_bf16 v[144:147], v[252:255], a[120:123], v[144:147]
    buffer_load_dwordx4 v25, s[20:23], s97 offen lds
    v_mfma_f32_16x16x32_bf16 v[148:151], v[252:255], a[124:127], v[148:151]
    ds_read_b64_tr_b16 v[246:247], v23 offset:4608
    v_mfma_f32_16x16x32_bf16 v[148:151], v[248:251], a[108:111], v[148:151]
    v_mfma_f32_16x16x32_bf16 v[152:155], v[232:235], a[96:99], v[152:155]
    s_add_u32 s97, s97, 27648
    ds_read_b64_tr_b16 v[248:249], v23 offset:8192
    v_mfma_f32_16x16x32_bf16 v[152:155], v[236:239], a[112:115], v[152:155]
    buffer_load_dwordx4 v26, s[20:23], s97 offen offset:1024 lds
    v_mfma_f32_16x16x32_bf16 v[156:159], v[236:239], a[116:119], v[156:159]
    ds_read_b64_tr_b16 v[250:251], v23 offset:8704
    v_mfma_f32_16x16x32_bf16 v[156:159], v[232:235], a[100:103], v[156:159]
    buffer_store_dwordx4 v[220:223], v17, s[36:39], s71 offen offset:1024 sc1
    v_mfma_f32_16x16x32_bf16 v[160:163], v[232:235], a[104:107], v[160:163]
    s_add_u32 s97, s97, 27648
    ds_read_b64_tr_b16 v[252:253], v23 offset:12288
    v_mfma_f32_16x16x32_bf16 v[160:163], v[236:239], a[120:123], v[160:163]
    buffer_load_dwordx4 v25, s[20:23], s97 offen offset:2048 lds
    v_mfma_f32_16x16x32_bf16 v[164:167], v[236:239], a[124:127], v[164:167]
    s_waitcnt lgkmcnt(3)
    ds_read_b64_tr_b16 v[254:255], v23 offset:12800
    v_mfma_f32_16x16x32_bf16 v[164:167], v[232:235], a[108:111], v[164:167]
    v_mfma_f32_16x16x32_bf16 v[168:171], v[240:243], a[0:3], 0
    ds_read_b64_tr_b16 v[232:233], v24
    v_mfma_f32_16x16x32_bf16 v[168:171], v[244:247], a[16:19], v[168:171]
    v_mfma_f32_16x16x32_bf16 v[172:175], v[244:247], a[20:23], 0
    s_add_u32 s97, s97, 27648
    ds_read_b64_tr_b16 v[234:235], v24 offset:512
    v_mfma_f32_16x16x32_bf16 v[172:175], v[240:243], a[4:7], v[172:175]
    buffer_load_dwordx4 v26, s[20:23], s97 offen offset:3072 lds
    v_mfma_f32_16x16x32_bf16 v[176:179], v[240:243], a[8:11], 0
    s_add_u32 s96, s96, 2
    ds_read_b64_tr_b16 v[236:237], v24 offset:4096
    v_mfma_f32_16x16x32_bf16 v[176:179], v[244:247], a[24:27], v[176:179]
    s_and_b32 s96, s96, 7
    s_mul_i32 s97, s96, 229376
    v_mfma_f32_16x16x32_bf16 v[180:183], v[244:247], a[28:31], 0
    s_waitcnt lgkmcnt(3)
    s_add_u32 m0, s76, 49152
    ds_read_b64_tr_b16 v[238:239], v24 offset:4608
    v_mfma_f32_16x16x32_bf16 v[180:183], v[240:243], a[12:15], v[180:183]
    buffer_load_dwordx4 v25, s[20:23], s97 offen lds
    v_mfma_f32_16x16x32_bf16 v[168:171], v[248:251], a[32:35], v[168:171]
    ds_read_b64_tr_b16 v[240:241], v24 offset:8192
    v_mfma_f32_16x16x32_bf16 v[168:171], v[252:255], a[48:51], v[168:171]
    v_mfma_f32_16x16x32_bf16 v[172:175], v[252:255], a[52:55], v[172:175]
    ds_read_b64_tr_b16 v[242:243], v24 offset:8704
    v_mfma_f32_16x16x32_bf16 v[172:175], v[248:251], a[36:39], v[172:175]
    v_mfma_f32_16x16x32_bf16 v[176:179], v[248:251], a[40:43], v[176:179]
    s_add_u32 s97, s97, 27648
    ds_read_b64_tr_b16 v[244:245], v24 offset:12288
    v_mfma_f32_16x16x32_bf16 v[176:179], v[252:255], a[56:59], v[176:179]
    buffer_store_dwordx4 v[224:227], v17, s[36:39], s71 offen offset:2048 sc1
    v_mfma_f32_16x16x32_bf16 v[180:183], v[252:255], a[60:63], v[180:183]
    s_waitcnt lgkmcnt(3)
    ds_read_b64_tr_b16 v[246:247], v24 offset:12800
    v_mfma_f32_16x16x32_bf16 v[180:183], v[248:251], a[44:47], v[180:183]
    buffer_load_dwordx4 v26, s[20:23], s97 offen offset:1024 lds
    v_mfma_f32_16x16x32_bf16 v[184:187], v[232:235], a[0:3], 0
    s_add_u32 s97, s97, 27648
    ds_read_b64_tr_b16 v[248:249], v28
    v_mfma_f32_16x16x32_bf16 v[184:187], v[236:239], a[16:19], v[184:187]
    buffer_load_dwordx4 v25, s[20:23], s97 offen offset:2048 lds
    v_mfma_f32_16x16x32_bf16 v[188:191], v[236:239], a[20:23], 0
    ds_read_b64_tr_b16 v[250:251], v28 offset:512
    v_mfma_f32_16x16x32_bf16 v[188:191], v[232:235], a[4:7], v[188:191]
    s_waitcnt vmcnt(18)
    ds_read_b128 a[160:163], v9 offset:8192
    v_mfma_f32_16x16x32_bf16 v[192:195], v[232:235], a[8:11], 0
    ds_read_b64_tr_b16 v[252:253], v28 offset:4096
    v_mfma_f32_16x16x32_bf16 v[192:195], v[236:239], a[24:27], v[192:195]
    s_add_u32 s97, s97, 27648
    ds_read_b128 a[176:179], v10 offset:8192
    v_mfma_f32_16x16x32_bf16 v[196:199], v[236:239], a[28:31], 0
    s_waitcnt lgkmcnt(5)
    ds_read_b64_tr_b16 v[254:255], v28 offset:4608
    v_mfma_f32_16x16x32_bf16 v[196:199], v[232:235], a[12:15], v[196:199]
    buffer_load_dwordx4 v26, s[20:23], s97 offen offset:3072 lds
    v_mfma_f32_16x16x32_bf16 v[184:187], v[240:243], a[32:35], v[184:187]
    s_add_u32 s81, s81, 128
    ds_read_b64_tr_b16 v[232:233], v28 offset:8192
    v_mfma_f32_16x16x32_bf16 v[184:187], v[244:247], a[48:51], v[184:187]
    s_and_b32 s81, s81, 1023
    v_mfma_f32_16x16x32_bf16 v[188:191], v[244:247], a[52:55], v[188:191]
    s_add_u32 m0, s77, 16384
    s_add_u32 s79, s72, s81
    ds_read_b64_tr_b16 v[234:235], v28 offset:8704
    v_mfma_f32_16x16x32_bf16 v[188:191], v[240:243], a[36:39], v[188:191]
    buffer_load_dwordx4 v15, s[8:11], s79 offen lds
    v_mfma_f32_16x16x32_bf16 v[192:195], v[240:243], a[40:43], v[192:195]
    ds_read_b64_tr_b16 v[236:237], v28 offset:12288
    v_mfma_f32_16x16x32_bf16 v[192:195], v[244:247], a[56:59], v[192:195]
    v_mfma_f32_16x16x32_bf16 v[196:199], v[244:247], a[60:63], v[196:199]
    s_waitcnt lgkmcnt(3)
    ds_read_b64_tr_b16 v[238:239], v28 offset:12800
    v_mfma_f32_16x16x32_bf16 v[196:199], v[240:243], a[44:47], v[196:199]
    buffer_store_dwordx4 v[228:231], v17, s[36:39], s71 offen offset:3072 sc1
    v_mfma_f32_16x16x32_bf16 v[200:203], v[248:251], a[0:3], 0
    ds_read_b64_tr_b16 v[240:241], v29
    v_mfma_f32_16x16x32_bf16 v[200:203], v[252:255], a[16:19], v[200:203]
    buffer_load_dwordx4 v16, s[8:11], s79 offen offset:1024 lds
    v_mfma_f32_16x16x32_bf16 v[204:207], v[252:255], a[20:23], 0
    ds_read_b64_tr_b16 v[242:243], v29 offset:512
    v_mfma_f32_16x16x32_bf16 v[204:207], v[248:251], a[4:7], v[204:207]
    s_waitcnt vmcnt(19)
    ds_read_b128 a[164:167], v9 offset:10240
    v_mfma_f32_16x16x32_bf16 v[208:211], v[248:251], a[8:11], 0
    s_add_u32 m0, s77, 18432
    ds_read_b64_tr_b16 v[244:245], v29 offset:4096
    v_mfma_f32_16x16x32_bf16 v[208:211], v[252:255], a[24:27], v[208:211]
    s_add_u32 s79, s73, s81
    ds_read_b128 a[180:183], v10 offset:10240
    v_mfma_f32_16x16x32_bf16 v[212:215], v[252:255], a[28:31], 0
    s_waitcnt lgkmcnt(5)
    ds_read_b64_tr_b16 v[246:247], v29 offset:4608
    v_mfma_f32_16x16x32_bf16 v[212:215], v[248:251], a[12:15], v[212:215]
    buffer_load_dwordx4 v15, s[8:11], s79 offen lds
    v_mfma_f32_16x16x32_bf16 v[200:203], v[232:235], a[32:35], v[200:203]
    ds_read_b64_tr_b16 v[248:249], v29 offset:8192
    v_mfma_f32_16x16x32_bf16 v[200:203], v[236:239], a[48:51], v[200:203]
    buffer_load_dwordx4 v16, s[8:11], s79 offen offset:1024 lds
    v_mfma_f32_16x16x32_bf16 v[204:207], v[236:239], a[52:55], v[204:207]
    ds_read_b64_tr_b16 v[250:251], v29 offset:8704
    v_mfma_f32_16x16x32_bf16 v[204:207], v[232:235], a[36:39], v[204:207]
    v_mfma_f32_16x16x32_bf16 v[208:211], v[232:235], a[40:43], v[208:211]
    s_add_u32 m0, s77, 20480
    ds_read_b64_tr_b16 v[252:253], v29 offset:12288
    v_mfma_f32_16x16x32_bf16 v[208:211], v[236:239], a[56:59], v[208:211]
    s_add_u32 s79, s74, s81
    v_mfma_f32_16x16x32_bf16 v[212:215], v[236:239], a[60:63], v[212:215]
    s_waitcnt lgkmcnt(3)
    ds_read_b64_tr_b16 v[254:255], v29 offset:12800
    v_mfma_f32_16x16x32_bf16 v[212:215], v[232:235], a[44:47], v[212:215]
    buffer_load_dwordx4 v15, s[8:11], s79 offen lds
    v_mfma_f32_16x16x32_bf16 v[216:219], v[240:243], a[0:3], 0
    ds_read_b64_tr_b16 v[232:233], v23 offset:16384
    v_mfma_f32_16x16x32_bf16 v[216:219], v[244:247], a[16:19], v[216:219]
    s_waitcnt vmcnt(20)
    ds_read_b128 a[168:171], v9 offset:12288
    v_mfma_f32_16x16x32_bf16 v[220:223], v[244:247], a[20:23], 0
    ds_read_b64_tr_b16 v[234:235], v23 offset:16896
    v_mfma_f32_16x16x32_bf16 v[220:223], v[240:243], a[4:7], v[220:223]
    ds_read_b128 a[184:187], v10 offset:12288
    v_mfma_f32_16x16x32_bf16 v[224:227], v[240:243], a[8:11], 0
    ds_read_b64_tr_b16 v[236:237], v23 offset:20480
    v_mfma_f32_16x16x32_bf16 v[224:227], v[244:247], a[24:27], v[224:227]
    buffer_load_dwordx4 v16, s[8:11], s79 offen offset:1024 lds
    v_mfma_f32_16x16x32_bf16 v[228:231], v[244:247], a[28:31], 0
    s_waitcnt lgkmcnt(5)
    s_add_u32 m0, s77, 22528
    s_add_u32 s79, s75, s81
    ds_read_b64_tr_b16 v[238:239], v23 offset:20992
    v_mfma_f32_16x16x32_bf16 v[228:231], v[240:243], a[12:15], v[228:231]
    buffer_load_dwordx4 v15, s[8:11], s79 offen lds
    v_mfma_f32_16x16x32_bf16 v[216:219], v[248:251], a[32:35], v[216:219]
    ds_read_b64_tr_b16 v[240:241], v23 offset:24576
    v_mov_b32 v35, 0x40000
    v_mfma_f32_16x16x32_bf16 v[216:219], v[252:255], a[48:51], v[216:219]
    v_mfma_f32_16x16x32_bf16 v[220:223], v[252:255], a[52:55], v[220:223]
    ds_read_b64_tr_b16 v[242:243], v23 offset:25088
    v_mfma_f32_16x16x32_bf16 v[220:223], v[248:251], a[36:39], v[220:223]
    v_mfma_f32_16x16x32_bf16 v[224:227], v[248:251], a[40:43], v[224:227]
    ds_read_b64_tr_b16 v[244:245], v23 offset:28672
    v_mfma_f32_16x16x32_bf16 v[224:227], v[252:255], a[56:59], v[224:227]
    buffer_load_dwordx4 v16, s[8:11], s79 offen offset:1024 lds
    v_mfma_f32_16x16x32_bf16 v[228:231], v[252:255], a[60:63], v[228:231]
    s_waitcnt lgkmcnt(3)
    ds_read_b64_tr_b16 v[246:247], v23 offset:29184
    v_mfma_f32_16x16x32_bf16 v[228:231], v[248:251], a[44:47], v[228:231]
    s_waitcnt vmcnt(20)
    ds_read_b128 a[172:175], v9 offset:14336
    v_mfma_f32_16x16x32_bf16 v[168:171], v[232:235], a[64:67], v[168:171]
    s_add_u32 s81, s81, 128
    ds_read_b64_tr_b16 v[248:249], v24 offset:16384
    v_mfma_f32_16x16x32_bf16 v[168:171], v[236:239], a[80:83], v[168:171]
    s_and_b32 s81, s81, 1023
    ds_read_b128 a[188:191], v10 offset:14336
    v_mfma_f32_16x16x32_bf16 v[172:175], v[236:239], a[84:87], v[172:175]
    s_add_u32 m0, s77, 0
    s_add_u32 s79, s72, s81
    ds_read_b64_tr_b16 v[250:251], v24 offset:16896
    v_mfma_f32_16x16x32_bf16 v[172:175], v[232:235], a[68:71], v[172:175]
    buffer_load_dwordx4 v15, s[8:11], s79 offen lds
    v_mfma_f32_16x16x32_bf16 v[176:179], v[232:235], a[72:75], v[176:179]
    ds_read_b64_tr_b16 v[252:253], v24 offset:20480
    v_mfma_f32_16x16x32_bf16 v[176:179], v[236:239], a[88:91], v[176:179]
    ds_read_b128 a[0:3], v35
    v_mfma_f32_16x16x32_bf16 v[180:183], v[236:239], a[92:95], v[180:183]
    s_waitcnt lgkmcnt(6)
    ds_read_b64_tr_b16 v[254:255], v24 offset:20992
    v_mfma_f32_16x16x32_bf16 v[180:183], v[232:235], a[76:79], v[180:183]
    buffer_load_dwordx4 v16, s[8:11], s79 offen offset:1024 lds
    v_mfma_f32_16x16x32_bf16 v[168:171], v[240:243], a[96:99], v[168:171]
    ds_read_b64_tr_b16 v[232:233], v24 offset:24576
    v_mfma_f32_16x16x32_bf16 v[168:171], v[244:247], a[112:115], v[168:171]
    s_bfe_u32 s70, s80, 0x6000d
    v_mfma_f32_16x16x32_bf16 v[172:175], v[244:247], a[116:119], v[172:175]
    s_add_u32 s70, s70, s0
    ds_read_b64_tr_b16 v[234:235], v24 offset:25088
    v_mfma_f32_16x16x32_bf16 v[172:175], v[240:243], a[100:103], v[172:175]
    s_lshr_b32 s69, s65, 2
    v_mfma_f32_16x16x32_bf16 v[176:179], v[240:243], a[104:107], v[176:179]
    s_mul_i32 s69, s69, 4224
    ds_read_b64_tr_b16 v[236:237], v24 offset:28672
    v_mfma_f32_16x16x32_bf16 v[176:179], v[244:247], a[120:123], v[176:179]
    s_add_u32 s70, s70, s69
    v_mfma_f32_16x16x32_bf16 v[180:183], v[244:247], a[124:127], v[180:183]
    s_waitcnt lgkmcnt(3)
    ds_read_b64_tr_b16 v[238:239], v24 offset:29184
    v_mfma_f32_16x16x32_bf16 v[180:183], v[240:243], a[108:111], v[180:183]
    s_waitcnt vmcnt(9)
    v_mfma_f32_16x16x32_bf16 v[184:187], v[248:251], a[64:67], v[184:187]
    s_add_u32 m0, s77, 2048
    ds_read_b64_tr_b16 v[240:241], v28 offset:16384
    v_mfma_f32_16x16x32_bf16 v[184:187], v[252:255], a[80:83], v[184:187]
    buffer_store_dword v31, v27, s[60:63], s70 offen sc1
    v_mfma_f32_16x16x32_bf16 v[188:191], v[252:255], a[84:87], v[188:191]
    s_add_u32 s79, s73, s81
    ds_read_b64_tr_b16 v[242:243], v28 offset:16896
    v_mfma_f32_16x16x32_bf16 v[188:191], v[248:251], a[68:71], v[188:191]
    buffer_load_dwordx4 v15, s[8:11], s79 offen lds
    v_mfma_f32_16x16x32_bf16 v[192:195], v[248:251], a[72:75], v[192:195]
    ds_read_b64_tr_b16 v[244:245], v28 offset:20480
    v_mfma_f32_16x16x32_bf16 v[192:195], v[252:255], a[88:91], v[192:195]
    buffer_load_dwordx4 v16, s[8:11], s79 offen offset:1024 lds
    v_mfma_f32_16x16x32_bf16 v[196:199], v[252:255], a[92:95], v[196:199]
    s_waitcnt lgkmcnt(3)
    s_add_u32 m0, s77, 4096
    s_add_u32 s79, s74, s81
    ds_read_b64_tr_b16 v[246:247], v28 offset:20992
    v_mfma_f32_16x16x32_bf16 v[196:199], v[248:251], a[76:79], v[196:199]
    buffer_load_dwordx4 v15, s[8:11], s79 offen lds
    v_mfma_f32_16x16x32_bf16 v[184:187], v[232:235], a[96:99], v[184:187]
    ds_read_b64_tr_b16 v[248:249], v28 offset:24576
    v_mfma_f32_16x16x32_bf16 v[184:187], v[236:239], a[112:115], v[184:187]
    ds_read_b128 a[4:7], v35
    v_mfma_f32_16x16x32_bf16 v[188:191], v[236:239], a[116:119], v[188:191]
    ds_read_b64_tr_b16 v[250:251], v28 offset:25088
    v_mfma_f32_16x16x32_bf16 v[188:191], v[232:235], a[100:103], v[188:191]
    buffer_load_dwordx4 v16, s[8:11], s79 offen offset:1024 lds
    v_mfma_f32_16x16x32_bf16 v[192:195], v[232:235], a[104:107], v[192:195]
    s_add_u32 m0, s77, 6144
    ds_read_b64_tr_b16 v[252:253], v28 offset:28672
    v_mfma_f32_16x16x32_bf16 v[192:195], v[236:239], a[120:123], v[192:195]
    s_add_u32 s79, s75, s81
    v_mfma_f32_16x16x32_bf16 v[196:199], v[236:239], a[124:127], v[196:199]
    s_waitcnt lgkmcnt(4)
    ds_read_b64_tr_b16 v[254:255], v28 offset:29184
    v_mfma_f32_16x16x32_bf16 v[196:199], v[232:235], a[108:111], v[196:199]
    buffer_load_dwordx4 v15, s[8:11], s79 offen lds
    v_mfma_f32_16x16x32_bf16 v[200:203], v[240:243], a[64:67], v[200:203]
    ds_read_b64_tr_b16 v[232:233], v29 offset:16384
    v_mfma_f32_16x16x32_bf16 v[200:203], v[244:247], a[80:83], v[200:203]
    ds_read_b128 a[8:11], v35
    v_mfma_f32_16x16x32_bf16 v[204:207], v[244:247], a[84:87], v[204:207]
    ds_read_b64_tr_b16 v[234:235], v29 offset:16896
    v_mfma_f32_16x16x32_bf16 v[204:207], v[240:243], a[68:71], v[204:207]
    ds_read_b128 a[12:15], v35
    v_mfma_f32_16x16x32_bf16 v[208:211], v[240:243], a[72:75], v[208:211]
    ds_read_b64_tr_b16 v[236:237], v29 offset:20480
    v_mfma_f32_16x16x32_bf16 v[208:211], v[244:247], a[88:91], v[208:211]
    buffer_load_dwordx4 v16, s[8:11], s79 offen offset:1024 lds
    v_mfma_f32_16x16x32_bf16 v[212:215], v[244:247], a[92:95], v[212:215]
    s_waitcnt lgkmcnt(5)
    ds_read_b64_tr_b16 v[238:239], v29 offset:20992
    v_mfma_f32_16x16x32_bf16 v[212:215], v[240:243], a[76:79], v[212:215]
    ds_read_b128 a[16:19], v35
    v_mfma_f32_16x16x32_bf16 v[200:203], v[248:251], a[96:99], v[200:203]
    ds_read_b64_tr_b16 v[240:241], v29 offset:24576
    v_mfma_f32_16x16x32_bf16 v[200:203], v[252:255], a[112:115], v[200:203]
    ds_read_b64_tr_b16 v[242:243], v29 offset:25088
    v_mfma_f32_16x16x32_bf16 v[204:207], v[252:255], a[116:119], v[204:207]
    ds_read_b64_tr_b16 v[244:245], v29 offset:28672
    v_mfma_f32_16x16x32_bf16 v[204:207], v[248:251], a[100:103], v[204:207]
    ds_read_b64_tr_b16 v[246:247], v29 offset:29184
    v_mfma_f32_16x16x32_bf16 v[208:211], v[248:251], a[104:107], v[208:211]
    ds_read_b128 a[20:23], v35
    v_mfma_f32_16x16x32_bf16 v[208:211], v[252:255], a[120:123], v[208:211]
    ds_read_b128 a[24:27], v35
    v_mfma_f32_16x16x32_bf16 v[212:215], v[252:255], a[124:127], v[212:215]
    s_waitcnt lgkmcnt(7)
    s_mov_b64 exec, s[6:7]
    ds_write_b16 v22, v20 offset:32768
    ds_write_b16 v22, v21 offset:49152
    s_mov_b64 exec, -1
    v_mfma_f32_16x16x32_bf16 v[212:215], v[248:251], a[108:111], v[212:215]
    ds_read_b128 a[28:31], v35
    v_mfma_f32_16x16x32_bf16 v[216:219], v[232:235], a[64:67], v[216:219]
    v_mfma_f32_16x16x32_bf16 v[216:219], v[236:239], a[80:83], v[216:219]
    s_waitcnt lgkmcnt(0)
    s_barrier
    v_mfma_f32_16x16x32_bf16 v[220:223], v[236:239], a[84:87], v[220:223]
    s_add_u32 s78, s78, 524288
    ds_read_b64_tr_b16 v[248:249], v23 offset:32768
    v_mfma_f32_16x16x32_bf16 v[220:223], v[232:235], a[68:71], v[220:223]
    s_and_b32 s78, s78, 4194303
    ds_read_b64_tr_b16 v[250:251], v23 offset:33280
    v_mfma_f32_16x16x32_bf16 v[224:227], v[232:235], a[72:75], v[224:227]
    s_add_u32 m0, s76, 0
    ds_read_b64_tr_b16 v[252:253], v23 offset:36864
    v_mfma_f32_16x16x32_bf16 v[224:227], v[236:239], a[88:91], v[224:227]
    buffer_load_dwordx4 v11, s[24:27], s78 offen lds
    v_mfma_f32_16x16x32_bf16 v[228:231], v[236:239], a[92:95], v[228:231]
    ds_read_b64_tr_b16 v[254:255], v23 offset:37376
    v_mfma_f32_16x16x32_bf16 v[228:231], v[232:235], a[76:79], v[228:231]
    buffer_load_dwordx4 v12, s[24:27], s78 offen offset:1024 lds
    v_mfma_f32_16x16x32_bf16 v[216:219], v[240:243], a[96:99], v[216:219]
    ds_read_b64_tr_b16 v[232:233], v23 offset:40960
    v_mfma_f32_16x16x32_bf16 v[216:219], v[244:247], a[112:115], v[216:219]
    ds_read_b128 a[32:35], v35
    v_mfma_f32_16x16x32_bf16 v[220:223], v[244:247], a[116:119], v[220:223]
    ds_read_b64_tr_b16 v[234:235], v23 offset:41472
    v_mfma_f32_16x16x32_bf16 v[220:223], v[240:243], a[100:103], v[220:223]
    s_waitcnt vmcnt(17)
    ds_read_b128 a[192:195], v9 offset:16384
    v_mfma_f32_16x16x32_bf16 v[224:227], v[240:243], a[104:107], v[224:227]
    ds_read_b64_tr_b16 v[236:237], v23 offset:45056
    v_mfma_f32_16x16x32_bf16 v[224:227], v[244:247], a[120:123], v[224:227]
    ds_read_b128 a[208:211], v10 offset:16384
    v_mfma_f32_16x16x32_bf16 v[228:231], v[244:247], a[124:127], v[228:231]
    s_waitcnt lgkmcnt(6)
    ds_read_b64_tr_b16 v[238:239], v23 offset:45568
    v_mfma_f32_16x16x32_bf16 v[228:231], v[240:243], a[108:111], v[228:231]
    buffer_load_dwordx4 v13, s[24:27], s78 offen offset:2048 lds
    v_mfma_f32_16x16x32_bf16 v[168:171], v[248:251], a[128:131], v[168:171]
    s_mov_b32 s36, s28
    ds_read_b64_tr_b16 v[240:241], v24 offset:32768
    v_mov_b32 v18, -1
    v_mfma_f32_16x16x32_bf16 v[168:171], v[252:255], a[144:147], v[168:171]
    s_mov_b32 s37, s29
    v_mov_b32 v19, -1
    v_mov_b32 v20, -1
    v_mfma_f32_16x16x32_bf16 v[172:175], v[252:255], a[148:151], v[172:175]
    s_andn2_b32 s0, s64, 0
    ds_read_b64_tr_b16 v[242:243], v24 offset:33280
    v_mov_b32 v21, -1
    v_mfma_f32_16x16x32_bf16 v[172:175], v[248:251], a[132:135], v[172:175]
    s_mul_i32 s0, s0, 8448
    v_mfma_f32_16x16x32_bf16 v[176:179], v[248:251], a[136:139], v[176:179]
    s_xor_b32 s97, s68, 2
    ds_read_b64_tr_b16 v[244:245], v24 offset:36864
    v_mfma_f32_16x16x32_bf16 v[176:179], v[252:255], a[152:155], v[176:179]
    s_waitcnt vmcnt(16)
    ds_read_b128 a[196:199], v9 offset:18432
    v_mfma_f32_16x16x32_bf16 v[180:183], v[252:255], a[156:159], v[180:183]
    s_waitcnt lgkmcnt(4)
    ds_read_b64_tr_b16 v[246:247], v24 offset:37376
    v_mfma_f32_16x16x32_bf16 v[180:183], v[248:251], a[140:143], v[180:183]
    s_lshl_b32 s97, s97, 11
    ds_read_b128 a[212:215], v10 offset:18432
    v_mfma_f32_16x16x32_bf16 v[168:171], v[232:235], a[160:163], v[168:171]
    ds_read_b64_tr_b16 v[248:249], v24 offset:40960
    v_mfma_f32_16x16x32_bf16 v[168:171], v[236:239], a[176:179], v[168:171]
    buffer_load_dwordx4 v14, s[24:27], s78 offen offset:3072 lds
    v_mfma_f32_16x16x32_bf16 v[172:175], v[236:239], a[180:183], v[172:175]
    s_add_u32 s78, s78, 524288
    s_and_b32 s78, s78, 4194303
    s_add_u32 m0, s76, 16384
    ds_read_b64_tr_b16 v[250:251], v24 offset:41472
    v_mfma_f32_16x16x32_bf16 v[172:175], v[232:235], a[164:167], v[172:175]
    buffer_load_dwordx4 v11, s[24:27], s78 offen lds
    v_mfma_f32_16x16x32_bf16 v[176:179], v[232:235], a[168:171], v[176:179]
    ds_read_b64_tr_b16 v[252:253], v24 offset:45056
    v_mfma_f32_16x16x32_bf16 v[176:179], v[236:239], a[184:187], v[176:179]
    buffer_load_dwordx4 v12, s[24:27], s78 offen offset:1024 lds
    v_mfma_f32_16x16x32_bf16 v[180:183], v[236:239], a[188:191], v[180:183]
    s_waitcnt lgkmcnt(4)
    ds_read_b64_tr_b16 v[254:255], v24 offset:45568
    v_mfma_f32_16x16x32_bf16 v[180:183], v[232:235], a[172:175], v[180:183]
    s_waitcnt vmcnt(17)
    ds_read_b128 a[200:203], v9 offset:20480
    v_mfma_f32_16x16x32_bf16 v[184:187], v[240:243], a[128:131], v[184:187]
    ds_read_b64_tr_b16 v[232:233], v28 offset:32768
    v_mfma_f32_16x16x32_bf16 v[184:187], v[244:247], a[144:147], v[184:187]
    ds_read_b128 a[216:219], v10 offset:20480
    v_mfma_f32_16x16x32_bf16 v[188:191], v[244:247], a[148:151], v[188:191]
    ds_read_b64_tr_b16 v[234:235], v28 offset:33280
    v_mfma_f32_16x16x32_bf16 v[188:191], v[240:243], a[132:135], v[188:191]
    buffer_load_dwordx4 v13, s[24:27], s78 offen offset:2048 lds
    v_mfma_f32_16x16x32_bf16 v[192:195], v[240:243], a[136:139], v[192:195]
    ds_read_b64_tr_b16 v[236:237], v28 offset:36864
    v_mfma_f32_16x16x32_bf16 v[192:195], v[244:247], a[152:155], v[192:195]
    buffer_load_dwordx4 v14, s[24:27], s78 offen offset:3072 lds
    v_mfma_f32_16x16x32_bf16 v[196:199], v[244:247], a[156:159], v[196:199]
    s_waitcnt lgkmcnt(5)
    ds_read_b64_tr_b16 v[238:239], v28 offset:37376
    v_mfma_f32_16x16x32_bf16 v[196:199], v[240:243], a[140:143], v[196:199]
    s_waitcnt vmcnt(17)
    ds_read_b128 a[204:207], v9 offset:22528
    v_mfma_f32_16x16x32_bf16 v[184:187], v[248:251], a[160:163], v[184:187]
    ds_read_b64_tr_b16 v[240:241], v28 offset:40960
    v_mfma_f32_16x16x32_bf16 v[184:187], v[252:255], a[176:179], v[184:187]
    ds_read_b128 a[220:223], v10 offset:22528
    v_mfma_f32_16x16x32_bf16 v[188:191], v[252:255], a[180:183], v[188:191]
    ds_read_b64_tr_b16 v[242:243], v28 offset:41472
    v_mfma_f32_16x16x32_bf16 v[188:191], v[248:251], a[164:167], v[188:191]
    s_waitcnt vmcnt(15)
    ds_read_b128 a[224:227], v9
    v_mfma_f32_16x16x32_bf16 v[192:195], v[248:251], a[168:171], v[192:195]
    ds_read_b64_tr_b16 v[244:245], v28 offset:45056
    v_mfma_f32_16x16x32_bf16 v[192:195], v[252:255], a[184:187], v[192:195]
    ds_read_b128 a[240:243], v10
    v_mfma_f32_16x16x32_bf16 v[196:199], v[252:255], a[188:191], v[196:199]
    s_waitcnt lgkmcnt(7)
    ds_read_b64_tr_b16 v[246:247], v28 offset:45568
    v_mfma_f32_16x16x32_bf16 v[196:199], v[248:251], a[172:175], v[196:199]
    s_waitcnt vmcnt(12)
    ds_read_b128 a[228:231], v9 offset:2048
    v_mfma_f32_16x16x32_bf16 v[200:203], v[232:235], a[128:131], v[200:203]
    ds_read_b64_tr_b16 v[248:249], v29 offset:32768
    v_mfma_f32_16x16x32_bf16 v[200:203], v[236:239], a[144:147], v[200:203]
    ds_read_b128 a[244:247], v10 offset:2048
    v_mfma_f32_16x16x32_bf16 v[204:207], v[236:239], a[148:151], v[204:207]
    s_getpc_b64 s[100:101]
    ds_read_b64_tr_b16 v[250:251], v29 offset:33280
    v_mfma_f32_16x16x32_bf16 v[204:207], v[232:235], a[132:135], v[204:207]
    global_load_dword v37, v32, s[100:101]
    v_mfma_f32_16x16x32_bf16 v[208:211], v[232:235], a[136:139], v[208:211]
    ds_read_b64_tr_b16 v[252:253], v29 offset:36864
    v_mfma_f32_16x16x32_bf16 v[208:211], v[236:239], a[152:155], v[208:211]
    buffer_store_dwordx4 v[18:21], v17, s[52:55], s12 offen sc1
    v_mfma_f32_16x16x32_bf16 v[212:215], v[236:239], a[156:159], v[212:215]
    s_waitcnt lgkmcnt(5)
    ds_read_b64_tr_b16 v[254:255], v29 offset:37376
    v_mfma_f32_16x16x32_bf16 v[212:215], v[232:235], a[140:143], v[212:215]
    s_waitcnt vmcnt(12)
    ds_read_b128 a[232:235], v9 offset:4096
    v_mfma_f32_16x16x32_bf16 v[200:203], v[240:243], a[160:163], v[200:203]
    ds_read_b64_tr_b16 v[232:233], v29 offset:40960
    v_mfma_f32_16x16x32_bf16 v[200:203], v[244:247], a[176:179], v[200:203]
L_hop6:
    s_cbranch_execz L_hop_ret
    ds_read_b128 a[248:251], v10 offset:4096
    v_mfma_f32_16x16x32_bf16 v[204:207], v[244:247], a[180:183], v[204:207]
    ds_read_b64_tr_b16 v[234:235], v29 offset:41472
    v_mfma_f32_16x16x32_bf16 v[204:207], v[240:243], a[164:167], v[204:207]
    buffer_store_dwordx4 v[18:21], v17, s[52:55], s12 offen offset:1024 sc1
    v_mfma_f32_16x16x32_bf16 v[208:211], v[240:243], a[168:171], v[208:211]
    ds_read_b64_tr_b16 v[236:237], v29 offset:45056
    v_mfma_f32_16x16x32_bf16 v[208:211], v[244:247], a[184:187], v[208:211]
    buffer_store_dwordx4 v[18:21], v17, s[52:55], s12 offen offset:2048 sc1
    v_mfma_f32_16x16x32_bf16 v[212:215], v[244:247], a[188:191], v[212:215]
    s_waitcnt lgkmcnt(5)
    ds_read_b64_tr_b16 v[238:239], v29 offset:45568
    v_mfma_f32_16x16x32_bf16 v[212:215], v[240:243], a[172:175], v[212:215]
    s_waitcnt vmcnt(12)
    ds_read_b128 a[236:239], v9 offset:6144
    v_mfma_f32_16x16x32_bf16 v[216:219], v[248:251], a[128:131], v[216:219]
    ds_read_b64_tr_b16 v[240:241], v23 offset:49152
    v_mfma_f32_16x16x32_bf16 v[216:219], v[252:255], a[144:147], v[216:219]
    ds_read_b128 a[252:255], v10 offset:6144
    v_mfma_f32_16x16x32_bf16 v[220:223], v[252:255], a[148:151], v[220:223]
    ds_read_b64_tr_b16 v[242:243], v23 offset:49664
    v_mfma_f32_16x16x32_bf16 v[220:223], v[248:251], a[132:135], v[220:223]
    buffer_store_dwordx4 v[18:21], v17, s[52:55], s12 offen offset:3072 sc1
    v_mfma_f32_16x16x32_bf16 v[224:227], v[248:251], a[136:139], v[224:227]
    ds_read_b64_tr_b16 v[244:245], v23 offset:53248
    v_mfma_f32_16x16x32_bf16 v[224:227], v[252:255], a[152:155], v[224:227]
    buffer_store_dwordx4 v[18:21], v17, s[52:55], s16 offen sc1
    v_mfma_f32_16x16x32_bf16 v[228:231], v[252:255], a[156:159], v[228:231]
    s_waitcnt lgkmcnt(5)
    ds_read_b64_tr_b16 v[246:247], v23 offset:53760
    v_mfma_f32_16x16x32_bf16 v[228:231], v[248:251], a[140:143], v[228:231]
    ds_read_b128 a[36:39], v35
    v_mfma_f32_16x16x32_bf16 v[216:219], v[232:235], a[160:163], v[216:219]
    ds_read_b64_tr_b16 v[248:249], v23 offset:57344
    v_mfma_f32_16x16x32_bf16 v[216:219], v[236:239], a[176:179], v[216:219]
    ds_read_b128 a[40:43], v35
    v_mfma_f32_16x16x32_bf16 v[220:223], v[236:239], a[180:183], v[220:223]
    ds_read_b64_tr_b16 v[250:251], v23 offset:57856
    v_mfma_f32_16x16x32_bf16 v[220:223], v[232:235], a[164:167], v[220:223]
    buffer_store_dwordx4 v[18:21], v17, s[52:55], s16 offen offset:1024 sc1
    v_mfma_f32_16x16x32_bf16 v[224:227], v[232:235], a[168:171], v[224:227]
    ds_read_b64_tr_b16 v[252:253], v23 offset:61440
    v_mfma_f32_16x16x32_bf16 v[224:227], v[236:239], a[184:187], v[224:227]
    ds_read_b128 a[44:47], v35
    v_mfma_f32_16x16x32_bf16 v[228:231], v[236:239], a[188:191], v[228:231]
    s_waitcnt lgkmcnt(6)
    ds_read_b64_tr_b16 v[254:255], v23 offset:61952
    v_mfma_f32_16x16x32_bf16 v[228:231], v[232:235], a[172:175], v[228:231]
    ds_read_b128 a[48:51], v35
    v_mfma_f32_16x16x32_bf16 v[168:171], v[240:243], a[192:195], v[168:171]
    ds_read_b64_tr_b16 v[232:233], v24 offset:49152
    v_mfma_f32_16x16x32_bf16 v[168:171], v[244:247], a[208:211], v[168:171]
    ds_read_b128 a[52:55], v35
    v_mfma_f32_16x16x32_bf16 v[172:175], v[244:247], a[212:215], v[172:175]
    ds_read_b64_tr_b16 v[234:235], v24 offset:49664
    v_mfma_f32_16x16x32_bf16 v[172:175], v[240:243], a[196:199], v[172:175]
    ds_read_b128 a[56:59], v35
    v_mfma_f32_16x16x32_bf16 v[176:179], v[240:243], a[200:203], v[176:179]
    ds_read_b64_tr_b16 v[236:237], v24 offset:53248
    v_add_u32 v9, 65536, v17
    v_mfma_f32_16x16x32_bf16 v[176:179], v[244:247], a[216:219], v[176:179]
    ds_read_b128 a[60:63], v35
    v_add_u32 v10, 65536, v17
    v_mfma_f32_16x16x32_bf16 v[180:183], v[244:247], a[220:223], v[180:183]
    s_waitcnt lgkmcnt(7)
    ds_read_b64_tr_b16 v[238:239], v24 offset:53760
    v_mfma_f32_16x16x32_bf16 v[180:183], v[240:243], a[204:207], v[180:183]
    ds_read_b128 a[64:67], v35
    v_mfma_f32_16x16x32_bf16 v[168:171], v[248:251], a[224:227], v[168:171]
    ds_read_b64_tr_b16 v[240:241], v24 offset:57344
    v_mfma_f32_16x16x32_bf16 v[168:171], v[252:255], a[240:243], v[168:171]
    ds_read_b128 a[68:71], v35
    v_mfma_f32_16x16x32_bf16 v[172:175], v[252:255], a[244:247], v[172:175]
    ds_read_b64_tr_b16 v[242:243], v24 offset:57856
    v_mfma_f32_16x16x32_bf16 v[172:175], v[248:251], a[228:231], v[172:175]
    ds_read_b128 a[72:75], v35
    v_mfma_f32_16x16x32_bf16 v[176:179], v[248:251], a[232:235], v[176:179]
    ds_read_b64_tr_b16 v[244:245], v24 offset:61440
    v_mfma_f32_16x16x32_bf16 v[176:179], v[252:255], a[248:251], v[176:179]
    ds_read_b128 a[76:79], v35
    v_mfma_f32_16x16x32_bf16 v[180:183], v[252:255], a[252:255], v[180:183]
    s_waitcnt lgkmcnt(7)
    ds_read_b64_tr_b16 v[246:247], v24 offset:61952
    v_mfma_f32_16x16x32_bf16 v[180:183], v[248:251], a[236:239], v[180:183]
    ds_read_b128 a[80:83], v35
    v_mfma_f32_16x16x32_bf16 v[184:187], v[232:235], a[192:195], v[184:187]
    ds_read_b64_tr_b16 v[248:249], v28 offset:49152
    v_mfma_f32_16x16x32_bf16 v[184:187], v[236:239], a[208:211], v[184:187]
    ds_read_b128 a[84:87], v35
    v_mfma_f32_16x16x32_bf16 v[188:191], v[236:239], a[212:215], v[188:191]
    ds_read_b64_tr_b16 v[250:251], v28 offset:49664
    v_mfma_f32_16x16x32_bf16 v[188:191], v[232:235], a[196:199], v[188:191]
    ds_read_b128 a[88:91], v35
    v_mfma_f32_16x16x32_bf16 v[192:195], v[232:235], a[200:203], v[192:195]
    ds_read_b64_tr_b16 v[252:253], v28 offset:53248
    v_mfma_f32_16x16x32_bf16 v[192:195], v[236:239], a[216:219], v[192:195]
    ds_read_b128 a[92:95], v35
    v_mfma_f32_16x16x32_bf16 v[196:199], v[236:239], a[220:223], v[196:199]
    s_waitcnt lgkmcnt(7)
    ds_read_b64_tr_b16 v[254:255], v28 offset:53760
    v_mfma_f32_16x16x32_bf16 v[196:199], v[232:235], a[204:207], v[196:199]
    ds_read_b128 a[96:99], v35
    v_mfma_f32_16x16x32_bf16 v[184:187], v[240:243], a[224:227], v[184:187]
    ds_read_b64_tr_b16 v[232:233], v28 offset:57344
    v_mfma_f32_16x16x32_bf16 v[184:187], v[244:247], a[240:243], v[184:187]
    ds_read_b128 a[100:103], v35
    v_mfma_f32_16x16x32_bf16 v[188:191], v[244:247], a[244:247], v[188:191]
    ds_read_b64_tr_b16 v[234:235], v28 offset:57856
    v_mfma_f32_16x16x32_bf16 v[188:191], v[240:243], a[228:231], v[188:191]
    ds_read_b128 a[104:107], v35
    v_mfma_f32_16x16x32_bf16 v[192:195], v[240:243], a[232:235], v[192:195]
    ds_read_b64_tr_b16 v[236:237], v28 offset:61440
    v_mfma_f32_16x16x32_bf16 v[192:195], v[244:247], a[248:251], v[192:195]
    ds_read_b128 a[108:111], v35
    v_mfma_f32_16x16x32_bf16 v[196:199], v[244:247], a[252:255], v[196:199]
    s_waitcnt lgkmcnt(7)
    ds_read_b64_tr_b16 v[238:239], v28 offset:61952
    v_mfma_f32_16x16x32_bf16 v[196:199], v[240:243], a[236:239], v[196:199]
    ds_read_b128 a[112:115], v35
    v_mfma_f32_16x16x32_bf16 v[200:203], v[248:251], a[192:195], v[200:203]
    ds_read_b64_tr_b16 v[240:241], v29 offset:49152
    v_mfma_f32_16x16x32_bf16 v[200:203], v[252:255], a[208:211], v[200:203]
    ds_read_b128 a[116:119], v35
    v_mfma_f32_16x16x32_bf16 v[204:207], v[252:255], a[212:215], v[204:207]
    ds_read_b64_tr_b16 v[242:243], v29 offset:49664
    v_mfma_f32_16x16x32_bf16 v[204:207], v[248:251], a[196:199], v[204:207]
    ds_read_b128 a[120:123], v35
    v_mfma_f32_16x16x32_bf16 v[208:211], v[248:251], a[200:203], v[208:211]
    ds_read_b64_tr_b16 v[244:245], v29 offset:53248
    v_mfma_f32_16x16x32_bf16 v[208:211], v[252:255], a[216:219], v[208:211]
    ds_read_b128 a[124:127], v35
    v_mfma_f32_16x16x32_bf16 v[212:215], v[252:255], a[220:223], v[212:215]
    s_waitcnt lgkmcnt(7)
    ds_read_b64_tr_b16 v[246:247], v29 offset:53760
    v_mfma_f32_16x16x32_bf16 v[212:215], v[248:251], a[204:207], v[212:215]
    v_mfma_f32_16x16x32_bf16 v[200:203], v[232:235], a[224:227], v[200:203]
    ds_read_b64_tr_b16 v[248:249], v29 offset:57344
    v_mfma_f32_16x16x32_bf16 v[200:203], v[236:239], a[240:243], v[200:203]
    ds_read_b64_tr_b16 v[250:251], v29 offset:57856
    v_mfma_f32_16x16x32_bf16 v[204:207], v[236:239], a[244:247], v[204:207]
    ds_read_b64_tr_b16 v[252:253], v29 offset:61440
    v_mfma_f32_16x16x32_bf16 v[204:207], v[232:235], a[228:231], v[204:207]
    ds_read_b64_tr_b16 v[254:255], v29 offset:61952
    v_mfma_f32_16x16x32_bf16 v[208:211], v[232:235], a[232:235], v[208:211]
    v_mfma_f32_16x16x32_bf16 v[208:211], v[236:239], a[248:251], v[208:211]
    v_mfma_f32_16x16x32_bf16 v[212:215], v[236:239], a[252:255], v[212:215]
    s_waitcnt lgkmcnt(4)
    v_mfma_f32_16x16x32_bf16 v[212:215], v[232:235], a[236:239], v[212:215]
    v_mfma_f32_16x16x32_bf16 v[216:219], v[240:243], a[192:195], v[216:219]
    s_waitcnt vmcnt(7)
    v_mul_f32 v28, 0xbfb8aa3b, v168
    v_mul_f32 v29, 0xbfb8aa3b, v172
    v_mfma_f32_16x16x32_bf16 v[216:219], v[244:247], a[208:211], v[216:219]
    s_waitcnt lgkmcnt(0)
    s_barrier
    v_mul_f32 v30, 0xbfb8aa3b, v176
    v_mfma_f32_16x16x32_bf16 v[220:223], v[244:247], a[212:215], v[220:223]
    s_add_u32 s78, s78, 524288
    ds_read_b64_tr_b16 v[232:233], v1
    v_mul_f32 v31, 0xbfb8aa3b, v180
    v_mfma_f32_16x16x32_bf16 v[220:223], v[240:243], a[196:199], v[220:223]
    s_and_b32 s78, s78, 4194303
    ds_read_b64_tr_b16 v[234:235], v1 offset:1024
    v_cvt_pk_bf16_f32 v168, v168, v169
    v_mfma_f32_16x16x32_bf16 v[224:227], v[240:243], a[200:203], v[224:227]
    s_add_u32 m0, s76, 32768
    ds_read_b64_tr_b16 v[236:237], v1 offset:8192
    v_cvt_pk_bf16_f32 v169, v170, v171
    v_mfma_f32_16x16x32_bf16 v[224:227], v[244:247], a[216:219], v[224:227]
    buffer_load_dwordx4 v11, s[24:27], s78 offen lds
    v_mfma_f32_16x16x32_bf16 v[228:231], v[244:247], a[220:223], v[228:231]
    s_waitcnt lgkmcnt(3)
    ds_read_b64_tr_b16 v[238:239], v1 offset:9216
    v_pk_max_i16 v168, v168, 0
    v_mfma_f32_16x16x32_bf16 v[228:231], v[240:243], a[204:207], v[228:231]
    buffer_load_dwordx4 v12, s[24:27], s78 offen offset:1024 lds
    v_mfma_f32_16x16x32_bf16 v[216:219], v[248:251], a[224:227], v[216:219]
    ds_read_b64_tr_b16 v[240:241], v2
    v_pk_max_i16 v169, v169, 0
    v_mfma_f32_16x16x32_bf16 v[216:219], v[252:255], a[240:243], v[216:219]
    v_cvt_pk_bf16_f32 v170, v184, v185
    v_cvt_pk_bf16_f32 v171, v186, v187
    v_mfma_f32_16x16x32_bf16 v[220:223], v[252:255], a[244:247], v[220:223]
    ds_read_b64_tr_b16 v[242:243], v2 offset:1024
    v_pk_max_i16 v170, v170, 0
    v_mfma_f32_16x16x32_bf16 v[220:223], v[248:251], a[228:231], v[220:223]
    buffer_load_dwordx4 v13, s[24:27], s78 offen offset:2048 lds
    v_mfma_f32_16x16x32_bf16 v[224:227], v[248:251], a[232:235], v[224:227]
    ds_read_b64_tr_b16 v[244:245], v2 offset:8192
    v_pk_max_i16 v171, v171, 0
    v_mfma_f32_16x16x32_bf16 v[224:227], v[252:255], a[248:251], v[224:227]
    v_cvt_pk_bf16_f32 v200, v200, v201
    v_cvt_pk_bf16_f32 v201, v202, v203
    v_mfma_f32_16x16x32_bf16 v[228:231], v[252:255], a[252:255], v[228:231]
    s_waitcnt lgkmcnt(3)
    ds_read_b64_tr_b16 v[246:247], v2 offset:9216
    v_pk_max_i16 v200, v200, 0
    v_mfma_f32_16x16x32_bf16 v[228:231], v[248:251], a[236:239], v[228:231]
    v_pk_max_i16 v201, v201, 0
    v_cvt_pk_bf16_f32 v202, v216, v217
    v_mfma_f32_16x16x32_bf16 v[40:43], v[232:235], a[128:131], v[40:43]
    ds_read_b64_tr_b16 v[248:249], v3
    v_cvt_pk_bf16_f32 v203, v218, v219
    v_mfma_f32_16x16x32_bf16 v[40:43], v[236:239], a[144:147], v[40:43]
    buffer_load_dwordx4 v14, s[24:27], s78 offen offset:3072 lds
    v_mfma_f32_16x16x32_bf16 v[44:47], v[236:239], a[148:151], v[44:47]
    ds_read_b64_tr_b16 v[250:251], v3 offset:1024
    v_pk_max_i16 v202, v202, 0
    v_mfma_f32_16x16x32_bf16 v[44:47], v[232:235], a[132:135], v[44:47]
    v_pk_max_i16 v203, v203, 0
    v_cvt_pk_bf16_f32 v172, v172, v173
    v_mfma_f32_16x16x32_bf16 v[48:51], v[232:235], a[136:139], v[48:51]
    ds_read_b64_tr_b16 v[252:253], v3 offset:8192
    v_cvt_pk_bf16_f32 v173, v174, v175
    v_mfma_f32_16x16x32_bf16 v[48:51], v[236:239], a[152:155], v[48:51]
    buffer_load_dword v38, v36, s[60:63], s0 offen sc1
    v_mfma_f32_16x16x32_bf16 v[52:55], v[236:239], a[156:159], v[52:55]
    s_waitcnt lgkmcnt(3)
    s_add_u32 s78, s78, 524288
    s_and_b32 s78, s78, 4194303
    s_add_u32 m0, s76, 49152
    ds_read_b64_tr_b16 v[254:255], v3 offset:9216
    v_mfma_f32_16x16x32_bf16 v[52:55], v[232:235], a[140:143], v[52:55]
    buffer_load_dwordx4 v11, s[24:27], s78 offen lds
    v_mfma_f32_16x16x32_bf16 v[56:59], v[240:243], a[128:131], v[56:59]
    ds_read_b64_tr_b16 v[232:233], v4
    v_pk_max_i16 v172, v172, 0
    v_mfma_f32_16x16x32_bf16 v[56:59], v[244:247], a[144:147], v[56:59]
    v_pk_max_i16 v173, v173, 0
    v_cvt_pk_bf16_f32 v174, v188, v189
    v_mfma_f32_16x16x32_bf16 v[60:63], v[244:247], a[148:151], v[60:63]
    ds_read_b64_tr_b16 v[234:235], v4 offset:1024
    v_cvt_pk_bf16_f32 v175, v190, v191
    v_mfma_f32_16x16x32_bf16 v[60:63], v[240:243], a[132:135], v[60:63]
    buffer_load_dwordx4 v12, s[24:27], s78 offen offset:1024 lds
    v_mfma_f32_16x16x32_bf16 v[64:67], v[240:243], a[136:139], v[64:67]
    ds_read_b64_tr_b16 v[236:237], v4 offset:8192
    v_pk_max_i16 v174, v174, 0
    v_mfma_f32_16x16x32_bf16 v[64:67], v[244:247], a[152:155], v[64:67]
    v_pk_max_i16 v175, v175, 0
    v_cvt_pk_bf16_f32 v204, v204, v205
    v_mfma_f32_16x16x32_bf16 v[68:71], v[244:247], a[156:159], v[68:71]
    s_waitcnt lgkmcnt(3)
    ds_read_b64_tr_b16 v[238:239], v4 offset:9216
    v_cvt_pk_bf16_f32 v205, v206, v207
    v_mfma_f32_16x16x32_bf16 v[68:71], v[240:243], a[140:143], v[68:71]
    v_pk_max_i16 v204, v204, 0
    v_pk_max_i16 v205, v205, 0
    v_mfma_f32_16x16x32_bf16 v[72:75], v[248:251], a[128:131], v[72:75]
    ds_read_b64_tr_b16 v[240:241], v5
    v_cvt_pk_bf16_f32 v206, v220, v221
    v_mfma_f32_16x16x32_bf16 v[72:75], v[252:255], a[144:147], v[72:75]
    buffer_load_dwordx4 v13, s[24:27], s78 offen offset:2048 lds
    v_mfma_f32_16x16x32_bf16 v[76:79], v[252:255], a[148:151], v[76:79]
    ds_read_b64_tr_b16 v[242:243], v5 offset:1024
    v_cvt_pk_bf16_f32 v207, v222, v223
    v_mfma_f32_16x16x32_bf16 v[76:79], v[248:251], a[132:135], v[76:79]
    v_pk_max_i16 v206, v206, 0
    v_pk_max_i16 v207, v207, 0
    v_mfma_f32_16x16x32_bf16 v[80:83], v[248:251], a[136:139], v[80:83]
    ds_read_b64_tr_b16 v[244:245], v5 offset:8192
    v_cvt_pk_bf16_f32 v176, v176, v177
    v_mfma_f32_16x16x32_bf16 v[80:83], v[252:255], a[152:155], v[80:83]
    buffer_load_dwordx4 v14, s[24:27], s78 offen offset:3072 lds
    v_mfma_f32_16x16x32_bf16 v[84:87], v[252:255], a[156:159], v[84:87]
    s_waitcnt lgkmcnt(3)
    ds_read_b64_tr_b16 v[246:247], v5 offset:9216
    v_cvt_pk_bf16_f32 v177, v178, v179
    v_mfma_f32_16x16x32_bf16 v[84:87], v[248:251], a[140:143], v[84:87]
    v_pk_max_i16 v176, v176, 0
    v_pk_max_i16 v177, v177, 0
    v_mfma_f32_16x16x32_bf16 v[88:91], v[232:235], a[128:131], v[88:91]
    ds_read_b64_tr_b16 v[248:249], v6
    v_cvt_pk_bf16_f32 v178, v192, v193
    v_mfma_f32_16x16x32_bf16 v[88:91], v[236:239], a[144:147], v[88:91]
    v_cvt_pk_bf16_f32 v179, v194, v195
    v_pk_max_i16 v178, v178, 0
    v_mfma_f32_16x16x32_bf16 v[92:95], v[236:239], a[148:151], v[92:95]
    ds_read_b64_tr_b16 v[250:251], v6 offset:1024
    v_pk_max_i16 v179, v179, 0
    v_mfma_f32_16x16x32_bf16 v[92:95], v[232:235], a[132:135], v[92:95]
    v_cvt_pk_bf16_f32 v208, v208, v209
    v_cvt_pk_bf16_f32 v209, v210, v211
    v_mfma_f32_16x16x32_bf16 v[96:99], v[232:235], a[136:139], v[96:99]
    ds_read_b64_tr_b16 v[252:253], v6 offset:8192
    v_pk_max_i16 v208, v208, 0
    v_mfma_f32_16x16x32_bf16 v[96:99], v[236:239], a[152:155], v[96:99]
    v_pk_max_i16 v209, v209, 0
    v_cvt_pk_bf16_f32 v210, v224, v225
    v_mfma_f32_16x16x32_bf16 v[100:103], v[236:239], a[156:159], v[100:103]
    s_waitcnt lgkmcnt(3)
    ds_read_b64_tr_b16 v[254:255], v6 offset:9216
    v_cvt_pk_bf16_f32 v211, v226, v227
    v_mfma_f32_16x16x32_bf16 v[100:103], v[232:235], a[140:143], v[100:103]
    v_pk_max_i16 v210, v210, 0
    v_pk_max_i16 v211, v211, 0
    v_mfma_f32_16x16x32_bf16 v[104:107], v[240:243], a[128:131], v[104:107]
    ds_read_b64_tr_b16 v[232:233], v7
    v_cvt_pk_bf16_f32 v180, v180, v181
    v_mfma_f32_16x16x32_bf16 v[104:107], v[244:247], a[144:147], v[104:107]
    v_cvt_pk_bf16_f32 v181, v182, v183
    v_pk_max_i16 v180, v180, 0
    v_mfma_f32_16x16x32_bf16 v[108:111], v[244:247], a[148:151], v[108:111]
    ds_read_b64_tr_b16 v[234:235], v7 offset:1024
    v_pk_max_i16 v181, v181, 0
    v_mfma_f32_16x16x32_bf16 v[108:111], v[240:243], a[132:135], v[108:111]
    v_cvt_pk_bf16_f32 v182, v196, v197
    v_cvt_pk_bf16_f32 v183, v198, v199
    v_mfma_f32_16x16x32_bf16 v[112:115], v[240:243], a[136:139], v[112:115]
    s_waitcnt vmcnt(4)
    ds_read_b64_tr_b16 v[236:237], v7 offset:8192
    v_cmp_eq_u32 vcc, 0, v38
    v_mfma_f32_16x16x32_bf16 v[112:115], v[244:247], a[152:155], v[112:115]
    v_add_u32 v11, s88, v17
    v_add_u32 v12, s88, v17
    v_mfma_f32_16x16x32_bf16 v[116:119], v[244:247], a[156:159], v[116:119]
    s_waitcnt lgkmcnt(3)
    s_cbranch_vccnz L_spin_kv
L_spin_kv_ret:
    ds_read_b64_tr_b16 v[238:239], v7 offset:9216
    v_mfma_f32_16x16x32_bf16 v[116:119], v[240:243], a[140:143], v[116:119]
    v_cmp_lt_u32 vcc, 1, v38
    v_add_u32 v13, s88, v17
    v_mfma_f32_16x16x32_bf16 v[120:123], v[248:251], a[128:131], v[120:123]
    s_add_u32 m0, s88, 65536
    ds_read_b64_tr_b16 v[240:241], v8
    v_and_b32 v36, 31, v36
    v_mfma_f32_16x16x32_bf16 v[120:123], v[252:255], a[144:147], v[120:123]
    s_mov_b32 s89, 0
    v_add_u32 v14, s88, v17
    v_pk_max_i16 v182, v182, 0
    v_mfma_f32_16x16x32_bf16 v[124:127], v[252:255], a[148:151], v[124:127]
    s_cmp_lg_u64 vcc, 0
    s_cselect_b32 s93, 0, 0x34000000
    ds_read_b64_tr_b16 v[242:243], v8 offset:1024
    v_mfma_f32_16x16x32_bf16 v[124:127], v[248:251], a[132:135], v[124:127]
    buffer_load_dwordx4 v11, s[36:39], s89 offen sc1 lds
    v_mfma_f32_16x16x32_bf16 v[128:131], v[248:251], a[136:139], v[128:131]
    ds_read_b64_tr_b16 v[244:245], v8 offset:8192
    v_pk_max_i16 v183, v183, 0
    v_mfma_f32_16x16x32_bf16 v[128:131], v[252:255], a[152:155], v[128:131]
    v_cvt_pk_bf16_f32 v212, v212, v213
    v_cvt_pk_bf16_f32 v213, v214, v215
    v_mfma_f32_16x16x32_bf16 v[132:135], v[252:255], a[156:159], v[132:135]
    s_waitcnt lgkmcnt(3)
    ds_read_b64_tr_b16 v[246:247], v8 offset:9216
    v_pk_max_i16 v212, v212, 0
    v_mfma_f32_16x16x32_bf16 v[132:135], v[248:251], a[140:143], v[132:135]
    buffer_load_dwordx4 v12, s[36:39], s89 offen offset:1024 sc1 lds
    v_mfma_f32_16x16x32_bf16 v[136:139], v[232:235], a[128:131], v[136:139]
    ds_read_b64_tr_b16 v[248:249], v1 offset:16384
    v_pk_max_i16 v213, v213, 0
    v_mfma_f32_16x16x32_bf16 v[136:139], v[236:239], a[144:147], v[136:139]
    v_cvt_pk_bf16_f32 v214, v228, v229
    v_cvt_pk_bf16_f32 v215, v230, v231
    v_mfma_f32_16x16x32_bf16 v[140:143], v[236:239], a[148:151], v[140:143]
    ds_read_b64_tr_b16 v[250:251], v1 offset:17408
    v_pk_max_i16 v214, v214, 0
    v_mfma_f32_16x16x32_bf16 v[140:143], v[232:235], a[132:135], v[140:143]
    v_pk_max_i16 v215, v215, 0
    v_mfma_f32_16x16x32_bf16 v[144:147], v[232:235], a[136:139], v[144:147]
    ds_read_b64_tr_b16 v[252:253], v1 offset:24576
    v_mfma_f32_16x16x32_bf16 v[144:147], v[236:239], a[152:155], v[144:147]
    buffer_load_dwordx4 v13, s[36:39], s89 offen offset:2048 sc1 lds
    v_mfma_f32_16x16x32_bf16 v[148:151], v[236:239], a[156:159], v[148:151]
    s_waitcnt lgkmcnt(3)
    ds_read_b64_tr_b16 v[254:255], v1 offset:25600
    v_mfma_f32_16x16x32_bf16 v[148:151], v[232:235], a[140:143], v[148:151]
    v_exp_f32 v28, v28
    v_mfma_f32_16x16x32_bf16 v[152:155], v[240:243], a[128:131], v[152:155]
    ds_read_b64_tr_b16 v[232:233], v2 offset:16384
    v_mfma_f32_16x16x32_bf16 v[152:155], v[244:247], a[144:147], v[152:155]
    buffer_load_dwordx4 v14, s[36:39], s89 offen offset:3072 sc1 lds
    v_mfma_f32_16x16x32_bf16 v[156:159], v[244:247], a[148:151], v[156:159]
    ds_read_b64_tr_b16 v[234:235], v2 offset:17408
    v_mfma_f32_16x16x32_bf16 v[156:159], v[240:243], a[132:135], v[156:159]
    s_add_u32 m0, s88, 69632
    v_exp_f32 v29, v29
    v_mfma_f32_16x16x32_bf16 v[160:163], v[240:243], a[136:139], v[160:163]
    s_mov_b32 s89, 4096
    ds_read_b64_tr_b16 v[236:237], v2 offset:24576
    v_mfma_f32_16x16x32_bf16 v[160:163], v[244:247], a[152:155], v[160:163]
    buffer_load_dwordx4 v11, s[36:39], s89 offen sc1 lds
    v_mfma_f32_16x16x32_bf16 v[164:167], v[244:247], a[156:159], v[164:167]
    s_waitcnt lgkmcnt(3)
    ds_read_b64_tr_b16 v[238:239], v2 offset:25600
    v_mfma_f32_16x16x32_bf16 v[164:167], v[240:243], a[140:143], v[164:167]
    v_exp_f32 v30, v30
    v_mfma_f32_16x16x32_bf16 v[40:43], v[248:251], a[160:163], v[40:43]
    s_lshl_b32 s7, s65, 3
    ds_read_b64_tr_b16 v[240:241], v3 offset:16384
    v_mfma_f32_16x16x32_bf16 v[40:43], v[252:255], a[176:179], v[40:43]
    buffer_load_dwordx4 v12, s[36:39], s89 offen offset:1024 sc1 lds
    v_mfma_f32_16x16x32_bf16 v[44:47], v[252:255], a[180:183], v[44:47]
    s_and_b32 s8, s68, 4
    ds_read_b64_tr_b16 v[242:243], v3 offset:17408
    v_mfma_f32_16x16x32_bf16 v[44:47], v[248:251], a[164:167], v[44:47]
    s_add_u32 s7, s7, s8
    v_exp_f32 v31, v31
    v_mfma_f32_16x16x32_bf16 v[48:51], v[248:251], a[168:171], v[48:51]
    s_add_u32 s7, s7, s66
    ds_read_b64_tr_b16 v[244:245], v3 offset:24576
    v_add_f32 v28, 1.0, v28
    v_mfma_f32_16x16x32_bf16 v[48:51], v[252:255], a[184:187], v[48:51]
    s_mul_i32 s8, s7, 7168
    v_add_f32 v29, 1.0, v29
    v_add_f32 v30, 1.0, v30
    v_mfma_f32_16x16x32_bf16 v[52:55], v[252:255], a[188:191], v[52:55]
    s_waitcnt lgkmcnt(3)
    ds_read_b64_tr_b16 v[246:247], v3 offset:25600
    v_add_f32 v31, 1.0, v31
    v_mfma_f32_16x16x32_bf16 v[52:55], v[248:251], a[172:175], v[52:55]
    buffer_load_dwordx4 v13, s[36:39], s89 offen offset:2048 sc1 lds
    v_mfma_f32_16x16x32_bf16 v[56:59], v[232:235], a[160:163], v[56:59]
    s_lshl_b32 s7, s7, 14
    ds_read_b64_tr_b16 v[248:249], v4 offset:16384
    v_mfma_f32_16x16x32_bf16 v[56:59], v[236:239], a[176:179], v[56:59]
    v_rcp_f32 v28, v28
    v_mfma_f32_16x16x32_bf16 v[60:63], v[236:239], a[180:183], v[60:63]
    ds_read_b64_tr_b16 v[250:251], v4 offset:17408
    v_mfma_f32_16x16x32_bf16 v[60:63], v[232:235], a[164:167], v[60:63]
    buffer_load_dwordx4 v14, s[36:39], s89 offen offset:3072 sc1 lds
    v_mfma_f32_16x16x32_bf16 v[64:67], v[232:235], a[168:171], v[64:67]
    s_add_u32 m0, s88, 98304
    ds_read_b64_tr_b16 v[252:253], v4 offset:24576
    v_mfma_f32_16x16x32_bf16 v[64:67], v[236:239], a[184:187], v[64:67]
    s_mov_b32 s89, 32768
    v_rcp_f32 v29, v29
    v_mfma_f32_16x16x32_bf16 v[68:71], v[236:239], a[188:191], v[68:71]
    s_waitcnt lgkmcnt(3)
    ds_read_b64_tr_b16 v[254:255], v4 offset:25600
    v_mfma_f32_16x16x32_bf16 v[68:71], v[232:235], a[172:175], v[68:71]
    buffer_load_dwordx4 v11, s[36:39], s89 offen sc1 lds
    v_mfma_f32_16x16x32_bf16 v[72:75], v[240:243], a[160:163], v[72:75]
    ds_read_b64_tr_b16 v[232:233], v5 offset:16384
    v_mfma_f32_16x16x32_bf16 v[72:75], v[244:247], a[176:179], v[72:75]
    v_rcp_f32 v30, v30
    v_mfma_f32_16x16x32_bf16 v[76:79], v[244:247], a[180:183], v[76:79]
    ds_read_b64_tr_b16 v[234:235], v5 offset:17408
    v_mfma_f32_16x16x32_bf16 v[76:79], v[240:243], a[164:167], v[76:79]
    v_rcp_f32 v31, v31
    v_mfma_f32_16x16x32_bf16 v[80:83], v[240:243], a[168:171], v[80:83]
    ds_read_b64_tr_b16 v[236:237], v5 offset:24576
    v_bfe_u32 v15, v17, 4, 4
    v_mfma_f32_16x16x32_bf16 v[80:83], v[244:247], a[184:187], v[80:83]
    buffer_load_dwordx4 v12, s[36:39], s89 offen offset:1024 sc1 lds
    v_mfma_f32_16x16x32_bf16 v[84:87], v[244:247], a[188:191], v[84:87]
    s_waitcnt lgkmcnt(3)
    ds_read_b64_tr_b16 v[238:239], v5 offset:25600
    v_bfe_u32 v26, v17, 8, 2
    v_mfma_f32_16x16x32_bf16 v[84:87], v[240:243], a[172:175], v[84:87]
    v_lshlrev_b32 v26, 2, v26
    v_sub_u32 v15, v15, v26
    v_mfma_f32_16x16x32_bf16 v[88:91], v[248:251], a[160:163], v[88:91]
    ds_read_b64_tr_b16 v[240:241], v6 offset:16384
    v_lshlrev_b32 v26, 4, s66
    v_mfma_f32_16x16x32_bf16 v[88:91], v[252:255], a[176:179], v[88:91]
    buffer_load_dwordx4 v13, s[36:39], s89 offen offset:2048 sc1 lds
    v_mfma_f32_16x16x32_bf16 v[92:95], v[252:255], a[180:183], v[92:95]
    ds_read_b64_tr_b16 v[242:243], v6 offset:17408
    v_sub_u32 v16, v15, v26
    v_mfma_f32_16x16x32_bf16 v[92:95], v[248:251], a[164:167], v[92:95]
    v_add_u32 v15, v15, v26
    v_add_u32 v16, 112, v16
    v_mfma_f32_16x16x32_bf16 v[96:99], v[248:251], a[168:171], v[96:99]
    ds_read_b64_tr_b16 v[244:245], v6 offset:24576
    v_cvt_f32_i32 v15, v15
    v_mfma_f32_16x16x32_bf16 v[96:99], v[252:255], a[184:187], v[96:99]
    buffer_load_dwordx4 v14, s[36:39], s89 offen offset:3072 sc1 lds
    v_mfma_f32_16x16x32_bf16 v[100:103], v[252:255], a[188:191], v[100:103]
    s_waitcnt lgkmcnt(3)
    ds_read_b64_tr_b16 v[246:247], v6 offset:25600
    v_cvt_f32_i32 v16, v16
    v_mfma_f32_16x16x32_bf16 v[100:103], v[248:251], a[172:175], v[100:103]
    v_mul_f32 v15, 0x71800000, v15
    v_mul_f32 v16, 0x71800000, v16
    v_mfma_f32_16x16x32_bf16 v[104:107], v[232:235], a[160:163], v[104:107]
    ds_read_b64_tr_b16 v[248:249], v7 offset:16384
    v_subrev_f32 v184, 0x00000000, v15
    v_mfma_f32_16x16x32_bf16 v[104:107], v[236:239], a[176:179], v[104:107]
    s_add_u32 m0, s88, 102400
    v_min_f32 v184, 0, v184
    v_subrev_f32 v185, 0x71800000, v15
    v_mfma_f32_16x16x32_bf16 v[108:111], v[236:239], a[180:183], v[108:111]
    s_mov_b32 s89, 36864
    ds_read_b64_tr_b16 v[250:251], v7 offset:17408
    v_min_f32 v185, 0, v185
    v_mfma_f32_16x16x32_bf16 v[108:111], v[232:235], a[164:167], v[108:111]
    buffer_load_dwordx4 v11, s[36:39], s89 offen sc1 lds
    v_mfma_f32_16x16x32_bf16 v[112:115], v[232:235], a[168:171], v[112:115]
    ds_read_b64_tr_b16 v[252:253], v7 offset:24576
    v_subrev_f32 v186, 0x72000000, v15
    v_mfma_f32_16x16x32_bf16 v[112:115], v[236:239], a[184:187], v[112:115]
    v_min_f32 v186, 0, v186
    v_subrev_f32 v187, 0x72400000, v15
    v_mfma_f32_16x16x32_bf16 v[116:119], v[236:239], a[188:191], v[116:119]
    s_waitcnt lgkmcnt(3)
    ds_read_b64_tr_b16 v[254:255], v7 offset:25600
    v_min_f32 v187, 0, v187
    v_mfma_f32_16x16x32_bf16 v[116:119], v[232:235], a[172:175], v[116:119]
    buffer_load_dwordx4 v12, s[36:39], s89 offen offset:1024 sc1 lds
    v_mfma_f32_16x16x32_bf16 v[120:123], v[240:243], a[160:163], v[120:123]
    ds_read_b64_tr_b16 v[232:233], v8 offset:16384
    v_subrev_f32 v188, 0x73800000, v15
    v_mfma_f32_16x16x32_bf16 v[120:123], v[244:247], a[176:179], v[120:123]
    ds_read_b64_tr_b16 v[234:235], v8 offset:17408
    v_min_f32 v188, 0, v188
    v_mfma_f32_16x16x32_bf16 v[124:127], v[244:247], a[180:183], v[124:127]
    ds_read_b64_tr_b16 v[236:237], v8 offset:24576
    v_subrev_f32 v189, 0x73880000, v15
    v_mfma_f32_16x16x32_bf16 v[124:127], v[240:243], a[164:167], v[124:127]
    ds_read_b64_tr_b16 v[238:239], v8 offset:25600
    v_min_f32 v189, 0, v189
    v_mfma_f32_16x16x32_bf16 v[128:131], v[240:243], a[168:171], v[128:131]
    buffer_load_dwordx4 v13, s[36:39], s89 offen offset:2048 sc1 lds
    v_mfma_f32_16x16x32_bf16 v[128:131], v[244:247], a[184:187], v[128:131]
    v_subrev_f32 v190, 0x73900000, v15
    v_min_f32 v190, 0, v190
    v_mfma_f32_16x16x32_bf16 v[132:135], v[244:247], a[188:191], v[132:135]
    s_waitcnt lgkmcnt(4)
    v_subrev_f32 v191, 0x73980000, v15
    v_min_f32 v191, 0, v191
    v_mfma_f32_16x16x32_bf16 v[132:135], v[240:243], a[172:175], v[132:135]
    buffer_load_dwordx4 v14, s[36:39], s89 offen offset:3072 sc1 lds
    v_mfma_f32_16x16x32_bf16 v[136:139], v[248:251], a[160:163], v[136:139]
    v_subrev_f32 v192, 0x74000000, v15
    v_min_f32 v192, 0, v192
    v_mfma_f32_16x16x32_bf16 v[136:139], v[252:255], a[176:179], v[136:139]
    s_waitcnt lgkmcnt(0)
    s_barrier
    v_subrev_f32 v193, 0x74040000, v15
    v_mfma_f32_16x16x32_bf16 v[140:143], v[252:255], a[180:183], v[140:143]
    ds_read_b64_tr_b16 v[240:241], v1 offset:32768
    v_min_f32 v193, 0, v193
    v_mfma_f32_16x16x32_bf16 v[140:143], v[248:251], a[164:167], v[140:143]
    s_add_u32 m0, s88, 131072
    ds_read_b64_tr_b16 v[242:243], v1 offset:33792
    v_subrev_f32 v194, 0x74080000, v15
    v_mfma_f32_16x16x32_bf16 v[144:147], v[248:251], a[168:171], v[144:147]
    s_mov_b32 s89, 65536
    ds_read_b64_tr_b16 v[244:245], v1 offset:40960
    v_min_f32 v194, 0, v194
    v_mfma_f32_16x16x32_bf16 v[144:147], v[252:255], a[184:187], v[144:147]
    buffer_load_dwordx4 v11, s[36:39], s89 offen sc1 lds
    v_mfma_f32_16x16x32_bf16 v[148:151], v[252:255], a[188:191], v[148:151]
    s_waitcnt lgkmcnt(3)
    ds_read_b64_tr_b16 v[246:247], v1 offset:41984
    v_subrev_f32 v195, 0x740c0000, v15
    v_mfma_f32_16x16x32_bf16 v[148:151], v[248:251], a[172:175], v[148:151]
    v_min_f32 v195, 0, v195
    v_subrev_f32 v196, 0x74400000, v15
    v_mfma_f32_16x16x32_bf16 v[152:155], v[232:235], a[160:163], v[152:155]
L_hop7:
    s_cbranch_execz L_hop_ret
    ds_read_b64_tr_b16 v[248:249], v2 offset:32768
    v_min_f32 v196, 0, v196
    v_mfma_f32_16x16x32_bf16 v[152:155], v[236:239], a[176:179], v[152:155]
    buffer_load_dwordx4 v12, s[36:39], s89 offen offset:1024 sc1 lds
    v_mfma_f32_16x16x32_bf16 v[156:159], v[236:239], a[180:183], v[156:159]
    ds_read_b64_tr_b16 v[250:251], v2 offset:33792
    v_subrev_f32 v197, 0x74440000, v15
    v_mfma_f32_16x16x32_bf16 v[156:159], v[232:235], a[164:167], v[156:159]
    v_min_f32 v197, 0, v197
    v_subrev_f32 v198, 0x74480000, v15
    v_mfma_f32_16x16x32_bf16 v[160:163], v[232:235], a[168:171], v[160:163]
    ds_read_b64_tr_b16 v[252:253], v2 offset:40960
    v_min_f32 v198, 0, v198
    v_mfma_f32_16x16x32_bf16 v[160:163], v[236:239], a[184:187], v[160:163]
    buffer_load_dwordx4 v13, s[36:39], s89 offen offset:2048 sc1 lds
    v_mfma_f32_16x16x32_bf16 v[164:167], v[236:239], a[188:191], v[164:167]
    s_waitcnt lgkmcnt(3)
    ds_read_b64_tr_b16 v[254:255], v2 offset:41984
    v_subrev_f32 v199, 0x744c0000, v15
    v_mfma_f32_16x16x32_bf16 v[164:167], v[232:235], a[172:175], v[164:167]
    v_min_f32 v199, 0, v199
    v_bfe_u32 v26, v17, 4, 2
    v_mfma_f32_16x16x32_bf16 v[40:43], v[240:243], a[192:195], v[40:43]
    ds_read_b64_tr_b16 v[232:233], v3 offset:32768
    v_min_u32 v26, 1, v26
    v_mfma_f32_16x16x32_bf16 v[40:43], v[244:247], a[208:211], v[40:43]
    v_subrev_u32 v26, 1, v26
    v_and_b32 v26, 0x3f803f80, v26
    v_mfma_f32_16x16x32_bf16 v[44:47], v[244:247], a[212:215], v[44:47]
    ds_read_b64_tr_b16 v[234:235], v3 offset:33792
    v_mfma_f32_16x16x32_bf16 v[44:47], v[240:243], a[196:199], v[44:47]
    buffer_load_dwordx4 v14, s[36:39], s89 offen offset:3072 sc1 lds
    v_mfma_f32_16x16x32_bf16 v[48:51], v[240:243], a[200:203], v[48:51]
    s_add_u32 m0, s88, 135168
    ds_read_b64_tr_b16 v[236:237], v3 offset:40960
    v_mfma_f32_16x16x32_bf16 v[48:51], v[244:247], a[216:219], v[48:51]
    s_mov_b32 s89, 69632
    v_mfma_f32_16x16x32_bf16 v[52:55], v[244:247], a[220:223], v[52:55]
    s_waitcnt lgkmcnt(3)
    ds_read_b64_tr_b16 v[238:239], v3 offset:41984
    v_lshrrev_b32 v23, 8, v17
    v_mfma_f32_16x16x32_bf16 v[52:55], v[240:243], a[204:207], v[52:55]
    buffer_load_dwordx4 v11, s[36:39], s89 offen sc1 lds
    v_mfma_f32_16x16x32_bf16 v[56:59], v[248:251], a[192:195], v[56:59]
    ds_read_b64_tr_b16 v[240:241], v4 offset:32768
    v_lshlrev_b32 v24, 5, v23
    v_mfma_f32_16x16x32_bf16 v[56:59], v[252:255], a[208:211], v[56:59]
    v_xor_b32 v24, v24, v17
    v_and_b32 v24, 255, v24
    v_mfma_f32_16x16x32_bf16 v[60:63], v[252:255], a[212:215], v[60:63]
    ds_read_b64_tr_b16 v[242:243], v4 offset:33792
    v_lshl_add_u32 v24, v23, 10, v24
    v_mfma_f32_16x16x32_bf16 v[60:63], v[248:251], a[196:199], v[60:63]
    buffer_load_dwordx4 v12, s[36:39], s89 offen offset:1024 sc1 lds
    v_mfma_f32_16x16x32_bf16 v[64:67], v[248:251], a[200:203], v[64:67]
    ds_read_b64_tr_b16 v[244:245], v4 offset:40960
    v_lshl_add_u32 v24, s66, 15, v24
    v_mfma_f32_16x16x32_bf16 v[64:67], v[252:255], a[216:219], v[64:67]
    v_xor_b32 v25, 128, v24
    v_add_u32 v18, 0, v24
    v_mfma_f32_16x16x32_bf16 v[68:71], v[252:255], a[220:223], v[68:71]
    s_waitcnt lgkmcnt(3)
    ds_read_b64_tr_b16 v[246:247], v4 offset:41984
    v_add_u32 v19, 15360, v24
    v_mfma_f32_16x16x32_bf16 v[68:71], v[248:251], a[204:207], v[68:71]
    v_add_u32 v20, 2048, v25
    v_add_u32 v21, 17408, v25
    v_mfma_f32_16x16x32_bf16 v[72:75], v[232:235], a[192:195], v[72:75]
    ds_read_b64_tr_b16 v[248:249], v5 offset:32768
    v_mfma_f32_16x16x32_bf16 v[72:75], v[236:239], a[208:211], v[72:75]
    buffer_load_dwordx4 v13, s[36:39], s89 offen offset:2048 sc1 lds
    v_mfma_f32_16x16x32_bf16 v[76:79], v[236:239], a[212:215], v[76:79]
    ds_read_b64_tr_b16 v[250:251], v5 offset:33792
    v_mfma_f32_16x16x32_bf16 v[76:79], v[232:235], a[196:199], v[76:79]
    v_mfma_f32_16x16x32_bf16 v[80:83], v[232:235], a[200:203], v[80:83]
    ds_read_b64_tr_b16 v[252:253], v5 offset:40960
    v_mfma_f32_16x16x32_bf16 v[80:83], v[236:239], a[216:219], v[80:83]
    buffer_load_dwordx4 v14, s[36:39], s89 offen offset:3072 sc1 lds
    v_mfma_f32_16x16x32_bf16 v[84:87], v[236:239], a[220:223], v[84:87]
    s_waitcnt lgkmcnt(3)
    ds_read_b64_tr_b16 v[254:255], v5 offset:41984
    v_mfma_f32_16x16x32_bf16 v[84:87], v[232:235], a[204:207], v[84:87]
    s_add_u32 m0, s88, 0
    v_mfma_f32_16x16x32_bf16 v[88:91], v[240:243], a[192:195], v[88:91]
    s_mov_b32 s89, 98304
    ds_read_b64_tr_b16 v[232:233], v6 offset:32768
    v_mfma_f32_16x16x32_bf16 v[88:91], v[244:247], a[208:211], v[88:91]
    buffer_load_dwordx4 v11, s[36:39], s89 offen sc1 lds
    v_mfma_f32_16x16x32_bf16 v[92:95], v[244:247], a[212:215], v[92:95]
    ds_read_b64_tr_b16 v[234:235], v6 offset:33792
    v_mfma_f32_16x16x32_bf16 v[92:95], v[240:243], a[196:199], v[92:95]
    v_mfma_f32_16x16x32_bf16 v[96:99], v[240:243], a[200:203], v[96:99]
    ds_read_b64_tr_b16 v[236:237], v6 offset:40960
    v_mfma_f32_16x16x32_bf16 v[96:99], v[244:247], a[216:219], v[96:99]
    buffer_load_dwordx4 v12, s[36:39], s89 offen offset:1024 sc1 lds
    v_mfma_f32_16x16x32_bf16 v[100:103], v[244:247], a[220:223], v[100:103]
    s_waitcnt lgkmcnt(3)
    ds_read_b64_tr_b16 v[238:239], v6 offset:41984
    v_mfma_f32_16x16x32_bf16 v[100:103], v[240:243], a[204:207], v[100:103]
    v_mfma_f32_16x16x32_bf16 v[104:107], v[248:251], a[192:195], v[104:107]
    ds_read_b64_tr_b16 v[240:241], v7 offset:32768
    v_mfma_f32_16x16x32_bf16 v[104:107], v[252:255], a[208:211], v[104:107]
    v_mfma_f32_16x16x32_bf16 v[108:111], v[252:255], a[212:215], v[108:111]
    ds_read_b64_tr_b16 v[242:243], v7 offset:33792
    v_mfma_f32_16x16x32_bf16 v[108:111], v[248:251], a[196:199], v[108:111]
    buffer_load_dwordx4 v13, s[36:39], s89 offen offset:2048 sc1 lds
    v_mfma_f32_16x16x32_bf16 v[112:115], v[248:251], a[200:203], v[112:115]
    ds_read_b64_tr_b16 v[244:245], v7 offset:40960
    v_mfma_f32_16x16x32_bf16 v[112:115], v[252:255], a[216:219], v[112:115]
    v_mfma_f32_16x16x32_bf16 v[116:119], v[252:255], a[220:223], v[116:119]
    s_waitcnt lgkmcnt(3)
    ds_read_b64_tr_b16 v[246:247], v7 offset:41984
    v_mfma_f32_16x16x32_bf16 v[116:119], v[248:251], a[204:207], v[116:119]
    buffer_load_dwordx4 v14, s[36:39], s89 offen offset:3072 sc1 lds
    v_mfma_f32_16x16x32_bf16 v[120:123], v[232:235], a[192:195], v[120:123]
    ds_read_b64_tr_b16 v[248:249], v8 offset:32768
    v_mfma_f32_16x16x32_bf16 v[120:123], v[236:239], a[208:211], v[120:123]
    ds_read_b64_tr_b16 v[250:251], v8 offset:33792
    v_mfma_f32_16x16x32_bf16 v[124:127], v[236:239], a[212:215], v[124:127]
    s_add_u32 m0, s88, 4096
    ds_read_b64_tr_b16 v[252:253], v8 offset:40960
    v_mfma_f32_16x16x32_bf16 v[124:127], v[232:235], a[196:199], v[124:127]
    s_mov_b32 s89, 102400
    ds_read_b64_tr_b16 v[254:255], v8 offset:41984
    v_mfma_f32_16x16x32_bf16 v[128:131], v[232:235], a[200:203], v[128:131]
    buffer_load_dwordx4 v11, s[36:39], s89 offen sc1 lds
    v_mfma_f32_16x16x32_bf16 v[128:131], v[236:239], a[216:219], v[128:131]
    v_mfma_f32_16x16x32_bf16 v[132:135], v[236:239], a[220:223], v[132:135]
    s_waitcnt lgkmcnt(4)
    v_mfma_f32_16x16x32_bf16 v[132:135], v[232:235], a[204:207], v[132:135]
    v_mfma_f32_16x16x32_bf16 v[136:139], v[240:243], a[192:195], v[136:139]
    s_waitcnt vmcnt(21)
    v_mfma_f32_16x16x32_bf16 v[136:139], v[244:247], a[208:211], v[136:139]
    s_barrier
    v_mfma_f32_16x16x32_bf16 v[140:143], v[244:247], a[212:215], v[140:143]
    ds_read_b64_tr_b16 v[232:233], v1 offset:49152
    v_mfma_f32_16x16x32_bf16 v[140:143], v[240:243], a[196:199], v[140:143]
    ds_read_b64_tr_b16 v[234:235], v1 offset:50176
    v_mfma_f32_16x16x32_bf16 v[144:147], v[240:243], a[200:203], v[144:147]
    ds_read_b64_tr_b16 v[236:237], v1 offset:57344
    v_mfma_f32_16x16x32_bf16 v[144:147], v[244:247], a[216:219], v[144:147]
    buffer_load_dwordx4 v12, s[36:39], s89 offen offset:1024 sc1 lds
    v_mfma_f32_16x16x32_bf16 v[148:151], v[244:247], a[220:223], v[148:151]
    s_waitcnt lgkmcnt(3)
    ds_read_b64_tr_b16 v[238:239], v1 offset:58368
    v_mfma_f32_16x16x32_bf16 v[148:151], v[240:243], a[204:207], v[148:151]
    buffer_load_dwordx4 v13, s[36:39], s89 offen offset:2048 sc1 lds
    v_mfma_f32_16x16x32_bf16 v[152:155], v[248:251], a[192:195], v[152:155]
    ds_read_b64_tr_b16 v[240:241], v2 offset:49152
    v_mfma_f32_16x16x32_bf16 v[152:155], v[252:255], a[208:211], v[152:155]
    ds_read_b128 a[128:131], v9
    v_mfma_f32_16x16x32_bf16 v[156:159], v[252:255], a[212:215], v[156:159]
    ds_read_b64_tr_b16 v[242:243], v2 offset:50176
    v_mfma_f32_16x16x32_bf16 v[156:159], v[248:251], a[196:199], v[156:159]
    buffer_load_dwordx4 v14, s[36:39], s89 offen offset:3072 sc1 lds
    v_mfma_f32_16x16x32_bf16 v[160:163], v[248:251], a[200:203], v[160:163]
    ds_read_b64_tr_b16 v[244:245], v2 offset:57344
    v_mfma_f32_16x16x32_bf16 v[160:163], v[252:255], a[216:219], v[160:163]
    s_add_u32 s71, s97, s83
    ds_read_b128 a[132:135], v9 offset:1024
    v_mfma_f32_16x16x32_bf16 v[164:167], v[252:255], a[220:223], v[164:167]
    s_waitcnt lgkmcnt(5)
    ds_read_b64_tr_b16 v[246:247], v2 offset:58368
    v_mfma_f32_16x16x32_bf16 v[164:167], v[248:251], a[204:207], v[164:167]
    buffer_store_dwordx4 v[168:171], v33, s[32:35], s71 offen sc1
    v_mfma_f32_16x16x32_bf16 v[40:43], v[232:235], a[224:227], v[40:43]
    ds_read_b64_tr_b16 v[248:249], v3 offset:49152
    v_mfma_f32_16x16x32_bf16 v[40:43], v[236:239], a[240:243], v[40:43]
    ds_read_b128 a[136:139], v9 offset:2048
    v_mfma_f32_16x16x32_bf16 v[44:47], v[236:239], a[244:247], v[44:47]
    ds_read_b64_tr_b16 v[250:251], v3 offset:50176
    v_mfma_f32_16x16x32_bf16 v[44:47], v[232:235], a[228:231], v[44:47]
    buffer_store_dwordx4 v[200:203], v33, s[32:35], s71 offen offset:1024 sc1
    v_mfma_f32_16x16x32_bf16 v[48:51], v[232:235], a[232:235], v[48:51]
    ds_read_b64_tr_b16 v[252:253], v3 offset:57344
    v_mfma_f32_16x16x32_bf16 v[48:51], v[236:239], a[248:251], v[48:51]
    ds_read_b128 a[140:143], v9 offset:3072
    v_mfma_f32_16x16x32_bf16 v[52:55], v[236:239], a[252:255], v[52:55]
    s_waitcnt lgkmcnt(5)
    ds_read_b64_tr_b16 v[254:255], v3 offset:58368
    v_cvt_pk_bf16_f32 v40, v40, v41
    v_mfma_f32_16x16x32_bf16 v[52:55], v[232:235], a[236:239], v[52:55]
    v_cvt_pk_bf16_f32 v41, v42, v43
    v_mfma_f32_16x16x32_bf16 v[56:59], v[240:243], a[224:227], v[56:59]
    ds_read_b64_tr_b16 v[232:233], v4 offset:49152
    v_cvt_pk_bf16_f32 v44, v44, v45
    v_mfma_f32_16x16x32_bf16 v[56:59], v[244:247], a[240:243], v[56:59]
    ds_read_b128 a[156:159], v9 offset:7168
    v_cvt_pk_bf16_f32 v45, v46, v47
    v_mfma_f32_16x16x32_bf16 v[60:63], v[244:247], a[244:247], v[60:63]
    s_add_u32 s71, s97, s84
    ds_read_b64_tr_b16 v[234:235], v4 offset:50176
    v_cvt_pk_bf16_f32 v48, v48, v49
    v_mfma_f32_16x16x32_bf16 v[60:63], v[240:243], a[228:231], v[60:63]
    buffer_store_dwordx4 v[172:175], v33, s[32:35], s71 offen sc1
    v_mfma_f32_16x16x32_bf16 v[64:67], v[240:243], a[232:235], v[64:67]
    ds_read_b64_tr_b16 v[236:237], v4 offset:57344
    v_cvt_pk_bf16_f32 v49, v50, v51
    v_mfma_f32_16x16x32_bf16 v[64:67], v[244:247], a[248:251], v[64:67]
    ds_read_b128 a[152:155], v9 offset:6144
    v_cvt_pk_bf16_f32 v52, v52, v53
    v_mfma_f32_16x16x32_bf16 v[68:71], v[244:247], a[252:255], v[68:71]
    s_waitcnt lgkmcnt(5)
    ds_read_b64_tr_b16 v[238:239], v4 offset:58368
    v_cvt_pk_bf16_f32 v53, v54, v55
    v_mfma_f32_16x16x32_bf16 v[68:71], v[240:243], a[236:239], v[68:71]
    buffer_store_dwordx4 v[204:207], v33, s[32:35], s71 offen offset:1024 sc1
    v_mfma_f32_16x16x32_bf16 v[72:75], v[248:251], a[224:227], v[72:75]
    ds_read_b64_tr_b16 v[240:241], v5 offset:49152
    v_cvt_pk_bf16_f32 v42, v56, v57
    v_mfma_f32_16x16x32_bf16 v[72:75], v[252:255], a[240:243], v[72:75]
    ds_read_b128 a[148:151], v9 offset:5120
    v_cvt_pk_bf16_f32 v43, v58, v59
    v_mfma_f32_16x16x32_bf16 v[76:79], v[252:255], a[244:247], v[76:79]
    s_add_u32 s71, s97, s85
    ds_read_b64_tr_b16 v[242:243], v5 offset:50176
    v_cvt_pk_bf16_f32 v46, v60, v61
    v_mfma_f32_16x16x32_bf16 v[76:79], v[248:251], a[228:231], v[76:79]
    buffer_store_dwordx4 v[176:179], v33, s[32:35], s71 offen sc1
    v_mfma_f32_16x16x32_bf16 v[80:83], v[248:251], a[232:235], v[80:83]
    ds_read_b64_tr_b16 v[244:245], v5 offset:57344
    v_cvt_pk_bf16_f32 v47, v62, v63
    v_mfma_f32_16x16x32_bf16 v[80:83], v[252:255], a[248:251], v[80:83]
    ds_read_b128 a[144:147], v9 offset:4096
    v_cvt_pk_bf16_f32 v50, v64, v65
    v_mfma_f32_16x16x32_bf16 v[84:87], v[252:255], a[252:255], v[84:87]
    s_waitcnt lgkmcnt(5)
    ds_read_b64_tr_b16 v[246:247], v5 offset:58368
    v_cvt_pk_bf16_f32 v51, v66, v67
    v_mfma_f32_16x16x32_bf16 v[84:87], v[248:251], a[236:239], v[84:87]
    buffer_store_dwordx4 v[208:211], v33, s[32:35], s71 offen offset:1024 sc1
    v_mfma_f32_16x16x32_bf16 v[88:91], v[232:235], a[224:227], v[88:91]
    ds_read_b64_tr_b16 v[248:249], v6 offset:49152
    v_cvt_pk_bf16_f32 v54, v68, v69
    v_mfma_f32_16x16x32_bf16 v[88:91], v[236:239], a[240:243], v[88:91]
    ds_read_b128 a[160:163], v9 offset:8192
    v_cvt_pk_bf16_f32 v55, v70, v71
    v_mfma_f32_16x16x32_bf16 v[92:95], v[236:239], a[244:247], v[92:95]
    ds_read_b64_tr_b16 v[250:251], v6 offset:50176
    v_cvt_pk_bf16_f32 v72, v72, v73
    v_mfma_f32_16x16x32_bf16 v[92:95], v[232:235], a[228:231], v[92:95]
    v_cvt_pk_bf16_f32 v73, v74, v75
    v_cvt_pk_bf16_f32 v76, v76, v77
    v_mfma_f32_16x16x32_bf16 v[96:99], v[232:235], a[232:235], v[96:99]
    ds_read_b64_tr_b16 v[252:253], v6 offset:57344
    v_cvt_pk_bf16_f32 v77, v78, v79
    v_mfma_f32_16x16x32_bf16 v[96:99], v[236:239], a[248:251], v[96:99]
    s_add_u32 s71, s97, s86
    ds_read_b128 a[164:167], v9 offset:9216
    v_cvt_pk_bf16_f32 v80, v80, v81
    v_mfma_f32_16x16x32_bf16 v[100:103], v[236:239], a[252:255], v[100:103]
    s_waitcnt lgkmcnt(5)
    ds_read_b64_tr_b16 v[254:255], v6 offset:58368
    v_cvt_pk_bf16_f32 v81, v82, v83
    v_mfma_f32_16x16x32_bf16 v[100:103], v[232:235], a[236:239], v[100:103]
    buffer_store_dwordx4 v[180:183], v33, s[32:35], s71 offen sc1
    v_mfma_f32_16x16x32_bf16 v[104:107], v[240:243], a[224:227], v[104:107]
    ds_read_b64_tr_b16 v[232:233], v7 offset:49152
    v_cvt_pk_bf16_f32 v84, v84, v85
    v_mfma_f32_16x16x32_bf16 v[104:107], v[244:247], a[240:243], v[104:107]
    ds_read_b128 a[168:171], v9 offset:10240
    v_cvt_pk_bf16_f32 v85, v86, v87
    v_mfma_f32_16x16x32_bf16 v[108:111], v[244:247], a[244:247], v[108:111]
    ds_read_b64_tr_b16 v[234:235], v7 offset:50176
    v_cvt_pk_bf16_f32 v74, v88, v89
    v_mfma_f32_16x16x32_bf16 v[108:111], v[240:243], a[228:231], v[108:111]
    buffer_store_dwordx4 v[212:215], v33, s[32:35], s71 offen offset:1024 sc1
    v_mfma_f32_16x16x32_bf16 v[112:115], v[240:243], a[232:235], v[112:115]
    ds_read_b64_tr_b16 v[236:237], v7 offset:57344
    v_cvt_pk_bf16_f32 v75, v90, v91
    v_mfma_f32_16x16x32_bf16 v[112:115], v[244:247], a[248:251], v[112:115]
    ds_read_b128 a[172:175], v9 offset:11264
    v_cvt_pk_bf16_f32 v78, v92, v93
    v_mfma_f32_16x16x32_bf16 v[116:119], v[244:247], a[252:255], v[116:119]
    s_waitcnt lgkmcnt(5)
    ds_read_b64_tr_b16 v[238:239], v7 offset:58368
    v_cvt_pk_bf16_f32 v79, v94, v95
    v_mfma_f32_16x16x32_bf16 v[116:119], v[240:243], a[236:239], v[116:119]
    buffer_store_dwordx4 v[28:31], v34, s[52:55], s19 offen sc1
    v_mfma_f32_16x16x32_bf16 v[120:123], v[248:251], a[224:227], v[120:123]
    s_mov_b32 s87, 65536
    ds_read_b64_tr_b16 v[240:241], v8 offset:49152
    v_bfe_u32 v32, v17, 5, 4
    v_mfma_f32_16x16x32_bf16 v[120:123], v[252:255], a[240:243], v[120:123]
    s_add_u32 s88, s88, 32768
    ds_read_b64_tr_b16 v[242:243], v8 offset:50176
    v_min_u32 v33, 6, v32
    v_mfma_f32_16x16x32_bf16 v[124:127], v[252:255], a[244:247], v[124:127]
    s_mov_b32 s89, 131072
    ds_read_b64_tr_b16 v[244:245], v8 offset:57344
    v_lshlrev_b32 v32, 10, v32
    v_mfma_f32_16x16x32_bf16 v[124:127], v[248:251], a[228:231], v[124:127]
    s_mov_b32 s90, 4096
    ds_read_b64_tr_b16 v[246:247], v8 offset:58368
    v_lshlrev_b32 v33, 10, v33
    v_mfma_f32_16x16x32_bf16 v[128:131], v[248:251], a[232:235], v[128:131]
    s_mov_b32 s91, 28672
    v_bfe_u32 v34, v17, 4, 1
    v_lshl_add_u32 v32, v34, 7, v32
    v_mfma_f32_16x16x32_bf16 v[128:131], v[252:255], a[248:251], v[128:131]
    s_lshl_b32 s92, s65, 1
    ds_read_b128 a[188:191], v9 offset:15360
    v_lshl_add_u32 v33, v34, 7, v33
    v_mfma_f32_16x16x32_bf16 v[132:135], v[252:255], a[252:255], v[132:135]
    s_waitcnt lgkmcnt(5)
    v_cvt_pk_bf16_f32 v82, v96, v97
    v_cvt_pk_bf16_f32 v83, v98, v99
    v_mfma_f32_16x16x32_bf16 v[132:135], v[248:251], a[236:239], v[132:135]
    v_cvt_pk_bf16_f32 v86, v100, v101
    v_cvt_pk_bf16_f32 v87, v102, v103
    v_cvt_pk_bf16_f32 v104, v104, v105
    v_mfma_f32_16x16x32_bf16 v[136:139], v[232:235], a[224:227], v[136:139]
    v_cvt_pk_bf16_f32 v105, v106, v107
    v_cvt_pk_bf16_f32 v108, v108, v109
    v_cvt_pk_bf16_f32 v109, v110, v111
    v_mfma_f32_16x16x32_bf16 v[136:139], v[236:239], a[240:243], v[136:139]
    s_waitcnt lgkmcnt(1)
    s_barrier
    v_cvt_pk_bf16_f32 v112, v112, v113
    v_cvt_pk_bf16_f32 v113, v114, v115
    v_mfma_f32_16x16x32_bf16 v[140:143], v[236:239], a[244:247], v[140:143]
    v_cvt_pk_bf16_f32 v116, v116, v117
    v_cvt_pk_bf16_f32 v117, v118, v119
    v_cvt_pk_bf16_f32 v106, v120, v121
    v_mfma_f32_16x16x32_bf16 v[140:143], v[232:235], a[228:231], v[140:143]
    ds_read_b128 a[184:187], v9 offset:14336
    ds_read_b128 a[180:183], v9 offset:13312
    v_cvt_pk_bf16_f32 v107, v122, v123
    v_mfma_f32_16x16x32_bf16 v[144:147], v[232:235], a[232:235], v[144:147]
    v_cvt_pk_bf16_f32 v110, v124, v125
    v_cvt_pk_bf16_f32 v111, v126, v127
    v_cvt_pk_bf16_f32 v114, v128, v129
    v_mfma_f32_16x16x32_bf16 v[144:147], v[236:239], a[248:251], v[144:147]
    ds_read_b128 a[176:179], v9 offset:12288
    ds_read_b128 a[192:195], v10 offset:16384
    v_cvt_pk_bf16_f32 v115, v130, v131
    v_mfma_f32_16x16x32_bf16 v[148:151], v[236:239], a[252:255], v[148:151]
    s_waitcnt lgkmcnt(5)
    v_cvt_pk_bf16_f32 v118, v132, v133
    v_cvt_pk_bf16_f32 v119, v134, v135
    v_cvt_pk_bf16_f32 v136, v136, v137
    v_mfma_f32_16x16x32_bf16 v[148:151], v[232:235], a[236:239], v[148:151]
    ds_read_b128 a[196:199], v10 offset:17408
    ds_read_b128 a[204:207], v10 offset:19456
    v_cvt_pk_bf16_f32 v137, v138, v139
    v_mfma_f32_16x16x32_bf16 v[152:155], v[240:243], a[224:227], v[152:155]
    v_cvt_pk_bf16_f32 v140, v140, v141
    v_cvt_pk_bf16_f32 v141, v142, v143
    v_mfma_f32_16x16x32_bf16 v[152:155], v[244:247], a[240:243], v[152:155]
    ds_read_b128 a[200:203], v10 offset:18432
    ds_read_b128 a[208:211], v10 offset:20480
    v_mfma_f32_16x16x32_bf16 v[156:159], v[244:247], a[244:247], v[156:159]
    v_cvt_pk_bf16_f32 v144, v144, v145
    v_cvt_pk_bf16_f32 v145, v146, v147
    v_mfma_f32_16x16x32_bf16 v[156:159], v[240:243], a[228:231], v[156:159]
    ds_read_b128 a[212:215], v10 offset:21504
    ds_read_b128 a[220:223], v10 offset:23552
    v_mfma_f32_16x16x32_bf16 v[160:163], v[240:243], a[232:235], v[160:163]
    v_cvt_pk_bf16_f32 v148, v148, v149
    v_cvt_pk_bf16_f32 v149, v150, v151
    v_mfma_f32_16x16x32_bf16 v[160:163], v[244:247], a[248:251], v[160:163]
    ds_read_b128 a[216:219], v10 offset:22528
    ds_read_b128 v[56:59], v35
    v_mfma_f32_16x16x32_bf16 v[164:167], v[244:247], a[252:255], v[164:167]
    v_cvt_pk_bf16_f32 v138, v152, v153
    v_cvt_pk_bf16_f32 v139, v154, v155
    v_mfma_f32_16x16x32_bf16 v[164:167], v[240:243], a[236:239], v[164:167]
    ds_read_b128 v[60:63], v35
    ds_read_b128 v[64:67], v35
    v_mfma_f32_16x16x32_bf16 v[168:171], a[128:131], v[40:43], 0
    v_cvt_pk_bf16_f32 v142, v156, v157
    v_cvt_pk_bf16_f32 v143, v158, v159
    v_mfma_f32_16x16x32_bf16 v[168:171], a[132:135], v[72:75], v[168:171]
    ds_read_b128 a[224:227], v10 offset:24576
    ds_read_b128 a[228:231], v10 offset:25600
    v_mfma_f32_16x16x32_bf16 v[168:171], a[136:139], v[104:107], v[168:171]
    v_cvt_pk_bf16_f32 v146, v160, v161
    v_cvt_pk_bf16_f32 v147, v162, v163
    v_mfma_f32_16x16x32_bf16 v[168:171], a[140:143], v[136:139], v[168:171]
    ds_read_b128 a[236:239], v10 offset:27648
    ds_read_b128 a[232:235], v10 offset:26624
    v_mfma_f32_16x16x32_bf16 v[172:175], a[156:159], v[136:139], 0
    v_cvt_pk_bf16_f32 v150, v164, v165
    v_cvt_pk_bf16_f32 v151, v166, v167
    v_mfma_f32_16x16x32_bf16 v[172:175], a[152:155], v[104:107], v[172:175]
    ds_read_b128 a[240:243], v10 offset:28672
    ds_read_b128 v[68:71], v35
    v_mov_b32 v248, v26
    v_mfma_f32_16x16x32_bf16 v[172:175], a[148:151], v[72:75], v[172:175]
    v_mov_b32 v249, v26
    v_mov_b32 v250, v26
    v_mov_b32 v251, v26
    v_mfma_f32_16x16x32_bf16 v[172:175], a[144:147], v[40:43], v[172:175]
    s_waitcnt lgkmcnt(6)
    v_mfma_f32_16x16x32_bf16 v[176:179], a[160:163], v[40:43], 0
    v_exp_f32 v168, v168
    v_mfma_f32_16x16x32_bf16 v[176:179], a[164:167], v[72:75], v[176:179]
    v_exp_f32 v169, v169
    v_mfma_f32_16x16x32_bf16 v[176:179], a[168:171], v[104:107], v[176:179]
    v_exp_f32 v170, v170
    v_mfma_f32_16x16x32_bf16 v[176:179], a[172:175], v[136:139], v[176:179]
    v_exp_f32 v171, v171
    v_mfma_f32_16x16x32_bf16 v[180:183], a[188:191], v[136:139], 0
    v_exp_f32 v172, v172
    v_mfma_f32_16x16x32_bf16 v[180:183], a[184:187], v[104:107], v[180:183]
    v_exp_f32 v173, v173
    v_mfma_f32_16x16x32_bf16 v[180:183], a[180:183], v[72:75], v[180:183]
    v_exp_f32 v174, v174
    v_mfma_f32_16x16x32_bf16 v[180:183], a[176:179], v[40:43], v[180:183]
    v_exp_f32 v175, v175
    v_exp_f32 v176, v176
    v_exp_f32 v177, v177
    v_exp_f32 v178, v178
    v_exp_f32 v179, v179
    v_cvt_pk_bf16_f32 v232, v168, v169
    v_cvt_pk_bf16_f32 v233, v170, v171
    v_cvt_pk_bf16_f32 v234, v172, v173
    v_cvt_pk_bf16_f32 v235, v174, v175
    v_cvt_pk_bf16_f32 v236, v176, v177
    v_cvt_pk_bf16_f32 v237, v178, v179
    buffer_load_dword v37, v33, s[40:43], s8 offen
    v_mfma_f32_16x16x32_bf16 v[200:203], a[128:131], v[48:51], 0
    v_exp_f32 v180, v180
    v_mfma_f32_16x16x32_bf16 v[200:203], a[132:135], v[80:83], v[200:203]
    ds_read_b128 a[244:247], v10 offset:29696
    ds_read_b128 a[252:255], v10 offset:31744
    v_mfma_f32_16x16x32_bf16 v[200:203], a[136:139], v[112:115], v[200:203]
    v_exp_f32 v181, v181
    v_mfma_f32_16x16x32_bf16 v[200:203], a[140:143], v[144:147], v[200:203]
    ds_read_b128 a[248:251], v10 offset:30720
    v_cvt_pk_bf16_f32 v238, v180, v181
    v_mfma_f32_16x16x32_bf16 v[204:207], a[156:159], v[144:147], 0
    s_waitcnt vmcnt(1)
    v_exp_f32 v182, v182
    v_mfma_f32_16x16x32_bf16 v[204:207], a[152:155], v[112:115], v[204:207]
    buffer_store_dword v39, v27, s[60:63], s3 offen sc1
    v_mfma_f32_16x16x32_bf16 v[204:207], a[148:151], v[80:83], v[204:207]
    v_exp_f32 v183, v183
    v_mfma_f32_16x16x32_bf16 v[204:207], a[144:147], v[48:51], v[204:207]
    s_cmp_eq_u32 s92, 0
    v_cvt_pk_bf16_f32 v239, v182, v183
    v_mfma_f32_16x16x32_bf16 v[208:211], a[160:163], v[48:51], 0
    buffer_store_dword v39, v27, s[60:63], s18 offen sc1
    s_cbranch_scc1 L_d0
.p2align 3
L_r1:
    v_mfma_f32_16x16x32_bf16 v[208:211], a[164:167], v[80:83], v[208:211]
    v_mfma_f32_16x16x32_bf16 v[208:211], a[168:171], v[112:115], v[208:211]
    s_mov_b32 m0, s88
    v_exp_f32 v200, v200
    v_mfma_f32_16x16x32_bf16 v[208:211], a[172:175], v[144:147], v[208:211]
    buffer_load_dwordx4 v11, s[36:39], s89 offen sc1 lds
    v_mfma_f32_16x16x32_bf16 v[212:215], a[188:191], v[144:147], 0
    v_exp_f32 v201, v201
    v_mfma_f32_16x16x32_bf16 v[212:215], a[184:187], v[112:115], v[212:215]
    v_cvt_pk_bf16_f32 v240, v200, v201
    v_add_f32 v65, v65, v200
    v_mfma_f32_16x16x32_bf16 v[212:215], a[180:183], v[80:83], v[212:215]
    s_waitcnt lgkmcnt(7)
    v_exp_f32 v202, v202
    v_mfma_f32_16x16x32_bf16 v[212:215], a[176:179], v[48:51], v[212:215]
    v_add_f32 v65, v65, v201
    v_add_f32 v65, v65, v202
    v_mfma_f32_16x16x32_bf16 a[0:3], a[192:195], v[232:235], a[0:3]
    v_exp_f32 v203, v203
    v_mfma_f32_16x16x32_bf16 a[0:3], a[196:199], v[236:239], a[0:3]
    v_cvt_pk_bf16_f32 v241, v202, v203
    v_add_f32 v65, v65, v203
    v_mfma_f32_16x16x32_bf16 a[4:7], a[204:207], v[236:239], a[4:7]
    v_exp_f32 v204, v204
    v_mfma_f32_16x16x32_bf16 a[4:7], a[200:203], v[232:235], a[4:7]
    buffer_load_dwordx4 v12, s[36:39], s89 offen offset:1024 sc1 lds
    v_mfma_f32_16x16x32_bf16 a[8:11], a[208:211], v[232:235], a[8:11]
    v_exp_f32 v205, v205
    v_mfma_f32_16x16x32_bf16 a[8:11], a[212:215], v[236:239], a[8:11]
    v_cvt_pk_bf16_f32 v242, v204, v205
    v_add_f32 v65, v65, v204
    v_mfma_f32_16x16x32_bf16 a[12:15], a[220:223], v[236:239], a[12:15]
    v_exp_f32 v206, v206
    v_mfma_f32_16x16x32_bf16 a[12:15], a[216:219], v[232:235], a[12:15]
    v_add_f32 v65, v65, v205
    v_add_f32 v65, v65, v206
    v_mfma_f32_16x16x32_bf16 a[16:19], a[224:227], v[232:235], a[16:19]
    s_waitcnt lgkmcnt(0)
    v_exp_f32 v207, v207
    v_mfma_f32_16x16x32_bf16 a[16:19], a[228:231], v[236:239], a[16:19]
    v_cvt_pk_bf16_f32 v243, v206, v207
    v_add_f32 v65, v65, v207
    v_mfma_f32_16x16x32_bf16 a[20:23], a[236:239], v[236:239], a[20:23]
    v_exp_f32 v208, v208
    v_mfma_f32_16x16x32_bf16 a[20:23], a[232:235], v[232:235], a[20:23]
    v_add_f32 v65, v65, v208
    v_mfma_f32_16x16x32_bf16 a[24:27], a[240:243], v[232:235], a[24:27]
    v_exp_f32 v209, v209
    v_mfma_f32_16x16x32_bf16 a[24:27], a[244:247], v[236:239], a[24:27]
    v_cvt_pk_bf16_f32 v244, v208, v209
    v_add_f32 v65, v65, v209
    v_mfma_f32_16x16x32_bf16 a[28:31], a[252:255], v[236:239], a[28:31]
    v_exp_f32 v210, v210
    v_mfma_f32_16x16x32_bf16 a[28:31], a[248:251], v[232:235], a[28:31]
    buffer_load_dwordx4 v13, s[36:39], s89 offen offset:2048 sc1 lds
    v_mfma_f32_16x16x32_bf16 v[56:59], v[248:251], v[232:235], v[56:59]
    v_exp_f32 v211, v211
    v_mfma_f32_16x16x32_bf16 v[56:59], v[248:251], v[236:239], v[56:59]
    v_cvt_pk_bf16_f32 v245, v210, v211
    v_add_f32 v65, v65, v210
    v_mfma_f32_16x16x32_bf16 v[168:171], a[128:131], v[44:47], 0
    v_exp_f32 v212, v212
    v_mfma_f32_16x16x32_bf16 v[168:171], a[132:135], v[76:79], v[168:171]
    v_add_f32 v65, v65, v211
    v_add_f32 v65, v65, v212
    v_mfma_f32_16x16x32_bf16 v[168:171], a[136:139], v[108:111], v[168:171]
    v_exp_f32 v213, v213
    v_mfma_f32_16x16x32_bf16 v[168:171], a[140:143], v[140:143], v[168:171]
    v_cvt_pk_bf16_f32 v246, v212, v213
    v_add_f32 v65, v65, v213
    v_mfma_f32_16x16x32_bf16 v[172:175], a[156:159], v[140:143], 0
    v_exp_f32 v214, v214
    v_mfma_f32_16x16x32_bf16 v[172:175], a[152:155], v[108:111], v[172:175]
    v_add_f32 v65, v65, v214
    v_mfma_f32_16x16x32_bf16 v[172:175], a[148:151], v[76:79], v[172:175]
    v_exp_f32 v215, v215
    v_mfma_f32_16x16x32_bf16 v[172:175], a[144:147], v[44:47], v[172:175]
    s_add_u32 s70, s89, s90
    v_cvt_pk_bf16_f32 v247, v214, v215
    v_add_f32 v65, v65, v215
    v_mfma_f32_16x16x32_bf16 v[176:179], a[160:163], v[44:47], 0
    buffer_load_dwordx4 v14, s[36:39], s89 offen offset:3072 sc1 lds
    v_mfma_f32_16x16x32_bf16 v[176:179], a[164:167], v[76:79], v[176:179]
    v_mfma_f32_16x16x32_bf16 v[176:179], a[168:171], v[108:111], v[176:179]
    v_exp_f32 v168, v168
    v_mfma_f32_16x16x32_bf16 v[176:179], a[172:175], v[140:143], v[176:179]
    v_add_f32 v61, v61, v168
    v_mfma_f32_16x16x32_bf16 v[180:183], a[188:191], v[140:143], 0
    v_exp_f32 v169, v169
    v_mfma_f32_16x16x32_bf16 v[180:183], a[184:187], v[108:111], v[180:183]
    v_cvt_pk_bf16_f32 v232, v168, v169
    v_add_f32 v61, v61, v169
    v_mfma_f32_16x16x32_bf16 v[180:183], a[180:183], v[76:79], v[180:183]
    s_add_u32 m0, s88, 4096
    v_exp_f32 v170, v170
    v_mfma_f32_16x16x32_bf16 v[180:183], a[176:179], v[44:47], v[180:183]
    buffer_load_dwordx4 v11, s[36:39], s70 offen sc1 lds
    v_mfma_f32_16x16x32_bf16 a[64:67], a[192:195], v[240:243], a[64:67]
    v_exp_f32 v171, v171
    v_mfma_f32_16x16x32_bf16 a[64:67], a[196:199], v[244:247], a[64:67]
    v_cvt_pk_bf16_f32 v233, v170, v171
    v_add_f32 v61, v61, v170
    v_mfma_f32_16x16x32_bf16 a[68:71], a[204:207], v[244:247], a[68:71]
    v_exp_f32 v172, v172
    v_mfma_f32_16x16x32_bf16 a[68:71], a[200:203], v[240:243], a[68:71]
    v_add_f32 v61, v61, v171
    v_add_f32 v61, v61, v172
    v_mfma_f32_16x16x32_bf16 a[72:75], a[208:211], v[240:243], a[72:75]
    v_exp_f32 v173, v173
    v_mfma_f32_16x16x32_bf16 a[72:75], a[212:215], v[244:247], a[72:75]
    v_cvt_pk_bf16_f32 v234, v172, v173
    v_add_f32 v61, v61, v173
    v_mfma_f32_16x16x32_bf16 a[76:79], a[220:223], v[244:247], a[76:79]
    v_exp_f32 v174, v174
    v_mfma_f32_16x16x32_bf16 a[76:79], a[216:219], v[240:243], a[76:79]
    v_add_f32 v61, v61, v174
    v_mfma_f32_16x16x32_bf16 a[80:83], a[224:227], v[240:243], a[80:83]
    v_exp_f32 v175, v175
    v_mfma_f32_16x16x32_bf16 a[80:83], a[228:231], v[244:247], a[80:83]
    v_cvt_pk_bf16_f32 v235, v174, v175
    v_add_f32 v61, v61, v175
    v_mfma_f32_16x16x32_bf16 a[84:87], a[236:239], v[244:247], a[84:87]
    v_exp_f32 v176, v176
    v_mfma_f32_16x16x32_bf16 a[84:87], a[232:235], v[240:243], a[84:87]
    buffer_load_dwordx4 v12, s[36:39], s70 offen offset:1024 sc1 lds
    v_mfma_f32_16x16x32_bf16 a[88:91], a[240:243], v[240:243], a[88:91]
L_hop8:
    s_cbranch_execz L_hop12
    v_exp_f32 v177, v177
    v_mfma_f32_16x16x32_bf16 a[88:91], a[244:247], v[244:247], a[88:91]
    v_cvt_pk_bf16_f32 v236, v176, v177
    v_add_f32 v61, v61, v176
    v_mfma_f32_16x16x32_bf16 a[92:95], a[252:255], v[244:247], a[92:95]
    v_exp_f32 v178, v178
    v_mfma_f32_16x16x32_bf16 a[92:95], a[248:251], v[240:243], a[92:95]
    v_add_f32 v61, v61, v177
    v_add_f32 v61, v61, v178
    v_mfma_f32_16x16x32_bf16 v[200:203], a[128:131], v[52:55], 0
    s_add_u32 s87, s87, 32768
    v_exp_f32 v179, v179
    v_mfma_f32_16x16x32_bf16 v[200:203], a[132:135], v[84:87], v[200:203]
    v_cvt_pk_bf16_f32 v237, v178, v179
    v_add_f32 v61, v61, v179
    v_mfma_f32_16x16x32_bf16 v[200:203], a[136:139], v[116:119], v[200:203]
    s_sub_u32 s69, s87, 163840
    v_exp_f32 v180, v180
    v_mfma_f32_16x16x32_bf16 v[200:203], a[140:143], v[148:151], v[200:203]
    v_add_f32 v61, v61, v180
    v_mfma_f32_16x16x32_bf16 v[204:207], a[156:159], v[148:151], 0
    s_min_u32 s87, s87, s69
    v_exp_f32 v181, v181
    v_mfma_f32_16x16x32_bf16 v[204:207], a[152:155], v[116:119], v[204:207]
    v_cvt_pk_bf16_f32 v238, v180, v181
    v_add_u32 v9, s87, v17
    v_mfma_f32_16x16x32_bf16 v[204:207], a[148:151], v[84:87], v[204:207]
    s_waitcnt vmcnt(22)
    v_exp_f32 v182, v182
    v_mfma_f32_16x16x32_bf16 v[204:207], a[144:147], v[52:55], v[204:207]
    v_add_f32 v61, v61, v181
    v_add_f32 v61, v61, v182
    v_mfma_f32_16x16x32_bf16 v[208:211], a[160:163], v[52:55], 0
    v_exp_f32 v183, v183
    v_mfma_f32_16x16x32_bf16 v[208:211], a[164:167], v[84:87], v[208:211]
    v_cvt_pk_bf16_f32 v239, v182, v183
    v_add_f32 v61, v61, v183
    v_mfma_f32_16x16x32_bf16 v[208:211], a[168:171], v[116:119], v[208:211]
    v_exp_f32 v200, v200
    v_mfma_f32_16x16x32_bf16 v[208:211], a[172:175], v[148:151], v[208:211]
    s_barrier
    v_mfma_f32_16x16x32_bf16 v[212:215], a[188:191], v[148:151], 0
    v_exp_f32 v201, v201
    v_mfma_f32_16x16x32_bf16 v[212:215], a[184:187], v[116:119], v[212:215]
    ds_read_b128 a[128:131], v9
    v_cvt_pk_bf16_f32 v240, v200, v201
    v_mfma_f32_16x16x32_bf16 v[212:215], a[180:183], v[84:87], v[212:215]
    v_exp_f32 v202, v202
    v_mfma_f32_16x16x32_bf16 v[212:215], a[176:179], v[52:55], v[212:215]
    ds_read_b128 a[132:135], v9 offset:1024
    ds_read_b128 a[136:139], v9 offset:2048
    v_mfma_f32_16x16x32_bf16 a[32:35], a[192:195], v[232:235], a[32:35]
    v_exp_f32 v203, v203
    v_mfma_f32_16x16x32_bf16 a[32:35], a[196:199], v[236:239], a[32:35]
    ds_read_b128 a[140:143], v9 offset:3072
    v_cvt_pk_bf16_f32 v241, v202, v203
    v_mfma_f32_16x16x32_bf16 a[36:39], a[204:207], v[236:239], a[36:39]
    v_exp_f32 v204, v204
    v_mfma_f32_16x16x32_bf16 a[36:39], a[200:203], v[232:235], a[36:39]
    ds_read_b128 a[156:159], v9 offset:7168
    v_mfma_f32_16x16x32_bf16 a[40:43], a[208:211], v[232:235], a[40:43]
    v_exp_f32 v205, v205
    v_mfma_f32_16x16x32_bf16 a[40:43], a[212:215], v[236:239], a[40:43]
    ds_read_b128 a[152:155], v9 offset:6144
    v_cvt_pk_bf16_f32 v242, v204, v205
    v_mfma_f32_16x16x32_bf16 a[44:47], a[220:223], v[236:239], a[44:47]
    v_exp_f32 v206, v206
    v_mfma_f32_16x16x32_bf16 a[44:47], a[216:219], v[232:235], a[44:47]
    ds_read_b128 a[148:151], v9 offset:5120
    ds_read_b128 a[144:147], v9 offset:4096
    v_mfma_f32_16x16x32_bf16 a[48:51], a[224:227], v[232:235], a[48:51]
    v_exp_f32 v207, v207
    v_mfma_f32_16x16x32_bf16 a[48:51], a[228:231], v[236:239], a[48:51]
    ds_read_b128 a[160:163], v9 offset:8192
    v_cvt_pk_bf16_f32 v243, v206, v207
    v_mfma_f32_16x16x32_bf16 a[52:55], a[236:239], v[236:239], a[52:55]
    v_exp_f32 v208, v208
    v_mfma_f32_16x16x32_bf16 a[52:55], a[232:235], v[232:235], a[52:55]
    ds_read_b128 a[164:167], v9 offset:9216
    v_mfma_f32_16x16x32_bf16 a[56:59], a[240:243], v[232:235], a[56:59]
    v_exp_f32 v209, v209
    v_mfma_f32_16x16x32_bf16 a[56:59], a[244:247], v[236:239], a[56:59]
    ds_read_b128 a[168:171], v9 offset:10240
    v_cvt_pk_bf16_f32 v244, v208, v209
    v_mfma_f32_16x16x32_bf16 a[60:63], a[252:255], v[236:239], a[60:63]
    s_waitcnt lgkmcnt(4)
    v_exp_f32 v210, v210
    v_mfma_f32_16x16x32_bf16 a[60:63], a[248:251], v[232:235], a[60:63]
    ds_read_b128 a[172:175], v9 offset:11264
    v_mfma_f32_16x16x32_bf16 v[168:171], a[128:131], v[40:43], 0
    v_exp_f32 v211, v211
    v_mfma_f32_16x16x32_bf16 v[168:171], a[132:135], v[72:75], v[168:171]
    ds_read_b128 a[188:191], v9 offset:15360
    v_cvt_pk_bf16_f32 v245, v210, v211
    v_mfma_f32_16x16x32_bf16 v[168:171], a[136:139], v[104:107], v[168:171]
    v_exp_f32 v212, v212
    v_mfma_f32_16x16x32_bf16 v[168:171], a[140:143], v[136:139], v[168:171]
    ds_read_b128 a[184:187], v9 offset:14336
    v_mfma_f32_16x16x32_bf16 v[172:175], a[156:159], v[136:139], 0
    v_exp_f32 v213, v213
    v_mfma_f32_16x16x32_bf16 v[172:175], a[152:155], v[104:107], v[172:175]
    ds_read_b128 a[180:183], v9 offset:13312
    v_cvt_pk_bf16_f32 v246, v212, v213
    v_mfma_f32_16x16x32_bf16 v[172:175], a[148:151], v[72:75], v[172:175]
    s_waitcnt lgkmcnt(4)
    v_exp_f32 v214, v214
    v_mfma_f32_16x16x32_bf16 v[172:175], a[144:147], v[40:43], v[172:175]
    ds_read_b128 a[176:179], v9 offset:12288
    v_mfma_f32_16x16x32_bf16 v[176:179], a[160:163], v[40:43], 0
    v_exp_f32 v215, v215
    v_mfma_f32_16x16x32_bf16 v[176:179], a[164:167], v[72:75], v[176:179]
    v_cvt_pk_bf16_f32 v247, v214, v215
    v_mfma_f32_16x16x32_bf16 v[176:179], a[168:171], v[104:107], v[176:179]
    s_waitcnt lgkmcnt(2)
    v_exp_f32 v168, v168
    v_mfma_f32_16x16x32_bf16 v[176:179], a[172:175], v[136:139], v[176:179]
    buffer_load_dwordx4 v13, s[36:39], s70 offen offset:2048 sc1 lds
    v_mfma_f32_16x16x32_bf16 v[180:183], a[188:191], v[136:139], 0
    v_exp_f32 v169, v169
    v_mfma_f32_16x16x32_bf16 v[180:183], a[184:187], v[104:107], v[180:183]
    s_waitcnt lgkmcnt(0)
    v_cvt_pk_bf16_f32 v232, v168, v169
    v_mov_b32 v10, v9
    v_mfma_f32_16x16x32_bf16 v[180:183], a[180:183], v[72:75], v[180:183]
    v_exp_f32 v170, v170
    v_mfma_f32_16x16x32_bf16 v[180:183], a[176:179], v[40:43], v[180:183]
    buffer_load_dwordx4 v14, s[36:39], s70 offen offset:3072 sc1 lds
    v_mfma_f32_16x16x32_bf16 a[96:99], a[192:195], v[240:243], a[96:99]
    s_add_u32 s88, s88, 32768
    v_exp_f32 v171, v171
    v_mfma_f32_16x16x32_bf16 a[96:99], a[196:199], v[244:247], a[96:99]
    ds_read_b128 a[192:195], v10 offset:16384
    v_cvt_pk_bf16_f32 v233, v170, v171
    v_mfma_f32_16x16x32_bf16 a[100:103], a[204:207], v[244:247], a[100:103]
    s_sub_u32 s69, s88, 163840
    v_exp_f32 v172, v172
    v_mfma_f32_16x16x32_bf16 a[100:103], a[200:203], v[240:243], a[100:103]
    ds_read_b128 a[196:199], v10 offset:17408
    ds_read_b128 a[204:207], v10 offset:19456
    v_mfma_f32_16x16x32_bf16 a[104:107], a[208:211], v[240:243], a[104:107]
    s_min_u32 s88, s88, s69
    v_exp_f32 v173, v173
    v_mfma_f32_16x16x32_bf16 a[104:107], a[212:215], v[244:247], a[104:107]
    ds_read_b128 a[200:203], v10 offset:18432
    v_cvt_pk_bf16_f32 v234, v172, v173
    v_mfma_f32_16x16x32_bf16 a[108:111], a[220:223], v[244:247], a[108:111]
    v_exp_f32 v174, v174
    v_mfma_f32_16x16x32_bf16 a[108:111], a[216:219], v[240:243], a[108:111]
    ds_read_b128 a[208:211], v10 offset:20480
    ds_read_b128 a[212:215], v10 offset:21504
    v_mfma_f32_16x16x32_bf16 a[112:115], a[224:227], v[240:243], a[112:115]
    s_add_u32 s89, s70, s91
    v_exp_f32 v175, v175
    v_mfma_f32_16x16x32_bf16 a[112:115], a[228:231], v[244:247], a[112:115]
    ds_read_b128 a[220:223], v10 offset:23552
    v_cvt_pk_bf16_f32 v235, v174, v175
    v_mfma_f32_16x16x32_bf16 a[116:119], a[236:239], v[244:247], a[116:119]
    s_sub_u32 s92, s92, 1
    v_exp_f32 v176, v176
    v_mfma_f32_16x16x32_bf16 a[116:119], a[232:235], v[240:243], a[116:119]
    ds_read_b128 a[216:219], v10 offset:22528
    ds_read_b128 a[224:227], v10 offset:24576
    v_mfma_f32_16x16x32_bf16 a[120:123], a[240:243], v[240:243], a[120:123]
    v_exp_f32 v177, v177
    v_mfma_f32_16x16x32_bf16 a[120:123], a[244:247], v[244:247], a[120:123]
    ds_read_b128 a[228:231], v10 offset:25600
    v_cvt_pk_bf16_f32 v236, v176, v177
    v_mfma_f32_16x16x32_bf16 a[124:127], a[252:255], v[244:247], a[124:127]
    v_exp_f32 v178, v178
    v_mfma_f32_16x16x32_bf16 a[124:127], a[248:251], v[240:243], a[124:127]
    ds_read_b128 a[236:239], v10 offset:27648
    ds_read_b128 a[232:235], v10 offset:26624
    v_mfma_f32_16x16x32_bf16 v[68:71], v[248:251], v[240:243], v[68:71]
    v_exp_f32 v179, v179
    v_mfma_f32_16x16x32_bf16 v[68:71], v[248:251], v[244:247], v[68:71]
    ds_read_b128 a[240:243], v10 offset:28672
    v_cvt_pk_bf16_f32 v237, v178, v179
    v_mfma_f32_16x16x32_bf16 v[200:203], a[128:131], v[48:51], 0
    v_exp_f32 v180, v180
    v_mfma_f32_16x16x32_bf16 v[200:203], a[132:135], v[80:83], v[200:203]
    ds_read_b128 a[244:247], v10 offset:29696
    ds_read_b128 a[252:255], v10 offset:31744
    v_mfma_f32_16x16x32_bf16 v[200:203], a[136:139], v[112:115], v[200:203]
    v_exp_f32 v181, v181
    v_mfma_f32_16x16x32_bf16 v[200:203], a[140:143], v[144:147], v[200:203]
    ds_read_b128 a[248:251], v10 offset:30720
    v_cvt_pk_bf16_f32 v238, v180, v181
    v_mfma_f32_16x16x32_bf16 v[204:207], a[156:159], v[144:147], 0
    v_exp_f32 v182, v182
    v_mfma_f32_16x16x32_bf16 v[204:207], a[152:155], v[112:115], v[204:207]
    v_mfma_f32_16x16x32_bf16 v[204:207], a[148:151], v[80:83], v[204:207]
    v_exp_f32 v183, v183
    v_mfma_f32_16x16x32_bf16 v[204:207], a[144:147], v[48:51], v[204:207]
    s_cmp_lg_u32 s92, 0
    v_cvt_pk_bf16_f32 v239, v182, v183
    v_mfma_f32_16x16x32_bf16 v[208:211], a[160:163], v[48:51], 0
    s_cbranch_scc1 L_r1
    s_cmp_eq_u32 s65, 7
    s_cbranch_scc0 L_d0
    s_mov_b32 s89, 0
    s_mov_b32 s90, 8192
    s_mov_b32 s91, 122880
    s_mov_b32 s36, s40
    s_mov_b32 s37, s41
    s_mov_b32 s38, s42
    v_mov_b32 v11, v18
    v_mov_b32 v12, v19
    v_mov_b32 v13, v20
    v_mov_b32 v14, v21
L_d0:
    v_mfma_f32_16x16x32_bf16 v[208:211], a[164:167], v[80:83], v[208:211]
    v_mov_b32 v152, v65
    v_mov_b32 v153, v61
    v_mfma_f32_16x16x32_bf16 v[208:211], a[168:171], v[112:115], v[208:211]
    s_mov_b32 m0, s88
    v_exp_f32 v200, v200
    v_mfma_f32_16x16x32_bf16 v[208:211], a[172:175], v[144:147], v[208:211]
    buffer_load_dwordx4 v11, s[36:39], s89 offen sc1 lds
    v_mfma_f32_16x16x32_bf16 v[212:215], a[188:191], v[144:147], 0
    v_exp_f32 v201, v201
    v_mfma_f32_16x16x32_bf16 v[212:215], a[184:187], v[112:115], v[212:215]
    v_cvt_pk_bf16_f32 v240, v200, v201
    v_permlane32_swap_b32 v152, v65
    v_mfma_f32_16x16x32_bf16 v[212:215], a[180:183], v[80:83], v[212:215]
    s_waitcnt lgkmcnt(7)
    v_exp_f32 v202, v202
    v_mfma_f32_16x16x32_bf16 v[212:215], a[176:179], v[48:51], v[212:215]
    buffer_load_dwordx4 v12, s[36:39], s89 offen offset:1024 sc1 lds
    v_mfma_f32_16x16x32_bf16 a[0:3], a[192:195], v[232:235], a[0:3]
    v_exp_f32 v203, v203
    v_mfma_f32_16x16x32_bf16 a[0:3], a[196:199], v[236:239], a[0:3]
    v_cvt_pk_bf16_f32 v241, v202, v203
    v_permlane32_swap_b32 v153, v61
    v_mfma_f32_16x16x32_bf16 a[4:7], a[204:207], v[236:239], a[4:7]
    v_exp_f32 v204, v204
    v_mfma_f32_16x16x32_bf16 a[4:7], a[200:203], v[232:235], a[4:7]
    v_add_f32 v65, v65, v152
    v_add_f32 v61, v61, v153
    v_mfma_f32_16x16x32_bf16 a[8:11], a[208:211], v[232:235], a[8:11]
    v_exp_f32 v205, v205
    v_mfma_f32_16x16x32_bf16 a[8:11], a[212:215], v[236:239], a[8:11]
    v_cvt_pk_bf16_f32 v242, v204, v205
    v_mov_b32 v152, v65
    v_mfma_f32_16x16x32_bf16 a[12:15], a[220:223], v[236:239], a[12:15]
    v_exp_f32 v206, v206
    v_mfma_f32_16x16x32_bf16 a[12:15], a[216:219], v[232:235], a[12:15]
    buffer_load_dwordx4 v13, s[36:39], s89 offen offset:2048 sc1 lds
    v_mfma_f32_16x16x32_bf16 a[16:19], a[224:227], v[232:235], a[16:19]
    s_waitcnt lgkmcnt(0)
    v_exp_f32 v207, v207
    v_mfma_f32_16x16x32_bf16 a[16:19], a[228:231], v[236:239], a[16:19]
    v_cvt_pk_bf16_f32 v243, v206, v207
    v_mov_b32 v153, v61
    v_mfma_f32_16x16x32_bf16 a[20:23], a[236:239], v[236:239], a[20:23]
    v_exp_f32 v208, v208
    v_mfma_f32_16x16x32_bf16 a[20:23], a[232:235], v[232:235], a[20:23]
    v_permlane16_swap_b32 v152, v65
    v_permlane16_swap_b32 v153, v61
    v_mfma_f32_16x16x32_bf16 a[24:27], a[240:243], v[232:235], a[24:27]
    v_exp_f32 v209, v209
    v_mfma_f32_16x16x32_bf16 a[24:27], a[244:247], v[236:239], a[24:27]
    v_cvt_pk_bf16_f32 v244, v208, v209
    v_add_f32 v65, v65, v152
    v_mfma_f32_16x16x32_bf16 a[28:31], a[252:255], v[236:239], a[28:31]
    s_add_u32 s70, s89, s90
    v_exp_f32 v210, v210
    v_mfma_f32_16x16x32_bf16 a[28:31], a[248:251], v[232:235], a[28:31]
    buffer_load_dwordx4 v14, s[36:39], s89 offen offset:3072 sc1 lds
    v_mfma_f32_16x16x32_bf16 v[56:59], v[248:251], v[232:235], v[56:59]
    v_exp_f32 v211, v211
    v_mfma_f32_16x16x32_bf16 v[56:59], v[248:251], v[236:239], v[56:59]
    v_cvt_pk_bf16_f32 v245, v210, v211
    v_add_f32 v61, v61, v153
    v_mfma_f32_16x16x32_bf16 v[168:171], a[128:131], v[44:47], v[184:187]
    v_exp_f32 v212, v212
    v_mfma_f32_16x16x32_bf16 v[168:171], a[132:135], v[76:79], v[168:171]
    v_add_f32 v64, v64, v65
    v_add_f32 v60, v60, v61
    v_mfma_f32_16x16x32_bf16 v[168:171], a[136:139], v[108:111], v[168:171]
    v_exp_f32 v213, v213
    v_mfma_f32_16x16x32_bf16 v[168:171], a[140:143], v[140:143], v[168:171]
    v_cvt_pk_bf16_f32 v246, v212, v213
    v_subrev_f32 v216, 0x74800000, v16
    v_mfma_f32_16x16x32_bf16 v[172:175], a[156:159], v[140:143], v[188:191]
    s_add_u32 m0, s88, 4096
    v_exp_f32 v214, v214
    v_mfma_f32_16x16x32_bf16 v[172:175], a[152:155], v[108:111], v[172:175]
    buffer_load_dwordx4 v11, s[36:39], s70 offen sc1 lds
    v_mfma_f32_16x16x32_bf16 v[172:175], a[148:151], v[76:79], v[172:175]
    v_exp_f32 v215, v215
    v_mfma_f32_16x16x32_bf16 v[172:175], a[144:147], v[44:47], v[172:175]
    v_cvt_pk_bf16_f32 v247, v214, v215
    v_and_b32 v35, 255, v17
    v_mfma_f32_16x16x32_bf16 v[176:179], a[160:163], v[44:47], v[192:195]
    v_min_f32 v216, 0, v216
    v_subrev_f32 v217, 0x74820000, v16
    v_mfma_f32_16x16x32_bf16 v[176:179], a[164:167], v[76:79], v[176:179]
    v_min_f32 v217, 0, v217
    v_subrev_f32 v218, 0x74840000, v16
    v_mfma_f32_16x16x32_bf16 v[176:179], a[168:171], v[108:111], v[176:179]
    s_bitcmp0_b32 s68, 2
    v_exp_f32 v168, v168
    v_mfma_f32_16x16x32_bf16 v[176:179], a[172:175], v[140:143], v[176:179]
    buffer_load_dwordx4 v12, s[36:39], s70 offen offset:1024 sc1 lds
    v_mfma_f32_16x16x32_bf16 v[180:183], a[188:191], v[140:143], v[196:199]
    s_cselect_b32 s94, s86, s84
    v_exp_f32 v169, v169
    v_mfma_f32_16x16x32_bf16 v[180:183], a[184:187], v[108:111], v[180:183]
    v_cvt_pk_bf16_f32 v232, v168, v169
    v_min_f32 v218, 0, v218
    v_mfma_f32_16x16x32_bf16 v[180:183], a[180:183], v[76:79], v[180:183]
    s_cselect_b32 s95, s83, s85
    v_exp_f32 v170, v170
    v_mfma_f32_16x16x32_bf16 v[180:183], a[176:179], v[44:47], v[180:183]
    v_subrev_f32 v219, 0x74860000, v16
    v_min_f32 v219, 0, v219
    v_mfma_f32_16x16x32_bf16 a[64:67], a[192:195], v[240:243], a[64:67]
    s_cselect_b32 s79, s75, s73
    v_exp_f32 v171, v171
    v_mfma_f32_16x16x32_bf16 a[64:67], a[196:199], v[244:247], a[64:67]
    v_cvt_pk_bf16_f32 v233, v170, v171
    v_subrev_f32 v220, 0x74a00000, v16
    v_mfma_f32_16x16x32_bf16 a[68:71], a[204:207], v[244:247], a[68:71]
    s_cselect_b32 s75, s72, s74
    v_exp_f32 v172, v172
    v_mfma_f32_16x16x32_bf16 a[68:71], a[200:203], v[240:243], a[68:71]
    buffer_load_dwordx4 v13, s[36:39], s70 offen offset:2048 sc1 lds
    v_mfma_f32_16x16x32_bf16 a[72:75], a[208:211], v[240:243], a[72:75]
    s_cselect_b32 s78, 540672, 0
    v_exp_f32 v173, v173
    v_mfma_f32_16x16x32_bf16 a[72:75], a[212:215], v[244:247], a[72:75]
    v_cvt_pk_bf16_f32 v234, v172, v173
    v_min_f32 v220, 0, v220
    v_mfma_f32_16x16x32_bf16 a[76:79], a[220:223], v[244:247], a[76:79]
    s_mov_b32 s74, s79
    v_exp_f32 v174, v174
    v_mfma_f32_16x16x32_bf16 a[76:79], a[216:219], v[240:243], a[76:79]
    v_subrev_f32 v221, 0x74a20000, v16
    v_min_f32 v221, 0, v221
    v_mfma_f32_16x16x32_bf16 a[80:83], a[224:227], v[240:243], a[80:83]
    s_add_u32 s78, s78, s1
    v_exp_f32 v175, v175
    v_mfma_f32_16x16x32_bf16 a[80:83], a[228:231], v[244:247], a[80:83]
    v_cvt_pk_bf16_f32 v235, v174, v175
    v_subrev_f32 v222, 0x74a40000, v16
    v_mfma_f32_16x16x32_bf16 a[84:87], a[236:239], v[244:247], a[84:87]
    s_add_u32 s78, s78, 540672
    v_exp_f32 v176, v176
    v_mfma_f32_16x16x32_bf16 a[84:87], a[232:235], v[240:243], a[84:87]
    buffer_load_dwordx4 v14, s[36:39], s70 offen offset:3072 sc1 lds
    v_mfma_f32_16x16x32_bf16 a[88:91], a[240:243], v[240:243], a[88:91]
    s_add_u32 s3, s3, 540672
    v_exp_f32 v177, v177
    v_mfma_f32_16x16x32_bf16 a[88:91], a[244:247], v[244:247], a[88:91]
    v_cvt_pk_bf16_f32 v236, v176, v177
    v_min_f32 v222, 0, v222
    v_mfma_f32_16x16x32_bf16 a[92:95], a[252:255], v[244:247], a[92:95]
    s_add_u32 s0, s3, 540672
    v_exp_f32 v178, v178
    v_mfma_f32_16x16x32_bf16 a[92:95], a[248:251], v[240:243], a[92:95]
    buffer_load_dword v37, v32, s[44:47], s7 offen
    v_mfma_f32_16x16x32_bf16 v[64:67], v[248:251], v[240:243], v[64:67]
    v_exp_f32 v179, v179
    v_mfma_f32_16x16x32_bf16 v[64:67], v[248:251], v[244:247], v[64:67]
    v_cvt_pk_bf16_f32 v237, v178, v179
    v_subrev_f32 v223, 0x74a60000, v16
    v_mfma_f32_16x16x32_bf16 v[200:203], a[128:131], v[52:55], 0
    s_add_u32 s87, s87, 32768
    v_exp_f32 v180, v180
    v_mfma_f32_16x16x32_bf16 v[200:203], a[132:135], v[84:87], v[200:203]
    v_min_f32 v223, 0, v223
    v_subrev_f32 v224, 0x74c00000, v16
    v_mfma_f32_16x16x32_bf16 v[200:203], a[136:139], v[116:119], v[200:203]
    s_sub_u32 s69, s87, 163840
    v_exp_f32 v181, v181
    v_mfma_f32_16x16x32_bf16 v[200:203], a[140:143], v[148:151], v[200:203]
    v_cvt_pk_bf16_f32 v238, v180, v181
    v_min_f32 v224, 0, v224
    v_mfma_f32_16x16x32_bf16 v[204:207], a[156:159], v[148:151], 0
    s_min_u32 s87, s87, s69
    v_exp_f32 v182, v182
    v_mfma_f32_16x16x32_bf16 v[204:207], a[152:155], v[116:119], v[204:207]
    v_add_u32 v9, s87, v17
    v_subrev_f32 v225, 0x74c20000, v16
    v_mfma_f32_16x16x32_bf16 v[204:207], a[148:151], v[84:87], v[204:207]
    s_waitcnt vmcnt(25)
    v_exp_f32 v183, v183
    v_mfma_f32_16x16x32_bf16 v[204:207], a[144:147], v[52:55], v[204:207]
    v_cvt_pk_bf16_f32 v239, v182, v183
    v_min_f32 v225, 0, v225
    v_mfma_f32_16x16x32_bf16 v[208:211], a[160:163], v[52:55], 0
    s_barrier
    v_subrev_f32 v226, 0x74c40000, v16
    v_min_f32 v226, 0, v226
    v_mfma_f32_16x16x32_bf16 v[208:211], a[164:167], v[84:87], v[208:211]
    ds_read_b128 a[128:131], v9
    v_subrev_f32 v227, 0x74c60000, v16
    v_mfma_f32_16x16x32_bf16 v[208:211], a[168:171], v[116:119], v[208:211]
    v_exp_f32 v200, v200
    v_mfma_f32_16x16x32_bf16 v[208:211], a[172:175], v[148:151], v[208:211]
    ds_read_b128 a[132:135], v9 offset:1024
    v_min_f32 v227, 0, v227
    v_mfma_f32_16x16x32_bf16 v[212:215], a[188:191], v[148:151], 0
    v_exp_f32 v201, v201
    v_mfma_f32_16x16x32_bf16 v[212:215], a[184:187], v[116:119], v[212:215]
    ds_read_b128 a[136:139], v9 offset:2048
    v_cvt_pk_bf16_f32 v240, v200, v201
    v_mfma_f32_16x16x32_bf16 v[212:215], a[180:183], v[84:87], v[212:215]
    v_exp_f32 v202, v202
    v_mfma_f32_16x16x32_bf16 v[212:215], a[176:179], v[52:55], v[212:215]
    ds_read_b128 a[140:143], v9 offset:3072
    v_subrev_f32 v228, 0x74e00000, v16
    v_mfma_f32_16x16x32_bf16 a[32:35], a[192:195], v[232:235], a[32:35]
    v_exp_f32 v203, v203
    v_mfma_f32_16x16x32_bf16 a[32:35], a[196:199], v[236:239], a[32:35]
    ds_read_b128 a[156:159], v9 offset:7168
    v_cvt_pk_bf16_f32 v241, v202, v203
    v_mfma_f32_16x16x32_bf16 a[36:39], a[204:207], v[236:239], a[36:39]
    v_exp_f32 v204, v204
    v_mfma_f32_16x16x32_bf16 a[36:39], a[200:203], v[232:235], a[36:39]
    ds_read_b128 a[152:155], v9 offset:6144
    v_min_f32 v228, 0, v228
    v_mfma_f32_16x16x32_bf16 a[40:43], a[208:211], v[232:235], a[40:43]
    v_exp_f32 v205, v205
    v_mfma_f32_16x16x32_bf16 a[40:43], a[212:215], v[236:239], a[40:43]
    ds_read_b128 a[148:151], v9 offset:5120
    v_cvt_pk_bf16_f32 v242, v204, v205
    v_mfma_f32_16x16x32_bf16 a[44:47], a[220:223], v[236:239], a[44:47]
    v_exp_f32 v206, v206
    v_mfma_f32_16x16x32_bf16 a[44:47], a[216:219], v[232:235], a[44:47]
    ds_read_b128 a[144:147], v9 offset:4096
    v_subrev_f32 v229, 0x74e20000, v16
    v_mfma_f32_16x16x32_bf16 a[48:51], a[224:227], v[232:235], a[48:51]
    v_exp_f32 v207, v207
    v_mfma_f32_16x16x32_bf16 a[48:51], a[228:231], v[236:239], a[48:51]
    ds_read_b128 a[160:163], v9 offset:8192
    v_cvt_pk_bf16_f32 v243, v206, v207
    v_mfma_f32_16x16x32_bf16 a[52:55], a[236:239], v[236:239], a[52:55]
    v_exp_f32 v208, v208
    v_mfma_f32_16x16x32_bf16 a[52:55], a[232:235], v[232:235], a[52:55]
    ds_read_b128 a[164:167], v9 offset:9216
    v_min_f32 v229, 0, v229
    v_mfma_f32_16x16x32_bf16 a[56:59], a[240:243], v[232:235], a[56:59]
    v_exp_f32 v209, v209
    v_mfma_f32_16x16x32_bf16 a[56:59], a[244:247], v[236:239], a[56:59]
    ds_read_b128 a[168:171], v9 offset:10240
    v_cvt_pk_bf16_f32 v244, v208, v209
    v_mfma_f32_16x16x32_bf16 a[60:63], a[252:255], v[236:239], a[60:63]
    v_exp_f32 v210, v210
    v_mfma_f32_16x16x32_bf16 a[60:63], a[248:251], v[232:235], a[60:63]
    ds_read_b128 a[172:175], v9 offset:11264
    v_subrev_f32 v230, 0x74e40000, v16
    v_mfma_f32_16x16x32_bf16 v[60:63], v[248:251], v[232:235], v[60:63]
    s_waitcnt lgkmcnt(5)
    v_exp_f32 v211, v211
    v_mfma_f32_16x16x32_bf16 v[60:63], v[248:251], v[236:239], v[60:63]
    ds_read_b128 a[188:191], v9 offset:15360
    v_cvt_pk_bf16_f32 v245, v210, v211
    v_mfma_f32_16x16x32_bf16 v[168:171], a[128:131], v[40:43], 0
    v_exp_f32 v212, v212
    v_mfma_f32_16x16x32_bf16 v[168:171], a[132:135], v[72:75], v[168:171]
    ds_read_b128 a[184:187], v9 offset:14336
    v_min_f32 v230, 0, v230
    v_mfma_f32_16x16x32_bf16 v[168:171], a[136:139], v[104:107], v[168:171]
    v_exp_f32 v213, v213
    v_mfma_f32_16x16x32_bf16 v[168:171], a[140:143], v[136:139], v[168:171]
    ds_read_b128 a[180:183], v9 offset:13312
    v_cvt_pk_bf16_f32 v246, v212, v213
    v_mfma_f32_16x16x32_bf16 v[172:175], a[156:159], v[136:139], 0
    v_exp_f32 v214, v214
    v_mfma_f32_16x16x32_bf16 v[172:175], a[152:155], v[104:107], v[172:175]
    ds_read_b128 a[176:179], v9 offset:12288
    v_subrev_f32 v231, 0x74e60000, v16
    v_mfma_f32_16x16x32_bf16 v[172:175], a[148:151], v[72:75], v[172:175]
    s_waitcnt lgkmcnt(3)
    v_exp_f32 v215, v215
    v_mfma_f32_16x16x32_bf16 v[172:175], a[144:147], v[40:43], v[172:175]
    v_cvt_pk_bf16_f32 v247, v214, v215
    v_min_f32 v231, 0, v231
    v_mfma_f32_16x16x32_bf16 v[176:179], a[160:163], v[40:43], 0
    v_mfma_f32_16x16x32_bf16 v[176:179], a[164:167], v[72:75], v[176:179]
    v_mfma_f32_16x16x32_bf16 v[176:179], a[168:171], v[104:107], v[176:179]
    v_exp_f32 v168, v168
    v_mfma_f32_16x16x32_bf16 v[176:179], a[172:175], v[136:139], v[176:179]
    v_mfma_f32_16x16x32_bf16 v[180:183], a[188:191], v[136:139], 0
    s_waitcnt lgkmcnt(0)
    v_exp_f32 v169, v169
    v_mfma_f32_16x16x32_bf16 v[180:183], a[184:187], v[104:107], v[180:183]
    v_cvt_pk_bf16_f32 v232, v168, v169
    v_mov_b32 v10, v9
    v_mfma_f32_16x16x32_bf16 v[180:183], a[180:183], v[72:75], v[180:183]
    v_exp_f32 v170, v170
    v_mfma_f32_16x16x32_bf16 v[180:183], a[176:179], v[40:43], v[180:183]
    v_mfma_f32_16x16x32_bf16 a[96:99], a[192:195], v[240:243], a[96:99]
    s_add_u32 s88, s88, 32768
    v_exp_f32 v171, v171
    v_mfma_f32_16x16x32_bf16 a[96:99], a[196:199], v[244:247], a[96:99]
    ds_read_b128 a[192:195], v10 offset:16384
    v_cvt_pk_bf16_f32 v233, v170, v171
    v_mfma_f32_16x16x32_bf16 a[100:103], a[204:207], v[244:247], a[100:103]
    s_sub_u32 s69, s88, 163840
    v_exp_f32 v172, v172
    v_mfma_f32_16x16x32_bf16 a[100:103], a[200:203], v[240:243], a[100:103]
    ds_read_b128 a[196:199], v10 offset:17408
    ds_read_b128 a[204:207], v10 offset:19456
    v_mfma_f32_16x16x32_bf16 a[104:107], a[208:211], v[240:243], a[104:107]
    s_min_u32 s88, s88, s69
    v_exp_f32 v173, v173
    v_mfma_f32_16x16x32_bf16 a[104:107], a[212:215], v[244:247], a[104:107]
    ds_read_b128 a[200:203], v10 offset:18432
    v_cvt_pk_bf16_f32 v234, v172, v173
    v_mfma_f32_16x16x32_bf16 a[108:111], a[220:223], v[244:247], a[108:111]
    v_exp_f32 v174, v174
    v_mfma_f32_16x16x32_bf16 a[108:111], a[216:219], v[240:243], a[108:111]
    ds_read_b128 a[208:211], v10 offset:20480
    ds_read_b128 a[212:215], v10 offset:21504
    v_mfma_f32_16x16x32_bf16 a[112:115], a[224:227], v[240:243], a[112:115]
    s_add_u32 s89, s70, s91
    v_exp_f32 v175, v175
    v_mfma_f32_16x16x32_bf16 a[112:115], a[228:231], v[244:247], a[112:115]
    ds_read_b128 a[220:223], v10 offset:23552
    v_cvt_pk_bf16_f32 v235, v174, v175
    v_mfma_f32_16x16x32_bf16 a[116:119], a[236:239], v[244:247], a[116:119]
    v_exp_f32 v176, v176
    v_mfma_f32_16x16x32_bf16 a[116:119], a[232:235], v[240:243], a[116:119]
    ds_read_b128 a[216:219], v10 offset:22528
    ds_read_b128 a[224:227], v10 offset:24576
    v_mfma_f32_16x16x32_bf16 a[120:123], a[240:243], v[240:243], a[120:123]
    v_exp_f32 v177, v177
    v_mfma_f32_16x16x32_bf16 a[120:123], a[244:247], v[244:247], a[120:123]
    ds_read_b128 a[228:231], v10 offset:25600
    v_cvt_pk_bf16_f32 v236, v176, v177
    v_mfma_f32_16x16x32_bf16 a[124:127], a[252:255], v[244:247], a[124:127]
    v_exp_f32 v178, v178
    v_mfma_f32_16x16x32_bf16 a[124:127], a[248:251], v[240:243], a[124:127]
    ds_read_b128 a[236:239], v10 offset:27648
    ds_read_b128 a[232:235], v10 offset:26624
    v_mfma_f32_16x16x32_bf16 v[68:71], v[248:251], v[240:243], v[68:71]
    v_exp_f32 v179, v179
    v_mfma_f32_16x16x32_bf16 v[68:71], v[248:251], v[244:247], v[68:71]
    ds_read_b128 a[240:243], v10 offset:28672
    v_cvt_pk_bf16_f32 v237, v178, v179
    v_mfma_f32_16x16x32_bf16 v[200:203], a[128:131], v[48:51], v[216:219]
    s_mul_i32 s10, s65, 3
    v_exp_f32 v180, v180
    v_mfma_f32_16x16x32_bf16 v[200:203], a[132:135], v[80:83], v[200:203]
    s_lshr_b32 s10, 0xa1614, s10
    ds_read_b128 a[244:247], v10 offset:29696
    ds_read_b128 a[252:255], v10 offset:31744
    v_mfma_f32_16x16x32_bf16 v[200:203], a[136:139], v[112:115], v[200:203]
    s_and_b32 s10, s10, 7
    v_exp_f32 v181, v181
    v_mfma_f32_16x16x32_bf16 v[200:203], a[140:143], v[144:147], v[200:203]
    s_lshl_b32 s10, s10, 15
    ds_read_b128 a[248:251], v10 offset:30720
    v_cvt_pk_bf16_f32 v238, v180, v181
    v_mfma_f32_16x16x32_bf16 v[204:207], a[156:159], v[144:147], v[220:223]
    s_lshl_b32 s11, s67, 6
    v_exp_f32 v182, v182
    v_mfma_f32_16x16x32_bf16 v[204:207], a[152:155], v[112:115], v[204:207]
    s_add_u32 s11, s11, s10
    v_mfma_f32_16x16x32_bf16 v[204:207], a[148:151], v[80:83], v[204:207]
    v_exp_f32 v183, v183
    v_mfma_f32_16x16x32_bf16 v[204:207], a[144:147], v[48:51], v[204:207]
    v_cvt_pk_bf16_f32 v239, v182, v183
    v_xor_b32 v1, s11, v1
    v_mfma_f32_16x16x32_bf16 v[208:211], a[160:163], v[48:51], v[224:227]
    s_mov_b32 m0, s88
    v_xor_b32 v2, s11, v2
    v_xor_b32 v3, s11, v3
    v_mfma_f32_16x16x32_bf16 v[208:211], a[164:167], v[80:83], v[208:211]
    buffer_load_dwordx4 v11, s[36:39], s89 offen sc1 lds
    v_mfma_f32_16x16x32_bf16 v[208:211], a[168:171], v[112:115], v[208:211]
    v_exp_f32 v200, v200
    v_mfma_f32_16x16x32_bf16 v[208:211], a[172:175], v[144:147], v[208:211]
    buffer_load_dword v38, v36, s[60:63], s1 offen sc1
    v_mfma_f32_16x16x32_bf16 v[212:215], a[188:191], v[144:147], v[228:231]
    v_exp_f32 v201, v201
    v_mfma_f32_16x16x32_bf16 v[212:215], a[184:187], v[112:115], v[212:215]
    v_cvt_pk_bf16_f32 v240, v200, v201
    v_xor_b32 v4, s11, v4
    v_mfma_f32_16x16x32_bf16 v[212:215], a[180:183], v[80:83], v[212:215]
    s_waitcnt lgkmcnt(7)
    v_exp_f32 v202, v202
    v_mfma_f32_16x16x32_bf16 v[212:215], a[176:179], v[48:51], v[212:215]
    buffer_load_dwordx4 v12, s[36:39], s89 offen offset:1024 sc1 lds
    v_mfma_f32_16x16x32_bf16 a[0:3], a[192:195], v[232:235], a[0:3]
    s_lshr_b32 s9, s2, 3
    v_exp_f32 v203, v203
    v_mfma_f32_16x16x32_bf16 a[0:3], a[196:199], v[236:239], a[0:3]
    s_lshl_b32 s9, s9, 2
    v_cvt_pk_bf16_f32 v241, v202, v203
    v_xor_b32 v5, s11, v5
    v_mfma_f32_16x16x32_bf16 a[4:7], a[204:207], v[236:239], a[4:7]
    s_add_u32 s9, s9, s66
    v_exp_f32 v204, v204
    v_mfma_f32_16x16x32_bf16 a[4:7], a[200:203], v[232:235], a[4:7]
    s_lshl_b32 s9, s9, 8
    v_xor_b32 v6, s11, v6
    v_xor_b32 v7, s11, v7
    v_mfma_f32_16x16x32_bf16 a[8:11], a[208:211], v[232:235], a[8:11]
    v_exp_f32 v205, v205
    v_mfma_f32_16x16x32_bf16 a[8:11], a[212:215], v[236:239], a[8:11]
    v_cvt_pk_bf16_f32 v242, v204, v205
    v_xor_b32 v8, s11, v8
    v_mfma_f32_16x16x32_bf16 a[12:15], a[220:223], v[236:239], a[12:15]
    v_exp_f32 v206, v206
    v_mfma_f32_16x16x32_bf16 a[12:15], a[216:219], v[232:235], a[12:15]
    buffer_load_dwordx4 v13, s[36:39], s89 offen offset:2048 sc1 lds
    v_mfma_f32_16x16x32_bf16 a[16:19], a[224:227], v[232:235], a[16:19]
    s_waitcnt lgkmcnt(0)
    v_exp_f32 v207, v207
    v_mfma_f32_16x16x32_bf16 a[16:19], a[228:231], v[236:239], a[16:19]
    v_cvt_pk_bf16_f32 v243, v206, v207
    v_mfma_f32_16x16x32_bf16 a[20:23], a[236:239], v[236:239], a[20:23]
    v_exp_f32 v208, v208
    v_mfma_f32_16x16x32_bf16 a[20:23], a[232:235], v[232:235], a[20:23]
    v_mfma_f32_16x16x32_bf16 a[24:27], a[240:243], v[232:235], a[24:27]
    v_exp_f32 v209, v209
    v_mfma_f32_16x16x32_bf16 a[24:27], a[244:247], v[236:239], a[24:27]
L_hop9:
    s_cbranch_execz L_hop13
    v_cvt_pk_bf16_f32 v244, v208, v209
    v_mfma_f32_16x16x32_bf16 a[28:31], a[252:255], v[236:239], a[28:31]
    s_add_u32 s70, s89, s90
    v_exp_f32 v210, v210
    v_mfma_f32_16x16x32_bf16 a[28:31], a[248:251], v[232:235], a[28:31]
    buffer_load_dwordx4 v14, s[36:39], s89 offen offset:3072 sc1 lds
    v_mfma_f32_16x16x32_bf16 v[56:59], v[248:251], v[232:235], v[56:59]
    v_exp_f32 v211, v211
    v_mfma_f32_16x16x32_bf16 v[56:59], v[248:251], v[236:239], v[56:59]
    s_add_u32 m0, s88, 4096
    v_cvt_pk_bf16_f32 v245, v210, v211
    v_bfe_u32 v34, v17, 4, 1
    v_mfma_f32_16x16x32_bf16 v[168:171], a[128:131], v[52:55], 0
    s_add_u32 s87, s87, 32768
    v_exp_f32 v212, v212
    v_mfma_f32_16x16x32_bf16 v[168:171], a[132:135], v[84:87], v[168:171]
    buffer_load_dwordx4 v11, s[36:39], s70 offen sc1 lds
    v_mfma_f32_16x16x32_bf16 v[168:171], a[136:139], v[116:119], v[168:171]
    s_sub_u32 s69, s87, 163840
    v_exp_f32 v213, v213
    v_mfma_f32_16x16x32_bf16 v[168:171], a[140:143], v[148:151], v[168:171]
    v_cvt_pk_bf16_f32 v246, v212, v213
    v_lshl_add_u32 v34, v34, 7, s9
    v_mfma_f32_16x16x32_bf16 v[172:175], a[156:159], v[148:151], 0
    s_min_u32 s87, s87, s69
    v_exp_f32 v214, v214
    v_mfma_f32_16x16x32_bf16 v[172:175], a[152:155], v[116:119], v[172:175]
    v_add_u32 v9, s87, v17
    v_mfma_f32_16x16x32_bf16 v[172:175], a[148:151], v[84:87], v[172:175]
    s_waitcnt vmcnt(23)
    v_exp_f32 v215, v215
    v_mfma_f32_16x16x32_bf16 v[172:175], a[144:147], v[52:55], v[172:175]
    v_cvt_pk_bf16_f32 v247, v214, v215
    v_mfma_f32_16x16x32_bf16 v[176:179], a[160:163], v[52:55], 0
    s_barrier
    v_mfma_f32_16x16x32_bf16 v[176:179], a[164:167], v[84:87], v[176:179]
    ds_read_b128 a[128:131], v9
    v_mfma_f32_16x16x32_bf16 v[176:179], a[168:171], v[116:119], v[176:179]
    v_exp_f32 v168, v168
    v_mfma_f32_16x16x32_bf16 v[176:179], a[172:175], v[148:151], v[176:179]
    ds_read_b128 a[132:135], v9 offset:1024
    v_mfma_f32_16x16x32_bf16 v[180:183], a[188:191], v[148:151], 0
    v_exp_f32 v169, v169
    v_mfma_f32_16x16x32_bf16 v[180:183], a[184:187], v[116:119], v[180:183]
    ds_read_b128 a[136:139], v9 offset:2048
    v_cvt_pk_bf16_f32 v232, v168, v169
    v_mfma_f32_16x16x32_bf16 v[180:183], a[180:183], v[84:87], v[180:183]
    v_exp_f32 v170, v170
    v_mfma_f32_16x16x32_bf16 v[180:183], a[176:179], v[52:55], v[180:183]
    ds_read_b128 a[140:143], v9 offset:3072
    v_mfma_f32_16x16x32_bf16 a[64:67], a[192:195], v[240:243], a[64:67]
    s_waitcnt vmcnt(4)
    v_exp_f32 v171, v171
    v_cmp_eq_u32 vcc, 0, v38
    v_mfma_f32_16x16x32_bf16 a[64:67], a[196:199], v[244:247], a[64:67]
    ds_read_b128 a[156:159], v9 offset:7168
    v_cvt_pk_bf16_f32 v233, v170, v171
    v_mfma_f32_16x16x32_bf16 a[68:71], a[204:207], v[244:247], a[68:71]
    s_cbranch_vccnz L_spin_h
L_spin_h_ret:
    v_exp_f32 v172, v172
    v_mfma_f32_16x16x32_bf16 a[68:71], a[200:203], v[240:243], a[68:71]
    ds_read_b128 a[152:155], v9 offset:6144
    buffer_load_dwordx4 v[28:31], v35, s[52:55], s19 offen sc1
    v_mfma_f32_16x16x32_bf16 a[72:75], a[208:211], v[240:243], a[72:75]
    v_exp_f32 v173, v173
    v_mfma_f32_16x16x32_bf16 a[72:75], a[212:215], v[244:247], a[72:75]
    ds_read_b128 a[148:151], v9 offset:5120
    v_cvt_pk_bf16_f32 v234, v172, v173
    v_mfma_f32_16x16x32_bf16 a[76:79], a[220:223], v[244:247], a[76:79]
    v_exp_f32 v174, v174
    v_mfma_f32_16x16x32_bf16 a[76:79], a[216:219], v[240:243], a[76:79]
    ds_read_b128 a[144:147], v9 offset:4096
    v_mfma_f32_16x16x32_bf16 a[80:83], a[224:227], v[240:243], a[80:83]
    v_exp_f32 v175, v175
    v_mfma_f32_16x16x32_bf16 a[80:83], a[228:231], v[244:247], a[80:83]
    ds_read_b128 a[160:163], v9 offset:8192
    v_cvt_pk_bf16_f32 v235, v174, v175
    v_mfma_f32_16x16x32_bf16 a[84:87], a[236:239], v[244:247], a[84:87]
    v_exp_f32 v176, v176
    v_mfma_f32_16x16x32_bf16 a[84:87], a[232:235], v[240:243], a[84:87]
    ds_read_b128 a[164:167], v9 offset:9216
    v_mfma_f32_16x16x32_bf16 a[88:91], a[240:243], v[240:243], a[88:91]
    v_exp_f32 v177, v177
    v_mfma_f32_16x16x32_bf16 a[88:91], a[244:247], v[244:247], a[88:91]
    ds_read_b128 a[168:171], v9 offset:10240
    v_cvt_pk_bf16_f32 v236, v176, v177
    v_mfma_f32_16x16x32_bf16 a[92:95], a[252:255], v[244:247], a[92:95]
    v_exp_f32 v178, v178
    v_mfma_f32_16x16x32_bf16 a[92:95], a[248:251], v[240:243], a[92:95]
    ds_read_b128 a[172:175], v9 offset:11264
    v_mfma_f32_16x16x32_bf16 v[64:67], v[248:251], v[240:243], v[64:67]
    s_waitcnt lgkmcnt(5)
    v_exp_f32 v179, v179
    v_mfma_f32_16x16x32_bf16 v[64:67], v[248:251], v[244:247], v[64:67]
    ds_read_b128 a[188:191], v9 offset:15360
    v_cvt_pk_bf16_f32 v237, v178, v179
    v_mfma_f32_16x16x32_bf16 v[200:203], a[128:131], v[40:43], 0
    v_exp_f32 v180, v180
    v_mfma_f32_16x16x32_bf16 v[200:203], a[132:135], v[72:75], v[200:203]
    ds_read_b128 a[184:187], v9 offset:14336
    v_mfma_f32_16x16x32_bf16 v[200:203], a[136:139], v[104:107], v[200:203]
    v_exp_f32 v181, v181
    v_mfma_f32_16x16x32_bf16 v[200:203], a[140:143], v[136:139], v[200:203]
    ds_read_b128 a[180:183], v9 offset:13312
    v_cvt_pk_bf16_f32 v238, v180, v181
    v_mfma_f32_16x16x32_bf16 v[204:207], a[156:159], v[136:139], 0
    v_exp_f32 v182, v182
    v_mfma_f32_16x16x32_bf16 v[204:207], a[152:155], v[104:107], v[204:207]
    ds_read_b128 a[176:179], v9 offset:12288
    v_mfma_f32_16x16x32_bf16 v[204:207], a[148:151], v[72:75], v[204:207]
    s_waitcnt lgkmcnt(3)
    v_exp_f32 v183, v183
    v_mfma_f32_16x16x32_bf16 v[204:207], a[144:147], v[40:43], v[204:207]
    v_cvt_pk_bf16_f32 v239, v182, v183
    v_mfma_f32_16x16x32_bf16 v[208:211], a[160:163], v[40:43], 0
    buffer_load_dwordx4 v12, s[36:39], s70 offen offset:1024 sc1 lds
    v_mfma_f32_16x16x32_bf16 v[208:211], a[164:167], v[72:75], v[208:211]
    v_mfma_f32_16x16x32_bf16 v[208:211], a[168:171], v[104:107], v[208:211]
    v_exp_f32 v200, v200
    v_mfma_f32_16x16x32_bf16 v[208:211], a[172:175], v[136:139], v[208:211]
    buffer_load_dwordx4 v13, s[36:39], s70 offen offset:2048 sc1 lds
    v_mfma_f32_16x16x32_bf16 v[212:215], a[188:191], v[136:139], 0
    s_waitcnt lgkmcnt(0)
    v_exp_f32 v201, v201
    v_mfma_f32_16x16x32_bf16 v[212:215], a[184:187], v[104:107], v[212:215]
    v_cvt_pk_bf16_f32 v240, v200, v201
    v_mov_b32 v10, v9
    v_mfma_f32_16x16x32_bf16 v[212:215], a[180:183], v[72:75], v[212:215]
    v_exp_f32 v202, v202
    v_mfma_f32_16x16x32_bf16 v[212:215], a[176:179], v[40:43], v[212:215]
    buffer_load_dwordx4 v14, s[36:39], s70 offen offset:3072 sc1 lds
    v_mfma_f32_16x16x32_bf16 a[96:99], a[192:195], v[232:235], a[96:99]
    s_add_u32 s88, s88, 32768
    v_exp_f32 v203, v203
    v_mfma_f32_16x16x32_bf16 a[96:99], a[196:199], v[236:239], a[96:99]
    ds_read_b128 a[192:195], v10 offset:16384
    v_cvt_pk_bf16_f32 v241, v202, v203
    v_mfma_f32_16x16x32_bf16 a[100:103], a[204:207], v[236:239], a[100:103]
    s_sub_u32 s69, s88, 163840
    v_exp_f32 v204, v204
    v_mfma_f32_16x16x32_bf16 a[100:103], a[200:203], v[232:235], a[100:103]
    ds_read_b128 a[196:199], v10 offset:17408
    ds_read_b128 a[204:207], v10 offset:19456
    v_mfma_f32_16x16x32_bf16 a[104:107], a[208:211], v[232:235], a[104:107]
    s_min_u32 s88, s88, s69
    v_exp_f32 v205, v205
    v_mfma_f32_16x16x32_bf16 a[104:107], a[212:215], v[236:239], a[104:107]
    ds_read_b128 a[200:203], v10 offset:18432
    v_cvt_pk_bf16_f32 v242, v204, v205
    v_mfma_f32_16x16x32_bf16 a[108:111], a[220:223], v[236:239], a[108:111]
    v_exp_f32 v206, v206
    v_mfma_f32_16x16x32_bf16 a[108:111], a[216:219], v[232:235], a[108:111]
    ds_read_b128 a[208:211], v10 offset:20480
    ds_read_b128 a[212:215], v10 offset:21504
    v_mfma_f32_16x16x32_bf16 a[112:115], a[224:227], v[232:235], a[112:115]
    s_add_u32 s89, s70, s91
    v_exp_f32 v207, v207
    v_mfma_f32_16x16x32_bf16 a[112:115], a[228:231], v[236:239], a[112:115]
    ds_read_b128 a[220:223], v10 offset:23552
    v_cvt_pk_bf16_f32 v243, v206, v207
    v_mfma_f32_16x16x32_bf16 a[116:119], a[236:239], v[236:239], a[116:119]
    v_exp_f32 v208, v208
    v_mfma_f32_16x16x32_bf16 a[116:119], a[232:235], v[232:235], a[116:119]
    ds_read_b128 a[216:219], v10 offset:22528
    ds_read_b128 a[224:227], v10 offset:24576
    v_mfma_f32_16x16x32_bf16 a[120:123], a[240:243], v[232:235], a[120:123]
    v_exp_f32 v209, v209
    v_mfma_f32_16x16x32_bf16 a[120:123], a[244:247], v[236:239], a[120:123]
    ds_read_b128 a[228:231], v10 offset:25600
    v_cvt_pk_bf16_f32 v244, v208, v209
    v_mfma_f32_16x16x32_bf16 a[124:127], a[252:255], v[236:239], a[124:127]
    v_exp_f32 v210, v210
    v_mfma_f32_16x16x32_bf16 a[124:127], a[248:251], v[232:235], a[124:127]
    ds_read_b128 a[236:239], v10 offset:27648
    ds_read_b128 a[232:235], v10 offset:26624
    v_mfma_f32_16x16x32_bf16 v[68:71], v[248:251], v[232:235], v[68:71]
    v_exp_f32 v211, v211
    v_mfma_f32_16x16x32_bf16 v[68:71], v[248:251], v[236:239], v[68:71]
    ds_read_b128 a[240:243], v10 offset:28672
    v_cvt_pk_bf16_f32 v245, v210, v211
    s_waitcnt vmcnt(3)
    v_subrev_u32 v61, 0x2b800000, v60
    v_cmp_le_u32 vcc, s93, v61
    s_nop 1
    s_cbranch_vccnz L_fb1
L_fb1_ret:
    v_rcp_f32 v60, v60
    s_lshl_b32 s71, s68, 12
    s_add_u32 s71, s71, s84
    s_add_u32 s71, s71, 14336
    v_mul_f32 v60, v60, v29
    v_accvgpr_read_b32 v44, a32
    v_accvgpr_read_b32 v45, a33
    v_accvgpr_read_b32 v46, a34
    v_accvgpr_read_b32 v47, a35
    v_accvgpr_read_b32 v152, a36
    v_accvgpr_read_b32 v153, a37
    v_accvgpr_read_b32 v154, a38
    v_accvgpr_read_b32 v155, a39
    v_pk_mul_f32 v[44:45], v[44:45], v[60:61] op_sel_hi:[1,0]
    v_pk_mul_f32 v[46:47], v[46:47], v[60:61] op_sel_hi:[1,0]
    v_pk_mul_f32 v[152:153], v[152:153], v[60:61] op_sel_hi:[1,0]
    v_pk_mul_f32 v[154:155], v[154:155], v[60:61] op_sel_hi:[1,0]
    v_cvt_pk_bf16_f32 v44, v44, v45
    v_cvt_pk_bf16_f32 v45, v46, v47
    v_cvt_pk_bf16_f32 v46, v152, v153
    v_cvt_pk_bf16_f32 v47, v154, v155
    buffer_store_dwordx4 v[44:47], v17, s[32:35], s71 offen sc1
    v_accvgpr_read_b32 v76, a40
    v_accvgpr_read_b32 v77, a41
    v_accvgpr_read_b32 v78, a42
    v_accvgpr_read_b32 v79, a43
    v_accvgpr_read_b32 v156, a44
    v_accvgpr_read_b32 v157, a45
    v_accvgpr_read_b32 v158, a46
    v_accvgpr_read_b32 v159, a47
    v_pk_mul_f32 v[76:77], v[76:77], v[60:61] op_sel_hi:[1,0]
    v_pk_mul_f32 v[78:79], v[78:79], v[60:61] op_sel_hi:[1,0]
    v_pk_mul_f32 v[156:157], v[156:157], v[60:61] op_sel_hi:[1,0]
    v_pk_mul_f32 v[158:159], v[158:159], v[60:61] op_sel_hi:[1,0]
    v_cvt_pk_bf16_f32 v76, v76, v77
    v_cvt_pk_bf16_f32 v77, v78, v79
    v_cvt_pk_bf16_f32 v78, v156, v157
    v_cvt_pk_bf16_f32 v79, v158, v159
    buffer_store_dwordx4 v[76:79], v17, s[32:35], s71 offen offset:1024 sc1
    v_accvgpr_read_b32 v108, a48
    v_accvgpr_read_b32 v109, a49
    v_accvgpr_read_b32 v110, a50
    v_accvgpr_read_b32 v111, a51
    v_accvgpr_read_b32 v152, a52
    v_accvgpr_read_b32 v153, a53
    v_accvgpr_read_b32 v154, a54
    v_accvgpr_read_b32 v155, a55
    v_pk_mul_f32 v[108:109], v[108:109], v[60:61] op_sel_hi:[1,0]
    v_pk_mul_f32 v[110:111], v[110:111], v[60:61] op_sel_hi:[1,0]
    v_pk_mul_f32 v[152:153], v[152:153], v[60:61] op_sel_hi:[1,0]
    v_pk_mul_f32 v[154:155], v[154:155], v[60:61] op_sel_hi:[1,0]
    v_cvt_pk_bf16_f32 v108, v108, v109
    v_cvt_pk_bf16_f32 v109, v110, v111
    v_cvt_pk_bf16_f32 v110, v152, v153
    v_cvt_pk_bf16_f32 v111, v154, v155
    buffer_store_dwordx4 v[108:111], v17, s[32:35], s71 offen offset:2048 sc1
    v_accvgpr_read_b32 v140, a56
    v_accvgpr_read_b32 v141, a57
    v_accvgpr_read_b32 v142, a58
    v_accvgpr_read_b32 v143, a59
    v_accvgpr_read_b32 v156, a60
    v_accvgpr_read_b32 v157, a61
    v_accvgpr_read_b32 v158, a62
    v_accvgpr_read_b32 v159, a63
    v_pk_mul_f32 v[140:141], v[140:141], v[60:61] op_sel_hi:[1,0]
    v_pk_mul_f32 v[142:143], v[142:143], v[60:61] op_sel_hi:[1,0]
    v_pk_mul_f32 v[156:157], v[156:157], v[60:61] op_sel_hi:[1,0]
    v_pk_mul_f32 v[158:159], v[158:159], v[60:61] op_sel_hi:[1,0]
    v_cvt_pk_bf16_f32 v140, v140, v141
    v_cvt_pk_bf16_f32 v141, v142, v143
    v_cvt_pk_bf16_f32 v142, v156, v157
    v_cvt_pk_bf16_f32 v143, v158, v159
    buffer_store_dwordx4 v[140:143], v17, s[32:35], s71 offen offset:3072 sc1
    v_subrev_u32 v65, 0x2b800000, v64
    v_cmp_le_u32 vcc, s93, v65
    s_nop 1
    s_cbranch_vccnz L_fb2
L_fb2_ret:
    v_rcp_f32 v64, v64
    s_lshl_b32 s71, s68, 12
    s_add_u32 s71, s71, s85
    s_add_u32 s71, s71, 14336
    v_mul_f32 v64, v64, v30
    v_accvgpr_read_b32 v48, a64
    v_accvgpr_read_b32 v49, a65
    v_accvgpr_read_b32 v50, a66
    v_accvgpr_read_b32 v51, a67
    v_accvgpr_read_b32 v152, a68
    v_accvgpr_read_b32 v153, a69
    v_accvgpr_read_b32 v154, a70
    v_accvgpr_read_b32 v155, a71
    v_pk_mul_f32 v[48:49], v[48:49], v[64:65] op_sel_hi:[1,0]
    v_pk_mul_f32 v[50:51], v[50:51], v[64:65] op_sel_hi:[1,0]
    v_pk_mul_f32 v[152:153], v[152:153], v[64:65] op_sel_hi:[1,0]
    v_pk_mul_f32 v[154:155], v[154:155], v[64:65] op_sel_hi:[1,0]
    v_cvt_pk_bf16_f32 v48, v48, v49
    v_cvt_pk_bf16_f32 v49, v50, v51
    v_cvt_pk_bf16_f32 v50, v152, v153
    v_cvt_pk_bf16_f32 v51, v154, v155
    buffer_store_dwordx4 v[48:51], v17, s[32:35], s71 offen sc1
    v_accvgpr_read_b32 v80, a72
    v_accvgpr_read_b32 v81, a73
    v_accvgpr_read_b32 v82, a74
    v_accvgpr_read_b32 v83, a75
    v_accvgpr_read_b32 v156, a76
    v_accvgpr_read_b32 v157, a77
    v_accvgpr_read_b32 v158, a78
    v_accvgpr_read_b32 v159, a79
    v_pk_mul_f32 v[80:81], v[80:81], v[64:65] op_sel_hi:[1,0]
    v_pk_mul_f32 v[82:83], v[82:83], v[64:65] op_sel_hi:[1,0]
    v_pk_mul_f32 v[156:157], v[156:157], v[64:65] op_sel_hi:[1,0]
    v_pk_mul_f32 v[158:159], v[158:159], v[64:65] op_sel_hi:[1,0]
    v_cvt_pk_bf16_f32 v80, v80, v81
    v_cvt_pk_bf16_f32 v81, v82, v83
    v_cvt_pk_bf16_f32 v82, v156, v157
    v_cvt_pk_bf16_f32 v83, v158, v159
    buffer_store_dwordx4 v[80:83], v17, s[32:35], s71 offen offset:1024 sc1
    v_accvgpr_read_b32 v112, a80
    v_accvgpr_read_b32 v113, a81
    v_accvgpr_read_b32 v114, a82
    v_accvgpr_read_b32 v115, a83
    v_accvgpr_read_b32 v152, a84
    v_accvgpr_read_b32 v153, a85
    v_accvgpr_read_b32 v154, a86
    v_accvgpr_read_b32 v155, a87
    v_pk_mul_f32 v[112:113], v[112:113], v[64:65] op_sel_hi:[1,0]
    v_pk_mul_f32 v[114:115], v[114:115], v[64:65] op_sel_hi:[1,0]
    v_pk_mul_f32 v[152:153], v[152:153], v[64:65] op_sel_hi:[1,0]
    v_pk_mul_f32 v[154:155], v[154:155], v[64:65] op_sel_hi:[1,0]
    v_cvt_pk_bf16_f32 v112, v112, v113
    v_cvt_pk_bf16_f32 v113, v114, v115
    v_cvt_pk_bf16_f32 v114, v152, v153
    v_cvt_pk_bf16_f32 v115, v154, v155
    buffer_store_dwordx4 v[112:115], v17, s[32:35], s71 offen offset:2048 sc1
    v_accvgpr_read_b32 v144, a88
    v_accvgpr_read_b32 v145, a89
    v_accvgpr_read_b32 v146, a90
    v_accvgpr_read_b32 v147, a91
    v_accvgpr_read_b32 v156, a92
    v_accvgpr_read_b32 v157, a93
    v_accvgpr_read_b32 v158, a94
    v_accvgpr_read_b32 v159, a95
    v_pk_mul_f32 v[144:145], v[144:145], v[64:65] op_sel_hi:[1,0]
    v_pk_mul_f32 v[146:147], v[146:147], v[64:65] op_sel_hi:[1,0]
    v_pk_mul_f32 v[156:157], v[156:157], v[64:65] op_sel_hi:[1,0]
    v_pk_mul_f32 v[158:159], v[158:159], v[64:65] op_sel_hi:[1,0]
    v_cvt_pk_bf16_f32 v144, v144, v145
    v_cvt_pk_bf16_f32 v145, v146, v147
    v_cvt_pk_bf16_f32 v146, v156, v157
    v_cvt_pk_bf16_f32 v147, v158, v159
    buffer_store_dwordx4 v[144:147], v17, s[32:35], s71 offen offset:3072 sc1
    s_lshl_b32 s69, s65, 1
    s_sub_u32 s92, 13, s69
    s_cmp_eq_u32 s65, 7
    s_cbranch_scc1 L_z7
    v_mfma_f32_16x16x32_bf16 v[168:171], a[128:131], v[52:55], 0
    s_add_u32 s87, s87, 32768
    v_exp_f32 v212, v212
    v_mfma_f32_16x16x32_bf16 v[168:171], a[132:135], v[84:87], v[168:171]
    ds_read_b128 a[244:247], v10 offset:29696
    ds_read_b128 a[252:255], v10 offset:31744
    v_mfma_f32_16x16x32_bf16 v[168:171], a[136:139], v[116:119], v[168:171]
    s_sub_u32 s69, s87, 163840
    v_exp_f32 v213, v213
    v_mfma_f32_16x16x32_bf16 v[168:171], a[140:143], v[148:151], v[168:171]
    ds_read_b128 a[248:251], v10 offset:30720
    v_cvt_pk_bf16_f32 v246, v212, v213
    v_mfma_f32_16x16x32_bf16 v[172:175], a[156:159], v[148:151], 0
    s_min_u32 s87, s87, s69
    v_exp_f32 v214, v214
    v_mfma_f32_16x16x32_bf16 v[172:175], a[152:155], v[116:119], v[172:175]
    v_add_u32 v9, s87, v17
    v_mfma_f32_16x16x32_bf16 v[172:175], a[148:151], v[84:87], v[172:175]
    v_exp_f32 v215, v215
    v_mfma_f32_16x16x32_bf16 v[172:175], a[144:147], v[52:55], v[172:175]
    v_cvt_pk_bf16_f32 v247, v214, v215
    v_mfma_f32_16x16x32_bf16 v[176:179], a[160:163], v[52:55], 0
    s_waitcnt lgkmcnt(0)
.p2align 3
L_r2:
    v_mfma_f32_16x16x32_bf16 v[176:179], a[164:167], v[84:87], v[176:179]
    s_barrier
    v_mfma_f32_16x16x32_bf16 v[176:179], a[168:171], v[116:119], v[176:179]
    v_exp_f32 v168, v168
    v_mfma_f32_16x16x32_bf16 v[176:179], a[172:175], v[148:151], v[176:179]
    ds_read_b128 a[128:131], v9
    ds_read_b128 a[132:135], v9 offset:1024
    v_mfma_f32_16x16x32_bf16 v[180:183], a[188:191], v[148:151], 0
    v_exp_f32 v169, v169
    v_mfma_f32_16x16x32_bf16 v[180:183], a[184:187], v[116:119], v[180:183]
    ds_read_b128 a[136:139], v9 offset:2048
    v_cvt_pk_bf16_f32 v232, v168, v169
    v_mfma_f32_16x16x32_bf16 v[180:183], a[180:183], v[84:87], v[180:183]
    s_waitcnt lgkmcnt(10)
    v_exp_f32 v170, v170
    v_mfma_f32_16x16x32_bf16 v[180:183], a[176:179], v[52:55], v[180:183]
    ds_read_b128 a[140:143], v9 offset:3072
    v_mfma_f32_16x16x32_bf16 a[0:3], a[192:195], v[240:243], a[0:3]
    v_exp_f32 v171, v171
    v_mfma_f32_16x16x32_bf16 a[0:3], a[196:199], v[244:247], a[0:3]
    ds_read_b128 a[156:159], v9 offset:7168
    v_cvt_pk_bf16_f32 v233, v170, v171
    v_mfma_f32_16x16x32_bf16 a[4:7], a[204:207], v[244:247], a[4:7]
    s_mov_b32 m0, s88
    v_exp_f32 v172, v172
    v_mfma_f32_16x16x32_bf16 a[4:7], a[200:203], v[240:243], a[4:7]
    buffer_load_dwordx4 v11, s[36:39], s89 offen sc1 lds
    v_mfma_f32_16x16x32_bf16 a[8:11], a[208:211], v[240:243], a[8:11]
    v_exp_f32 v173, v173
    v_mfma_f32_16x16x32_bf16 a[8:11], a[212:215], v[244:247], a[8:11]
    ds_read_b128 a[152:155], v9 offset:6144
    v_cvt_pk_bf16_f32 v234, v172, v173
    v_mfma_f32_16x16x32_bf16 a[12:15], a[220:223], v[244:247], a[12:15]
    v_exp_f32 v174, v174
    v_mfma_f32_16x16x32_bf16 a[12:15], a[216:219], v[240:243], a[12:15]
    ds_read_b128 a[148:151], v9 offset:5120
    ds_read_b128 a[144:147], v9 offset:4096
    v_mfma_f32_16x16x32_bf16 a[16:19], a[224:227], v[240:243], a[16:19]
    s_waitcnt lgkmcnt(8)
    v_exp_f32 v175, v175
    v_mfma_f32_16x16x32_bf16 a[16:19], a[228:231], v[244:247], a[16:19]
    ds_read_b128 a[160:163], v9 offset:8192
    v_cvt_pk_bf16_f32 v235, v174, v175
    v_mfma_f32_16x16x32_bf16 a[20:23], a[236:239], v[244:247], a[20:23]
    v_exp_f32 v176, v176
    v_mfma_f32_16x16x32_bf16 a[20:23], a[232:235], v[240:243], a[20:23]
    buffer_load_dwordx4 v12, s[36:39], s89 offen offset:1024 sc1 lds
    v_mfma_f32_16x16x32_bf16 a[24:27], a[240:243], v[240:243], a[24:27]
    v_exp_f32 v177, v177
    v_mfma_f32_16x16x32_bf16 a[24:27], a[244:247], v[244:247], a[24:27]
    ds_read_b128 a[164:167], v9 offset:9216
    v_cvt_pk_bf16_f32 v236, v176, v177
    v_mfma_f32_16x16x32_bf16 a[28:31], a[252:255], v[244:247], a[28:31]
    v_exp_f32 v178, v178
    v_mfma_f32_16x16x32_bf16 a[28:31], a[248:251], v[240:243], a[28:31]
    ds_read_b128 a[168:171], v9 offset:10240
    v_mfma_f32_16x16x32_bf16 v[56:59], v[248:251], v[240:243], v[56:59]
    s_waitcnt lgkmcnt(6)
    v_exp_f32 v179, v179
    v_mfma_f32_16x16x32_bf16 v[56:59], v[248:251], v[244:247], v[56:59]
    ds_read_b128 a[172:175], v9 offset:11264
    v_cvt_pk_bf16_f32 v237, v178, v179
    v_mfma_f32_16x16x32_bf16 v[200:203], a[128:131], v[40:43], 0
    v_exp_f32 v180, v180
    v_mfma_f32_16x16x32_bf16 v[200:203], a[132:135], v[72:75], v[200:203]
    buffer_load_dwordx4 v13, s[36:39], s89 offen offset:2048 sc1 lds
    v_mfma_f32_16x16x32_bf16 v[200:203], a[136:139], v[104:107], v[200:203]
    v_exp_f32 v181, v181
    v_mfma_f32_16x16x32_bf16 v[200:203], a[140:143], v[136:139], v[200:203]
    ds_read_b128 a[188:191], v9 offset:15360
    v_cvt_pk_bf16_f32 v238, v180, v181
    v_mfma_f32_16x16x32_bf16 v[204:207], a[156:159], v[136:139], 0
    s_waitcnt lgkmcnt(4)
    v_exp_f32 v182, v182
    v_mfma_f32_16x16x32_bf16 v[204:207], a[152:155], v[104:107], v[204:207]
    ds_read_b128 a[184:187], v9 offset:14336
    v_mfma_f32_16x16x32_bf16 v[204:207], a[148:151], v[72:75], v[204:207]
    v_exp_f32 v183, v183
    v_mfma_f32_16x16x32_bf16 v[204:207], a[144:147], v[40:43], v[204:207]
    s_add_u32 s70, s89, s90
    ds_read_b128 a[180:183], v9 offset:13312
    v_cvt_pk_bf16_f32 v239, v182, v183
    v_mfma_f32_16x16x32_bf16 v[208:211], a[160:163], v[40:43], 0
    s_waitcnt lgkmcnt(2)
    ds_read_b128 a[176:179], v9 offset:12288
    v_mfma_f32_16x16x32_bf16 v[208:211], a[164:167], v[72:75], v[208:211]
    buffer_load_dwordx4 v14, s[36:39], s89 offen offset:3072 sc1 lds
    v_mfma_f32_16x16x32_bf16 v[208:211], a[168:171], v[104:107], v[208:211]
    s_add_u32 m0, s88, 4096
    v_exp_f32 v200, v200
    v_mfma_f32_16x16x32_bf16 v[208:211], a[172:175], v[136:139], v[208:211]
    buffer_load_dwordx4 v11, s[36:39], s70 offen sc1 lds
    v_mfma_f32_16x16x32_bf16 v[212:215], a[188:191], v[136:139], 0
    s_waitcnt lgkmcnt(1)
    v_exp_f32 v201, v201
    v_mfma_f32_16x16x32_bf16 v[212:215], a[184:187], v[104:107], v[212:215]
    v_cvt_pk_bf16_f32 v240, v200, v201
    v_mov_b32 v10, v9
    v_mfma_f32_16x16x32_bf16 v[212:215], a[180:183], v[72:75], v[212:215]
    s_waitcnt lgkmcnt(0)
    v_exp_f32 v202, v202
    v_mfma_f32_16x16x32_bf16 v[212:215], a[176:179], v[40:43], v[212:215]
    buffer_load_dwordx4 v12, s[36:39], s70 offen offset:1024 sc1 lds
    v_mfma_f32_16x16x32_bf16 a[96:99], a[192:195], v[232:235], a[96:99]
    s_add_u32 s88, s88, 32768
    v_exp_f32 v203, v203
    v_mfma_f32_16x16x32_bf16 a[96:99], a[196:199], v[236:239], a[96:99]
    ds_read_b128 a[192:195], v10 offset:16384
    v_cvt_pk_bf16_f32 v241, v202, v203
    v_mfma_f32_16x16x32_bf16 a[100:103], a[204:207], v[236:239], a[100:103]
    s_sub_u32 s69, s88, 163840
    v_exp_f32 v204, v204
    v_mfma_f32_16x16x32_bf16 a[100:103], a[200:203], v[232:235], a[100:103]
    ds_read_b128 a[196:199], v10 offset:17408
    ds_read_b128 a[204:207], v10 offset:19456
    v_mfma_f32_16x16x32_bf16 a[104:107], a[208:211], v[232:235], a[104:107]
    s_min_u32 s88, s88, s69
    v_exp_f32 v205, v205
    v_mfma_f32_16x16x32_bf16 a[104:107], a[212:215], v[236:239], a[104:107]
    ds_read_b128 a[200:203], v10 offset:18432
    v_cvt_pk_bf16_f32 v242, v204, v205
    v_mfma_f32_16x16x32_bf16 a[108:111], a[220:223], v[236:239], a[108:111]
    v_exp_f32 v206, v206
    v_mfma_f32_16x16x32_bf16 a[108:111], a[216:219], v[232:235], a[108:111]
    buffer_load_dwordx4 v13, s[36:39], s70 offen offset:2048 sc1 lds
    v_mfma_f32_16x16x32_bf16 a[112:115], a[224:227], v[232:235], a[112:115]
    v_exp_f32 v207, v207
    v_mfma_f32_16x16x32_bf16 a[112:115], a[228:231], v[236:239], a[112:115]
    ds_read_b128 a[208:211], v10 offset:20480
    v_cvt_pk_bf16_f32 v243, v206, v207
    v_mfma_f32_16x16x32_bf16 a[116:119], a[236:239], v[236:239], a[116:119]
    v_exp_f32 v208, v208
    v_mfma_f32_16x16x32_bf16 a[116:119], a[232:235], v[232:235], a[116:119]
    ds_read_b128 a[212:215], v10 offset:21504
    ds_read_b128 a[220:223], v10 offset:23552
    v_mfma_f32_16x16x32_bf16 a[120:123], a[240:243], v[232:235], a[120:123]
    v_exp_f32 v209, v209
    v_mfma_f32_16x16x32_bf16 a[120:123], a[244:247], v[236:239], a[120:123]
    ds_read_b128 a[216:219], v10 offset:22528
    v_cvt_pk_bf16_f32 v244, v208, v209
    v_mfma_f32_16x16x32_bf16 a[124:127], a[252:255], v[236:239], a[124:127]
    v_exp_f32 v210, v210
    v_mfma_f32_16x16x32_bf16 a[124:127], a[248:251], v[232:235], a[124:127]
    buffer_load_dwordx4 v14, s[36:39], s70 offen offset:3072 sc1 lds
    v_mfma_f32_16x16x32_bf16 v[68:71], v[248:251], v[232:235], v[68:71]
    s_add_u32 s89, s70, s91
    v_exp_f32 v211, v211
    v_mfma_f32_16x16x32_bf16 v[68:71], v[248:251], v[236:239], v[68:71]
    ds_read_b128 a[224:227], v10 offset:24576
    v_cvt_pk_bf16_f32 v245, v210, v211
    v_mfma_f32_16x16x32_bf16 v[168:171], a[128:131], v[52:55], 0
    s_add_u32 s87, s87, 32768
    v_exp_f32 v212, v212
    v_mfma_f32_16x16x32_bf16 v[168:171], a[132:135], v[84:87], v[168:171]
    ds_read_b128 a[228:231], v10 offset:25600
    ds_read_b128 a[236:239], v10 offset:27648
    v_mfma_f32_16x16x32_bf16 v[168:171], a[136:139], v[116:119], v[168:171]
    s_sub_u32 s69, s87, 163840
    v_exp_f32 v213, v213
    v_mfma_f32_16x16x32_bf16 v[168:171], a[140:143], v[148:151], v[168:171]
    ds_read_b128 a[232:235], v10 offset:26624
    v_cvt_pk_bf16_f32 v246, v212, v213
    v_mfma_f32_16x16x32_bf16 v[172:175], a[156:159], v[148:151], 0
    s_min_u32 s87, s87, s69
    v_exp_f32 v214, v214
    v_mfma_f32_16x16x32_bf16 v[172:175], a[152:155], v[116:119], v[172:175]
    ds_read_b128 a[240:243], v10 offset:28672
    v_add_u32 v9, s87, v17
    v_mfma_f32_16x16x32_bf16 v[172:175], a[148:151], v[84:87], v[172:175]
    v_exp_f32 v215, v215
    v_mfma_f32_16x16x32_bf16 v[172:175], a[144:147], v[52:55], v[172:175]
    ds_read_b128 a[244:247], v10 offset:29696
    v_cvt_pk_bf16_f32 v247, v214, v215
    v_mfma_f32_16x16x32_bf16 v[176:179], a[160:163], v[52:55], 0
    s_mov_b32 m0, s88
    ds_read_b128 a[252:255], v10 offset:31744
    ds_read_b128 a[248:251], v10 offset:30720
    v_mfma_f32_16x16x32_bf16 v[176:179], a[164:167], v[84:87], v[176:179]
    buffer_load_dwordx4 v11, s[36:39], s89 offen sc1 lds
    v_mfma_f32_16x16x32_bf16 v[176:179], a[168:171], v[116:119], v[176:179]
    v_exp_f32 v168, v168
    v_mfma_f32_16x16x32_bf16 v[176:179], a[172:175], v[148:151], v[176:179]
    ds_read_b128 a[128:131], v9
    ds_read_b128 a[132:135], v9 offset:1024
    v_mfma_f32_16x16x32_bf16 v[180:183], a[188:191], v[148:151], 0
    v_exp_f32 v169, v169
    v_mfma_f32_16x16x32_bf16 v[180:183], a[184:187], v[116:119], v[180:183]
    ds_read_b128 a[136:139], v9 offset:2048
    v_cvt_pk_bf16_f32 v232, v168, v169
    v_mfma_f32_16x16x32_bf16 v[180:183], a[180:183], v[84:87], v[180:183]
    s_waitcnt lgkmcnt(10)
    v_exp_f32 v170, v170
    v_mfma_f32_16x16x32_bf16 v[180:183], a[176:179], v[52:55], v[180:183]
    buffer_load_dwordx4 v12, s[36:39], s89 offen offset:1024 sc1 lds
    v_mfma_f32_16x16x32_bf16 a[0:3], a[192:195], v[240:243], a[0:3]
    v_exp_f32 v171, v171
    v_mfma_f32_16x16x32_bf16 a[0:3], a[196:199], v[244:247], a[0:3]
    ds_read_b128 a[140:143], v9 offset:3072
    v_cvt_pk_bf16_f32 v233, v170, v171
    v_mfma_f32_16x16x32_bf16 a[4:7], a[204:207], v[244:247], a[4:7]
    v_exp_f32 v172, v172
    v_mfma_f32_16x16x32_bf16 a[4:7], a[200:203], v[240:243], a[4:7]
    ds_read_b128 a[156:159], v9 offset:7168
    ds_read_b128 a[152:155], v9 offset:6144
    v_mfma_f32_16x16x32_bf16 a[8:11], a[208:211], v[240:243], a[8:11]
    v_exp_f32 v173, v173
    v_mfma_f32_16x16x32_bf16 a[8:11], a[212:215], v[244:247], a[8:11]
    ds_read_b128 a[148:151], v9 offset:5120
    v_cvt_pk_bf16_f32 v234, v172, v173
    v_mfma_f32_16x16x32_bf16 a[12:15], a[220:223], v[244:247], a[12:15]
    v_exp_f32 v174, v174
    v_mfma_f32_16x16x32_bf16 a[12:15], a[216:219], v[240:243], a[12:15]
    buffer_load_dwordx4 v13, s[36:39], s89 offen offset:2048 sc1 lds
    v_mfma_f32_16x16x32_bf16 a[16:19], a[224:227], v[240:243], a[16:19]
    s_waitcnt lgkmcnt(7)
    v_exp_f32 v175, v175
    v_mfma_f32_16x16x32_bf16 a[16:19], a[228:231], v[244:247], a[16:19]
L_hop10:
    s_cbranch_execz L_hop14
    ds_read_b128 a[144:147], v9 offset:4096
    v_cvt_pk_bf16_f32 v235, v174, v175
    v_mfma_f32_16x16x32_bf16 a[20:23], a[236:239], v[244:247], a[20:23]
    v_exp_f32 v176, v176
    v_mfma_f32_16x16x32_bf16 a[20:23], a[232:235], v[240:243], a[20:23]
    ds_read_b128 a[160:163], v9 offset:8192
    ds_read_b128 a[164:167], v9 offset:9216
    v_mfma_f32_16x16x32_bf16 a[24:27], a[240:243], v[240:243], a[24:27]
    v_exp_f32 v177, v177
    v_mfma_f32_16x16x32_bf16 a[24:27], a[244:247], v[244:247], a[24:27]
    ds_read_b128 a[168:171], v9 offset:10240
    v_cvt_pk_bf16_f32 v236, v176, v177
    v_mfma_f32_16x16x32_bf16 a[28:31], a[252:255], v[244:247], a[28:31]
    s_add_u32 s70, s89, s90
    v_exp_f32 v178, v178
    v_mfma_f32_16x16x32_bf16 a[28:31], a[248:251], v[240:243], a[28:31]
    buffer_load_dwordx4 v14, s[36:39], s89 offen offset:3072 sc1 lds
    v_mfma_f32_16x16x32_bf16 v[56:59], v[248:251], v[240:243], v[56:59]
    s_waitcnt lgkmcnt(4)
    v_exp_f32 v179, v179
    v_mfma_f32_16x16x32_bf16 v[56:59], v[248:251], v[244:247], v[56:59]
    ds_read_b128 a[172:175], v9 offset:11264
    v_cvt_pk_bf16_f32 v237, v178, v179
    v_mfma_f32_16x16x32_bf16 v[200:203], a[128:131], v[40:43], 0
    s_add_u32 m0, s88, 4096
    v_exp_f32 v180, v180
    v_mfma_f32_16x16x32_bf16 v[200:203], a[132:135], v[72:75], v[200:203]
    buffer_load_dwordx4 v11, s[36:39], s70 offen sc1 lds
    v_mfma_f32_16x16x32_bf16 v[200:203], a[136:139], v[104:107], v[200:203]
    v_exp_f32 v181, v181
    v_mfma_f32_16x16x32_bf16 v[200:203], a[140:143], v[136:139], v[200:203]
    ds_read_b128 a[188:191], v9 offset:15360
    v_cvt_pk_bf16_f32 v238, v180, v181
    v_mfma_f32_16x16x32_bf16 v[204:207], a[156:159], v[136:139], 0
    v_exp_f32 v182, v182
    v_mfma_f32_16x16x32_bf16 v[204:207], a[152:155], v[104:107], v[204:207]
    ds_read_b128 a[184:187], v9 offset:14336
    v_mfma_f32_16x16x32_bf16 v[204:207], a[148:151], v[72:75], v[204:207]
    s_waitcnt lgkmcnt(3)
    v_exp_f32 v183, v183
    v_mfma_f32_16x16x32_bf16 v[204:207], a[144:147], v[40:43], v[204:207]
    ds_read_b128 a[180:183], v9 offset:13312
    v_cvt_pk_bf16_f32 v239, v182, v183
    v_mfma_f32_16x16x32_bf16 v[208:211], a[160:163], v[40:43], 0
    ds_read_b128 a[176:179], v9 offset:12288
    v_mfma_f32_16x16x32_bf16 v[208:211], a[164:167], v[72:75], v[208:211]
    buffer_load_dwordx4 v12, s[36:39], s70 offen offset:1024 sc1 lds
    v_mfma_f32_16x16x32_bf16 v[208:211], a[168:171], v[104:107], v[208:211]
    s_waitcnt lgkmcnt(3)
    v_exp_f32 v200, v200
    v_mfma_f32_16x16x32_bf16 v[208:211], a[172:175], v[136:139], v[208:211]
    buffer_load_dwordx4 v13, s[36:39], s70 offen offset:2048 sc1 lds
    v_mfma_f32_16x16x32_bf16 v[212:215], a[188:191], v[136:139], 0
    s_waitcnt lgkmcnt(1)
    v_exp_f32 v201, v201
    v_mfma_f32_16x16x32_bf16 v[212:215], a[184:187], v[104:107], v[212:215]
    v_cvt_pk_bf16_f32 v240, v200, v201
    v_mov_b32 v10, v9
    v_mfma_f32_16x16x32_bf16 v[212:215], a[180:183], v[72:75], v[212:215]
    s_waitcnt lgkmcnt(0)
    v_exp_f32 v202, v202
    v_mfma_f32_16x16x32_bf16 v[212:215], a[176:179], v[40:43], v[212:215]
    buffer_load_dwordx4 v14, s[36:39], s70 offen offset:3072 sc1 lds
    v_mfma_f32_16x16x32_bf16 a[96:99], a[192:195], v[232:235], a[96:99]
    s_add_u32 s88, s88, 32768
    v_exp_f32 v203, v203
    v_mfma_f32_16x16x32_bf16 a[96:99], a[196:199], v[236:239], a[96:99]
    ds_read_b128 a[192:195], v10 offset:16384
    v_cvt_pk_bf16_f32 v241, v202, v203
    v_mfma_f32_16x16x32_bf16 a[100:103], a[204:207], v[236:239], a[100:103]
    s_sub_u32 s69, s88, 163840
    v_exp_f32 v204, v204
    v_mfma_f32_16x16x32_bf16 a[100:103], a[200:203], v[232:235], a[100:103]
    ds_read_b128 a[196:199], v10 offset:17408
    ds_read_b128 a[204:207], v10 offset:19456
    v_mfma_f32_16x16x32_bf16 a[104:107], a[208:211], v[232:235], a[104:107]
    s_min_u32 s88, s88, s69
    v_exp_f32 v205, v205
    v_mfma_f32_16x16x32_bf16 a[104:107], a[212:215], v[236:239], a[104:107]
    ds_read_b128 a[200:203], v10 offset:18432
    v_cvt_pk_bf16_f32 v242, v204, v205
    v_mfma_f32_16x16x32_bf16 a[108:111], a[220:223], v[236:239], a[108:111]
    v_exp_f32 v206, v206
    v_mfma_f32_16x16x32_bf16 a[108:111], a[216:219], v[232:235], a[108:111]
    ds_read_b128 a[208:211], v10 offset:20480
    ds_read_b128 a[212:215], v10 offset:21504
    v_mfma_f32_16x16x32_bf16 a[112:115], a[224:227], v[232:235], a[112:115]
    s_add_u32 s89, s70, s91
    v_exp_f32 v207, v207
    v_mfma_f32_16x16x32_bf16 a[112:115], a[228:231], v[236:239], a[112:115]
    ds_read_b128 a[220:223], v10 offset:23552
    v_cvt_pk_bf16_f32 v243, v206, v207
    v_mfma_f32_16x16x32_bf16 a[116:119], a[236:239], v[236:239], a[116:119]
    s_sub_u32 s92, s92, 1
    v_exp_f32 v208, v208
    v_mfma_f32_16x16x32_bf16 a[116:119], a[232:235], v[232:235], a[116:119]
    ds_read_b128 a[216:219], v10 offset:22528
    ds_read_b128 a[224:227], v10 offset:24576
    v_mfma_f32_16x16x32_bf16 a[120:123], a[240:243], v[232:235], a[120:123]
    v_exp_f32 v209, v209
    v_mfma_f32_16x16x32_bf16 a[120:123], a[244:247], v[236:239], a[120:123]
    ds_read_b128 a[228:231], v10 offset:25600
    v_cvt_pk_bf16_f32 v244, v208, v209
    v_mfma_f32_16x16x32_bf16 a[124:127], a[252:255], v[236:239], a[124:127]
    v_exp_f32 v210, v210
    v_mfma_f32_16x16x32_bf16 a[124:127], a[248:251], v[232:235], a[124:127]
    ds_read_b128 a[236:239], v10 offset:27648
    ds_read_b128 a[232:235], v10 offset:26624
    v_mfma_f32_16x16x32_bf16 v[68:71], v[248:251], v[232:235], v[68:71]
    v_exp_f32 v211, v211
    v_mfma_f32_16x16x32_bf16 v[68:71], v[248:251], v[236:239], v[68:71]
    ds_read_b128 a[240:243], v10 offset:28672
    v_cvt_pk_bf16_f32 v245, v210, v211
    v_mfma_f32_16x16x32_bf16 v[168:171], a[128:131], v[52:55], 0
    s_add_u32 s87, s87, 32768
    v_exp_f32 v212, v212
    v_mfma_f32_16x16x32_bf16 v[168:171], a[132:135], v[84:87], v[168:171]
    ds_read_b128 a[244:247], v10 offset:29696
    ds_read_b128 a[252:255], v10 offset:31744
    v_mfma_f32_16x16x32_bf16 v[168:171], a[136:139], v[116:119], v[168:171]
    s_sub_u32 s69, s87, 163840
    v_exp_f32 v213, v213
    v_mfma_f32_16x16x32_bf16 v[168:171], a[140:143], v[148:151], v[168:171]
    ds_read_b128 a[248:251], v10 offset:30720
    v_cvt_pk_bf16_f32 v246, v212, v213
    v_mfma_f32_16x16x32_bf16 v[172:175], a[156:159], v[148:151], 0
    s_min_u32 s87, s87, s69
    v_exp_f32 v214, v214
    v_mfma_f32_16x16x32_bf16 v[172:175], a[152:155], v[116:119], v[172:175]
    v_add_u32 v9, s87, v17
    v_mfma_f32_16x16x32_bf16 v[172:175], a[148:151], v[84:87], v[172:175]
    s_waitcnt vmcnt(8)
    v_exp_f32 v215, v215
    v_mfma_f32_16x16x32_bf16 v[172:175], a[144:147], v[52:55], v[172:175]
    s_cmp_lg_u32 s92, 0
    v_cvt_pk_bf16_f32 v247, v214, v215
    v_mfma_f32_16x16x32_bf16 v[176:179], a[160:163], v[52:55], 0
    s_waitcnt lgkmcnt(0)
    s_cbranch_scc1 L_r2
    s_getpc_b64 s[24:25]
    global_load_dword v37, v34, s[24:25]
    v_mfma_f32_16x16x32_bf16 v[176:179], a[164:167], v[84:87], v[176:179]
    s_barrier
    v_mfma_f32_16x16x32_bf16 v[176:179], a[168:171], v[116:119], v[176:179]
    s_add_u32 s72, s94, 0
    v_exp_f32 v168, v168
    v_mfma_f32_16x16x32_bf16 v[176:179], a[172:175], v[148:151], v[176:179]
    ds_read_b128 a[128:131], v9
    ds_read_b128 a[132:135], v9 offset:1024
    buffer_load_dwordx4 a[32:35], v17, s[32:35], s72 offen sc1
    v_mfma_f32_16x16x32_bf16 v[180:183], a[188:191], v[148:151], 0
    s_mov_b32 s89, 0
    v_exp_f32 v169, v169
    v_mfma_f32_16x16x32_bf16 v[180:183], a[184:187], v[116:119], v[180:183]
    s_mov_b32 s90, 8192
    ds_read_b128 a[136:139], v9 offset:2048
    v_cvt_pk_bf16_f32 v232, v168, v169
    v_mfma_f32_16x16x32_bf16 v[180:183], a[180:183], v[84:87], v[180:183]
    s_add_u32 s73, s95, 0
    v_exp_f32 v170, v170
    v_mfma_f32_16x16x32_bf16 v[180:183], a[176:179], v[52:55], v[180:183]
    ds_read_b128 a[140:143], v9 offset:3072
    buffer_load_dwordx4 a[36:39], v17, s[32:35], s73 offen sc1
    v_mfma_f32_16x16x32_bf16 a[0:3], a[192:195], v[240:243], a[0:3]
    s_mov_b32 s91, 122880
    v_exp_f32 v171, v171
    v_mfma_f32_16x16x32_bf16 a[0:3], a[196:199], v[244:247], a[0:3]
    ds_read_b128 a[156:159], v9 offset:7168
    v_cvt_pk_bf16_f32 v233, v170, v171
    v_mfma_f32_16x16x32_bf16 a[4:7], a[204:207], v[244:247], a[4:7]
    s_mov_b32 m0, s88
    v_exp_f32 v172, v172
    v_mfma_f32_16x16x32_bf16 a[4:7], a[200:203], v[240:243], a[4:7]
    buffer_load_dwordx4 v18, s[40:43], s89 offen lds
    v_mfma_f32_16x16x32_bf16 a[8:11], a[208:211], v[240:243], a[8:11]
    v_exp_f32 v173, v173
    v_mfma_f32_16x16x32_bf16 a[8:11], a[212:215], v[244:247], a[8:11]
    ds_read_b128 a[152:155], v9 offset:6144
    v_cvt_pk_bf16_f32 v234, v172, v173
    v_mfma_f32_16x16x32_bf16 a[12:15], a[220:223], v[244:247], a[12:15]
    v_exp_f32 v174, v174
    v_mfma_f32_16x16x32_bf16 a[12:15], a[216:219], v[240:243], a[12:15]
    ds_read_b128 a[148:151], v9 offset:5120
    ds_read_b128 a[144:147], v9 offset:4096
    buffer_load_dwordx4 a[40:43], v17, s[32:35], s72 offen offset:1024 sc1
    v_mfma_f32_16x16x32_bf16 a[16:19], a[224:227], v[240:243], a[16:19]
    v_exp_f32 v175, v175
    v_mfma_f32_16x16x32_bf16 a[16:19], a[228:231], v[244:247], a[16:19]
    ds_read_b128 a[160:163], v9 offset:8192
    v_cvt_pk_bf16_f32 v235, v174, v175
    v_mfma_f32_16x16x32_bf16 a[20:23], a[236:239], v[244:247], a[20:23]
    v_exp_f32 v176, v176
    v_mfma_f32_16x16x32_bf16 a[20:23], a[232:235], v[240:243], a[20:23]
    buffer_load_dwordx4 v19, s[40:43], s89 offen offset:1024 lds
    v_mfma_f32_16x16x32_bf16 a[24:27], a[240:243], v[240:243], a[24:27]
    v_exp_f32 v177, v177
    v_mfma_f32_16x16x32_bf16 a[24:27], a[244:247], v[244:247], a[24:27]
    ds_read_b128 a[164:167], v9 offset:9216
    v_cvt_pk_bf16_f32 v236, v176, v177
    v_mfma_f32_16x16x32_bf16 a[28:31], a[252:255], v[244:247], a[28:31]
    v_exp_f32 v178, v178
    v_mfma_f32_16x16x32_bf16 a[28:31], a[248:251], v[240:243], a[28:31]
    ds_read_b128 a[168:171], v9 offset:10240
    buffer_load_dwordx4 a[44:47], v17, s[32:35], s73 offen offset:1024 sc1
    v_mfma_f32_16x16x32_bf16 v[56:59], v[248:251], v[240:243], v[56:59]
    s_waitcnt lgkmcnt(6)
    v_exp_f32 v179, v179
    v_mfma_f32_16x16x32_bf16 v[56:59], v[248:251], v[244:247], v[56:59]
    ds_read_b128 a[172:175], v9 offset:11264
    v_cvt_pk_bf16_f32 v237, v178, v179
    v_mfma_f32_16x16x32_bf16 v[200:203], a[128:131], v[40:43], 0
    v_exp_f32 v180, v180
    v_mfma_f32_16x16x32_bf16 v[200:203], a[132:135], v[72:75], v[200:203]
    buffer_load_dwordx4 v20, s[40:43], s89 offen offset:2048 lds
    v_mfma_f32_16x16x32_bf16 v[200:203], a[136:139], v[104:107], v[200:203]
    v_exp_f32 v181, v181
    v_mfma_f32_16x16x32_bf16 v[200:203], a[140:143], v[136:139], v[200:203]
    ds_read_b128 a[188:191], v9 offset:15360
    v_cvt_pk_bf16_f32 v238, v180, v181
    v_mfma_f32_16x16x32_bf16 v[204:207], a[156:159], v[136:139], 0
    s_waitcnt lgkmcnt(4)
    v_exp_f32 v182, v182
    v_mfma_f32_16x16x32_bf16 v[204:207], a[152:155], v[104:107], v[204:207]
    ds_read_b128 a[184:187], v9 offset:14336
    buffer_load_dwordx4 a[48:51], v17, s[32:35], s72 offen offset:2048 sc1
    v_mfma_f32_16x16x32_bf16 v[204:207], a[148:151], v[72:75], v[204:207]
    v_exp_f32 v183, v183
    v_mfma_f32_16x16x32_bf16 v[204:207], a[144:147], v[40:43], v[204:207]
    s_add_u32 s70, s89, s90
    ds_read_b128 a[180:183], v9 offset:13312
    v_cvt_pk_bf16_f32 v239, v182, v183
    v_mfma_f32_16x16x32_bf16 v[208:211], a[160:163], v[40:43], 0
    s_waitcnt lgkmcnt(2)
    ds_read_b128 a[176:179], v9 offset:12288
    v_mfma_f32_16x16x32_bf16 v[208:211], a[164:167], v[72:75], v[208:211]
    buffer_load_dwordx4 v21, s[40:43], s89 offen offset:3072 lds
    v_mfma_f32_16x16x32_bf16 v[208:211], a[168:171], v[104:107], v[208:211]
    s_add_u32 m0, s88, 4096
    v_exp_f32 v200, v200
    v_mfma_f32_16x16x32_bf16 v[208:211], a[172:175], v[136:139], v[208:211]
    buffer_load_dwordx4 v18, s[40:43], s70 offen lds
    v_mfma_f32_16x16x32_bf16 v[212:215], a[188:191], v[136:139], 0
    s_waitcnt lgkmcnt(1)
    v_exp_f32 v201, v201
    v_mfma_f32_16x16x32_bf16 v[212:215], a[184:187], v[104:107], v[212:215]
    v_cvt_pk_bf16_f32 v240, v200, v201
    v_mov_b32 v10, v9
    v_mfma_f32_16x16x32_bf16 v[212:215], a[180:183], v[72:75], v[212:215]
    s_waitcnt lgkmcnt(0)
    v_exp_f32 v202, v202
    v_mfma_f32_16x16x32_bf16 v[212:215], a[176:179], v[40:43], v[212:215]
    buffer_load_dwordx4 v19, s[40:43], s70 offen offset:1024 lds
    v_mfma_f32_16x16x32_bf16 a[96:99], a[192:195], v[232:235], a[96:99]
    s_add_u32 s88, s88, 32768
    v_exp_f32 v203, v203
    v_mfma_f32_16x16x32_bf16 a[96:99], a[196:199], v[236:239], a[96:99]
    ds_read_b128 a[192:195], v10 offset:16384
    v_cvt_pk_bf16_f32 v241, v202, v203
    v_mfma_f32_16x16x32_bf16 a[100:103], a[204:207], v[236:239], a[100:103]
    s_sub_u32 s69, s88, 163840
    v_exp_f32 v204, v204
    v_mfma_f32_16x16x32_bf16 a[100:103], a[200:203], v[232:235], a[100:103]
    ds_read_b128 a[196:199], v10 offset:17408
    ds_read_b128 a[204:207], v10 offset:19456
    buffer_load_dwordx4 a[52:55], v17, s[32:35], s73 offen offset:2048 sc1
    v_mfma_f32_16x16x32_bf16 a[104:107], a[208:211], v[232:235], a[104:107]
    s_min_u32 s88, s88, s69
    v_exp_f32 v205, v205
    v_mfma_f32_16x16x32_bf16 a[104:107], a[212:215], v[236:239], a[104:107]
    ds_read_b128 a[200:203], v10 offset:18432
    v_cvt_pk_bf16_f32 v242, v204, v205
    v_mfma_f32_16x16x32_bf16 a[108:111], a[220:223], v[236:239], a[108:111]
    v_exp_f32 v206, v206
    v_mfma_f32_16x16x32_bf16 a[108:111], a[216:219], v[232:235], a[108:111]
    buffer_load_dwordx4 v20, s[40:43], s70 offen offset:2048 lds
    v_mfma_f32_16x16x32_bf16 a[112:115], a[224:227], v[232:235], a[112:115]
    v_exp_f32 v207, v207
    v_mfma_f32_16x16x32_bf16 a[112:115], a[228:231], v[236:239], a[112:115]
    ds_read_b128 a[208:211], v10 offset:20480
    v_cvt_pk_bf16_f32 v243, v206, v207
    v_mfma_f32_16x16x32_bf16 a[116:119], a[236:239], v[236:239], a[116:119]
    v_exp_f32 v208, v208
    v_mfma_f32_16x16x32_bf16 a[116:119], a[232:235], v[232:235], a[116:119]
    ds_read_b128 a[212:215], v10 offset:21504
    ds_read_b128 a[220:223], v10 offset:23552
    buffer_load_dwordx4 a[56:59], v17, s[32:35], s72 offen offset:3072 sc1
    v_mfma_f32_16x16x32_bf16 a[120:123], a[240:243], v[232:235], a[120:123]
    v_exp_f32 v209, v209
    v_mfma_f32_16x16x32_bf16 a[120:123], a[244:247], v[236:239], a[120:123]
    ds_read_b128 a[216:219], v10 offset:22528
    v_cvt_pk_bf16_f32 v244, v208, v209
    v_mfma_f32_16x16x32_bf16 a[124:127], a[252:255], v[236:239], a[124:127]
    v_exp_f32 v210, v210
    v_mfma_f32_16x16x32_bf16 a[124:127], a[248:251], v[232:235], a[124:127]
    buffer_load_dwordx4 v21, s[40:43], s70 offen offset:3072 lds
    v_mfma_f32_16x16x32_bf16 v[68:71], v[248:251], v[232:235], v[68:71]
    s_add_u32 s89, s70, s91
    v_exp_f32 v211, v211
    v_mfma_f32_16x16x32_bf16 v[68:71], v[248:251], v[236:239], v[68:71]
    ds_read_b128 a[224:227], v10 offset:24576
    buffer_load_dwordx4 a[60:63], v17, s[32:35], s73 offen offset:3072 sc1
    v_cvt_pk_bf16_f32 v245, v210, v211
    v_mfma_f32_16x16x32_bf16 v[168:171], a[128:131], v[52:55], 0
    s_add_u32 s87, s87, 32768
    v_exp_f32 v212, v212
    v_mfma_f32_16x16x32_bf16 v[168:171], a[132:135], v[84:87], v[168:171]
    ds_read_b128 a[228:231], v10 offset:25600
    ds_read_b128 a[236:239], v10 offset:27648
    v_mfma_f32_16x16x32_bf16 v[168:171], a[136:139], v[116:119], v[168:171]
    s_sub_u32 s69, s87, 163840
    v_exp_f32 v213, v213
    v_mfma_f32_16x16x32_bf16 v[168:171], a[140:143], v[148:151], v[168:171]
    ds_read_b128 a[232:235], v10 offset:26624
    v_cvt_pk_bf16_f32 v246, v212, v213
    v_mfma_f32_16x16x32_bf16 v[172:175], a[156:159], v[148:151], 0
    s_min_u32 s87, s87, s69
    s_add_u32 s72, s94, 4096
    v_exp_f32 v214, v214
    v_mfma_f32_16x16x32_bf16 v[172:175], a[152:155], v[116:119], v[172:175]
    ds_read_b128 a[240:243], v10 offset:28672
    buffer_load_dwordx4 a[64:67], v17, s[32:35], s72 offen sc1
    v_add_u32 v9, s87, v17
    v_mfma_f32_16x16x32_bf16 v[172:175], a[148:151], v[84:87], v[172:175]
    v_exp_f32 v215, v215
    v_mfma_f32_16x16x32_bf16 v[172:175], a[144:147], v[52:55], v[172:175]
    ds_read_b128 a[244:247], v10 offset:29696
    v_cvt_pk_bf16_f32 v247, v214, v215
    v_mfma_f32_16x16x32_bf16 v[176:179], a[160:163], v[52:55], 0
    s_mov_b32 m0, s88
    ds_read_b128 a[252:255], v10 offset:31744
    ds_read_b128 a[248:251], v10 offset:30720
    v_mfma_f32_16x16x32_bf16 v[176:179], a[164:167], v[84:87], v[176:179]
    buffer_load_dwordx4 v18, s[40:43], s89 offen lds
    v_mfma_f32_16x16x32_bf16 v[176:179], a[168:171], v[116:119], v[176:179]
    v_exp_f32 v168, v168
    v_mfma_f32_16x16x32_bf16 v[176:179], a[172:175], v[148:151], v[176:179]
    ds_read_b128 a[128:131], v9
    ds_read_b128 a[132:135], v9 offset:1024
    v_mfma_f32_16x16x32_bf16 v[180:183], a[188:191], v[148:151], 0
    v_exp_f32 v169, v169
    v_mfma_f32_16x16x32_bf16 v[180:183], a[184:187], v[116:119], v[180:183]
    ds_read_b128 a[136:139], v9 offset:2048
    v_cvt_pk_bf16_f32 v232, v168, v169
    v_mfma_f32_16x16x32_bf16 v[180:183], a[180:183], v[84:87], v[180:183]
    s_waitcnt lgkmcnt(10)
    v_exp_f32 v170, v170
    v_mfma_f32_16x16x32_bf16 v[180:183], a[176:179], v[52:55], v[180:183]
    buffer_load_dwordx4 v19, s[40:43], s89 offen offset:1024 lds
    v_mfma_f32_16x16x32_bf16 a[0:3], a[192:195], v[240:243], a[0:3]
    v_exp_f32 v171, v171
    v_mfma_f32_16x16x32_bf16 a[0:3], a[196:199], v[244:247], a[0:3]
    ds_read_b128 a[140:143], v9 offset:3072
    v_cvt_pk_bf16_f32 v233, v170, v171
    v_mfma_f32_16x16x32_bf16 a[4:7], a[204:207], v[244:247], a[4:7]
    s_add_u32 s73, s95, 4096
    v_exp_f32 v172, v172
    v_mfma_f32_16x16x32_bf16 a[4:7], a[200:203], v[240:243], a[4:7]
    ds_read_b128 a[156:159], v9 offset:7168
    ds_read_b128 a[152:155], v9 offset:6144
    buffer_load_dwordx4 a[68:71], v17, s[32:35], s73 offen sc1
    v_mfma_f32_16x16x32_bf16 a[8:11], a[208:211], v[240:243], a[8:11]
    v_exp_f32 v173, v173
    v_mfma_f32_16x16x32_bf16 a[8:11], a[212:215], v[244:247], a[8:11]
    ds_read_b128 a[148:151], v9 offset:5120
    v_cvt_pk_bf16_f32 v234, v172, v173
    v_mfma_f32_16x16x32_bf16 a[12:15], a[220:223], v[244:247], a[12:15]
    v_exp_f32 v174, v174
    v_mfma_f32_16x16x32_bf16 a[12:15], a[216:219], v[240:243], a[12:15]
    buffer_load_dwordx4 v20, s[40:43], s89 offen offset:2048 lds
    v_mfma_f32_16x16x32_bf16 a[16:19], a[224:227], v[240:243], a[16:19]
    s_waitcnt lgkmcnt(7)
    v_exp_f32 v175, v175
    v_mfma_f32_16x16x32_bf16 a[16:19], a[228:231], v[244:247], a[16:19]
    ds_read_b128 a[144:147], v9 offset:4096
    v_cvt_pk_bf16_f32 v235, v174, v175
    v_mfma_f32_16x16x32_bf16 a[20:23], a[236:239], v[244:247], a[20:23]
    v_exp_f32 v176, v176
    v_mfma_f32_16x16x32_bf16 a[20:23], a[232:235], v[240:243], a[20:23]
    ds_read_b128 a[160:163], v9 offset:8192
    ds_read_b128 a[164:167], v9 offset:9216
    buffer_load_dwordx4 a[72:75], v17, s[32:35], s72 offen offset:1024 sc1
    v_mfma_f32_16x16x32_bf16 a[24:27], a[240:243], v[240:243], a[24:27]
    v_exp_f32 v177, v177
    v_mfma_f32_16x16x32_bf16 a[24:27], a[244:247], v[244:247], a[24:27]
    ds_read_b128 a[168:171], v9 offset:10240
    v_cvt_pk_bf16_f32 v236, v176, v177
    v_mfma_f32_16x16x32_bf16 a[28:31], a[252:255], v[244:247], a[28:31]
    s_add_u32 s70, s89, s90
    v_exp_f32 v178, v178
    v_mfma_f32_16x16x32_bf16 a[28:31], a[248:251], v[240:243], a[28:31]
    buffer_load_dwordx4 v21, s[40:43], s89 offen offset:3072 lds
    v_mfma_f32_16x16x32_bf16 v[56:59], v[248:251], v[240:243], v[56:59]
    s_waitcnt lgkmcnt(4)
    v_exp_f32 v179, v179
    v_mfma_f32_16x16x32_bf16 v[56:59], v[248:251], v[244:247], v[56:59]
    ds_read_b128 a[172:175], v9 offset:11264
    v_cvt_pk_bf16_f32 v237, v178, v179
    v_mfma_f32_16x16x32_bf16 v[200:203], a[128:131], v[40:43], 0
    s_add_u32 m0, s88, 4096
    v_exp_f32 v180, v180
    v_mfma_f32_16x16x32_bf16 v[200:203], a[132:135], v[72:75], v[200:203]
    buffer_load_dwordx4 v18, s[40:43], s70 offen lds
    v_mfma_f32_16x16x32_bf16 v[200:203], a[136:139], v[104:107], v[200:203]
    v_exp_f32 v181, v181
    v_mfma_f32_16x16x32_bf16 v[200:203], a[140:143], v[136:139], v[200:203]
    ds_read_b128 a[188:191], v9 offset:15360
    v_cvt_pk_bf16_f32 v238, v180, v181
    v_mfma_f32_16x16x32_bf16 v[204:207], a[156:159], v[136:139], 0
    v_exp_f32 v182, v182
    v_mfma_f32_16x16x32_bf16 v[204:207], a[152:155], v[104:107], v[204:207]
    ds_read_b128 a[184:187], v9 offset:14336
    buffer_load_dwordx4 a[76:79], v17, s[32:35], s73 offen offset:1024 sc1
    v_mfma_f32_16x16x32_bf16 v[204:207], a[148:151], v[72:75], v[204:207]
    s_waitcnt lgkmcnt(3)
    v_exp_f32 v183, v183
    v_mfma_f32_16x16x32_bf16 v[204:207], a[144:147], v[40:43], v[204:207]
    ds_read_b128 a[180:183], v9 offset:13312
    v_cvt_pk_bf16_f32 v239, v182, v183
    v_mfma_f32_16x16x32_bf16 v[208:211], a[160:163], v[40:43], 0
    ds_read_b128 a[176:179], v9 offset:12288
    v_mfma_f32_16x16x32_bf16 v[208:211], a[164:167], v[72:75], v[208:211]
    buffer_load_dwordx4 v19, s[40:43], s70 offen offset:1024 lds
    v_mfma_f32_16x16x32_bf16 v[208:211], a[168:171], v[104:107], v[208:211]
    s_waitcnt lgkmcnt(3)
    v_exp_f32 v200, v200
    v_mfma_f32_16x16x32_bf16 v[208:211], a[172:175], v[136:139], v[208:211]
    buffer_load_dwordx4 v20, s[40:43], s70 offen offset:2048 lds
    v_mfma_f32_16x16x32_bf16 v[212:215], a[188:191], v[136:139], 0
    s_waitcnt lgkmcnt(1)
    v_exp_f32 v201, v201
    v_mfma_f32_16x16x32_bf16 v[212:215], a[184:187], v[104:107], v[212:215]
    v_cvt_pk_bf16_f32 v240, v200, v201
    v_mov_b32 v10, v9
    v_mfma_f32_16x16x32_bf16 v[212:215], a[180:183], v[72:75], v[212:215]
    s_waitcnt lgkmcnt(0)
    v_exp_f32 v202, v202
    v_mfma_f32_16x16x32_bf16 v[212:215], a[176:179], v[40:43], v[212:215]
    buffer_load_dwordx4 v21, s[40:43], s70 offen offset:3072 lds
    v_mfma_f32_16x16x32_bf16 a[96:99], a[192:195], v[232:235], a[96:99]
    s_add_u32 s88, s88, 32768
    v_exp_f32 v203, v203
    v_mfma_f32_16x16x32_bf16 a[96:99], a[196:199], v[236:239], a[96:99]
    ds_read_b128 a[192:195], v10 offset:16384
    v_cvt_pk_bf16_f32 v241, v202, v203
    v_mfma_f32_16x16x32_bf16 a[100:103], a[204:207], v[236:239], a[100:103]
    s_sub_u32 s69, s88, 163840
    v_exp_f32 v204, v204
    v_mfma_f32_16x16x32_bf16 a[100:103], a[200:203], v[232:235], a[100:103]
    ds_read_b128 a[196:199], v10 offset:17408
    ds_read_b128 a[204:207], v10 offset:19456
    buffer_load_dwordx4 a[80:83], v17, s[32:35], s72 offen offset:2048 sc1
    v_mfma_f32_16x16x32_bf16 a[104:107], a[208:211], v[232:235], a[104:107]
    s_min_u32 s88, s88, s69
    v_exp_f32 v205, v205
    v_mfma_f32_16x16x32_bf16 a[104:107], a[212:215], v[236:239], a[104:107]
    ds_read_b128 a[200:203], v10 offset:18432
    v_cvt_pk_bf16_f32 v242, v204, v205
    v_mfma_f32_16x16x32_bf16 a[108:111], a[220:223], v[236:239], a[108:111]
    v_exp_f32 v206, v206
    v_mfma_f32_16x16x32_bf16 a[108:111], a[216:219], v[232:235], a[108:111]
    ds_read_b128 a[208:211], v10 offset:20480
    ds_read_b128 a[212:215], v10 offset:21504
    buffer_load_dwordx4 a[84:87], v17, s[32:35], s73 offen offset:2048 sc1
    v_mfma_f32_16x16x32_bf16 a[112:115], a[224:227], v[232:235], a[112:115]
    s_add_u32 s89, s70, s91
    v_exp_f32 v207, v207
    v_mfma_f32_16x16x32_bf16 a[112:115], a[228:231], v[236:239], a[112:115]
    ds_read_b128 a[220:223], v10 offset:23552
    v_cvt_pk_bf16_f32 v243, v206, v207
    v_mfma_f32_16x16x32_bf16 a[116:119], a[236:239], v[236:239], a[116:119]
    v_exp_f32 v208, v208
    v_mfma_f32_16x16x32_bf16 a[116:119], a[232:235], v[232:235], a[116:119]
    ds_read_b128 a[216:219], v10 offset:22528
    ds_read_b128 a[224:227], v10 offset:24576
    buffer_load_dwordx4 a[88:91], v17, s[32:35], s72 offen offset:3072 sc1
    v_mfma_f32_16x16x32_bf16 a[120:123], a[240:243], v[232:235], a[120:123]
    v_exp_f32 v209, v209
    v_mfma_f32_16x16x32_bf16 a[120:123], a[244:247], v[236:239], a[120:123]
    ds_read_b128 a[228:231], v10 offset:25600
    v_cvt_pk_bf16_f32 v244, v208, v209
    v_mfma_f32_16x16x32_bf16 a[124:127], a[252:255], v[236:239], a[124:127]
    v_exp_f32 v210, v210
    v_mfma_f32_16x16x32_bf16 a[124:127], a[248:251], v[232:235], a[124:127]
    ds_read_b128 a[236:239], v10 offset:27648
    ds_read_b128 a[232:235], v10 offset:26624
    buffer_load_dwordx4 a[92:95], v17, s[32:35], s73 offen offset:3072 sc1
    v_mfma_f32_16x16x32_bf16 v[68:71], v[248:251], v[232:235], v[68:71]
    v_exp_f32 v211, v211
    v_mfma_f32_16x16x32_bf16 v[68:71], v[248:251], v[236:239], v[68:71]
    ds_read_b128 a[240:243], v10 offset:28672
    v_cvt_pk_bf16_f32 v245, v210, v211
L_e0:
    v_mfma_f32_16x16x32_bf16 v[168:171], a[128:131], v[52:55], v[184:187]
    s_add_u32 s87, s87, 32768
    v_exp_f32 v212, v212
    v_mfma_f32_16x16x32_bf16 v[168:171], a[132:135], v[84:87], v[168:171]
    ds_read_b128 a[244:247], v10 offset:29696
    ds_read_b128 a[252:255], v10 offset:31744
    v_mfma_f32_16x16x32_bf16 v[168:171], a[136:139], v[116:119], v[168:171]
    s_sub_u32 s69, s87, 163840
    v_exp_f32 v213, v213
    v_mfma_f32_16x16x32_bf16 v[168:171], a[140:143], v[148:151], v[168:171]
    ds_read_b128 a[248:251], v10 offset:30720
    v_cvt_pk_bf16_f32 v246, v212, v213
    v_mfma_f32_16x16x32_bf16 v[172:175], a[156:159], v[148:151], v[188:191]
    s_min_u32 s87, s87, s69
    v_exp_f32 v214, v214
    v_mfma_f32_16x16x32_bf16 v[172:175], a[152:155], v[116:119], v[172:175]
    v_add_u32 v9, s87, v17
    v_mfma_f32_16x16x32_bf16 v[172:175], a[148:151], v[84:87], v[172:175]
    s_waitcnt vmcnt(17)
    v_exp_f32 v215, v215
    v_mfma_f32_16x16x32_bf16 v[172:175], a[144:147], v[52:55], v[172:175]
    v_cvt_pk_bf16_f32 v247, v214, v215
    v_mfma_f32_16x16x32_bf16 v[176:179], a[160:163], v[52:55], v[192:195]
    v_mfma_f32_16x16x32_bf16 v[176:179], a[164:167], v[84:87], v[176:179]
    s_barrier
    v_mfma_f32_16x16x32_bf16 v[176:179], a[168:171], v[116:119], v[176:179]
    v_exp_f32 v168, v168
    v_mfma_f32_16x16x32_bf16 v[176:179], a[172:175], v[148:151], v[176:179]
    ds_read_b128 a[128:131], v9
    ds_read_b128 a[132:135], v9 offset:1024
    v_mfma_f32_16x16x32_bf16 v[180:183], a[188:191], v[148:151], v[196:199]
    v_exp_f32 v169, v169
    v_mfma_f32_16x16x32_bf16 v[180:183], a[184:187], v[116:119], v[180:183]
    ds_read_b128 a[136:139], v9 offset:2048
    v_cvt_pk_bf16_f32 v232, v168, v169
    v_mfma_f32_16x16x32_bf16 v[180:183], a[180:183], v[84:87], v[180:183]
    s_waitcnt lgkmcnt(10)
    v_exp_f32 v170, v170
    v_mfma_f32_16x16x32_bf16 v[180:183], a[176:179], v[52:55], v[180:183]
    ds_read_b128 a[140:143], v9 offset:3072
    v_mfma_f32_16x16x32_bf16 a[0:3], a[192:195], v[240:243], a[0:3]
    v_exp_f32 v171, v171
    v_mfma_f32_16x16x32_bf16 a[0:3], a[196:199], v[244:247], a[0:3]
    ds_read_b128 a[156:159], v9 offset:7168
    v_cvt_pk_bf16_f32 v233, v170, v171
    v_mfma_f32_16x16x32_bf16 a[4:7], a[204:207], v[244:247], a[4:7]
    s_mov_b32 m0, s88
    v_exp_f32 v172, v172
    v_mfma_f32_16x16x32_bf16 a[4:7], a[200:203], v[240:243], a[4:7]
    buffer_load_dwordx4 v18, s[40:43], s89 offen lds
    v_mfma_f32_16x16x32_bf16 a[8:11], a[208:211], v[240:243], a[8:11]
    v_exp_f32 v173, v173
    v_mfma_f32_16x16x32_bf16 a[8:11], a[212:215], v[244:247], a[8:11]
    ds_read_b128 a[152:155], v9 offset:6144
    v_cvt_pk_bf16_f32 v234, v172, v173
    v_mfma_f32_16x16x32_bf16 a[12:15], a[220:223], v[244:247], a[12:15]
    v_exp_f32 v174, v174
    v_mfma_f32_16x16x32_bf16 a[12:15], a[216:219], v[240:243], a[12:15]
    ds_read_b128 a[148:151], v9 offset:5120
    ds_read_b128 a[144:147], v9 offset:4096
    v_mfma_f32_16x16x32_bf16 a[16:19], a[224:227], v[240:243], a[16:19]
    s_waitcnt lgkmcnt(8)
    v_exp_f32 v175, v175
    v_mfma_f32_16x16x32_bf16 a[16:19], a[228:231], v[244:247], a[16:19]
    ds_read_b128 a[160:163], v9 offset:8192
    v_cvt_pk_bf16_f32 v235, v174, v175
    v_mfma_f32_16x16x32_bf16 a[20:23], a[236:239], v[244:247], a[20:23]
    v_exp_f32 v176, v176
    v_mfma_f32_16x16x32_bf16 a[20:23], a[232:235], v[240:243], a[20:23]
    buffer_load_dwordx4 v19, s[40:43], s89 offen offset:1024 lds
    v_mfma_f32_16x16x32_bf16 a[24:27], a[240:243], v[240:243], a[24:27]
    v_exp_f32 v177, v177
    v_mfma_f32_16x16x32_bf16 a[24:27], a[244:247], v[244:247], a[24:27]
    ds_read_b128 a[164:167], v9 offset:9216
    v_cvt_pk_bf16_f32 v236, v176, v177
    v_mfma_f32_16x16x32_bf16 a[28:31], a[252:255], v[244:247], a[28:31]
    v_exp_f32 v178, v178
    v_mfma_f32_16x16x32_bf16 a[28:31], a[248:251], v[240:243], a[28:31]
    ds_read_b128 a[168:171], v9 offset:10240
    v_mfma_f32_16x16x32_bf16 v[56:59], v[248:251], v[240:243], v[56:59]
    s_waitcnt lgkmcnt(6)
    v_exp_f32 v179, v179
    v_mfma_f32_16x16x32_bf16 v[56:59], v[248:251], v[244:247], v[56:59]
    ds_read_b128 a[172:175], v9 offset:11264
    v_cvt_pk_bf16_f32 v237, v178, v179
    v_mfma_f32_16x16x32_bf16 v[200:203], a[128:131], v[40:43], v[216:219]
    v_exp_f32 v180, v180
    v_mfma_f32_16x16x32_bf16 v[200:203], a[132:135], v[72:75], v[200:203]
    buffer_load_dwordx4 v20, s[40:43], s89 offen offset:2048 lds
    v_mfma_f32_16x16x32_bf16 v[200:203], a[136:139], v[104:107], v[200:203]
    v_exp_f32 v181, v181
    v_mfma_f32_16x16x32_bf16 v[200:203], a[140:143], v[136:139], v[200:203]
    ds_read_b128 a[188:191], v9 offset:15360
    v_cvt_pk_bf16_f32 v238, v180, v181
    v_mfma_f32_16x16x32_bf16 v[204:207], a[156:159], v[136:139], v[220:223]
    s_waitcnt lgkmcnt(4)
    s_add_u32 s72, s94, 8192
    v_exp_f32 v182, v182
    v_mfma_f32_16x16x32_bf16 v[204:207], a[152:155], v[104:107], v[204:207]
L_hop11:
    s_cbranch_execz L_hop15
    ds_read_b128 a[184:187], v9 offset:14336
    buffer_load_dwordx4 a[128:131], v17, s[32:35], s72 offen sc1
    v_mfma_f32_16x16x32_bf16 v[204:207], a[148:151], v[72:75], v[204:207]
    v_exp_f32 v183, v183
    v_mfma_f32_16x16x32_bf16 v[204:207], a[144:147], v[40:43], v[204:207]
    s_add_u32 s70, s89, s90
    ds_read_b128 a[180:183], v9 offset:13312
    v_cvt_pk_bf16_f32 v239, v182, v183
    v_mfma_f32_16x16x32_bf16 v[208:211], a[160:163], v[40:43], v[224:227]
    s_waitcnt lgkmcnt(2)
    ds_read_b128 a[176:179], v9 offset:12288
    v_mfma_f32_16x16x32_bf16 v[208:211], a[164:167], v[72:75], v[208:211]
    buffer_load_dwordx4 v21, s[40:43], s89 offen offset:3072 lds
    v_mfma_f32_16x16x32_bf16 v[208:211], a[168:171], v[104:107], v[208:211]
    s_add_u32 m0, s88, 4096
    v_exp_f32 v200, v200
    v_mfma_f32_16x16x32_bf16 v[208:211], a[172:175], v[136:139], v[208:211]
    buffer_load_dwordx4 v18, s[40:43], s70 offen lds
    v_mfma_f32_16x16x32_bf16 v[212:215], a[188:191], v[136:139], v[228:231]
    s_waitcnt lgkmcnt(1)
    s_add_u32 s73, s95, 8192
    v_exp_f32 v201, v201
    v_mfma_f32_16x16x32_bf16 v[212:215], a[184:187], v[104:107], v[212:215]
    buffer_load_dwordx4 a[132:135], v17, s[32:35], s73 offen sc1
    v_cvt_pk_bf16_f32 v240, v200, v201
    v_mov_b32 v10, v9
    v_mfma_f32_16x16x32_bf16 v[212:215], a[180:183], v[72:75], v[212:215]
    s_waitcnt lgkmcnt(0)
    v_exp_f32 v202, v202
    v_mfma_f32_16x16x32_bf16 v[212:215], a[176:179], v[40:43], v[212:215]
    buffer_load_dwordx4 v19, s[40:43], s70 offen offset:1024 lds
    v_mfma_f32_16x16x32_bf16 a[96:99], a[192:195], v[232:235], a[96:99]
    s_add_u32 s88, s88, 32768
    v_exp_f32 v203, v203
    v_mfma_f32_16x16x32_bf16 a[96:99], a[196:199], v[236:239], a[96:99]
    ds_read_b128 a[192:195], v10 offset:16384
    v_cvt_pk_bf16_f32 v241, v202, v203
    v_mfma_f32_16x16x32_bf16 a[100:103], a[204:207], v[236:239], a[100:103]
    s_sub_u32 s69, s88, 163840
    v_exp_f32 v204, v204
    v_mfma_f32_16x16x32_bf16 a[100:103], a[200:203], v[232:235], a[100:103]
    ds_read_b128 a[196:199], v10 offset:17408
    ds_read_b128 a[204:207], v10 offset:19456
    buffer_load_dwordx4 a[136:139], v17, s[32:35], s72 offen offset:1024 sc1
    v_mfma_f32_16x16x32_bf16 a[104:107], a[208:211], v[232:235], a[104:107]
    s_min_u32 s88, s88, s69
    v_exp_f32 v205, v205
    v_mfma_f32_16x16x32_bf16 a[104:107], a[212:215], v[236:239], a[104:107]
    ds_read_b128 a[200:203], v10 offset:18432
    v_cvt_pk_bf16_f32 v242, v204, v205
    v_mfma_f32_16x16x32_bf16 a[108:111], a[220:223], v[236:239], a[108:111]
    v_exp_f32 v206, v206
    v_mfma_f32_16x16x32_bf16 a[108:111], a[216:219], v[232:235], a[108:111]
    buffer_load_dwordx4 v20, s[40:43], s70 offen offset:2048 lds
    v_mfma_f32_16x16x32_bf16 a[112:115], a[224:227], v[232:235], a[112:115]
    v_exp_f32 v207, v207
    v_mfma_f32_16x16x32_bf16 a[112:115], a[228:231], v[236:239], a[112:115]
    ds_read_b128 a[208:211], v10 offset:20480
    buffer_load_dwordx4 a[140:143], v17, s[32:35], s73 offen offset:1024 sc1
    v_cvt_pk_bf16_f32 v243, v206, v207
    v_mfma_f32_16x16x32_bf16 a[116:119], a[236:239], v[236:239], a[116:119]
    v_exp_f32 v208, v208
    v_mfma_f32_16x16x32_bf16 a[116:119], a[232:235], v[232:235], a[116:119]
    ds_read_b128 a[212:215], v10 offset:21504
    ds_read_b128 a[220:223], v10 offset:23552
    v_mfma_f32_16x16x32_bf16 a[120:123], a[240:243], v[232:235], a[120:123]
    v_exp_f32 v209, v209
    v_mfma_f32_16x16x32_bf16 a[120:123], a[244:247], v[236:239], a[120:123]
    ds_read_b128 a[216:219], v10 offset:22528
    buffer_load_dwordx4 a[144:147], v17, s[32:35], s72 offen offset:2048 sc1
    v_cvt_pk_bf16_f32 v244, v208, v209
    v_mfma_f32_16x16x32_bf16 a[124:127], a[252:255], v[236:239], a[124:127]
    v_exp_f32 v210, v210
    v_mfma_f32_16x16x32_bf16 a[124:127], a[248:251], v[232:235], a[124:127]
    buffer_load_dwordx4 v21, s[40:43], s70 offen offset:3072 lds
    v_mfma_f32_16x16x32_bf16 v[68:71], v[248:251], v[232:235], v[68:71]
    s_add_u32 s89, s70, s91
    v_exp_f32 v211, v211
    v_mfma_f32_16x16x32_bf16 v[68:71], v[248:251], v[236:239], v[68:71]
    ds_read_b128 a[224:227], v10 offset:24576
    buffer_load_dwordx4 a[148:151], v17, s[32:35], s73 offen offset:2048 sc1
    v_cvt_pk_bf16_f32 v245, v210, v211
    ds_read_b128 a[228:231], v10 offset:25600
    ds_read_b128 a[236:239], v10 offset:27648
    v_exp_f32 v212, v212
    ds_read_b128 a[232:235], v10 offset:26624
    ds_read_b128 a[240:243], v10 offset:28672
    v_exp_f32 v213, v213
    buffer_load_dwordx4 a[152:155], v17, s[32:35], s72 offen offset:3072 sc1
    ds_read_b128 a[244:247], v10 offset:29696
    ds_read_b128 a[252:255], v10 offset:31744
    v_exp_f32 v214, v214
    ds_read_b128 a[248:251], v10 offset:30720
    v_exp_f32 v215, v215
    buffer_load_dwordx4 a[156:159], v17, s[32:35], s73 offen offset:3072 sc1
    v_cvt_pk_bf16_f32 v246, v212, v213
    v_cvt_pk_bf16_f32 v247, v214, v215
    s_mov_b32 s87, s10
    v_subrev_u32 v69, 0x2b800000, v68
    v_cmp_le_u32 vcc, s93, v69
    s_nop 1
    s_cbranch_vccnz L_fb3
L_fb3_ret:
    v_mfma_f32_16x16x32_bf16 v[56:59], v[248:251], v[240:243], v[56:59]
    s_add_u32 s72, s94, 12288
    v_rcp_f32 v68, v68
    v_mfma_f32_16x16x32_bf16 v[56:59], v[248:251], v[244:247], v[56:59]
    s_waitcnt lgkmcnt(8)
    buffer_load_dwordx4 a[160:163], v17, s[32:35], s72 offen sc1
    v_mfma_f32_16x16x32_bf16 a[0:3], a[192:195], v[240:243], a[0:3]
    s_add_u32 s73, s95, 12288
    v_mul_f32 v68, v68, v31
    v_accvgpr_read_b32 v88, a96
    v_accvgpr_read_b32 v89, a97
    v_mfma_f32_16x16x32_bf16 a[0:3], a[196:199], v[244:247], a[0:3]
    buffer_load_dwordx4 a[164:167], v17, s[32:35], s73 offen sc1
    v_accvgpr_read_b32 v90, a98
    v_mfma_f32_16x16x32_bf16 a[4:7], a[204:207], v[244:247], a[4:7]
    s_lshl_b32 s71, s68, 12
    v_accvgpr_read_b32 v91, a99
    v_accvgpr_read_b32 v152, a100
    v_accvgpr_read_b32 v153, a101
    v_mfma_f32_16x16x32_bf16 a[4:7], a[200:203], v[240:243], a[4:7]
    buffer_load_dwordx4 a[168:171], v17, s[32:35], s72 offen offset:1024 sc1
    v_accvgpr_read_b32 v154, a102
    v_mfma_f32_16x16x32_bf16 a[8:11], a[208:211], v[240:243], a[8:11]
    s_waitcnt vmcnt(35)
    ds_read_b64_tr_b16 v[52:53], v1
    v_accvgpr_read_b32 v155, a103
    v_mul_f32 v88, v88, v68
    v_mfma_f32_16x16x32_bf16 a[8:11], a[212:215], v[244:247], a[8:11]
    buffer_store_dword v39, v27, s[60:63], s3 offen sc1
    ds_read_b64_tr_b16 v[54:55], v1 offset:1024
    v_mfma_f32_16x16x32_bf16 a[12:15], a[220:223], v[244:247], a[12:15]
    s_add_u32 s71, s71, s86
    ds_read_b64_tr_b16 v[84:85], v1 offset:8192
    v_mul_f32 v89, v89, v68
    v_mul_f32 v90, v90, v68
    v_mfma_f32_16x16x32_bf16 a[12:15], a[216:219], v[240:243], a[12:15]
    s_waitcnt lgkmcnt(3)
    ds_read_b64_tr_b16 v[86:87], v1 offset:9216
    buffer_load_dwordx4 a[172:175], v17, s[32:35], s73 offen offset:1024 sc1
    v_mfma_f32_16x16x32_bf16 a[16:19], a[224:227], v[240:243], a[16:19]
    s_add_u32 s71, s71, 14336
    ds_read_b64_tr_b16 v[116:117], v2
    v_mul_f32 v91, v91, v68
    v_mul_f32 v152, v152, v68
    v_mfma_f32_16x16x32_bf16 a[16:19], a[228:231], v[244:247], a[16:19]
    ds_read_b64_tr_b16 v[118:119], v2 offset:1024
    v_mul_f32 v153, v153, v68
    v_mul_f32 v154, v154, v68
    v_mfma_f32_16x16x32_bf16 a[20:23], a[236:239], v[244:247], a[20:23]
    ds_read_b64_tr_b16 v[148:149], v2 offset:8192
    v_mul_f32 v155, v155, v68
    v_cvt_pk_bf16_f32 v88, v88, v89
    v_mfma_f32_16x16x32_bf16 a[20:23], a[232:235], v[240:243], a[20:23]
    ds_read_b64_tr_b16 v[150:151], v2 offset:9216
    v_cvt_pk_bf16_f32 v89, v90, v91
    v_cvt_pk_bf16_f32 v90, v152, v153
    v_subrev_u32 v57, 0x2b800000, v56
    v_mfma_f32_16x16x32_bf16 a[24:27], a[240:243], v[240:243], a[24:27]
    ds_read_b64_tr_b16 v[160:161], v3
    v_cvt_pk_bf16_f32 v91, v154, v155
    v_accvgpr_read_b32 v92, a104
    v_cmp_le_u32 vcc, s93, v57
    v_mfma_f32_16x16x32_bf16 a[24:27], a[244:247], v[244:247], a[24:27]
    ds_read_b64_tr_b16 v[162:163], v3 offset:1024
    buffer_store_dwordx4 v[88:91], v17, s[32:35], s71 offen sc1
    v_mfma_f32_16x16x32_bf16 a[28:31], a[252:255], v[244:247], a[28:31]
    s_waitcnt vmcnt(34)
    ds_read_b64_tr_b16 v[164:165], v3 offset:8192
    v_accvgpr_read_b32 v93, a105
    v_accvgpr_read_b32 v94, a106
    v_mfma_f32_16x16x32_bf16 a[28:31], a[248:251], v[240:243], a[28:31]
    s_waitcnt lgkmcnt(7)
    ds_read_b64_tr_b16 v[166:167], v3 offset:9216
    v_accvgpr_read_b32 v95, a107
    v_accvgpr_read_b32 v156, a108
    s_cbranch_vccnz L_fb0
L_fb0_ret:
    v_mfma_f32_16x16x32_bf16 v[168:171], v[52:55], a[32:35], 0
    ds_read_b64_tr_b16 v[40:41], v4
    v_accvgpr_read_b32 v157, a109
    v_accvgpr_read_b32 v158, a110
    v_mfma_f32_16x16x32_bf16 v[168:171], v[84:87], a[40:43], v[168:171]
    ds_read_b64_tr_b16 v[42:43], v4 offset:1024
    v_accvgpr_read_b32 v159, a111
    v_mul_f32 v92, v92, v68
    v_mfma_f32_16x16x32_bf16 v[172:175], v[84:87], a[44:47], 0
    ds_read_b64_tr_b16 v[72:73], v4 offset:8192
    v_mul_f32 v93, v93, v68
    v_mul_f32 v94, v94, v68
    v_mfma_f32_16x16x32_bf16 v[172:175], v[52:55], a[36:39], v[172:175]
    s_waitcnt lgkmcnt(7)
    ds_read_b64_tr_b16 v[74:75], v4 offset:9216
    v_mul_f32 v95, v95, v68
    v_mul_f32 v156, v156, v68
    v_mfma_f32_16x16x32_bf16 v[176:179], v[116:119], a[32:35], 0
    ds_read_b64_tr_b16 v[104:105], v5
    v_mul_f32 v157, v157, v68
    v_mul_f32 v158, v158, v68
    v_mfma_f32_16x16x32_bf16 v[176:179], v[148:151], a[40:43], v[176:179]
    s_add_u32 s69, s87, 32768
    ds_read_b64_tr_b16 v[106:107], v5 offset:1024
    v_mul_f32 v159, v159, v68
    v_cvt_pk_bf16_f32 v92, v92, v93
    v_mfma_f32_16x16x32_bf16 v[180:183], v[148:151], a[44:47], 0
    s_sub_u32 s79, s69, 163840
    ds_read_b64_tr_b16 v[136:137], v5 offset:8192
    v_cvt_pk_bf16_f32 v93, v94, v95
    v_cvt_pk_bf16_f32 v94, v156, v157
    v_mfma_f32_16x16x32_bf16 v[180:183], v[116:119], a[36:39], v[180:183]
    s_waitcnt lgkmcnt(7)
    ds_read_b64_tr_b16 v[138:139], v5 offset:9216
    v_cvt_pk_bf16_f32 v95, v158, v159
    v_accvgpr_read_b32 v96, a112
    v_mfma_f32_16x16x32_bf16 v[184:187], v[160:163], a[32:35], 0
    ds_read_b64_tr_b16 v[52:53], v6
    buffer_store_dwordx4 v[92:95], v17, s[32:35], s71 offen offset:1024 sc1
    v_mfma_f32_16x16x32_bf16 v[184:187], v[164:167], a[40:43], v[184:187]
    s_min_u32 s69, s69, s79
    ds_read_b64_tr_b16 v[54:55], v6 offset:1024
    v_accvgpr_read_b32 v97, a113
    v_accvgpr_read_b32 v98, a114
    v_mfma_f32_16x16x32_bf16 v[188:191], v[164:167], a[44:47], 0
    s_sub_u32 s79, s69, s87
    ds_read_b64_tr_b16 v[84:85], v6 offset:8192
    v_accvgpr_read_b32 v99, a115
    v_accvgpr_read_b32 v152, a116
    v_mfma_f32_16x16x32_bf16 v[188:191], v[160:163], a[36:39], v[188:191]
    s_waitcnt lgkmcnt(7)
    ds_read_b64_tr_b16 v[86:87], v6 offset:9216
    v_accvgpr_read_b32 v153, a117
    v_accvgpr_read_b32 v154, a118
    v_mfma_f32_16x16x32_bf16 v[192:195], v[40:43], a[32:35], 0
    s_add_u32 s5, s66, 1
    ds_read_b64_tr_b16 v[116:117], v7
    v_accvgpr_read_b32 v155, a119
    v_mul_f32 v96, v96, v68
    v_mfma_f32_16x16x32_bf16 v[192:195], v[72:75], a[40:43], v[192:195]
    s_lshr_b32 s5, s5, 1
    ds_read_b64_tr_b16 v[118:119], v7 offset:1024
    v_mul_f32 v97, v97, v68
    v_mul_f32 v98, v98, v68
    v_mfma_f32_16x16x32_bf16 v[196:199], v[72:75], a[44:47], 0
    s_lshl_b32 s5, s5, 15
    ds_read_b64_tr_b16 v[148:149], v7 offset:8192
    v_mul_f32 v99, v99, v68
    v_mul_f32 v152, v152, v68
    v_mfma_f32_16x16x32_bf16 v[196:199], v[40:43], a[36:39], v[196:199]
    s_waitcnt lgkmcnt(7)
    ds_read_b64_tr_b16 v[150:151], v7 offset:9216
    v_mul_f32 v153, v153, v68
    v_mul_f32 v154, v154, v68
    v_mfma_f32_16x16x32_bf16 v[200:203], v[104:107], a[32:35], 0
    s_and_b32 s6, s66, 1
    ds_read_b64_tr_b16 v[160:161], v8
    v_mul_f32 v155, v155, v68
    v_cvt_pk_bf16_f32 v96, v96, v97
    v_mfma_f32_16x16x32_bf16 v[200:203], v[136:139], a[40:43], v[200:203]
    s_lshl_b32 s6, s6, 13
    ds_read_b64_tr_b16 v[162:163], v8 offset:1024
    v_cvt_pk_bf16_f32 v97, v98, v99
    v_cvt_pk_bf16_f32 v98, v152, v153
    v_mfma_f32_16x16x32_bf16 v[204:207], v[136:139], a[44:47], 0
    s_sub_u32 s5, s5, s6
    ds_read_b64_tr_b16 v[164:165], v8 offset:8192
    v_cvt_pk_bf16_f32 v99, v154, v155
    v_accvgpr_read_b32 v100, a120
    v_mfma_f32_16x16x32_bf16 v[204:207], v[104:107], a[36:39], v[204:207]
    s_waitcnt lgkmcnt(7)
    ds_read_b64_tr_b16 v[166:167], v8 offset:9216
    v_accvgpr_read_b32 v101, a121
    v_accvgpr_read_b32 v102, a122
    v_mfma_f32_16x16x32_bf16 v[208:211], v[52:55], a[32:35], 0
    ds_read_b64_tr_b16 v[40:41], v1 offset:16384
    buffer_store_dwordx4 v[96:99], v17, s[32:35], s71 offen offset:2048 sc1
    v_mfma_f32_16x16x32_bf16 v[208:211], v[84:87], a[40:43], v[208:211]
    s_mov_b32 s87, s69
    ds_read_b64_tr_b16 v[42:43], v1 offset:17408
    v_accvgpr_read_b32 v103, a123
    v_accvgpr_read_b32 v156, a124
    v_mfma_f32_16x16x32_bf16 v[212:215], v[84:87], a[44:47], 0
    ds_read_b64_tr_b16 v[72:73], v1 offset:24576
    v_accvgpr_read_b32 v157, a125
    v_accvgpr_read_b32 v158, a126
    v_mfma_f32_16x16x32_bf16 v[212:215], v[52:55], a[36:39], v[212:215]
    s_waitcnt lgkmcnt(7)
    ds_read_b64_tr_b16 v[74:75], v1 offset:25600
    v_add_u32 v1, s79, v1
    v_accvgpr_read_b32 v159, a127
    v_mfma_f32_16x16x32_bf16 v[216:219], v[116:119], a[32:35], 0
    ds_read_b64_tr_b16 v[104:105], v2 offset:16384
    v_mul_f32 v100, v100, v68
    v_mul_f32 v101, v101, v68
    v_mfma_f32_16x16x32_bf16 v[216:219], v[148:151], a[40:43], v[216:219]
    ds_read_b64_tr_b16 v[106:107], v2 offset:17408
    v_mul_f32 v102, v102, v68
    v_mul_f32 v103, v103, v68
    v_mfma_f32_16x16x32_bf16 v[220:223], v[148:151], a[44:47], 0
    ds_read_b64_tr_b16 v[136:137], v2 offset:24576
    v_mul_f32 v156, v156, v68
    v_mul_f32 v157, v157, v68
    v_mfma_f32_16x16x32_bf16 v[220:223], v[116:119], a[36:39], v[220:223]
    s_waitcnt lgkmcnt(7)
    ds_read_b64_tr_b16 v[138:139], v2 offset:25600
    v_add_u32 v2, s79, v2
    v_mul_f32 v158, v158, v68
    v_mfma_f32_16x16x32_bf16 v[224:227], v[160:163], a[32:35], 0
    ds_read_b64_tr_b16 v[52:53], v3 offset:16384
    v_mul_f32 v159, v159, v68
    v_cvt_pk_bf16_f32 v100, v100, v101
    v_mfma_f32_16x16x32_bf16 v[224:227], v[164:167], a[40:43], v[224:227]
    ds_read_b64_tr_b16 v[54:55], v3 offset:17408
    v_cvt_pk_bf16_f32 v101, v102, v103
    v_cvt_pk_bf16_f32 v102, v156, v157
    v_mfma_f32_16x16x32_bf16 v[228:231], v[164:167], a[44:47], 0
    s_waitcnt vmcnt(32)
    ds_read_b64_tr_b16 v[84:85], v3 offset:24576
    v_cvt_pk_bf16_f32 v103, v158, v159
    v_mfma_f32_16x16x32_bf16 v[228:231], v[160:163], a[36:39], v[228:231]
    s_waitcnt lgkmcnt(7)
    ds_read_b64_tr_b16 v[86:87], v3 offset:25600
    v_add_u32 v3, s79, v3
    v_mfma_f32_16x16x32_bf16 v[168:171], v[40:43], a[48:51], v[168:171]
    ds_read_b64_tr_b16 v[116:117], v4 offset:16384
    buffer_store_dwordx4 v[100:103], v17, s[32:35], s71 offen offset:3072 sc1
    v_mfma_f32_16x16x32_bf16 v[168:171], v[72:75], a[56:59], v[168:171]
    s_lshl_b32 s71, s68, 12
    ds_read_b64_tr_b16 v[118:119], v4 offset:17408
    v_rcp_f32 v56, v56
    v_mfma_f32_16x16x32_bf16 v[172:175], v[72:75], a[60:63], v[172:175]
    s_add_u32 s71, s71, s83
    ds_read_b64_tr_b16 v[148:149], v4 offset:24576
    v_mul_f32 v56, v56, v28
    v_accvgpr_read_b32 v120, a0
    v_mfma_f32_16x16x32_bf16 v[172:175], v[40:43], a[52:55], v[172:175]
    s_waitcnt lgkmcnt(7)
    ds_read_b64_tr_b16 v[150:151], v4 offset:25600
    v_add_u32 v4, s79, v4
    v_accvgpr_read_b32 v121, a1
    v_mfma_f32_16x16x32_bf16 v[176:179], v[104:107], a[48:51], v[176:179]
    s_add_u32 s71, s71, 14336
    ds_read_b64_tr_b16 v[160:161], v5 offset:16384
    v_accvgpr_read_b32 v122, a2
    v_accvgpr_read_b32 v123, a3
    v_mfma_f32_16x16x32_bf16 v[176:179], v[136:139], a[56:59], v[176:179]
    ds_read_b64_tr_b16 v[162:163], v5 offset:17408
    v_accvgpr_read_b32 v152, a4
    v_accvgpr_read_b32 v153, a5
    v_mfma_f32_16x16x32_bf16 v[180:183], v[136:139], a[60:63], v[180:183]
    ds_read_b64_tr_b16 v[164:165], v5 offset:24576
    v_accvgpr_read_b32 v154, a6
    v_accvgpr_read_b32 v155, a7
    v_mfma_f32_16x16x32_bf16 v[180:183], v[104:107], a[52:55], v[180:183]
    s_waitcnt lgkmcnt(7)
    ds_read_b64_tr_b16 v[166:167], v5 offset:25600
    v_add_u32 v5, s79, v5
    v_mul_f32 v120, v120, v56
    v_mfma_f32_16x16x32_bf16 v[184:187], v[52:55], a[48:51], v[184:187]
    ds_read_b64_tr_b16 v[40:41], v6 offset:16384
    v_mul_f32 v121, v121, v56
    v_mul_f32 v122, v122, v56
    v_mfma_f32_16x16x32_bf16 v[184:187], v[84:87], a[56:59], v[184:187]
    ds_read_b64_tr_b16 v[42:43], v6 offset:17408
    v_mul_f32 v123, v123, v56
    v_mul_f32 v152, v152, v56
    v_mfma_f32_16x16x32_bf16 v[188:191], v[84:87], a[60:63], v[188:191]
    ds_read_b64_tr_b16 v[72:73], v6 offset:24576
    v_mul_f32 v153, v153, v56
    v_mul_f32 v154, v154, v56
    v_mfma_f32_16x16x32_bf16 v[188:191], v[52:55], a[52:55], v[188:191]
    s_waitcnt lgkmcnt(7)
    ds_read_b64_tr_b16 v[74:75], v6 offset:25600
    v_add_u32 v6, s79, v6
    v_mul_f32 v155, v155, v56
    v_mfma_f32_16x16x32_bf16 v[192:195], v[116:119], a[48:51], v[192:195]
    ds_read_b64_tr_b16 v[104:105], v7 offset:16384
    v_cvt_pk_bf16_f32 v120, v120, v121
    v_cvt_pk_bf16_f32 v121, v122, v123
    v_mfma_f32_16x16x32_bf16 v[192:195], v[148:151], a[56:59], v[192:195]
    ds_read_b64_tr_b16 v[106:107], v7 offset:17408
    v_cvt_pk_bf16_f32 v122, v152, v153
    v_cvt_pk_bf16_f32 v123, v154, v155
    v_mfma_f32_16x16x32_bf16 v[196:199], v[148:151], a[60:63], v[196:199]
    ds_read_b64_tr_b16 v[136:137], v7 offset:24576
    buffer_store_dwordx4 v[120:123], v17, s[32:35], s71 offen sc1
    v_mfma_f32_16x16x32_bf16 v[196:199], v[116:119], a[52:55], v[196:199]
    s_waitcnt lgkmcnt(7)
    ds_read_b64_tr_b16 v[138:139], v7 offset:25600
    v_add_u32 v7, s79, v7
    v_accvgpr_read_b32 v124, a8
    v_mfma_f32_16x16x32_bf16 v[200:203], v[160:163], a[48:51], v[200:203]
    ds_read_b64_tr_b16 v[52:53], v8 offset:16384
    v_accvgpr_read_b32 v125, a9
    v_accvgpr_read_b32 v126, a10
    v_mfma_f32_16x16x32_bf16 v[200:203], v[164:167], a[56:59], v[200:203]
    ds_read_b64_tr_b16 v[54:55], v8 offset:17408
    v_accvgpr_read_b32 v127, a11
    v_accvgpr_read_b32 v156, a12
    v_mfma_f32_16x16x32_bf16 v[204:207], v[164:167], a[60:63], v[204:207]
    s_waitcnt vmcnt(30)
    ds_read_b64_tr_b16 v[84:85], v8 offset:24576
    v_accvgpr_read_b32 v157, a13
    v_accvgpr_read_b32 v158, a14
    v_mfma_f32_16x16x32_bf16 v[204:207], v[160:163], a[52:55], v[204:207]
    s_waitcnt lgkmcnt(7)
    ds_read_b64_tr_b16 v[86:87], v8 offset:25600
    v_add_u32 v8, s79, v8
    v_accvgpr_read_b32 v159, a15
    v_mfma_f32_16x16x32_bf16 v[208:211], v[40:43], a[48:51], v[208:211]
    s_barrier
    ds_read_b64_tr_b16 v[116:117], v1
    v_mul_f32 v124, v124, v56
    v_mul_f32 v125, v125, v56
    v_mfma_f32_16x16x32_bf16 v[208:211], v[72:75], a[56:59], v[208:211]
    ds_read_b64_tr_b16 v[118:119], v1 offset:1024
    v_mul_f32 v126, v126, v56
    v_mul_f32 v127, v127, v56
    v_mfma_f32_16x16x32_bf16 v[212:215], v[72:75], a[60:63], v[212:215]
    ds_read_b64_tr_b16 v[148:149], v1 offset:8192
    v_mul_f32 v156, v156, v56
    v_mul_f32 v157, v157, v56
    v_mfma_f32_16x16x32_bf16 v[212:215], v[40:43], a[52:55], v[212:215]
    s_waitcnt lgkmcnt(7)
    ds_read_b64_tr_b16 v[150:151], v1 offset:9216
    v_mul_f32 v158, v158, v56
    v_mul_f32 v159, v159, v56
    v_mfma_f32_16x16x32_bf16 v[216:219], v[104:107], a[48:51], v[216:219]
    ds_read_b64_tr_b16 v[160:161], v2
    v_cvt_pk_bf16_f32 v124, v124, v125
    v_cvt_pk_bf16_f32 v125, v126, v127
    v_mfma_f32_16x16x32_bf16 v[216:219], v[136:139], a[56:59], v[216:219]
    ds_read_b64_tr_b16 v[162:163], v2 offset:1024
    v_cvt_pk_bf16_f32 v126, v156, v157
    v_cvt_pk_bf16_f32 v127, v158, v159
    v_mfma_f32_16x16x32_bf16 v[220:223], v[136:139], a[60:63], v[220:223]
    ds_read_b64_tr_b16 v[164:165], v2 offset:8192
    buffer_store_dwordx4 v[124:127], v17, s[32:35], s71 offen offset:1024 sc1
    v_mfma_f32_16x16x32_bf16 v[220:223], v[104:107], a[52:55], v[220:223]
    s_waitcnt lgkmcnt(7)
    ds_read_b64_tr_b16 v[166:167], v2 offset:9216
    v_accvgpr_read_b32 v128, a16
    v_accvgpr_read_b32 v129, a17
    v_mfma_f32_16x16x32_bf16 v[224:227], v[52:55], a[48:51], v[224:227]
    ds_read_b64_tr_b16 v[40:41], v3
    v_accvgpr_read_b32 v130, a18
    v_accvgpr_read_b32 v131, a19
    v_mfma_f32_16x16x32_bf16 v[224:227], v[84:87], a[56:59], v[224:227]
    ds_read_b64_tr_b16 v[42:43], v3 offset:1024
    v_accvgpr_read_b32 v152, a20
    v_accvgpr_read_b32 v153, a21
    v_mfma_f32_16x16x32_bf16 v[228:231], v[84:87], a[60:63], v[228:231]
    ds_read_b64_tr_b16 v[72:73], v3 offset:8192
    v_accvgpr_read_b32 v154, a22
    v_accvgpr_read_b32 v155, a23
    v_mfma_f32_16x16x32_bf16 v[228:231], v[52:55], a[52:55], v[228:231]
    s_waitcnt lgkmcnt(7)
    ds_read_b64_tr_b16 v[74:75], v3 offset:9216
    v_mul_f32 v128, v128, v56
    v_mul_f32 v129, v129, v56
    v_mfma_f32_16x16x32_bf16 v[168:171], v[116:119], a[64:67], v[168:171]
    ds_read_b64_tr_b16 v[104:105], v4
    v_mul_f32 v130, v130, v56
    v_mul_f32 v131, v131, v56
    v_mfma_f32_16x16x32_bf16 v[168:171], v[148:151], a[72:75], v[168:171]
    ds_read_b64_tr_b16 v[106:107], v4 offset:1024
    v_mul_f32 v152, v152, v56
    v_mul_f32 v153, v153, v56
    v_mfma_f32_16x16x32_bf16 v[172:175], v[148:151], a[76:79], v[172:175]
    ds_read_b64_tr_b16 v[136:137], v4 offset:8192
    v_mul_f32 v154, v154, v56
    v_mul_f32 v155, v155, v56
    v_mfma_f32_16x16x32_bf16 v[172:175], v[116:119], a[68:71], v[172:175]
    s_waitcnt lgkmcnt(7)
    ds_read_b64_tr_b16 v[138:139], v4 offset:9216
    v_cvt_pk_bf16_f32 v128, v128, v129
    v_cvt_pk_bf16_f32 v129, v130, v131
    v_mfma_f32_16x16x32_bf16 v[176:179], v[160:163], a[64:67], v[176:179]
    ds_read_b64_tr_b16 v[52:53], v5
    v_cvt_pk_bf16_f32 v130, v152, v153
    v_cvt_pk_bf16_f32 v131, v154, v155
    v_mfma_f32_16x16x32_bf16 v[176:179], v[164:167], a[72:75], v[176:179]
    ds_read_b64_tr_b16 v[54:55], v5 offset:1024
    buffer_store_dwordx4 v[128:131], v17, s[32:35], s71 offen offset:2048 sc1
    v_mfma_f32_16x16x32_bf16 v[180:183], v[164:167], a[76:79], v[180:183]
    ds_read_b64_tr_b16 v[84:85], v5 offset:8192
    v_accvgpr_read_b32 v132, a24
    v_accvgpr_read_b32 v133, a25
    v_mfma_f32_16x16x32_bf16 v[180:183], v[160:163], a[68:71], v[180:183]
    s_waitcnt lgkmcnt(7)
    ds_read_b64_tr_b16 v[86:87], v5 offset:9216
    v_accvgpr_read_b32 v134, a26
    v_accvgpr_read_b32 v135, a27
    v_mfma_f32_16x16x32_bf16 v[184:187], v[40:43], a[64:67], v[184:187]
    ds_read_b64_tr_b16 v[116:117], v6
    v_accvgpr_read_b32 v156, a28
    v_accvgpr_read_b32 v157, a29
    v_mfma_f32_16x16x32_bf16 v[184:187], v[72:75], a[72:75], v[184:187]
    s_add_u32 s69, s87, 32768
    ds_read_b64_tr_b16 v[118:119], v6 offset:1024
    v_accvgpr_read_b32 v158, a30
    v_accvgpr_read_b32 v159, a31
    v_mfma_f32_16x16x32_bf16 v[188:191], v[72:75], a[76:79], v[188:191]
    s_sub_u32 s79, s69, 163840
    ds_read_b64_tr_b16 v[148:149], v6 offset:8192
    v_mul_f32 v132, v132, v56
    v_mul_f32 v133, v133, v56
    v_mfma_f32_16x16x32_bf16 v[188:191], v[40:43], a[68:71], v[188:191]
    s_waitcnt lgkmcnt(7)
    ds_read_b64_tr_b16 v[150:151], v6 offset:9216
    v_mul_f32 v134, v134, v56
    v_mul_f32 v135, v135, v56
    v_mfma_f32_16x16x32_bf16 v[192:195], v[104:107], a[64:67], v[192:195]
    s_min_u32 s69, s69, s79
    ds_read_b64_tr_b16 v[160:161], v7
    v_mul_f32 v156, v156, v56
    v_mul_f32 v157, v157, v56
    v_mfma_f32_16x16x32_bf16 v[192:195], v[136:139], a[72:75], v[192:195]
    s_sub_u32 m0, s88, s76
    ds_read_b64_tr_b16 v[162:163], v7 offset:1024
    v_mul_f32 v158, v158, v56
    v_mul_f32 v159, v159, v56
    v_mfma_f32_16x16x32_bf16 v[196:199], v[136:139], a[76:79], v[196:199]
    s_sub_u32 s89, s89, s5
    ds_read_b64_tr_b16 v[164:165], v7 offset:8192
    v_cvt_pk_bf16_f32 v132, v132, v133
    v_cvt_pk_bf16_f32 v133, v134, v135
    v_mfma_f32_16x16x32_bf16 v[196:199], v[104:107], a[68:71], v[196:199]
    s_waitcnt lgkmcnt(7)
    ds_read_b64_tr_b16 v[166:167], v7 offset:9216
    v_cvt_pk_bf16_f32 v134, v156, v157
    v_cvt_pk_bf16_f32 v135, v158, v159
    v_mfma_f32_16x16x32_bf16 v[200:203], v[52:55], a[64:67], v[200:203]
    ds_read_b64_tr_b16 v[40:41], v8
    buffer_store_dwordx4 v[132:135], v17, s[32:35], s71 offen offset:3072 sc1
    v_mfma_f32_16x16x32_bf16 v[200:203], v[84:87], a[72:75], v[200:203]
    ds_read_b64_tr_b16 v[42:43], v8 offset:1024
    buffer_load_dwordx4 v18, s[40:43], s89 offen lds
    v_mfma_f32_16x16x32_bf16 v[204:207], v[84:87], a[76:79], v[204:207]
    s_sub_u32 s79, s69, s87
    ds_read_b64_tr_b16 v[72:73], v8 offset:8192
    v_mfma_f32_16x16x32_bf16 v[204:207], v[52:55], a[68:71], v[204:207]
    s_waitcnt lgkmcnt(7)
    ds_read_b64_tr_b16 v[74:75], v8 offset:9216
    v_mfma_f32_16x16x32_bf16 v[208:211], v[116:119], a[64:67], v[208:211]
    ds_read_b64_tr_b16 v[104:105], v1 offset:16384
    buffer_load_dwordx4 v19, s[40:43], s89 offen offset:1024 lds
    v_mfma_f32_16x16x32_bf16 v[208:211], v[148:151], a[72:75], v[208:211]
    s_mov_b32 s87, s69
    ds_read_b64_tr_b16 v[106:107], v1 offset:17408
    v_mfma_f32_16x16x32_bf16 v[212:215], v[148:151], a[76:79], v[212:215]
    ds_read_b64_tr_b16 v[136:137], v1 offset:24576
    buffer_load_dwordx4 v20, s[40:43], s89 offen offset:2048 lds
    v_mfma_f32_16x16x32_bf16 v[212:215], v[116:119], a[68:71], v[212:215]
    s_waitcnt lgkmcnt(7)
    ds_read_b64_tr_b16 v[138:139], v1 offset:25600
    v_add_u32 v1, s79, v1
    v_mfma_f32_16x16x32_bf16 v[216:219], v[160:163], a[64:67], v[216:219]
    s_bitcmp0_b32 s68, 2
    s_cselect_b64 s[26:27], -1, 0
    ds_read_b64_tr_b16 v[52:53], v2 offset:16384
    v_mfma_f32_16x16x32_bf16 v[216:219], v[164:167], a[72:75], v[216:219]
    ds_read_b64_tr_b16 v[54:55], v2 offset:17408
    buffer_load_dwordx4 v21, s[40:43], s89 offen offset:3072 lds
    v_mfma_f32_16x16x32_bf16 v[220:223], v[164:167], a[76:79], v[220:223]
    s_add_u32 s88, s88, 32768
    ds_read_b64_tr_b16 v[84:85], v2 offset:24576
    v_cndmask_b32 v34, v29, v31, s[26:27]
    v_mfma_f32_16x16x32_bf16 v[220:223], v[160:163], a[68:71], v[220:223]
    s_waitcnt lgkmcnt(7)
    ds_read_b64_tr_b16 v[86:87], v2 offset:25600
    v_add_u32 v2, s79, v2
    v_mfma_f32_16x16x32_bf16 v[224:227], v[40:43], a[64:67], v[224:227]
    s_sub_u32 s92, s88, 163840
    ds_read_b64_tr_b16 v[116:117], v3 offset:16384
    v_cndmask_b32 v35, v30, v28, s[26:27]
    v_mfma_f32_16x16x32_bf16 v[224:227], v[72:75], a[72:75], v[224:227]
    s_min_u32 s88, s88, s92
    ds_read_b64_tr_b16 v[118:119], v3 offset:17408
    v_sub_f32 v34, 1.0, v34
    v_mfma_f32_16x16x32_bf16 v[228:231], v[72:75], a[76:79], v[228:231]
    s_waitcnt vmcnt(33)
    s_xor_b32 s89, s68, 0
    ds_read_b64_tr_b16 v[148:149], v3 offset:24576
    v_mfma_f32_16x16x32_bf16 v[228:231], v[40:43], a[68:71], v[228:231]
    s_waitcnt lgkmcnt(7)
    s_lshl_b32 s89, s89, 17
    ds_read_b64_tr_b16 v[150:151], v3 offset:25600
    v_add_u32 v3, s79, v3
    v_mfma_f32_16x16x32_bf16 v[168:171], v[104:107], a[80:83], v[168:171]
    s_add_u32 s90, s89, 8192
    s_mov_b32 m0, s88
    ds_read_b64_tr_b16 v[160:161], v4 offset:16384
    v_mfma_f32_16x16x32_bf16 v[168:171], v[136:139], a[88:91], v[168:171]
L_hop12:
    s_cbranch_execz L_hop_ret1
    ds_read_b64_tr_b16 v[162:163], v4 offset:17408
    buffer_load_dwordx4 v18, s[44:47], s89 offen lds
    v_mfma_f32_16x16x32_bf16 v[172:175], v[136:139], a[92:95], v[172:175]
    ds_read_b64_tr_b16 v[164:165], v4 offset:24576
    v_sub_f32 v35, 1.0, v35
    v_mfma_f32_16x16x32_bf16 v[172:175], v[104:107], a[84:87], v[172:175]
    s_waitcnt lgkmcnt(7)
    ds_read_b64_tr_b16 v[166:167], v4 offset:25600
    v_add_u32 v4, s79, v4
    v_mfma_f32_16x16x32_bf16 v[176:179], v[52:55], a[80:83], v[176:179]
    ds_read_b64_tr_b16 v[40:41], v5 offset:16384
    buffer_load_dwordx4 v19, s[44:47], s89 offen offset:1024 lds
    v_mfma_f32_16x16x32_bf16 v[176:179], v[84:87], a[88:91], v[176:179]
    ds_read_b64_tr_b16 v[42:43], v5 offset:17408
    v_cndmask_b32 v88, v44, v88, s[26:27]
    v_mfma_f32_16x16x32_bf16 v[180:183], v[84:87], a[92:95], v[180:183]
    ds_read_b64_tr_b16 v[72:73], v5 offset:24576
    buffer_load_dwordx4 v20, s[44:47], s89 offen offset:2048 lds
    v_mfma_f32_16x16x32_bf16 v[180:183], v[52:55], a[84:87], v[180:183]
    s_waitcnt lgkmcnt(7)
    ds_read_b64_tr_b16 v[74:75], v5 offset:25600
    v_add_u32 v5, s79, v5
    v_mfma_f32_16x16x32_bf16 v[184:187], v[116:119], a[80:83], v[184:187]
    ds_read_b64_tr_b16 v[104:105], v6 offset:16384
    buffer_load_dwordx4 v21, s[44:47], s89 offen offset:3072 lds
    v_mfma_f32_16x16x32_bf16 v[184:187], v[148:151], a[88:91], v[184:187]
    ds_read_b64_tr_b16 v[106:107], v6 offset:17408
    v_cndmask_b32 v89, v45, v89, s[26:27]
    v_mfma_f32_16x16x32_bf16 v[188:191], v[148:151], a[92:95], v[188:191]
    s_add_u32 m0, s88, 4096
    ds_read_b64_tr_b16 v[136:137], v6 offset:24576
    v_cndmask_b32 v90, v46, v90, s[26:27]
    v_mfma_f32_16x16x32_bf16 v[188:191], v[116:119], a[84:87], v[188:191]
    s_waitcnt lgkmcnt(7)
    ds_read_b64_tr_b16 v[138:139], v6 offset:25600
    v_add_u32 v6, s79, v6
    v_mfma_f32_16x16x32_bf16 v[192:195], v[160:163], a[80:83], v[192:195]
    ds_read_b64_tr_b16 v[52:53], v7 offset:16384
    buffer_load_dwordx4 v18, s[44:47], s90 offen lds
    v_mfma_f32_16x16x32_bf16 v[192:195], v[164:167], a[88:91], v[192:195]
    ds_read_b64_tr_b16 v[54:55], v7 offset:17408
    v_cndmask_b32 v91, v47, v91, s[26:27]
    v_mfma_f32_16x16x32_bf16 v[196:199], v[164:167], a[92:95], v[196:199]
    ds_read_b64_tr_b16 v[84:85], v7 offset:24576
    v_cndmask_b32 v92, v76, v92, s[26:27]
    v_mfma_f32_16x16x32_bf16 v[196:199], v[160:163], a[84:87], v[196:199]
    s_waitcnt lgkmcnt(7)
    ds_read_b64_tr_b16 v[86:87], v7 offset:25600
    v_add_u32 v7, s79, v7
    v_mfma_f32_16x16x32_bf16 v[200:203], v[40:43], a[80:83], v[200:203]
    ds_read_b64_tr_b16 v[116:117], v8 offset:16384
    buffer_load_dwordx4 v19, s[44:47], s90 offen offset:1024 lds
    v_mfma_f32_16x16x32_bf16 v[200:203], v[72:75], a[88:91], v[200:203]
    ds_read_b64_tr_b16 v[118:119], v8 offset:17408
    v_cndmask_b32 v93, v77, v93, s[26:27]
    v_mfma_f32_16x16x32_bf16 v[204:207], v[72:75], a[92:95], v[204:207]
    s_waitcnt vmcnt(26)
    ds_read_b64_tr_b16 v[148:149], v8 offset:24576
    v_cndmask_b32 v94, v78, v94, s[26:27]
    v_mfma_f32_16x16x32_bf16 v[204:207], v[40:43], a[84:87], v[204:207]
    s_waitcnt lgkmcnt(7)
    ds_read_b64_tr_b16 v[150:151], v8 offset:25600
    v_add_u32 v8, s79, v8
    v_mfma_f32_16x16x32_bf16 v[208:211], v[104:107], a[80:83], v[208:211]
    s_barrier
    ds_read_b64_tr_b16 v[160:161], v1
    v_cndmask_b32 v95, v79, v95, s[26:27]
    v_mfma_f32_16x16x32_bf16 v[208:211], v[136:139], a[88:91], v[208:211]
    ds_read_b64_tr_b16 v[162:163], v1 offset:1024
    buffer_load_dwordx4 v20, s[44:47], s90 offen offset:2048 lds
    v_mfma_f32_16x16x32_bf16 v[212:215], v[136:139], a[92:95], v[212:215]
    ds_read_b64_tr_b16 v[164:165], v1 offset:8192
    v_cndmask_b32 v96, v108, v96, s[26:27]
    v_mfma_f32_16x16x32_bf16 v[212:215], v[104:107], a[84:87], v[212:215]
    s_waitcnt lgkmcnt(7)
    ds_read_b64_tr_b16 v[166:167], v1 offset:9216
    v_cndmask_b32 v97, v109, v97, s[26:27]
    v_mfma_f32_16x16x32_bf16 v[216:219], v[52:55], a[80:83], v[216:219]
    ds_read_b64_tr_b16 v[40:41], v2
    buffer_load_dwordx4 v21, s[44:47], s90 offen offset:3072 lds
    v_mfma_f32_16x16x32_bf16 v[216:219], v[84:87], a[88:91], v[216:219]
    s_add_u32 s88, s88, 32768
    ds_read_b64_tr_b16 v[42:43], v2 offset:1024
    v_cndmask_b32 v98, v110, v98, s[26:27]
    v_mfma_f32_16x16x32_bf16 v[220:223], v[84:87], a[92:95], v[220:223]
    s_sub_u32 s92, s88, 163840
    s_min_u32 s88, s88, s92
    ds_read_b64_tr_b16 v[72:73], v2 offset:8192
    v_mfma_f32_16x16x32_bf16 v[220:223], v[52:55], a[84:87], v[220:223]
    s_waitcnt lgkmcnt(7)
    s_xor_b32 s89, s68, 1
    ds_read_b64_tr_b16 v[74:75], v2 offset:9216
    v_mfma_f32_16x16x32_bf16 v[224:227], v[116:119], a[80:83], v[224:227]
    s_waitcnt vmcnt(12)
    s_lshl_b32 s89, s89, 17
    ds_read_b64_tr_b16 v[104:105], v3
    v_mfma_f32_16x16x32_bf16 v[224:227], v[148:151], a[88:91], v[224:227]
    ds_read_b64_tr_b16 v[106:107], v3 offset:1024
    buffer_store_dword v39, v27, s[60:63], s0 offen sc1
    v_mfma_f32_16x16x32_bf16 v[228:231], v[148:151], a[92:95], v[228:231]
    s_add_u32 s90, s89, 8192
    ds_read_b64_tr_b16 v[136:137], v3 offset:8192
    v_mfma_f32_16x16x32_bf16 v[228:231], v[116:119], a[84:87], v[228:231]
    s_waitcnt lgkmcnt(7)
    s_mov_b32 m0, s88
    ds_read_b64_tr_b16 v[138:139], v3 offset:9216
    v_mfma_f32_16x16x32_bf16 v[168:171], v[160:163], a[128:131], v[168:171]
    ds_read_b64_tr_b16 v[52:53], v4
    buffer_load_dwordx4 v18, s[44:47], s89 offen lds
    v_mfma_f32_16x16x32_bf16 v[168:171], v[164:167], a[136:139], v[168:171]
    ds_read_b64_tr_b16 v[54:55], v4 offset:1024
    v_cndmask_b32 v99, v111, v99, s[26:27]
    v_mfma_f32_16x16x32_bf16 v[172:175], v[164:167], a[140:143], v[172:175]
    ds_read_b64_tr_b16 v[84:85], v4 offset:8192
    buffer_load_dwordx4 v19, s[44:47], s89 offen offset:1024 lds
    v_mfma_f32_16x16x32_bf16 v[172:175], v[160:163], a[132:135], v[172:175]
    s_waitcnt lgkmcnt(7)
    ds_read_b64_tr_b16 v[86:87], v4 offset:9216
    v_cndmask_b32 v100, v140, v100, s[26:27]
    v_mfma_f32_16x16x32_bf16 v[176:179], v[40:43], a[128:131], v[176:179]
    ds_read_b64_tr_b16 v[116:117], v5
    buffer_load_dwordx4 v20, s[44:47], s89 offen offset:2048 lds
    v_mfma_f32_16x16x32_bf16 v[176:179], v[72:75], a[136:139], v[176:179]
    ds_read_b64_tr_b16 v[118:119], v5 offset:1024
    v_cndmask_b32 v101, v141, v101, s[26:27]
    v_mfma_f32_16x16x32_bf16 v[180:183], v[72:75], a[140:143], v[180:183]
    ds_read_b64_tr_b16 v[148:149], v5 offset:8192
    v_cndmask_b32 v102, v142, v102, s[26:27]
    v_mfma_f32_16x16x32_bf16 v[180:183], v[40:43], a[132:135], v[180:183]
    s_waitcnt lgkmcnt(7)
    ds_read_b64_tr_b16 v[150:151], v5 offset:9216
    v_cndmask_b32 v103, v143, v103, s[26:27]
    v_mfma_f32_16x16x32_bf16 v[184:187], v[104:107], a[128:131], v[184:187]
    ds_read_b64_tr_b16 v[160:161], v6
    buffer_load_dwordx4 v21, s[44:47], s89 offen offset:3072 lds
    v_mfma_f32_16x16x32_bf16 v[184:187], v[136:139], a[136:139], v[184:187]
    s_add_u32 m0, s88, 4096
    ds_read_b64_tr_b16 v[162:163], v6 offset:1024
    v_cndmask_b32 v120, v48, v120, s[26:27]
    v_mfma_f32_16x16x32_bf16 v[188:191], v[136:139], a[140:143], v[188:191]
    ds_read_b64_tr_b16 v[164:165], v6 offset:8192
    buffer_load_dwordx4 v18, s[44:47], s90 offen lds
    v_mfma_f32_16x16x32_bf16 v[188:191], v[104:107], a[132:135], v[188:191]
    s_waitcnt lgkmcnt(7)
    ds_read_b64_tr_b16 v[166:167], v6 offset:9216
    v_cndmask_b32 v121, v49, v121, s[26:27]
    v_mfma_f32_16x16x32_bf16 v[192:195], v[52:55], a[128:131], v[192:195]
    ds_read_b64_tr_b16 v[40:41], v7
    v_cndmask_b32 v122, v50, v122, s[26:27]
    v_mfma_f32_16x16x32_bf16 v[192:195], v[84:87], a[136:139], v[192:195]
    s_add_u32 s69, s87, 32768
    ds_read_b64_tr_b16 v[42:43], v7 offset:1024
    v_cndmask_b32 v123, v51, v123, s[26:27]
    v_mfma_f32_16x16x32_bf16 v[196:199], v[84:87], a[140:143], v[196:199]
    ds_read_b64_tr_b16 v[72:73], v7 offset:8192
    buffer_load_dwordx4 v19, s[44:47], s90 offen offset:1024 lds
    v_mfma_f32_16x16x32_bf16 v[196:199], v[52:55], a[132:135], v[196:199]
    s_waitcnt lgkmcnt(7)
    ds_read_b64_tr_b16 v[74:75], v7 offset:9216
    v_cndmask_b32 v124, v80, v124, s[26:27]
    v_mfma_f32_16x16x32_bf16 v[200:203], v[116:119], a[128:131], v[200:203]
    s_sub_u32 s79, s69, 163840
    ds_read_b64_tr_b16 v[104:105], v8
    v_cndmask_b32 v125, v81, v125, s[26:27]
    v_mfma_f32_16x16x32_bf16 v[200:203], v[148:151], a[136:139], v[200:203]
    s_min_u32 s69, s69, s79
    ds_read_b64_tr_b16 v[106:107], v8 offset:1024
    v_cndmask_b32 v126, v82, v126, s[26:27]
    v_mfma_f32_16x16x32_bf16 v[204:207], v[148:151], a[140:143], v[204:207]
    ds_read_b64_tr_b16 v[136:137], v8 offset:8192
    buffer_load_dwordx4 v20, s[44:47], s90 offen offset:2048 lds
    v_mfma_f32_16x16x32_bf16 v[204:207], v[116:119], a[132:135], v[204:207]
    s_waitcnt lgkmcnt(7)
    ds_read_b64_tr_b16 v[138:139], v8 offset:9216
    v_cndmask_b32 v127, v83, v127, s[26:27]
    v_mfma_f32_16x16x32_bf16 v[208:211], v[160:163], a[128:131], v[208:211]
    s_sub_u32 s79, s69, s87
    ds_read_b64_tr_b16 v[52:53], v1 offset:16384
    v_cndmask_b32 v128, v112, v128, s[26:27]
    v_mfma_f32_16x16x32_bf16 v[208:211], v[164:167], a[136:139], v[208:211]
    s_mov_b32 s87, s69
    ds_read_b64_tr_b16 v[54:55], v1 offset:17408
    v_cndmask_b32 v129, v113, v129, s[26:27]
    v_mfma_f32_16x16x32_bf16 v[212:215], v[164:167], a[140:143], v[212:215]
    ds_read_b64_tr_b16 v[84:85], v1 offset:24576
    buffer_load_dwordx4 v21, s[44:47], s90 offen offset:3072 lds
    v_mfma_f32_16x16x32_bf16 v[212:215], v[160:163], a[132:135], v[212:215]
    s_waitcnt lgkmcnt(7)
    ds_read_b64_tr_b16 v[86:87], v1 offset:25600
    v_add_u32 v1, s79, v1
    v_mfma_f32_16x16x32_bf16 v[216:219], v[40:43], a[128:131], v[216:219]
    ds_read_b64_tr_b16 v[116:117], v2 offset:16384
    v_cndmask_b32 v130, v114, v130, s[26:27]
    v_mfma_f32_16x16x32_bf16 v[216:219], v[72:75], a[136:139], v[216:219]
    ds_read_b64_tr_b16 v[118:119], v2 offset:17408
    v_cndmask_b32 v131, v115, v131, s[26:27]
    v_mfma_f32_16x16x32_bf16 v[220:223], v[72:75], a[140:143], v[220:223]
    ds_read_b64_tr_b16 v[148:149], v2 offset:24576
    v_cndmask_b32 v132, v144, v132, s[26:27]
    v_mfma_f32_16x16x32_bf16 v[220:223], v[40:43], a[132:135], v[220:223]
    s_waitcnt lgkmcnt(7)
    ds_read_b64_tr_b16 v[150:151], v2 offset:25600
    v_add_u32 v2, s79, v2
    v_mfma_f32_16x16x32_bf16 v[224:227], v[104:107], a[128:131], v[224:227]
    ds_read_b64_tr_b16 v[160:161], v3 offset:16384
    v_cndmask_b32 v133, v145, v133, s[26:27]
    v_mfma_f32_16x16x32_bf16 v[224:227], v[136:139], a[136:139], v[224:227]
    ds_read_b64_tr_b16 v[162:163], v3 offset:17408
    v_cndmask_b32 v134, v146, v134, s[26:27]
    v_mfma_f32_16x16x32_bf16 v[228:231], v[136:139], a[140:143], v[228:231]
    ds_read_b64_tr_b16 v[164:165], v3 offset:24576
    v_cndmask_b32 v135, v147, v135, s[26:27]
    v_mfma_f32_16x16x32_bf16 v[228:231], v[104:107], a[132:135], v[228:231]
    s_waitcnt lgkmcnt(7)
    ds_read_b64_tr_b16 v[166:167], v3 offset:25600
    v_add_u32 v3, s79, v3
    v_mfma_f32_16x16x32_bf16 v[168:171], v[52:55], a[144:147], v[168:171]
    ds_read_b64_tr_b16 v[40:41], v4 offset:16384
    v_mfma_f32_16x16x32_bf16 v[168:171], v[84:87], a[152:155], v[168:171]
    s_add_u32 s69, s87, 32768
    ds_read_b64_tr_b16 v[42:43], v4 offset:17408
    v_mfma_f32_16x16x32_bf16 v[172:175], v[84:87], a[156:159], v[172:175]
    s_sub_u32 s81, s69, 163840
    ds_read_b64_tr_b16 v[72:73], v4 offset:24576
    v_mfma_f32_16x16x32_bf16 v[172:175], v[52:55], a[148:151], v[172:175]
    s_waitcnt lgkmcnt(7)
    ds_read_b64_tr_b16 v[74:75], v4 offset:25600
    v_add_u32 v4, s79, v4
    v_mfma_f32_16x16x32_bf16 v[176:179], v[116:119], a[144:147], v[176:179]
    s_min_u32 s69, s69, s81
    ds_read_b64_tr_b16 v[104:105], v5 offset:16384
    v_mfma_f32_16x16x32_bf16 v[176:179], v[148:151], a[152:155], v[176:179]
    s_sub_u32 s81, s69, s87
    ds_read_b64_tr_b16 v[106:107], v5 offset:17408
    v_mfma_f32_16x16x32_bf16 v[180:183], v[148:151], a[156:159], v[180:183]
    s_mov_b32 s87, s69
    ds_read_b64_tr_b16 v[136:137], v5 offset:24576
    v_mfma_f32_16x16x32_bf16 v[180:183], v[116:119], a[148:151], v[180:183]
    s_waitcnt lgkmcnt(7)
    ds_read_b64_tr_b16 v[138:139], v5 offset:25600
    v_add_u32 v5, s79, v5
    v_mfma_f32_16x16x32_bf16 v[184:187], v[160:163], a[144:147], v[184:187]
    s_add_u32 s88, s88, 32768
    ds_read_b64_tr_b16 v[52:53], v6 offset:16384
    v_mfma_f32_16x16x32_bf16 v[184:187], v[164:167], a[152:155], v[184:187]
    s_sub_u32 s92, s88, 163840
    ds_read_b64_tr_b16 v[54:55], v6 offset:17408
    v_mfma_f32_16x16x32_bf16 v[188:191], v[164:167], a[156:159], v[188:191]
    s_min_u32 s88, s88, s92
    ds_read_b64_tr_b16 v[84:85], v6 offset:24576
    v_mfma_f32_16x16x32_bf16 v[188:191], v[160:163], a[148:151], v[188:191]
    s_waitcnt lgkmcnt(7)
    ds_read_b64_tr_b16 v[86:87], v6 offset:25600
    v_add_u32 v6, s79, v6
    v_mfma_f32_16x16x32_bf16 v[192:195], v[40:43], a[144:147], v[192:195]
    ds_read_b64_tr_b16 v[116:117], v7 offset:16384
    buffer_load_dword v38, v36, s[60:63], s78 offen sc1
    v_mfma_f32_16x16x32_bf16 v[192:195], v[72:75], a[152:155], v[192:195]
    s_xor_b32 s89, s68, 2
    ds_read_b64_tr_b16 v[118:119], v7 offset:17408
    v_mfma_f32_16x16x32_bf16 v[196:199], v[72:75], a[156:159], v[196:199]
    s_lshl_b32 s89, s89, 17
    ds_read_b64_tr_b16 v[148:149], v7 offset:24576
    v_mfma_f32_16x16x32_bf16 v[196:199], v[40:43], a[148:151], v[196:199]
    s_waitcnt lgkmcnt(7)
    ds_read_b64_tr_b16 v[150:151], v7 offset:25600
    v_add_u32 v7, s79, v7
    v_mfma_f32_16x16x32_bf16 v[200:203], v[104:107], a[144:147], v[200:203]
    s_add_u32 s90, s89, 8192
    ds_read_b64_tr_b16 v[160:161], v8 offset:16384
    v_mfma_f32_16x16x32_bf16 v[200:203], v[136:139], a[152:155], v[200:203]
    s_mov_b32 m0, s88
    ds_read_b64_tr_b16 v[162:163], v8 offset:17408
    v_mfma_f32_16x16x32_bf16 v[204:207], v[136:139], a[156:159], v[204:207]
    s_waitcnt vmcnt(18)
    ds_read_b64_tr_b16 v[164:165], v8 offset:24576
    v_mfma_f32_16x16x32_bf16 v[204:207], v[104:107], a[148:151], v[204:207]
    s_waitcnt lgkmcnt(7)
    ds_read_b64_tr_b16 v[166:167], v8 offset:25600
    v_add_u32 v8, s79, v8
    v_mfma_f32_16x16x32_bf16 v[208:211], v[52:55], a[144:147], v[208:211]
    s_barrier
    ds_read_b64_tr_b16 v[40:41], v1
    v_mfma_f32_16x16x32_bf16 v[208:211], v[84:87], a[152:155], v[208:211]
    ds_read_b64_tr_b16 v[42:43], v1 offset:1024
    buffer_load_dwordx4 v18, s[44:47], s89 offen lds
    v_mfma_f32_16x16x32_bf16 v[212:215], v[84:87], a[156:159], v[212:215]
    ds_read_b64_tr_b16 v[72:73], v1 offset:8192
    v_mfma_f32_16x16x32_bf16 v[212:215], v[52:55], a[148:151], v[212:215]
    s_waitcnt lgkmcnt(7)
    ds_read_b64_tr_b16 v[74:75], v1 offset:9216
    v_add_u32 v1, s81, v1
    v_mfma_f32_16x16x32_bf16 v[216:219], v[116:119], a[144:147], v[216:219]
    ds_read_b64_tr_b16 v[104:105], v2
    buffer_load_dwordx4 v19, s[44:47], s89 offen offset:1024 lds
    v_mfma_f32_16x16x32_bf16 v[216:219], v[148:151], a[152:155], v[216:219]
    ds_read_b64_tr_b16 v[106:107], v2 offset:1024
    v_mfma_f32_16x16x32_bf16 v[220:223], v[148:151], a[156:159], v[220:223]
    ds_read_b64_tr_b16 v[136:137], v2 offset:8192
    v_mfma_f32_16x16x32_bf16 v[220:223], v[116:119], a[148:151], v[220:223]
    s_waitcnt lgkmcnt(7)
    ds_read_b64_tr_b16 v[138:139], v2 offset:9216
    v_add_u32 v2, s81, v2
    v_mfma_f32_16x16x32_bf16 v[224:227], v[160:163], a[144:147], v[224:227]
    ds_read_b64_tr_b16 v[52:53], v3
    buffer_load_dwordx4 v20, s[44:47], s89 offen offset:2048 lds
    v_mfma_f32_16x16x32_bf16 v[224:227], v[164:167], a[152:155], v[224:227]
    ds_read_b64_tr_b16 v[54:55], v3 offset:1024
    v_mfma_f32_16x16x32_bf16 v[228:231], v[164:167], a[156:159], v[228:231]
    ds_read_b64_tr_b16 v[84:85], v3 offset:8192
    v_mfma_f32_16x16x32_bf16 v[228:231], v[160:163], a[148:151], v[228:231]
    s_waitcnt lgkmcnt(7)
    ds_read_b64_tr_b16 v[86:87], v3 offset:9216
    v_add_u32 v3, s81, v3
    v_mfma_f32_16x16x32_bf16 v[168:171], v[40:43], a[160:163], v[168:171]
    ds_read_b64_tr_b16 v[116:117], v4
    buffer_load_dwordx4 v21, s[44:47], s89 offen offset:3072 lds
    v_mfma_f32_16x16x32_bf16 v[168:171], v[72:75], a[168:171], v[168:171]
    ds_read_b64_tr_b16 v[118:119], v4 offset:1024
    v_mfma_f32_16x16x32_bf16 v[172:175], v[72:75], a[172:175], v[172:175]
    s_add_u32 m0, s88, 4096
    ds_read_b64_tr_b16 v[148:149], v4 offset:8192
    v_mfma_f32_16x16x32_bf16 v[172:175], v[40:43], a[164:167], v[172:175]
    s_waitcnt lgkmcnt(7)
    ds_read_b64_tr_b16 v[150:151], v4 offset:9216
    v_add_u32 v4, s81, v4
    v_mfma_f32_16x16x32_bf16 v[176:179], v[104:107], a[160:163], v[176:179]
    ds_read_b64_tr_b16 v[160:161], v5
    buffer_load_dwordx4 v18, s[44:47], s90 offen lds
    v_mfma_f32_16x16x32_bf16 v[176:179], v[136:139], a[168:171], v[176:179]
    ds_read_b64_tr_b16 v[162:163], v5 offset:1024
    v_mul_f32 v168, v168, v34
    v_mfma_f32_16x16x32_bf16 v[180:183], v[136:139], a[172:175], v[180:183]
    ds_read_b64_tr_b16 v[164:165], v5 offset:8192
    v_mul_f32 v169, v169, v34
    v_mfma_f32_16x16x32_bf16 v[180:183], v[104:107], a[164:167], v[180:183]
    s_waitcnt lgkmcnt(7)
    ds_read_b64_tr_b16 v[166:167], v5 offset:9216
    v_add_u32 v5, s81, v5
    v_mfma_f32_16x16x32_bf16 v[184:187], v[52:55], a[160:163], v[184:187]
    s_waitcnt vmcnt(5)
    ds_read_b64_tr_b16 v[40:41], v6
    v_cmp_eq_u32 vcc, 0, v38
    v_mfma_f32_16x16x32_bf16 v[184:187], v[84:87], a[168:171], v[184:187]
    ds_read_b64_tr_b16 v[42:43], v6 offset:1024
    buffer_load_dwordx4 v19, s[44:47], s90 offen offset:1024 lds
    v_mfma_f32_16x16x32_bf16 v[188:191], v[84:87], a[172:175], v[188:191]
    s_xor_b32 s6, s68, 1
    ds_read_b64_tr_b16 v[72:73], v6 offset:8192
    s_cbranch_vccz L_spin_ctx_ret
L_spin_ctx:
    s_sleep 1
    buffer_load_dword v38, v36, s[60:63], s78 offen sc1
    s_waitcnt vmcnt(0)
    v_cmp_eq_u32 vcc, 0, v38
    s_nop 4
    s_cbranch_vccnz L_spin_ctx
L_spin_ctx_ret:
    v_mfma_f32_16x16x32_bf16 v[188:191], v[52:55], a[164:167], v[188:191]
    s_waitcnt lgkmcnt(7)
    ds_read_b64_tr_b16 v[74:75], v6 offset:9216
    v_add_u32 v6, s81, v6
    v_mfma_f32_16x16x32_bf16 v[192:195], v[116:119], a[160:163], v[192:195]
    ds_read_b64_tr_b16 v[104:105], v7
    buffer_load_dwordx4 v20, s[44:47], s90 offen offset:2048 lds
    v_mfma_f32_16x16x32_bf16 v[192:195], v[148:151], a[168:171], v[192:195]
    s_lshl_b32 s6, s6, 12
    ds_read_b64_tr_b16 v[106:107], v7 offset:1024
    v_mul_f32 v170, v170, v34
    v_mfma_f32_16x16x32_bf16 v[196:199], v[148:151], a[172:175], v[196:199]
    s_add_u32 s6, s6, 14336
    ds_read_b64_tr_b16 v[136:137], v7 offset:8192
    v_mul_f32 v171, v171, v34
    v_mul_f32 v172, v172, v35
    v_mfma_f32_16x16x32_bf16 v[196:199], v[116:119], a[164:167], v[196:199]
    s_waitcnt lgkmcnt(7)
    ds_read_b64_tr_b16 v[138:139], v7 offset:9216
    v_add_u32 v7, s81, v7
    v_mul_f32 v173, v173, v35
    v_mfma_f32_16x16x32_bf16 v[200:203], v[160:163], a[160:163], v[200:203]
    ds_read_b64_tr_b16 v[52:53], v8
    buffer_load_dwordx4 v21, s[44:47], s90 offen offset:3072 lds
    v_mfma_f32_16x16x32_bf16 v[200:203], v[164:167], a[168:171], v[200:203]
    s_add_u32 s72, s94, s6
    ds_read_b64_tr_b16 v[54:55], v8 offset:1024
    v_mul_f32 v174, v174, v35
    v_mul_f32 v175, v175, v35
    v_mfma_f32_16x16x32_bf16 v[204:207], v[164:167], a[172:175], v[204:207]
    ds_read_b64_tr_b16 v[84:85], v8 offset:8192
    v_mul_f32 v176, v176, v34
    v_mul_f32 v177, v177, v34
    v_mfma_f32_16x16x32_bf16 v[204:207], v[160:163], a[164:167], v[204:207]
    s_waitcnt lgkmcnt(7)
    ds_read_b64_tr_b16 v[86:87], v8 offset:9216
    v_add_u32 v8, s81, v8
    v_mul_f32 v178, v178, v34
    v_mfma_f32_16x16x32_bf16 v[208:211], v[40:43], a[160:163], v[208:211]
    s_barrier
    ds_read_b64_tr_b16 v[116:117], v1
    v_mul_f32 v179, v179, v34
    v_mul_f32 v180, v180, v35
    v_mfma_f32_16x16x32_bf16 v[208:211], v[72:75], a[168:171], v[208:211]
    ds_read_b64_tr_b16 v[118:119], v1 offset:1024
    buffer_load_dwordx4 a[192:195], v17, s[32:35], s72 offen sc1
    v_mfma_f32_16x16x32_bf16 v[212:215], v[72:75], a[172:175], v[212:215]
    s_add_u32 s73, s95, s6
    ds_read_b64_tr_b16 v[148:149], v1 offset:8192
    v_mul_f32 v181, v181, v35
    v_mul_f32 v182, v182, v35
    v_mfma_f32_16x16x32_bf16 v[212:215], v[40:43], a[164:167], v[212:215]
    s_waitcnt lgkmcnt(7)
    ds_read_b64_tr_b16 v[150:151], v1 offset:9216
    v_mul_f32 v183, v183, v35
    v_mul_f32 v184, v184, v34
    v_mfma_f32_16x16x32_bf16 v[216:219], v[104:107], a[160:163], v[216:219]
    ds_read_b64_tr_b16 v[160:161], v2
    buffer_load_dwordx4 a[196:199], v17, s[32:35], s73 offen sc1
    v_mfma_f32_16x16x32_bf16 v[216:219], v[136:139], a[168:171], v[216:219]
    ds_read_b64_tr_b16 v[162:163], v2 offset:1024
    v_mul_f32 v185, v185, v34
    v_mul_f32 v186, v186, v34
    v_mfma_f32_16x16x32_bf16 v[220:223], v[136:139], a[172:175], v[220:223]
    ds_read_b64_tr_b16 v[164:165], v2 offset:8192
    v_mul_f32 v187, v187, v34
    v_mul_f32 v188, v188, v35
    v_mfma_f32_16x16x32_bf16 v[220:223], v[104:107], a[164:167], v[220:223]
    s_waitcnt lgkmcnt(7)
    ds_read_b64_tr_b16 v[166:167], v2 offset:9216
    v_mul_f32 v189, v189, v35
    v_mul_f32 v190, v190, v35
    v_mfma_f32_16x16x32_bf16 v[224:227], v[52:55], a[160:163], v[224:227]
    ds_read_b64_tr_b16 v[40:41], v3
    buffer_load_dwordx4 a[200:203], v17, s[32:35], s72 offen offset:1024 sc1
    v_mfma_f32_16x16x32_bf16 v[224:227], v[84:87], a[168:171], v[224:227]
    ds_read_b64_tr_b16 v[42:43], v3 offset:1024
    v_mul_f32 v191, v191, v35
    v_mul_f32 v192, v192, v34
    v_mfma_f32_16x16x32_bf16 v[228:231], v[84:87], a[172:175], v[228:231]
    ds_read_b64_tr_b16 v[72:73], v3 offset:8192
    v_mul_f32 v193, v193, v34
    v_mul_f32 v194, v194, v34
    v_mfma_f32_16x16x32_bf16 v[228:231], v[52:55], a[164:167], v[228:231]
    s_waitcnt lgkmcnt(7)
    ds_read_b64_tr_b16 v[74:75], v3 offset:9216
    v_mul_f32 v195, v195, v34
    v_mul_f32 v196, v196, v35
    v_mfma_f32_16x16x32_bf16 v[168:171], v[116:119], v[88:91], v[168:171]
    ds_read_b64_tr_b16 v[104:105], v4
    buffer_load_dwordx4 a[204:207], v17, s[32:35], s73 offen offset:1024 sc1
    v_mfma_f32_16x16x32_bf16 v[168:171], v[148:151], v[92:95], v[168:171]
    ds_read_b64_tr_b16 v[106:107], v4 offset:1024
    v_mul_f32 v197, v197, v35
    v_mul_f32 v198, v198, v35
    v_mfma_f32_16x16x32_bf16 v[172:175], v[148:151], v[124:127], v[172:175]
    ds_read_b64_tr_b16 v[136:137], v4 offset:8192
    buffer_load_dwordx4 a[208:211], v17, s[32:35], s72 offen offset:2048 sc1
    v_mfma_f32_16x16x32_bf16 v[172:175], v[116:119], v[120:123], v[172:175]
    s_waitcnt lgkmcnt(7)
    ds_read_b64_tr_b16 v[138:139], v4 offset:9216
    v_mul_f32 v199, v199, v35
    v_mul_f32 v200, v200, v34
    v_mfma_f32_16x16x32_bf16 v[176:179], v[160:163], v[88:91], v[176:179]
    ds_read_b64_tr_b16 v[52:53], v5
    v_mul_f32 v201, v201, v34
    v_mul_f32 v202, v202, v34
    v_mfma_f32_16x16x32_bf16 v[176:179], v[164:167], v[92:95], v[176:179]
    s_add_u32 s69, s87, 32768
    ds_read_b64_tr_b16 v[54:55], v5 offset:1024
    v_mul_f32 v203, v203, v34
    v_mul_f32 v204, v204, v35
    v_mfma_f32_16x16x32_bf16 v[180:183], v[164:167], v[124:127], v[180:183]
    ds_read_b64_tr_b16 v[84:85], v5 offset:8192
    buffer_load_dwordx4 a[212:215], v17, s[32:35], s73 offen offset:2048 sc1
    v_mfma_f32_16x16x32_bf16 v[180:183], v[160:163], v[120:123], v[180:183]
    s_waitcnt lgkmcnt(7)
    ds_read_b64_tr_b16 v[86:87], v5 offset:9216
    v_mul_f32 v205, v205, v35
    v_mul_f32 v206, v206, v35
    v_mfma_f32_16x16x32_bf16 v[184:187], v[40:43], v[88:91], v[184:187]
    s_sub_u32 s79, s69, 163840
    ds_read_b64_tr_b16 v[116:117], v6
    v_mul_f32 v207, v207, v35
    v_mul_f32 v208, v208, v34
    v_mfma_f32_16x16x32_bf16 v[184:187], v[72:75], v[92:95], v[184:187]
    s_min_u32 s69, s69, s79
    ds_read_b64_tr_b16 v[118:119], v6 offset:1024
    v_mul_f32 v209, v209, v34
    v_mul_f32 v210, v210, v34
    v_mfma_f32_16x16x32_bf16 v[188:191], v[72:75], v[124:127], v[188:191]
    ds_read_b64_tr_b16 v[148:149], v6 offset:8192
    buffer_load_dwordx4 a[216:219], v17, s[32:35], s72 offen offset:3072 sc1
    v_mfma_f32_16x16x32_bf16 v[188:191], v[40:43], v[120:123], v[188:191]
    s_waitcnt lgkmcnt(7)
    ds_read_b64_tr_b16 v[150:151], v6 offset:9216
    v_mul_f32 v211, v211, v34
    v_mul_f32 v212, v212, v35
    v_mfma_f32_16x16x32_bf16 v[192:195], v[104:107], v[88:91], v[192:195]
    s_sub_u32 s79, s69, s87
    ds_read_b64_tr_b16 v[160:161], v7
    v_mul_f32 v213, v213, v35
    v_mul_f32 v214, v214, v35
    v_mfma_f32_16x16x32_bf16 v[192:195], v[136:139], v[92:95], v[192:195]
    s_mov_b32 s87, s69
    ds_read_b64_tr_b16 v[162:163], v7 offset:1024
    v_mul_f32 v215, v215, v35
    v_mul_f32 v216, v216, v34
    v_mfma_f32_16x16x32_bf16 v[196:199], v[136:139], v[124:127], v[196:199]
    ds_read_b64_tr_b16 v[164:165], v7 offset:8192
    buffer_load_dwordx4 a[220:223], v17, s[32:35], s73 offen offset:3072 sc1
    v_mfma_f32_16x16x32_bf16 v[196:199], v[104:107], v[120:123], v[196:199]
    s_waitcnt lgkmcnt(7)
    ds_read_b64_tr_b16 v[166:167], v7 offset:9216
    v_mul_f32 v217, v217, v34
    v_mul_f32 v218, v218, v34
    v_mfma_f32_16x16x32_bf16 v[200:203], v[52:55], v[88:91], v[200:203]
    s_xor_b32 s6, s68, 2
    ds_read_b64_tr_b16 v[40:41], v8
    v_mul_f32 v219, v219, v34
    v_mul_f32 v220, v220, v35
    v_mfma_f32_16x16x32_bf16 v[200:203], v[84:87], v[92:95], v[200:203]
    s_lshl_b32 s6, s6, 12
    ds_read_b64_tr_b16 v[42:43], v8 offset:1024
    v_mul_f32 v221, v221, v35
    v_mul_f32 v222, v222, v35
    v_mfma_f32_16x16x32_bf16 v[204:207], v[84:87], v[124:127], v[204:207]
    s_add_u32 s6, s6, 14336
    ds_read_b64_tr_b16 v[72:73], v8 offset:8192
    v_mul_f32 v223, v223, v35
    v_mul_f32 v224, v224, v34
    v_mfma_f32_16x16x32_bf16 v[204:207], v[52:55], v[120:123], v[204:207]
    s_waitcnt lgkmcnt(7)
    s_add_u32 s72, s94, s6
    ds_read_b64_tr_b16 v[74:75], v8 offset:9216
    v_mul_f32 v225, v225, v34
    v_mfma_f32_16x16x32_bf16 v[208:211], v[116:119], v[88:91], v[208:211]
    ds_read_b64_tr_b16 v[104:105], v1 offset:16384
    buffer_load_dwordx4 a[224:227], v17, s[32:35], s72 offen sc1
    v_mfma_f32_16x16x32_bf16 v[208:211], v[148:151], v[92:95], v[208:211]
    s_add_u32 s73, s95, s6
    ds_read_b64_tr_b16 v[106:107], v1 offset:17408
    v_mul_f32 v226, v226, v34
    v_mul_f32 v227, v227, v34
    v_mfma_f32_16x16x32_bf16 v[212:215], v[148:151], v[124:127], v[212:215]
    ds_read_b64_tr_b16 v[136:137], v1 offset:24576
    buffer_load_dwordx4 a[228:231], v17, s[32:35], s73 offen sc1
    v_mfma_f32_16x16x32_bf16 v[212:215], v[116:119], v[120:123], v[212:215]
    s_waitcnt lgkmcnt(7)
    ds_read_b64_tr_b16 v[138:139], v1 offset:25600
    v_add_u32 v1, s79, v1
    v_mul_f32 v228, v228, v35
    v_mfma_f32_16x16x32_bf16 v[216:219], v[160:163], v[88:91], v[216:219]
    ds_read_b64_tr_b16 v[52:53], v2 offset:16384
    v_mul_f32 v229, v229, v35
    v_mul_f32 v230, v230, v35
    v_mfma_f32_16x16x32_bf16 v[216:219], v[164:167], v[92:95], v[216:219]
    ds_read_b64_tr_b16 v[54:55], v2 offset:17408
    buffer_load_dwordx4 a[232:235], v17, s[32:35], s72 offen offset:1024 sc1
    v_mfma_f32_16x16x32_bf16 v[220:223], v[164:167], v[124:127], v[220:223]
    ds_read_b64_tr_b16 v[84:85], v2 offset:24576
    v_mul_f32 v231, v231, v35
    v_mfma_f32_16x16x32_bf16 v[220:223], v[160:163], v[120:123], v[220:223]
    s_waitcnt lgkmcnt(7)
    ds_read_b64_tr_b16 v[86:87], v2 offset:25600
    v_add_u32 v2, s79, v2
    v_mfma_f32_16x16x32_bf16 v[224:227], v[40:43], v[88:91], v[224:227]
    ds_read_b64_tr_b16 v[116:117], v3 offset:16384
    v_and_b32 v36, 15, v36
    v_mfma_f32_16x16x32_bf16 v[224:227], v[72:75], v[92:95], v[224:227]
    ds_read_b64_tr_b16 v[118:119], v3 offset:17408
    buffer_load_dwordx4 a[236:239], v17, s[32:35], s73 offen offset:1024 sc1
    v_mfma_f32_16x16x32_bf16 v[228:231], v[72:75], v[124:127], v[228:231]
    ds_read_b64_tr_b16 v[148:149], v3 offset:24576
    v_mfma_f32_16x16x32_bf16 v[228:231], v[40:43], v[120:123], v[228:231]
    s_waitcnt lgkmcnt(7)
    ds_read_b64_tr_b16 v[150:151], v3 offset:25600
    v_add_u32 v3, s79, v3
    v_mfma_f32_16x16x32_bf16 v[168:171], v[104:107], v[96:99], v[168:171]
    ds_read_b64_tr_b16 v[160:161], v4 offset:16384
    v_mfma_f32_16x16x32_bf16 v[168:171], v[136:139], v[100:103], v[168:171]
    ds_read_b64_tr_b16 v[162:163], v4 offset:17408
    buffer_load_dwordx4 a[240:243], v17, s[32:35], s72 offen offset:2048 sc1
    v_mfma_f32_16x16x32_bf16 v[172:175], v[136:139], v[132:135], v[172:175]
    s_add_u32 s88, s88, 32768
    ds_read_b64_tr_b16 v[164:165], v4 offset:24576
    v_mfma_f32_16x16x32_bf16 v[172:175], v[104:107], v[128:131], v[172:175]
    s_waitcnt lgkmcnt(7)
    ds_read_b64_tr_b16 v[166:167], v4 offset:25600
    v_add_u32 v4, s79, v4
    v_mfma_f32_16x16x32_bf16 v[176:179], v[52:55], v[96:99], v[176:179]
    ds_read_b64_tr_b16 v[40:41], v5 offset:16384
    buffer_load_dwordx4 a[244:247], v17, s[32:35], s73 offen offset:2048 sc1
    v_mfma_f32_16x16x32_bf16 v[176:179], v[84:87], v[100:103], v[176:179]
    s_sub_u32 s92, s88, 163840
    ds_read_b64_tr_b16 v[42:43], v5 offset:17408
    v_mfma_f32_16x16x32_bf16 v[180:183], v[84:87], v[132:135], v[180:183]
    s_min_u32 s88, s88, s92
    ds_read_b64_tr_b16 v[72:73], v5 offset:24576
    v_mfma_f32_16x16x32_bf16 v[180:183], v[52:55], v[128:131], v[180:183]
    s_waitcnt lgkmcnt(7)
    ds_read_b64_tr_b16 v[74:75], v5 offset:25600
    v_add_u32 v5, s79, v5
    v_mfma_f32_16x16x32_bf16 v[184:187], v[116:119], v[96:99], v[184:187]
L_hop13:
    s_cbranch_execz L_hop_ret1
    ds_read_b64_tr_b16 v[104:105], v6 offset:16384
    buffer_load_dwordx4 a[248:251], v17, s[32:35], s72 offen offset:3072 sc1
    v_mfma_f32_16x16x32_bf16 v[184:187], v[148:151], v[100:103], v[184:187]
    s_xor_b32 s89, s68, 3
    ds_read_b64_tr_b16 v[106:107], v6 offset:17408
    v_mfma_f32_16x16x32_bf16 v[188:191], v[148:151], v[132:135], v[188:191]
    s_lshl_b32 s89, s89, 17
    ds_read_b64_tr_b16 v[136:137], v6 offset:24576
    v_mfma_f32_16x16x32_bf16 v[188:191], v[116:119], v[128:131], v[188:191]
    s_waitcnt lgkmcnt(7)
    ds_read_b64_tr_b16 v[138:139], v6 offset:25600
    v_add_u32 v6, s79, v6
    v_mfma_f32_16x16x32_bf16 v[192:195], v[160:163], v[96:99], v[192:195]
    ds_read_b64_tr_b16 v[52:53], v7 offset:16384
    buffer_load_dwordx4 a[252:255], v17, s[32:35], s73 offen offset:3072 sc1
    v_mfma_f32_16x16x32_bf16 v[192:195], v[164:167], v[100:103], v[192:195]
    s_add_u32 s90, s89, 8192
    ds_read_b64_tr_b16 v[54:55], v7 offset:17408
    v_mfma_f32_16x16x32_bf16 v[196:199], v[164:167], v[132:135], v[196:199]
    s_mov_b32 m0, s88
    ds_read_b64_tr_b16 v[84:85], v7 offset:24576
    v_mfma_f32_16x16x32_bf16 v[196:199], v[160:163], v[128:131], v[196:199]
    s_waitcnt lgkmcnt(7)
    ds_read_b64_tr_b16 v[86:87], v7 offset:25600
    v_add_u32 v7, s79, v7
    v_mfma_f32_16x16x32_bf16 v[200:203], v[40:43], v[96:99], v[200:203]
    ds_read_b64_tr_b16 v[116:117], v8 offset:16384
    buffer_load_dwordx4 v18, s[44:47], s89 offen lds
    v_mfma_f32_16x16x32_bf16 v[200:203], v[72:75], v[100:103], v[200:203]
    ds_read_b64_tr_b16 v[118:119], v8 offset:17408
    v_mfma_f32_16x16x32_bf16 v[204:207], v[72:75], v[132:135], v[204:207]
    ds_read_b64_tr_b16 v[148:149], v8 offset:24576
    v_mfma_f32_16x16x32_bf16 v[204:207], v[40:43], v[128:131], v[204:207]
    s_waitcnt lgkmcnt(7)
    ds_read_b64_tr_b16 v[150:151], v8 offset:25600
    v_add_u32 v8, s79, v8
    v_mfma_f32_16x16x32_bf16 v[208:211], v[104:107], v[96:99], v[208:211]
    s_barrier
    ds_read_b64_tr_b16 v[160:161], v1
    v_mfma_f32_16x16x32_bf16 v[208:211], v[136:139], v[100:103], v[208:211]
    ds_read_b64_tr_b16 v[162:163], v1 offset:1024
    buffer_load_dwordx4 v19, s[44:47], s89 offen offset:1024 lds
    v_mfma_f32_16x16x32_bf16 v[212:215], v[136:139], v[132:135], v[212:215]
    ds_read_b64_tr_b16 v[164:165], v1 offset:8192
    v_mfma_f32_16x16x32_bf16 v[212:215], v[104:107], v[128:131], v[212:215]
    s_waitcnt lgkmcnt(7)
    ds_read_b64_tr_b16 v[166:167], v1 offset:9216
    v_mfma_f32_16x16x32_bf16 v[216:219], v[52:55], v[96:99], v[216:219]
    ds_read_b64_tr_b16 v[40:41], v2
    buffer_load_dwordx4 v20, s[44:47], s89 offen offset:2048 lds
    v_mfma_f32_16x16x32_bf16 v[216:219], v[84:87], v[100:103], v[216:219]
    ds_read_b64_tr_b16 v[42:43], v2 offset:1024
    v_mfma_f32_16x16x32_bf16 v[220:223], v[84:87], v[132:135], v[220:223]
    ds_read_b64_tr_b16 v[72:73], v2 offset:8192
    v_mfma_f32_16x16x32_bf16 v[220:223], v[52:55], v[128:131], v[220:223]
    s_waitcnt lgkmcnt(7)
    ds_read_b64_tr_b16 v[74:75], v2 offset:9216
    v_mfma_f32_16x16x32_bf16 v[224:227], v[116:119], v[96:99], v[224:227]
    ds_read_b64_tr_b16 v[104:105], v3
    buffer_load_dwordx4 v21, s[44:47], s89 offen offset:3072 lds
    v_mfma_f32_16x16x32_bf16 v[224:227], v[148:151], v[100:103], v[224:227]
    s_add_u32 m0, s88, 4096
    ds_read_b64_tr_b16 v[106:107], v3 offset:1024
    v_mfma_f32_16x16x32_bf16 v[228:231], v[148:151], v[132:135], v[228:231]
    s_waitcnt vmcnt(16)
    ds_read_b64_tr_b16 v[136:137], v3 offset:8192
    v_mfma_f32_16x16x32_bf16 v[228:231], v[116:119], v[128:131], v[228:231]
    s_waitcnt lgkmcnt(7)
    ds_read_b64_tr_b16 v[138:139], v3 offset:9216
    v_mfma_f32_16x16x32_bf16 v[168:171], v[160:163], a[192:195], v[168:171]
    ds_read_b64_tr_b16 v[52:53], v4
    buffer_load_dwordx4 v18, s[44:47], s90 offen lds
    v_mfma_f32_16x16x32_bf16 v[168:171], v[164:167], a[200:203], v[168:171]
    ds_read_b64_tr_b16 v[54:55], v4 offset:1024
    v_mfma_f32_16x16x32_bf16 v[172:175], v[164:167], a[204:207], v[172:175]
    s_add_u32 s69, s87, 32768
    ds_read_b64_tr_b16 v[84:85], v4 offset:8192
    v_mfma_f32_16x16x32_bf16 v[172:175], v[160:163], a[196:199], v[172:175]
    s_waitcnt lgkmcnt(7)
    ds_read_b64_tr_b16 v[86:87], v4 offset:9216
    v_mfma_f32_16x16x32_bf16 v[176:179], v[40:43], a[192:195], v[176:179]
    ds_read_b64_tr_b16 v[116:117], v5
    buffer_load_dwordx4 v19, s[44:47], s90 offen offset:1024 lds
    v_mfma_f32_16x16x32_bf16 v[176:179], v[72:75], a[200:203], v[176:179]
    s_sub_u32 s79, s69, 163840
    ds_read_b64_tr_b16 v[118:119], v5 offset:1024
    v_mfma_f32_16x16x32_bf16 v[180:183], v[72:75], a[204:207], v[180:183]
    s_xor_b32 s6, s68, 3
    ds_read_b64_tr_b16 v[148:149], v5 offset:8192
    v_mfma_f32_16x16x32_bf16 v[180:183], v[40:43], a[196:199], v[180:183]
    s_waitcnt lgkmcnt(7)
    ds_read_b64_tr_b16 v[150:151], v5 offset:9216
    v_mfma_f32_16x16x32_bf16 v[184:187], v[104:107], a[192:195], v[184:187]
    ds_read_b64_tr_b16 v[160:161], v6
    buffer_load_dwordx4 v20, s[44:47], s90 offen offset:2048 lds
    v_mfma_f32_16x16x32_bf16 v[184:187], v[136:139], a[200:203], v[184:187]
    s_lshl_b32 s6, s6, 12
    ds_read_b64_tr_b16 v[162:163], v6 offset:1024
    v_mfma_f32_16x16x32_bf16 v[188:191], v[136:139], a[204:207], v[188:191]
    ds_read_b64_tr_b16 v[164:165], v6 offset:8192
    buffer_load_dwordx4 v21, s[44:47], s90 offen offset:3072 lds
    v_mfma_f32_16x16x32_bf16 v[188:191], v[104:107], a[196:199], v[188:191]
    s_waitcnt lgkmcnt(7)
    ds_read_b64_tr_b16 v[166:167], v6 offset:9216
    v_mfma_f32_16x16x32_bf16 v[192:195], v[52:55], a[192:195], v[192:195]
    s_add_u32 s6, s6, 14336
    ds_read_b64_tr_b16 v[40:41], v7
    v_mfma_f32_16x16x32_bf16 v[192:195], v[84:87], a[200:203], v[192:195]
    s_add_u32 s72, s94, s6
    ds_read_b64_tr_b16 v[42:43], v7 offset:1024
    v_mfma_f32_16x16x32_bf16 v[196:199], v[84:87], a[204:207], v[196:199]
    ds_read_b64_tr_b16 v[72:73], v7 offset:8192
    buffer_load_dwordx4 a[96:99], v17, s[32:35], s72 offen sc1
    v_mfma_f32_16x16x32_bf16 v[196:199], v[52:55], a[196:199], v[196:199]
    s_waitcnt lgkmcnt(7)
    ds_read_b64_tr_b16 v[74:75], v7 offset:9216
    v_mfma_f32_16x16x32_bf16 v[200:203], v[116:119], a[192:195], v[200:203]
    s_min_u32 s69, s69, s79
    ds_read_b64_tr_b16 v[104:105], v8
    v_mfma_f32_16x16x32_bf16 v[200:203], v[148:151], a[200:203], v[200:203]
    s_add_u32 s73, s95, s6
    ds_read_b64_tr_b16 v[106:107], v8 offset:1024
    v_mfma_f32_16x16x32_bf16 v[204:207], v[148:151], a[204:207], v[204:207]
    ds_read_b64_tr_b16 v[136:137], v8 offset:8192
    buffer_load_dwordx4 a[100:103], v17, s[32:35], s73 offen sc1
    v_mfma_f32_16x16x32_bf16 v[204:207], v[116:119], a[196:199], v[204:207]
    s_waitcnt lgkmcnt(7)
    ds_read_b64_tr_b16 v[138:139], v8 offset:9216
    v_mfma_f32_16x16x32_bf16 v[208:211], v[160:163], a[192:195], v[208:211]
    s_sub_u32 s79, s69, s87
    ds_read_b64_tr_b16 v[52:53], v1 offset:16384
    v_mfma_f32_16x16x32_bf16 v[208:211], v[164:167], a[200:203], v[208:211]
    s_mov_b32 s87, s69
    ds_read_b64_tr_b16 v[54:55], v1 offset:17408
    v_mfma_f32_16x16x32_bf16 v[212:215], v[164:167], a[204:207], v[212:215]
    ds_read_b64_tr_b16 v[84:85], v1 offset:24576
    buffer_load_dwordx4 a[104:107], v17, s[32:35], s72 offen offset:1024 sc1
    v_mfma_f32_16x16x32_bf16 v[212:215], v[160:163], a[196:199], v[212:215]
    s_waitcnt lgkmcnt(7)
    ds_read_b64_tr_b16 v[86:87], v1 offset:25600
    v_add_u32 v1, s79, v1
    v_mfma_f32_16x16x32_bf16 v[216:219], v[40:43], a[192:195], v[216:219]
    s_and_b32 s71, s64, 3
    ds_read_b64_tr_b16 v[116:117], v2 offset:16384
    v_mfma_f32_16x16x32_bf16 v[216:219], v[72:75], a[200:203], v[216:219]
    s_lshl_b32 s71, s71, 8
    ds_read_b64_tr_b16 v[118:119], v2 offset:17408
    v_mfma_f32_16x16x32_bf16 v[220:223], v[72:75], a[204:207], v[220:223]
    ds_read_b64_tr_b16 v[148:149], v2 offset:24576
    buffer_load_dwordx4 a[108:111], v17, s[32:35], s73 offen offset:1024 sc1
    v_mfma_f32_16x16x32_bf16 v[220:223], v[40:43], a[196:199], v[220:223]
    s_waitcnt lgkmcnt(7)
    ds_read_b64_tr_b16 v[150:151], v2 offset:25600
    v_add_u32 v2, s79, v2
    v_mfma_f32_16x16x32_bf16 v[224:227], v[104:107], a[192:195], v[224:227]
    s_lshl_b32 s70, s67, 6
    ds_read_b64_tr_b16 v[160:161], v3 offset:16384
    v_mfma_f32_16x16x32_bf16 v[224:227], v[136:139], a[200:203], v[224:227]
    ds_read_b64_tr_b16 v[162:163], v3 offset:17408
    buffer_load_dwordx4 a[112:115], v17, s[32:35], s72 offen offset:2048 sc1
    v_mfma_f32_16x16x32_bf16 v[228:231], v[136:139], a[204:207], v[228:231]
    s_waitcnt vmcnt(21)
    ds_read_b64_tr_b16 v[164:165], v3 offset:24576
    v_mfma_f32_16x16x32_bf16 v[228:231], v[104:107], a[196:199], v[228:231]
    s_waitcnt lgkmcnt(7)
    ds_read_b64_tr_b16 v[166:167], v3 offset:25600
    v_add_u32 v3, s79, v3
    v_mfma_f32_16x16x32_bf16 v[168:171], v[52:55], a[208:211], v[168:171]
    s_add_u32 s88, s88, 32768
    ds_read_b64_tr_b16 v[40:41], v4 offset:16384
    v_mfma_f32_16x16x32_bf16 v[168:171], v[84:87], a[216:219], v[168:171]
    ds_read_b64_tr_b16 v[42:43], v4 offset:17408
    buffer_load_dwordx4 a[116:119], v17, s[32:35], s73 offen offset:2048 sc1
    v_mfma_f32_16x16x32_bf16 v[172:175], v[84:87], a[220:223], v[172:175]
    s_sub_u32 s92, s88, 163840
    ds_read_b64_tr_b16 v[72:73], v4 offset:24576
    v_mfma_f32_16x16x32_bf16 v[172:175], v[52:55], a[212:215], v[172:175]
    s_waitcnt lgkmcnt(7)
    ds_read_b64_tr_b16 v[74:75], v4 offset:25600
    v_add_u32 v4, s79, v4
    v_mfma_f32_16x16x32_bf16 v[176:179], v[116:119], a[208:211], v[176:179]
    s_min_u32 s88, s88, s92
    ds_read_b64_tr_b16 v[104:105], v5 offset:16384
    v_mfma_f32_16x16x32_bf16 v[176:179], v[148:151], a[216:219], v[176:179]
    ds_read_b64_tr_b16 v[106:107], v5 offset:17408
    buffer_load_dwordx4 a[120:123], v17, s[32:35], s72 offen offset:3072 sc1
    v_mfma_f32_16x16x32_bf16 v[180:183], v[148:151], a[220:223], v[180:183]
    s_xor_b32 s89, s68, 4
    ds_read_b64_tr_b16 v[136:137], v5 offset:24576
    v_mfma_f32_16x16x32_bf16 v[180:183], v[116:119], a[212:215], v[180:183]
    s_waitcnt lgkmcnt(7)
    ds_read_b64_tr_b16 v[138:139], v5 offset:25600
    v_add_u32 v5, s79, v5
    v_mfma_f32_16x16x32_bf16 v[184:187], v[160:163], a[208:211], v[184:187]
    s_lshl_b32 s89, s89, 17
    ds_read_b64_tr_b16 v[52:53], v6 offset:16384
    v_mfma_f32_16x16x32_bf16 v[184:187], v[164:167], a[216:219], v[184:187]
    ds_read_b64_tr_b16 v[54:55], v6 offset:17408
    buffer_load_dwordx4 a[124:127], v17, s[32:35], s73 offen offset:3072 sc1
    v_mfma_f32_16x16x32_bf16 v[188:191], v[164:167], a[220:223], v[188:191]
    s_add_u32 s90, s89, 8192
    ds_read_b64_tr_b16 v[84:85], v6 offset:24576
    v_mfma_f32_16x16x32_bf16 v[188:191], v[160:163], a[212:215], v[188:191]
    s_waitcnt lgkmcnt(7)
    ds_read_b64_tr_b16 v[86:87], v6 offset:25600
    v_add_u32 v6, s79, v6
    v_mfma_f32_16x16x32_bf16 v[192:195], v[40:43], a[208:211], v[192:195]
    s_mov_b32 m0, s88
    ds_read_b64_tr_b16 v[116:117], v7 offset:16384
    v_mfma_f32_16x16x32_bf16 v[192:195], v[72:75], a[216:219], v[192:195]
    ds_read_b64_tr_b16 v[118:119], v7 offset:17408
    buffer_load_dwordx4 v18, s[44:47], s89 offen lds
    v_mfma_f32_16x16x32_bf16 v[196:199], v[72:75], a[220:223], v[196:199]
    s_add_u32 s71, s71, s70
    ds_read_b64_tr_b16 v[148:149], v7 offset:24576
    v_mfma_f32_16x16x32_bf16 v[196:199], v[40:43], a[212:215], v[196:199]
    s_waitcnt lgkmcnt(7)
    ds_read_b64_tr_b16 v[150:151], v7 offset:25600
    v_add_u32 v7, s79, v7
    v_mfma_f32_16x16x32_bf16 v[200:203], v[104:107], a[208:211], v[200:203]
    ds_read_b64_tr_b16 v[160:161], v8 offset:16384
    buffer_load_dwordx4 v19, s[44:47], s89 offen offset:1024 lds
    v_mfma_f32_16x16x32_bf16 v[200:203], v[136:139], a[216:219], v[200:203]
    s_add_u32 s74, s74, s71
    ds_read_b64_tr_b16 v[162:163], v8 offset:17408
    v_mfma_f32_16x16x32_bf16 v[204:207], v[136:139], a[220:223], v[204:207]
    ds_read_b64_tr_b16 v[164:165], v8 offset:24576
    v_mfma_f32_16x16x32_bf16 v[204:207], v[104:107], a[212:215], v[204:207]
    s_waitcnt lgkmcnt(7)
    ds_read_b64_tr_b16 v[166:167], v8 offset:25600
    v_add_u32 v8, s79, v8
    v_mfma_f32_16x16x32_bf16 v[208:211], v[52:55], a[208:211], v[208:211]
    s_barrier
    ds_read_b64_tr_b16 v[40:41], v1
    v_mfma_f32_16x16x32_bf16 v[208:211], v[84:87], a[216:219], v[208:211]
    ds_read_b64_tr_b16 v[42:43], v1 offset:1024
    buffer_load_dwordx4 v20, s[44:47], s89 offen offset:2048 lds
    v_mfma_f32_16x16x32_bf16 v[212:215], v[84:87], a[220:223], v[212:215]
    s_add_u32 s75, s75, s71
    ds_read_b64_tr_b16 v[72:73], v1 offset:8192
    v_mfma_f32_16x16x32_bf16 v[212:215], v[52:55], a[212:215], v[212:215]
    s_waitcnt lgkmcnt(7)
    ds_read_b64_tr_b16 v[74:75], v1 offset:9216
    v_mfma_f32_16x16x32_bf16 v[216:219], v[116:119], a[208:211], v[216:219]
    ds_read_b64_tr_b16 v[104:105], v2
    buffer_load_dwordx4 v21, s[44:47], s89 offen offset:3072 lds
    v_mfma_f32_16x16x32_bf16 v[216:219], v[148:151], a[216:219], v[216:219]
    ds_read_b64_tr_b16 v[106:107], v2 offset:1024
    v_mfma_f32_16x16x32_bf16 v[220:223], v[148:151], a[220:223], v[220:223]
    s_add_u32 m0, s88, 4096
    ds_read_b64_tr_b16 v[136:137], v2 offset:8192
    v_mfma_f32_16x16x32_bf16 v[220:223], v[116:119], a[212:215], v[220:223]
    s_waitcnt lgkmcnt(7)
    ds_read_b64_tr_b16 v[138:139], v2 offset:9216
    v_mfma_f32_16x16x32_bf16 v[224:227], v[160:163], a[208:211], v[224:227]
    ds_read_b64_tr_b16 v[52:53], v3
    buffer_load_dwordx4 v18, s[44:47], s90 offen lds
    v_mfma_f32_16x16x32_bf16 v[224:227], v[164:167], a[216:219], v[224:227]
    ds_read_b64_tr_b16 v[54:55], v3 offset:1024
    v_mfma_f32_16x16x32_bf16 v[228:231], v[164:167], a[220:223], v[228:231]
    s_waitcnt vmcnt(25)
    ds_read_b64_tr_b16 v[84:85], v3 offset:8192
    v_mfma_f32_16x16x32_bf16 v[228:231], v[160:163], a[212:215], v[228:231]
    s_waitcnt lgkmcnt(7)
    ds_read_b64_tr_b16 v[86:87], v3 offset:9216
    v_mfma_f32_16x16x32_bf16 v[168:171], v[40:43], a[224:227], v[168:171]
    ds_read_b64_tr_b16 v[116:117], v4
    buffer_load_dwordx4 v19, s[44:47], s90 offen offset:1024 lds
    v_mfma_f32_16x16x32_bf16 v[168:171], v[72:75], a[232:235], v[168:171]
    ds_read_b64_tr_b16 v[118:119], v4 offset:1024
    v_mfma_f32_16x16x32_bf16 v[172:175], v[72:75], a[236:239], v[172:175]
    s_add_u32 s69, s87, 32768
    ds_read_b64_tr_b16 v[148:149], v4 offset:8192
    v_mfma_f32_16x16x32_bf16 v[172:175], v[40:43], a[228:231], v[172:175]
    s_waitcnt lgkmcnt(7)
    ds_read_b64_tr_b16 v[150:151], v4 offset:9216
    v_mfma_f32_16x16x32_bf16 v[176:179], v[104:107], a[224:227], v[176:179]
    ds_read_b64_tr_b16 v[160:161], v5
    buffer_load_dwordx4 v20, s[44:47], s90 offen offset:2048 lds
    v_mfma_f32_16x16x32_bf16 v[176:179], v[136:139], a[232:235], v[176:179]
    s_xor_b32 s6, s68, 4
    ds_read_b64_tr_b16 v[162:163], v5 offset:1024
    v_mfma_f32_16x16x32_bf16 v[180:183], v[136:139], a[236:239], v[180:183]
    s_lshl_b32 s6, s6, 12
    ds_read_b64_tr_b16 v[164:165], v5 offset:8192
    v_mfma_f32_16x16x32_bf16 v[180:183], v[104:107], a[228:231], v[180:183]
    s_waitcnt lgkmcnt(7)
    ds_read_b64_tr_b16 v[166:167], v5 offset:9216
    v_mfma_f32_16x16x32_bf16 v[184:187], v[52:55], a[224:227], v[184:187]
    ds_read_b64_tr_b16 v[40:41], v6
    buffer_load_dwordx4 v21, s[44:47], s90 offen offset:3072 lds
    v_mfma_f32_16x16x32_bf16 v[184:187], v[84:87], a[232:235], v[184:187]
    s_add_u32 s6, s6, 14336
    ds_read_b64_tr_b16 v[42:43], v6 offset:1024
    v_mfma_f32_16x16x32_bf16 v[188:191], v[84:87], a[236:239], v[188:191]
    s_add_u32 s72, s94, s6
    ds_read_b64_tr_b16 v[72:73], v6 offset:8192
    v_mfma_f32_16x16x32_bf16 v[188:191], v[52:55], a[228:231], v[188:191]
    s_waitcnt lgkmcnt(7)
    ds_read_b64_tr_b16 v[74:75], v6 offset:9216
    v_mfma_f32_16x16x32_bf16 v[192:195], v[116:119], a[224:227], v[192:195]
    ds_read_b64_tr_b16 v[104:105], v7
    buffer_load_dwordx4 a[0:3], v17, s[32:35], s72 offen sc1
    v_mfma_f32_16x16x32_bf16 v[192:195], v[148:151], a[232:235], v[192:195]
    s_sub_u32 s79, s69, 163840
    ds_read_b64_tr_b16 v[106:107], v7 offset:1024
    v_mfma_f32_16x16x32_bf16 v[196:199], v[148:151], a[236:239], v[196:199]
    s_add_u32 s73, s95, s6
    ds_read_b64_tr_b16 v[136:137], v7 offset:8192
    v_mfma_f32_16x16x32_bf16 v[196:199], v[116:119], a[228:231], v[196:199]
    s_waitcnt lgkmcnt(7)
    ds_read_b64_tr_b16 v[138:139], v7 offset:9216
    v_mfma_f32_16x16x32_bf16 v[200:203], v[160:163], a[224:227], v[200:203]
    ds_read_b64_tr_b16 v[52:53], v8
    buffer_load_dwordx4 a[4:7], v17, s[32:35], s73 offen sc1
    v_mfma_f32_16x16x32_bf16 v[200:203], v[164:167], a[232:235], v[200:203]
    s_min_u32 s69, s69, s79
    ds_read_b64_tr_b16 v[54:55], v8 offset:1024
    v_mfma_f32_16x16x32_bf16 v[204:207], v[164:167], a[236:239], v[204:207]
    s_sub_u32 s79, s69, s87
    ds_read_b64_tr_b16 v[84:85], v8 offset:8192
    v_mfma_f32_16x16x32_bf16 v[204:207], v[160:163], a[228:231], v[204:207]
    s_waitcnt lgkmcnt(7)
    ds_read_b64_tr_b16 v[86:87], v8 offset:9216
    v_mfma_f32_16x16x32_bf16 v[208:211], v[40:43], a[224:227], v[208:211]
    ds_read_b64_tr_b16 v[116:117], v1 offset:16384
    buffer_load_dwordx4 a[8:11], v17, s[32:35], s72 offen offset:1024 sc1
    v_mfma_f32_16x16x32_bf16 v[208:211], v[72:75], a[232:235], v[208:211]
    s_mov_b32 s87, s69
    ds_read_b64_tr_b16 v[118:119], v1 offset:17408
    v_mfma_f32_16x16x32_bf16 v[212:215], v[72:75], a[236:239], v[212:215]
    ds_read_b64_tr_b16 v[148:149], v1 offset:24576
    buffer_load_dwordx4 a[12:15], v17, s[32:35], s73 offen offset:1024 sc1
    v_mfma_f32_16x16x32_bf16 v[212:215], v[40:43], a[228:231], v[212:215]
    s_waitcnt lgkmcnt(7)
    ds_read_b64_tr_b16 v[150:151], v1 offset:25600
    v_add_u32 v1, s79, v1
    v_mfma_f32_16x16x32_bf16 v[216:219], v[104:107], a[224:227], v[216:219]
    ds_read_b64_tr_b16 v[160:161], v2 offset:16384
    v_mfma_f32_16x16x32_bf16 v[216:219], v[136:139], a[232:235], v[216:219]
    s_add_u32 s88, s88, 32768
    ds_read_b64_tr_b16 v[162:163], v2 offset:17408
    v_mfma_f32_16x16x32_bf16 v[220:223], v[136:139], a[236:239], v[220:223]
    ds_read_b64_tr_b16 v[164:165], v2 offset:24576
    buffer_load_dwordx4 a[16:19], v17, s[32:35], s72 offen offset:2048 sc1
    v_mfma_f32_16x16x32_bf16 v[220:223], v[104:107], a[228:231], v[220:223]
    s_waitcnt lgkmcnt(7)
    ds_read_b64_tr_b16 v[166:167], v2 offset:25600
    v_add_u32 v2, s79, v2
    v_mfma_f32_16x16x32_bf16 v[224:227], v[52:55], a[224:227], v[224:227]
    s_sub_u32 s92, s88, 163840
    ds_read_b64_tr_b16 v[40:41], v3 offset:16384
    v_mfma_f32_16x16x32_bf16 v[224:227], v[84:87], a[232:235], v[224:227]
    s_min_u32 s88, s88, s92
    ds_read_b64_tr_b16 v[42:43], v3 offset:17408
    v_mfma_f32_16x16x32_bf16 v[228:231], v[84:87], a[236:239], v[228:231]
    s_waitcnt vmcnt(29)
    ds_read_b64_tr_b16 v[72:73], v3 offset:24576
    v_mfma_f32_16x16x32_bf16 v[228:231], v[52:55], a[228:231], v[228:231]
    s_waitcnt lgkmcnt(7)
    ds_read_b64_tr_b16 v[74:75], v3 offset:25600
    v_add_u32 v3, s79, v3
    v_mfma_f32_16x16x32_bf16 v[168:171], v[116:119], a[240:243], v[168:171]
    ds_read_b64_tr_b16 v[104:105], v4 offset:16384
    buffer_load_dwordx4 a[20:23], v17, s[32:35], s73 offen offset:2048 sc1
    v_mfma_f32_16x16x32_bf16 v[168:171], v[148:151], a[248:251], v[168:171]
    s_xor_b32 s89, s68, 5
    ds_read_b64_tr_b16 v[106:107], v4 offset:17408
    v_mfma_f32_16x16x32_bf16 v[172:175], v[148:151], a[252:255], v[172:175]
    ds_read_b64_tr_b16 v[136:137], v4 offset:24576
    buffer_load_dwordx4 a[24:27], v17, s[32:35], s72 offen offset:3072 sc1
    v_mfma_f32_16x16x32_bf16 v[172:175], v[116:119], a[244:247], v[172:175]
    s_waitcnt lgkmcnt(7)
    ds_read_b64_tr_b16 v[138:139], v4 offset:25600
    v_add_u32 v4, s79, v4
    v_mfma_f32_16x16x32_bf16 v[176:179], v[160:163], a[240:243], v[176:179]
    s_lshl_b32 s89, s89, 17
    ds_read_b64_tr_b16 v[52:53], v5 offset:16384
    v_mfma_f32_16x16x32_bf16 v[176:179], v[164:167], a[248:251], v[176:179]
    s_add_u32 s90, s89, 8192
    ds_read_b64_tr_b16 v[54:55], v5 offset:17408
    v_mfma_f32_16x16x32_bf16 v[180:183], v[164:167], a[252:255], v[180:183]
    ds_read_b64_tr_b16 v[84:85], v5 offset:24576
    buffer_load_dwordx4 a[28:31], v17, s[32:35], s73 offen offset:3072 sc1
    v_mfma_f32_16x16x32_bf16 v[180:183], v[160:163], a[244:247], v[180:183]
    s_waitcnt lgkmcnt(7)
    ds_read_b64_tr_b16 v[86:87], v5 offset:25600
    v_add_u32 v5, s79, v5
    v_mfma_f32_16x16x32_bf16 v[184:187], v[40:43], a[240:243], v[184:187]
    s_mov_b32 m0, s88
    ds_read_b64_tr_b16 v[116:117], v6 offset:16384
    v_mfma_f32_16x16x32_bf16 v[184:187], v[72:75], a[248:251], v[184:187]
    ds_read_b64_tr_b16 v[118:119], v6 offset:17408
    buffer_load_dwordx4 v18, s[44:47], s89 offen lds
    v_mfma_f32_16x16x32_bf16 v[188:191], v[72:75], a[252:255], v[188:191]
    ds_read_b64_tr_b16 v[148:149], v6 offset:24576
    v_mfma_f32_16x16x32_bf16 v[188:191], v[40:43], a[244:247], v[188:191]
    s_waitcnt lgkmcnt(7)
    ds_read_b64_tr_b16 v[150:151], v6 offset:25600
    v_add_u32 v6, s79, v6
    v_mfma_f32_16x16x32_bf16 v[192:195], v[104:107], a[240:243], v[192:195]
    ds_read_b64_tr_b16 v[160:161], v7 offset:16384
    v_mfma_f32_16x16x32_bf16 v[192:195], v[136:139], a[248:251], v[192:195]
    ds_read_b64_tr_b16 v[162:163], v7 offset:17408
    buffer_load_dwordx4 v19, s[44:47], s89 offen offset:1024 lds
    v_mfma_f32_16x16x32_bf16 v[196:199], v[136:139], a[252:255], v[196:199]
    ds_read_b64_tr_b16 v[164:165], v7 offset:24576
    v_mfma_f32_16x16x32_bf16 v[196:199], v[104:107], a[244:247], v[196:199]
    s_waitcnt lgkmcnt(7)
    ds_read_b64_tr_b16 v[166:167], v7 offset:25600
    v_add_u32 v7, s79, v7
    v_mfma_f32_16x16x32_bf16 v[200:203], v[52:55], a[240:243], v[200:203]
    ds_read_b64_tr_b16 v[40:41], v8 offset:16384
    v_mfma_f32_16x16x32_bf16 v[200:203], v[84:87], a[248:251], v[200:203]
    ds_read_b64_tr_b16 v[42:43], v8 offset:17408
    buffer_load_dwordx4 v20, s[44:47], s89 offen offset:2048 lds
    v_mfma_f32_16x16x32_bf16 v[204:207], v[84:87], a[252:255], v[204:207]
    s_waitcnt vmcnt(27)
    ds_read_b64_tr_b16 v[72:73], v8 offset:24576
    v_mfma_f32_16x16x32_bf16 v[204:207], v[52:55], a[244:247], v[204:207]
    s_waitcnt lgkmcnt(7)
    ds_read_b64_tr_b16 v[74:75], v8 offset:25600
    v_add_u32 v8, s79, v8
    v_mfma_f32_16x16x32_bf16 v[208:211], v[116:119], a[240:243], v[208:211]
    s_barrier
    ds_read_b64_tr_b16 v[104:105], v3
    v_mfma_f32_16x16x32_bf16 v[208:211], v[148:151], a[248:251], v[208:211]
    ds_read_b64_tr_b16 v[106:107], v3 offset:1024
    buffer_load_dwordx4 v21, s[44:47], s89 offen offset:3072 lds
    v_mfma_f32_16x16x32_bf16 v[212:215], v[148:151], a[252:255], v[212:215]
    s_add_u32 s69, s87, 32768
    ds_read_b64_tr_b16 v[136:137], v3 offset:8192
    v_mfma_f32_16x16x32_bf16 v[212:215], v[116:119], a[244:247], v[212:215]
    s_waitcnt lgkmcnt(7)
    ds_read_b64_tr_b16 v[138:139], v3 offset:9216
    v_mfma_f32_16x16x32_bf16 v[216:219], v[160:163], a[240:243], v[216:219]
    s_add_u32 m0, s88, 4096
    ds_read_b64_tr_b16 v[52:53], v4
    v_mfma_f32_16x16x32_bf16 v[216:219], v[164:167], a[248:251], v[216:219]
    ds_read_b64_tr_b16 v[54:55], v4 offset:1024
    buffer_load_dwordx4 v18, s[44:47], s90 offen lds
    v_mfma_f32_16x16x32_bf16 v[220:223], v[164:167], a[252:255], v[220:223]
    s_sub_u32 s20, s69, 163840
    ds_read_b64_tr_b16 v[84:85], v4 offset:8192
    v_mfma_f32_16x16x32_bf16 v[220:223], v[160:163], a[244:247], v[220:223]
    s_waitcnt lgkmcnt(7)
    ds_read_b64_tr_b16 v[86:87], v4 offset:9216
    v_mfma_f32_16x16x32_bf16 v[224:227], v[40:43], a[240:243], v[224:227]
    ds_read_b64_tr_b16 v[116:117], v5
    buffer_load_dwordx4 v19, s[44:47], s90 offen offset:1024 lds
    v_mfma_f32_16x16x32_bf16 v[224:227], v[72:75], a[248:251], v[224:227]
    s_min_u32 s69, s69, s20
    ds_read_b64_tr_b16 v[118:119], v5 offset:1024
    v_mfma_f32_16x16x32_bf16 v[228:231], v[72:75], a[252:255], v[228:231]
    s_waitcnt vmcnt(26)
    ds_read_b64_tr_b16 v[148:149], v5 offset:8192
    v_mfma_f32_16x16x32_bf16 v[228:231], v[40:43], a[244:247], v[228:231]
    s_waitcnt lgkmcnt(7)
    ds_read_b64_tr_b16 v[150:151], v5 offset:9216
    v_mfma_f32_16x16x32_bf16 v[184:187], v[104:107], a[96:99], v[184:187]
    ds_read_b64_tr_b16 v[160:161], v6
    buffer_load_dwordx4 v20, s[44:47], s90 offen offset:2048 lds
    v_mfma_f32_16x16x32_bf16 v[184:187], v[136:139], a[104:107], v[184:187]
    s_xor_b32 s6, s68, 5
    ds_read_b64_tr_b16 v[162:163], v6 offset:1024
    v_mfma_f32_16x16x32_bf16 v[188:191], v[136:139], a[108:111], v[188:191]
    s_lshl_b32 s6, s6, 12
    ds_read_b64_tr_b16 v[164:165], v6 offset:8192
    v_mfma_f32_16x16x32_bf16 v[188:191], v[104:107], a[100:103], v[188:191]
    s_waitcnt lgkmcnt(7)
    ds_read_b64_tr_b16 v[166:167], v6 offset:9216
    v_mfma_f32_16x16x32_bf16 v[192:195], v[52:55], a[96:99], v[192:195]
    ds_read_b64_tr_b16 v[40:41], v7
    buffer_load_dwordx4 v21, s[44:47], s90 offen offset:3072 lds
    v_mfma_f32_16x16x32_bf16 v[192:195], v[84:87], a[104:107], v[192:195]
    s_add_u32 s6, s6, 14336
    ds_read_b64_tr_b16 v[42:43], v7 offset:1024
    v_mfma_f32_16x16x32_bf16 v[196:199], v[84:87], a[108:111], v[196:199]
    s_add_u32 s72, s94, s6
    ds_read_b64_tr_b16 v[72:73], v7 offset:8192
    v_mfma_f32_16x16x32_bf16 v[196:199], v[52:55], a[100:103], v[196:199]
    s_waitcnt lgkmcnt(7)
    ds_read_b64_tr_b16 v[74:75], v7 offset:9216
    v_mfma_f32_16x16x32_bf16 v[200:203], v[116:119], a[96:99], v[200:203]
    ds_read_b64_tr_b16 v[104:105], v8
    buffer_load_dwordx4 a[176:179], v17, s[32:35], s72 offen sc1
    v_mfma_f32_16x16x32_bf16 v[200:203], v[148:151], a[104:107], v[200:203]
    s_sub_u32 s20, s69, s87
    ds_read_b64_tr_b16 v[106:107], v8 offset:1024
    v_mfma_f32_16x16x32_bf16 v[204:207], v[148:151], a[108:111], v[204:207]
    s_add_u32 s73, s95, s6
    ds_read_b64_tr_b16 v[136:137], v8 offset:8192
    v_mfma_f32_16x16x32_bf16 v[204:207], v[116:119], a[100:103], v[204:207]
    s_waitcnt lgkmcnt(7)
    ds_read_b64_tr_b16 v[138:139], v8 offset:9216
    v_mfma_f32_16x16x32_bf16 v[208:211], v[160:163], a[96:99], v[208:211]
    ds_read_b64_tr_b16 v[52:53], v3 offset:16384
    buffer_load_dwordx4 a[180:183], v17, s[32:35], s73 offen sc1
    v_mfma_f32_16x16x32_bf16 v[208:211], v[164:167], a[104:107], v[208:211]
    s_mov_b32 s87, s69
    ds_read_b64_tr_b16 v[54:55], v3 offset:17408
    v_mfma_f32_16x16x32_bf16 v[212:215], v[164:167], a[108:111], v[212:215]
    ds_read_b64_tr_b16 v[84:85], v3 offset:24576
    v_mfma_f32_16x16x32_bf16 v[212:215], v[160:163], a[100:103], v[212:215]
    s_waitcnt lgkmcnt(7)
    ds_read_b64_tr_b16 v[86:87], v3 offset:25600
    v_add_u32 v3, s20, v3
    v_mfma_f32_16x16x32_bf16 v[216:219], v[40:43], a[96:99], v[216:219]
    ds_read_b64_tr_b16 v[116:117], v4 offset:16384
    buffer_load_dwordx4 a[184:187], v17, s[32:35], s72 offen offset:1024 sc1
    v_mfma_f32_16x16x32_bf16 v[216:219], v[72:75], a[104:107], v[216:219]
    ds_read_b64_tr_b16 v[118:119], v4 offset:17408
    v_mfma_f32_16x16x32_bf16 v[220:223], v[72:75], a[108:111], v[220:223]
    ds_read_b64_tr_b16 v[148:149], v4 offset:24576
    v_mfma_f32_16x16x32_bf16 v[220:223], v[40:43], a[100:103], v[220:223]
    s_waitcnt lgkmcnt(7)
    ds_read_b64_tr_b16 v[150:151], v4 offset:25600
    v_add_u32 v4, s20, v4
    v_mfma_f32_16x16x32_bf16 v[224:227], v[104:107], a[96:99], v[224:227]
    ds_read_b64_tr_b16 v[160:161], v5 offset:16384
    buffer_load_dwordx4 a[188:191], v17, s[32:35], s73 offen offset:1024 sc1
    v_mfma_f32_16x16x32_bf16 v[224:227], v[136:139], a[104:107], v[224:227]
    s_add_u32 s88, s88, 32768
    ds_read_b64_tr_b16 v[162:163], v5 offset:17408
    v_mfma_f32_16x16x32_bf16 v[228:231], v[136:139], a[108:111], v[228:231]
    s_waitcnt vmcnt(28)
    ds_read_b64_tr_b16 v[164:165], v5 offset:24576
    v_mfma_f32_16x16x32_bf16 v[228:231], v[104:107], a[100:103], v[228:231]
    s_waitcnt lgkmcnt(7)
    ds_read_b64_tr_b16 v[166:167], v5 offset:25600
    v_add_u32 v5, s20, v5
    v_mfma_f32_16x16x32_bf16 v[184:187], v[52:55], a[112:115], v[184:187]
    ds_read_b64_tr_b16 v[40:41], v6 offset:16384
    buffer_load_dwordx4 a[32:35], v17, s[32:35], s72 offen offset:2048 sc1
    v_mfma_f32_16x16x32_bf16 v[184:187], v[84:87], a[120:123], v[184:187]
    s_sub_u32 s92, s88, 163840
    ds_read_b64_tr_b16 v[42:43], v6 offset:17408
    v_mfma_f32_16x16x32_bf16 v[188:191], v[84:87], a[124:127], v[188:191]
    s_min_u32 s88, s88, s92
    ds_read_b64_tr_b16 v[72:73], v6 offset:24576
    v_mfma_f32_16x16x32_bf16 v[188:191], v[52:55], a[116:119], v[188:191]
    s_waitcnt lgkmcnt(7)
    ds_read_b64_tr_b16 v[74:75], v6 offset:25600
    v_add_u32 v6, s20, v6
    v_mfma_f32_16x16x32_bf16 v[192:195], v[116:119], a[112:115], v[192:195]
    ds_read_b64_tr_b16 v[104:105], v7 offset:16384
    buffer_load_dwordx4 a[36:39], v17, s[32:35], s73 offen offset:2048 sc1
    v_mfma_f32_16x16x32_bf16 v[192:195], v[148:151], a[120:123], v[192:195]
    s_xor_b32 s89, s68, 6
    ds_read_b64_tr_b16 v[106:107], v7 offset:17408
    v_mfma_f32_16x16x32_bf16 v[196:199], v[148:151], a[124:127], v[196:199]
    s_lshl_b32 s89, s89, 17
    ds_read_b64_tr_b16 v[136:137], v7 offset:24576
    v_mfma_f32_16x16x32_bf16 v[196:199], v[116:119], a[116:119], v[196:199]
    s_waitcnt lgkmcnt(7)
    ds_read_b64_tr_b16 v[138:139], v7 offset:25600
    v_add_u32 v7, s20, v7
    v_mfma_f32_16x16x32_bf16 v[200:203], v[160:163], a[112:115], v[200:203]
    ds_read_b64_tr_b16 v[52:53], v8 offset:16384
    buffer_load_dwordx4 a[40:43], v17, s[32:35], s72 offen offset:3072 sc1
    v_mfma_f32_16x16x32_bf16 v[200:203], v[164:167], a[120:123], v[200:203]
    s_add_u32 s90, s89, 8192
    ds_read_b64_tr_b16 v[54:55], v8 offset:17408
    v_mfma_f32_16x16x32_bf16 v[204:207], v[164:167], a[124:127], v[204:207]
    s_waitcnt vmcnt(23)
    ds_read_b64_tr_b16 v[84:85], v8 offset:24576
    v_mfma_f32_16x16x32_bf16 v[204:207], v[160:163], a[116:119], v[204:207]
    s_waitcnt lgkmcnt(7)
    ds_read_b64_tr_b16 v[86:87], v8 offset:25600
    v_add_u32 v8, s20, v8
    v_mfma_f32_16x16x32_bf16 v[208:211], v[40:43], a[112:115], v[208:211]
    s_barrier
    ds_read_b64_tr_b16 v[116:117], v3
    v_mfma_f32_16x16x32_bf16 v[208:211], v[72:75], a[120:123], v[208:211]
L_hop14:
    s_cbranch_execz L_hop_ret1
    ds_read_b64_tr_b16 v[118:119], v3 offset:1024
    buffer_load_dwordx4 a[44:47], v17, s[32:35], s73 offen offset:3072 sc1
    v_mfma_f32_16x16x32_bf16 v[212:215], v[72:75], a[124:127], v[212:215]
    s_mov_b32 m0, s88
    ds_read_b64_tr_b16 v[148:149], v3 offset:8192
    v_mfma_f32_16x16x32_bf16 v[212:215], v[40:43], a[116:119], v[212:215]
    s_waitcnt lgkmcnt(7)
    ds_read_b64_tr_b16 v[150:151], v3 offset:9216
    v_mfma_f32_16x16x32_bf16 v[216:219], v[104:107], a[112:115], v[216:219]
    ds_read_b64_tr_b16 v[160:161], v4
    buffer_load_dwordx4 v18, s[44:47], s89 offen lds
    v_mfma_f32_16x16x32_bf16 v[216:219], v[136:139], a[120:123], v[216:219]
    ds_read_b64_tr_b16 v[162:163], v4 offset:1024
    v_mfma_f32_16x16x32_bf16 v[220:223], v[136:139], a[124:127], v[220:223]
    ds_read_b64_tr_b16 v[164:165], v4 offset:8192
    buffer_load_dwordx4 v19, s[44:47], s89 offen offset:1024 lds
    v_mfma_f32_16x16x32_bf16 v[220:223], v[104:107], a[116:119], v[220:223]
    s_waitcnt lgkmcnt(7)
    ds_read_b64_tr_b16 v[166:167], v4 offset:9216
    v_mfma_f32_16x16x32_bf16 v[224:227], v[52:55], a[112:115], v[224:227]
    ds_read_b64_tr_b16 v[40:41], v5
    v_mfma_f32_16x16x32_bf16 v[224:227], v[84:87], a[120:123], v[224:227]
    ds_read_b64_tr_b16 v[42:43], v5 offset:1024
    v_mfma_f32_16x16x32_bf16 v[228:231], v[84:87], a[124:127], v[228:231]
    s_waitcnt vmcnt(22)
    ds_read_b64_tr_b16 v[72:73], v5 offset:8192
    v_mfma_f32_16x16x32_bf16 v[228:231], v[52:55], a[116:119], v[228:231]
    s_waitcnt lgkmcnt(7)
    ds_read_b64_tr_b16 v[74:75], v5 offset:9216
    v_mfma_f32_16x16x32_bf16 v[184:187], v[116:119], a[0:3], v[184:187]
    ds_read_b64_tr_b16 v[104:105], v6
    buffer_load_dwordx4 v20, s[44:47], s89 offen offset:2048 lds
    v_mfma_f32_16x16x32_bf16 v[184:187], v[148:151], a[8:11], v[184:187]
    s_add_u32 s69, s87, 32768
    ds_read_b64_tr_b16 v[106:107], v6 offset:1024
    v_mfma_f32_16x16x32_bf16 v[188:191], v[148:151], a[12:15], v[188:191]
    ds_read_b64_tr_b16 v[136:137], v6 offset:8192
    buffer_load_dwordx4 v21, s[44:47], s89 offen offset:3072 lds
    v_mfma_f32_16x16x32_bf16 v[188:191], v[116:119], a[4:7], v[188:191]
    s_waitcnt lgkmcnt(7)
    ds_read_b64_tr_b16 v[138:139], v6 offset:9216
    v_mfma_f32_16x16x32_bf16 v[192:195], v[160:163], a[0:3], v[192:195]
    s_add_u32 m0, s88, 4096
    ds_read_b64_tr_b16 v[52:53], v7
    v_mfma_f32_16x16x32_bf16 v[192:195], v[164:167], a[8:11], v[192:195]
    ds_read_b64_tr_b16 v[54:55], v7 offset:1024
    buffer_load_dwordx4 v18, s[44:47], s90 offen lds
    v_mfma_f32_16x16x32_bf16 v[196:199], v[164:167], a[12:15], v[196:199]
    s_sub_u32 s21, s69, 163840
    ds_read_b64_tr_b16 v[84:85], v7 offset:8192
    v_mfma_f32_16x16x32_bf16 v[196:199], v[160:163], a[4:7], v[196:199]
    s_waitcnt lgkmcnt(7)
    ds_read_b64_tr_b16 v[86:87], v7 offset:9216
    v_mfma_f32_16x16x32_bf16 v[200:203], v[40:43], a[0:3], v[200:203]
    s_min_u32 s69, s69, s21
    ds_read_b64_tr_b16 v[116:117], v8
    v_mfma_f32_16x16x32_bf16 v[200:203], v[72:75], a[8:11], v[200:203]
    ds_read_b64_tr_b16 v[118:119], v8 offset:1024
    buffer_load_dwordx4 v19, s[44:47], s90 offen offset:1024 lds
    v_mfma_f32_16x16x32_bf16 v[204:207], v[72:75], a[12:15], v[204:207]
    s_sub_u32 s21, s69, s87
    ds_read_b64_tr_b16 v[148:149], v8 offset:8192
    v_mfma_f32_16x16x32_bf16 v[204:207], v[40:43], a[4:7], v[204:207]
    s_waitcnt lgkmcnt(7)
    ds_read_b64_tr_b16 v[150:151], v8 offset:9216
    v_mfma_f32_16x16x32_bf16 v[208:211], v[104:107], a[0:3], v[208:211]
    s_mov_b32 s87, s69
    ds_read_b64_tr_b16 v[160:161], v3 offset:16384
    v_mfma_f32_16x16x32_bf16 v[208:211], v[136:139], a[8:11], v[208:211]
    ds_read_b64_tr_b16 v[162:163], v3 offset:17408
    buffer_load_dwordx4 v20, s[44:47], s90 offen offset:2048 lds
    v_mfma_f32_16x16x32_bf16 v[212:215], v[136:139], a[12:15], v[212:215]
    s_xor_b32 s6, s68, 6
    ds_read_b64_tr_b16 v[164:165], v3 offset:24576
    v_mfma_f32_16x16x32_bf16 v[212:215], v[104:107], a[4:7], v[212:215]
    s_waitcnt lgkmcnt(7)
    ds_read_b64_tr_b16 v[166:167], v3 offset:25600
    v_add_u32 v3, s21, v3
    v_mfma_f32_16x16x32_bf16 v[216:219], v[52:55], a[0:3], v[216:219]
    s_lshl_b32 s6, s6, 12
    ds_read_b64_tr_b16 v[40:41], v4 offset:16384
    v_mfma_f32_16x16x32_bf16 v[216:219], v[84:87], a[8:11], v[216:219]
    ds_read_b64_tr_b16 v[42:43], v4 offset:17408
    buffer_load_dwordx4 v21, s[44:47], s90 offen offset:3072 lds
    v_mfma_f32_16x16x32_bf16 v[220:223], v[84:87], a[12:15], v[220:223]
    s_add_u32 s6, s6, 14336
    ds_read_b64_tr_b16 v[72:73], v4 offset:24576
    v_mfma_f32_16x16x32_bf16 v[220:223], v[52:55], a[4:7], v[220:223]
    s_waitcnt lgkmcnt(7)
    ds_read_b64_tr_b16 v[74:75], v4 offset:25600
    v_add_u32 v4, s21, v4
    v_mfma_f32_16x16x32_bf16 v[224:227], v[116:119], a[0:3], v[224:227]
    s_add_u32 s72, s94, s6
    ds_read_b64_tr_b16 v[104:105], v5 offset:16384
    v_mfma_f32_16x16x32_bf16 v[224:227], v[148:151], a[8:11], v[224:227]
    ds_read_b64_tr_b16 v[106:107], v5 offset:17408
    buffer_load_dwordx4 a[48:51], v17, s[32:35], s72 offen sc1
    v_mfma_f32_16x16x32_bf16 v[228:231], v[148:151], a[12:15], v[228:231]
    s_waitcnt vmcnt(25)
    ds_read_b64_tr_b16 v[136:137], v5 offset:24576
    v_mfma_f32_16x16x32_bf16 v[228:231], v[116:119], a[4:7], v[228:231]
    s_waitcnt lgkmcnt(7)
    s_add_u32 s73, s95, s6
    ds_read_b64_tr_b16 v[138:139], v5 offset:25600
    v_add_u32 v5, s21, v5
    v_mfma_f32_16x16x32_bf16 v[184:187], v[160:163], a[16:19], v[184:187]
    ds_read_b64_tr_b16 v[52:53], v6 offset:16384
    buffer_load_dwordx4 a[52:55], v17, s[32:35], s73 offen sc1
    v_mfma_f32_16x16x32_bf16 v[184:187], v[164:167], a[24:27], v[184:187]
    ds_read_b64_tr_b16 v[54:55], v6 offset:17408
    v_mfma_f32_16x16x32_bf16 v[188:191], v[164:167], a[28:31], v[188:191]
    ds_read_b64_tr_b16 v[84:85], v6 offset:24576
    v_mfma_f32_16x16x32_bf16 v[188:191], v[160:163], a[20:23], v[188:191]
    s_waitcnt lgkmcnt(7)
    ds_read_b64_tr_b16 v[86:87], v6 offset:25600
    v_add_u32 v6, s21, v6
    v_mfma_f32_16x16x32_bf16 v[192:195], v[40:43], a[16:19], v[192:195]
    ds_read_b64_tr_b16 v[116:117], v7 offset:16384
    buffer_load_dwordx4 a[56:59], v17, s[32:35], s72 offen offset:1024 sc1
    v_mfma_f32_16x16x32_bf16 v[192:195], v[72:75], a[24:27], v[192:195]
    ds_read_b64_tr_b16 v[118:119], v7 offset:17408
    v_mfma_f32_16x16x32_bf16 v[196:199], v[72:75], a[28:31], v[196:199]
    ds_read_b64_tr_b16 v[148:149], v7 offset:24576
    v_mfma_f32_16x16x32_bf16 v[196:199], v[40:43], a[20:23], v[196:199]
    s_waitcnt lgkmcnt(7)
    ds_read_b64_tr_b16 v[150:151], v7 offset:25600
    v_add_u32 v7, s21, v7
    v_mfma_f32_16x16x32_bf16 v[200:203], v[104:107], a[16:19], v[200:203]
    ds_read_b64_tr_b16 v[160:161], v8 offset:16384
    buffer_load_dwordx4 a[60:63], v17, s[32:35], s73 offen offset:1024 sc1
    v_mfma_f32_16x16x32_bf16 v[200:203], v[136:139], a[24:27], v[200:203]
    s_add_u32 s88, s88, 32768
    ds_read_b64_tr_b16 v[162:163], v8 offset:17408
    v_mfma_f32_16x16x32_bf16 v[204:207], v[136:139], a[28:31], v[204:207]
    s_waitcnt vmcnt(20)
    ds_read_b64_tr_b16 v[164:165], v8 offset:24576
    v_mfma_f32_16x16x32_bf16 v[204:207], v[104:107], a[20:23], v[204:207]
    s_waitcnt lgkmcnt(7)
    ds_read_b64_tr_b16 v[166:167], v8 offset:25600
    v_add_u32 v8, s21, v8
    v_mfma_f32_16x16x32_bf16 v[208:211], v[52:55], a[16:19], v[208:211]
    s_barrier
    ds_read_b64_tr_b16 v[40:41], v3
    v_mfma_f32_16x16x32_bf16 v[208:211], v[84:87], a[24:27], v[208:211]
    ds_read_b64_tr_b16 v[42:43], v3 offset:1024
    buffer_load_dwordx4 a[64:67], v17, s[32:35], s72 offen offset:2048 sc1
    v_mfma_f32_16x16x32_bf16 v[212:215], v[84:87], a[28:31], v[212:215]
    s_sub_u32 s92, s88, 163840
    ds_read_b64_tr_b16 v[72:73], v3 offset:8192
    v_mfma_f32_16x16x32_bf16 v[212:215], v[52:55], a[20:23], v[212:215]
    s_waitcnt lgkmcnt(7)
    ds_read_b64_tr_b16 v[74:75], v3 offset:9216
    v_mfma_f32_16x16x32_bf16 v[216:219], v[116:119], a[16:19], v[216:219]
    ds_read_b64_tr_b16 v[104:105], v4
    buffer_load_dwordx4 a[68:71], v17, s[32:35], s73 offen offset:2048 sc1
    v_mfma_f32_16x16x32_bf16 v[216:219], v[148:151], a[24:27], v[216:219]
    s_min_u32 s88, s88, s92
    ds_read_b64_tr_b16 v[106:107], v4 offset:1024
    v_mfma_f32_16x16x32_bf16 v[220:223], v[148:151], a[28:31], v[220:223]
    s_xor_b32 s89, s68, 7
    ds_read_b64_tr_b16 v[136:137], v4 offset:8192
    v_mfma_f32_16x16x32_bf16 v[220:223], v[116:119], a[20:23], v[220:223]
    s_waitcnt lgkmcnt(7)
    ds_read_b64_tr_b16 v[138:139], v4 offset:9216
    v_mfma_f32_16x16x32_bf16 v[224:227], v[160:163], a[16:19], v[224:227]
    ds_read_b64_tr_b16 v[52:53], v5
    buffer_load_dwordx4 a[72:75], v17, s[32:35], s72 offen offset:3072 sc1
    v_mfma_f32_16x16x32_bf16 v[224:227], v[164:167], a[24:27], v[224:227]
    s_lshl_b32 s89, s89, 17
    ds_read_b64_tr_b16 v[54:55], v5 offset:1024
    v_mfma_f32_16x16x32_bf16 v[228:231], v[164:167], a[28:31], v[228:231]
    s_waitcnt vmcnt(19)
    ds_read_b64_tr_b16 v[84:85], v5 offset:8192
    v_mfma_f32_16x16x32_bf16 v[228:231], v[160:163], a[20:23], v[228:231]
    s_waitcnt lgkmcnt(7)
    ds_read_b64_tr_b16 v[86:87], v5 offset:9216
    v_mfma_f32_16x16x32_bf16 v[184:187], v[40:43], a[176:179], v[184:187]
    ds_read_b64_tr_b16 v[116:117], v6
    buffer_load_dwordx4 a[76:79], v17, s[32:35], s73 offen offset:3072 sc1
    v_mfma_f32_16x16x32_bf16 v[184:187], v[72:75], a[184:187], v[184:187]
    s_add_u32 s90, s89, 8192
    ds_read_b64_tr_b16 v[118:119], v6 offset:1024
    v_mfma_f32_16x16x32_bf16 v[188:191], v[72:75], a[188:191], v[188:191]
    s_mov_b32 m0, s88
    ds_read_b64_tr_b16 v[148:149], v6 offset:8192
    v_mfma_f32_16x16x32_bf16 v[188:191], v[40:43], a[180:183], v[188:191]
    s_waitcnt lgkmcnt(7)
    ds_read_b64_tr_b16 v[150:151], v6 offset:9216
    v_mfma_f32_16x16x32_bf16 v[192:195], v[104:107], a[176:179], v[192:195]
    ds_read_b64_tr_b16 v[160:161], v7
    buffer_load_dwordx4 v18, s[44:47], s89 offen lds
    v_mfma_f32_16x16x32_bf16 v[192:195], v[136:139], a[184:187], v[192:195]
    s_add_u32 s69, s87, 32768
    ds_read_b64_tr_b16 v[162:163], v7 offset:1024
    v_mfma_f32_16x16x32_bf16 v[196:199], v[136:139], a[188:191], v[196:199]
    s_sub_u32 s22, s69, 163840
    ds_read_b64_tr_b16 v[164:165], v7 offset:8192
    v_mfma_f32_16x16x32_bf16 v[196:199], v[104:107], a[180:183], v[196:199]
    s_waitcnt lgkmcnt(7)
    ds_read_b64_tr_b16 v[166:167], v7 offset:9216
    v_mfma_f32_16x16x32_bf16 v[200:203], v[52:55], a[176:179], v[200:203]
    ds_read_b64_tr_b16 v[40:41], v8
    buffer_load_dwordx4 v19, s[44:47], s89 offen offset:1024 lds
    v_mfma_f32_16x16x32_bf16 v[200:203], v[84:87], a[184:187], v[200:203]
    s_min_u32 s69, s69, s22
    ds_read_b64_tr_b16 v[42:43], v8 offset:1024
    v_mfma_f32_16x16x32_bf16 v[204:207], v[84:87], a[188:191], v[204:207]
    s_sub_u32 s22, s69, s87
    ds_read_b64_tr_b16 v[72:73], v8 offset:8192
    v_mfma_f32_16x16x32_bf16 v[204:207], v[52:55], a[180:183], v[204:207]
    s_waitcnt lgkmcnt(7)
    ds_read_b64_tr_b16 v[74:75], v8 offset:9216
    v_mfma_f32_16x16x32_bf16 v[208:211], v[116:119], a[176:179], v[208:211]
    ds_read_b64_tr_b16 v[104:105], v3 offset:16384
    buffer_load_dwordx4 v20, s[44:47], s89 offen offset:2048 lds
    v_mfma_f32_16x16x32_bf16 v[208:211], v[148:151], a[184:187], v[208:211]
    s_mov_b32 s87, s69
    ds_read_b64_tr_b16 v[106:107], v3 offset:17408
    v_mfma_f32_16x16x32_bf16 v[212:215], v[148:151], a[188:191], v[212:215]
    ds_read_b64_tr_b16 v[136:137], v3 offset:24576
    buffer_load_dwordx4 v21, s[44:47], s89 offen offset:3072 lds
    v_mfma_f32_16x16x32_bf16 v[212:215], v[116:119], a[180:183], v[212:215]
    s_waitcnt lgkmcnt(7)
    ds_read_b64_tr_b16 v[138:139], v3 offset:25600
    v_add_u32 v3, s22, v3
    v_mfma_f32_16x16x32_bf16 v[216:219], v[160:163], a[176:179], v[216:219]
    ds_read_b64_tr_b16 v[52:53], v4 offset:16384
    buffer_load_dword v38, v36, s[60:63], s17 offen sc1
    v_mfma_f32_16x16x32_bf16 v[216:219], v[164:167], a[184:187], v[216:219]
    s_add_u32 m0, s88, 4096
    ds_read_b64_tr_b16 v[54:55], v4 offset:17408
    v_mfma_f32_16x16x32_bf16 v[220:223], v[164:167], a[188:191], v[220:223]
    ds_read_b64_tr_b16 v[84:85], v4 offset:24576
    buffer_load_dwordx4 v18, s[44:47], s90 offen lds
    v_mfma_f32_16x16x32_bf16 v[220:223], v[160:163], a[180:183], v[220:223]
    s_waitcnt lgkmcnt(7)
    ds_read_b64_tr_b16 v[86:87], v4 offset:25600
    v_add_u32 v4, s22, v4
    v_mfma_f32_16x16x32_bf16 v[224:227], v[40:43], a[176:179], v[224:227]
    ds_read_b64_tr_b16 v[116:117], v5 offset:16384
    v_mfma_f32_16x16x32_bf16 v[224:227], v[72:75], a[184:187], v[224:227]
    ds_read_b64_tr_b16 v[118:119], v5 offset:17408
    v_mfma_f32_16x16x32_bf16 v[228:231], v[72:75], a[188:191], v[228:231]
    s_waitcnt vmcnt(22)
    ds_read_b64_tr_b16 v[148:149], v5 offset:24576
    v_mfma_f32_16x16x32_bf16 v[228:231], v[40:43], a[180:183], v[228:231]
    s_waitcnt lgkmcnt(7)
    ds_read_b64_tr_b16 v[150:151], v5 offset:25600
    v_add_u32 v5, s22, v5
    v_mfma_f32_16x16x32_bf16 v[184:187], v[104:107], a[32:35], v[184:187]
    ds_read_b64_tr_b16 v[160:161], v6 offset:16384
    buffer_load_dwordx4 v19, s[44:47], s90 offen offset:1024 lds
    v_mfma_f32_16x16x32_bf16 v[184:187], v[136:139], a[40:43], v[184:187]
    s_xor_b32 s6, s68, 7
    ds_read_b64_tr_b16 v[162:163], v6 offset:17408
    v_mfma_f32_16x16x32_bf16 v[188:191], v[136:139], a[44:47], v[188:191]
    ds_read_b64_tr_b16 v[164:165], v6 offset:24576
    buffer_load_dwordx4 v20, s[44:47], s90 offen offset:2048 lds
    v_mfma_f32_16x16x32_bf16 v[188:191], v[104:107], a[36:39], v[188:191]
    s_waitcnt lgkmcnt(7)
    ds_read_b64_tr_b16 v[166:167], v6 offset:25600
    v_add_u32 v6, s22, v6
    v_mfma_f32_16x16x32_bf16 v[192:195], v[52:55], a[32:35], v[192:195]
    s_lshl_b32 s6, s6, 12
    ds_read_b64_tr_b16 v[40:41], v7 offset:16384
    v_mfma_f32_16x16x32_bf16 v[192:195], v[84:87], a[40:43], v[192:195]
    s_add_u32 s6, s6, 14336
    ds_read_b64_tr_b16 v[42:43], v7 offset:17408
    v_mfma_f32_16x16x32_bf16 v[196:199], v[84:87], a[44:47], v[196:199]
    ds_read_b64_tr_b16 v[72:73], v7 offset:24576
    buffer_load_dwordx4 v21, s[44:47], s90 offen offset:3072 lds
    v_mfma_f32_16x16x32_bf16 v[196:199], v[52:55], a[36:39], v[196:199]
    s_waitcnt lgkmcnt(7)
    ds_read_b64_tr_b16 v[74:75], v7 offset:25600
    v_add_u32 v7, s22, v7
    v_mfma_f32_16x16x32_bf16 v[200:203], v[116:119], a[32:35], v[200:203]
    s_add_u32 s72, s94, s6
    ds_read_b64_tr_b16 v[104:105], v8 offset:16384
    v_mfma_f32_16x16x32_bf16 v[200:203], v[148:151], a[40:43], v[200:203]
    ds_read_b64_tr_b16 v[106:107], v8 offset:17408
    buffer_load_dwordx4 a[80:83], v17, s[32:35], s72 offen sc1
    v_mfma_f32_16x16x32_bf16 v[204:207], v[148:151], a[44:47], v[204:207]
    s_waitcnt vmcnt(18)
    ds_read_b64_tr_b16 v[136:137], v8 offset:24576
    v_mfma_f32_16x16x32_bf16 v[204:207], v[116:119], a[36:39], v[204:207]
    s_waitcnt lgkmcnt(7)
    ds_read_b64_tr_b16 v[138:139], v8 offset:25600
    v_add_u32 v8, s22, v8
    v_mfma_f32_16x16x32_bf16 v[208:211], v[160:163], a[32:35], v[208:211]
    s_barrier
    s_add_u32 s73, s95, s6
    ds_read_b64_tr_b16 v[52:53], v3
    v_mfma_f32_16x16x32_bf16 v[208:211], v[164:167], a[40:43], v[208:211]
    ds_read_b64_tr_b16 v[54:55], v3 offset:1024
    buffer_load_dwordx4 a[84:87], v17, s[32:35], s73 offen sc1
    v_mfma_f32_16x16x32_bf16 v[212:215], v[164:167], a[44:47], v[212:215]
    ds_read_b64_tr_b16 v[84:85], v3 offset:8192
    v_mfma_f32_16x16x32_bf16 v[212:215], v[160:163], a[36:39], v[212:215]
    s_waitcnt lgkmcnt(7)
    ds_read_b64_tr_b16 v[86:87], v3 offset:9216
    v_mfma_f32_16x16x32_bf16 v[216:219], v[40:43], a[32:35], v[216:219]
    ds_read_b64_tr_b16 v[116:117], v4
    v_mfma_f32_16x16x32_bf16 v[216:219], v[72:75], a[40:43], v[216:219]
    ds_read_b64_tr_b16 v[118:119], v4 offset:1024
    buffer_load_dwordx4 a[88:91], v17, s[32:35], s72 offen offset:1024 sc1
    v_mfma_f32_16x16x32_bf16 v[220:223], v[72:75], a[44:47], v[220:223]
    ds_read_b64_tr_b16 v[148:149], v4 offset:8192
    v_mfma_f32_16x16x32_bf16 v[220:223], v[40:43], a[36:39], v[220:223]
    s_waitcnt lgkmcnt(7)
    ds_read_b64_tr_b16 v[150:151], v4 offset:9216
    v_mfma_f32_16x16x32_bf16 v[224:227], v[104:107], a[32:35], v[224:227]
    ds_read_b64_tr_b16 v[160:161], v5
    v_mfma_f32_16x16x32_bf16 v[224:227], v[136:139], a[40:43], v[224:227]
    ds_read_b64_tr_b16 v[162:163], v5 offset:1024
    buffer_load_dwordx4 a[92:95], v17, s[32:35], s73 offen offset:1024 sc1
    v_mfma_f32_16x16x32_bf16 v[228:231], v[136:139], a[44:47], v[228:231]
    s_waitcnt vmcnt(17)
    ds_read_b64_tr_b16 v[164:165], v5 offset:8192
    v_mfma_f32_16x16x32_bf16 v[228:231], v[104:107], a[36:39], v[228:231]
    s_waitcnt lgkmcnt(7)
    ds_read_b64_tr_b16 v[166:167], v5 offset:9216
    v_mfma_f32_16x16x32_bf16 v[184:187], v[52:55], a[48:51], v[184:187]
    ds_read_b64_tr_b16 v[40:41], v6
    v_mfma_f32_16x16x32_bf16 v[184:187], v[84:87], a[56:59], v[184:187]
    ds_read_b64_tr_b16 v[42:43], v6 offset:1024
    buffer_load_dwordx4 a[128:131], v17, s[32:35], s72 offen offset:2048 sc1
    v_mfma_f32_16x16x32_bf16 v[188:191], v[84:87], a[60:63], v[188:191]
    ds_read_b64_tr_b16 v[72:73], v6 offset:8192
    v_mfma_f32_16x16x32_bf16 v[188:191], v[52:55], a[52:55], v[188:191]
    s_waitcnt lgkmcnt(7)
    ds_read_b64_tr_b16 v[74:75], v6 offset:9216
    v_mfma_f32_16x16x32_bf16 v[192:195], v[116:119], a[48:51], v[192:195]
    ds_read_b64_tr_b16 v[104:105], v7
    buffer_load_dwordx4 a[132:135], v17, s[32:35], s73 offen offset:2048 sc1
    v_mfma_f32_16x16x32_bf16 v[192:195], v[148:151], a[56:59], v[192:195]
    s_add_u32 s69, s87, 32768
    ds_read_b64_tr_b16 v[106:107], v7 offset:1024
    v_mfma_f32_16x16x32_bf16 v[196:199], v[148:151], a[60:63], v[196:199]
    s_sub_u32 s23, s69, 163840
    ds_read_b64_tr_b16 v[136:137], v7 offset:8192
    v_mfma_f32_16x16x32_bf16 v[196:199], v[116:119], a[52:55], v[196:199]
    s_waitcnt lgkmcnt(7)
    ds_read_b64_tr_b16 v[138:139], v7 offset:9216
    v_mfma_f32_16x16x32_bf16 v[200:203], v[160:163], a[48:51], v[200:203]
    ds_read_b64_tr_b16 v[52:53], v8
    buffer_load_dwordx4 a[136:139], v17, s[32:35], s72 offen offset:3072 sc1
    v_mfma_f32_16x16x32_bf16 v[200:203], v[164:167], a[56:59], v[200:203]
    s_min_u32 s69, s69, s23
    ds_read_b64_tr_b16 v[54:55], v8 offset:1024
    v_mfma_f32_16x16x32_bf16 v[204:207], v[164:167], a[60:63], v[204:207]
    s_sub_u32 s23, s69, s87
    ds_read_b64_tr_b16 v[84:85], v8 offset:8192
    v_mfma_f32_16x16x32_bf16 v[204:207], v[160:163], a[52:55], v[204:207]
    s_waitcnt lgkmcnt(7)
    ds_read_b64_tr_b16 v[86:87], v8 offset:9216
    v_mfma_f32_16x16x32_bf16 v[208:211], v[40:43], a[48:51], v[208:211]
    ds_read_b64_tr_b16 v[116:117], v3 offset:16384
    buffer_load_dwordx4 a[140:143], v17, s[32:35], s73 offen offset:3072 sc1
    v_mfma_f32_16x16x32_bf16 v[208:211], v[72:75], a[56:59], v[208:211]
    s_mov_b32 s87, s69
    ds_read_b64_tr_b16 v[118:119], v3 offset:17408
    v_mfma_f32_16x16x32_bf16 v[212:215], v[72:75], a[60:63], v[212:215]
    ds_read_b64_tr_b16 v[148:149], v3 offset:24576
    v_mfma_f32_16x16x32_bf16 v[212:215], v[40:43], a[52:55], v[212:215]
    s_waitcnt lgkmcnt(7)
    ds_read_b64_tr_b16 v[150:151], v3 offset:25600
    v_add_u32 v3, s23, v3
    v_mfma_f32_16x16x32_bf16 v[216:219], v[104:107], a[48:51], v[216:219]
    s_waitcnt vmcnt(12)
    ds_read_b64_tr_b16 v[160:161], v4 offset:16384
    v_cmp_eq_u32 vcc, 0, v38
    v_mfma_f32_16x16x32_bf16 v[216:219], v[136:139], a[56:59], v[216:219]
    ds_read_b64_tr_b16 v[162:163], v4 offset:17408
    v_mfma_f32_16x16x32_bf16 v[220:223], v[136:139], a[60:63], v[220:223]
    s_cbranch_vccnz L_spin_clr
L_spin_clr_ret:
    ds_read_b64_tr_b16 v[164:165], v4 offset:24576
    v_mfma_f32_16x16x32_bf16 v[220:223], v[104:107], a[52:55], v[220:223]
    s_waitcnt lgkmcnt(7)
    ds_read_b64_tr_b16 v[166:167], v4 offset:25600
    v_add_u32 v4, s23, v4
    v_mfma_f32_16x16x32_bf16 v[224:227], v[52:55], a[48:51], v[224:227]
    ds_read_b64_tr_b16 v[40:41], v5 offset:16384
    v_mfma_f32_16x16x32_bf16 v[224:227], v[84:87], a[56:59], v[224:227]
    ds_read_b64_tr_b16 v[42:43], v5 offset:17408
    v_mfma_f32_16x16x32_bf16 v[228:231], v[84:87], a[60:63], v[228:231]
    ds_read_b64_tr_b16 v[72:73], v5 offset:24576
    v_mfma_f32_16x16x32_bf16 v[228:231], v[52:55], a[52:55], v[228:231]
    s_waitcnt lgkmcnt(7)
    ds_read_b64_tr_b16 v[74:75], v5 offset:25600
    v_add_u32 v5, s23, v5
    v_mfma_f32_16x16x32_bf16 v[184:187], v[116:119], a[64:67], v[184:187]
    ds_read_b64_tr_b16 v[104:105], v6 offset:16384
    v_mfma_f32_16x16x32_bf16 v[184:187], v[148:151], a[72:75], v[184:187]
    ds_read_b64_tr_b16 v[106:107], v6 offset:17408
    v_mfma_f32_16x16x32_bf16 v[188:191], v[148:151], a[76:79], v[188:191]
    ds_read_b64_tr_b16 v[136:137], v6 offset:24576
    v_mfma_f32_16x16x32_bf16 v[188:191], v[116:119], a[68:71], v[188:191]
    s_waitcnt lgkmcnt(7)
    ds_read_b64_tr_b16 v[138:139], v6 offset:25600
    v_add_u32 v6, s23, v6
    v_mfma_f32_16x16x32_bf16 v[192:195], v[160:163], a[64:67], v[192:195]
    ds_read_b64_tr_b16 v[52:53], v7 offset:16384
    v_mfma_f32_16x16x32_bf16 v[192:195], v[164:167], a[72:75], v[192:195]
    ds_read_b64_tr_b16 v[54:55], v7 offset:17408
    v_mfma_f32_16x16x32_bf16 v[196:199], v[164:167], a[76:79], v[196:199]
    ds_read_b64_tr_b16 v[84:85], v7 offset:24576
    v_mfma_f32_16x16x32_bf16 v[196:199], v[160:163], a[68:71], v[196:199]
    s_waitcnt lgkmcnt(7)
    ds_read_b64_tr_b16 v[86:87], v7 offset:25600
    v_add_u32 v7, s23, v7
    v_mfma_f32_16x16x32_bf16 v[200:203], v[40:43], a[64:67], v[200:203]
    ds_read_b64_tr_b16 v[116:117], v8 offset:16384
    v_mfma_f32_16x16x32_bf16 v[200:203], v[72:75], a[72:75], v[200:203]
    ds_read_b64_tr_b16 v[118:119], v8 offset:17408
    v_mfma_f32_16x16x32_bf16 v[204:207], v[72:75], a[76:79], v[204:207]
    s_waitcnt vmcnt(8)
    ds_read_b64_tr_b16 v[148:149], v8 offset:24576
    v_mfma_f32_16x16x32_bf16 v[204:207], v[40:43], a[68:71], v[204:207]
    s_waitcnt lgkmcnt(7)
    ds_read_b64_tr_b16 v[150:151], v8 offset:25600
    v_add_u32 v8, s23, v8
    v_mfma_f32_16x16x32_bf16 v[208:211], v[104:107], a[64:67], v[208:211]
    s_barrier
    ds_read_b64_tr_b16 v[160:161], v3
    v_mfma_f32_16x16x32_bf16 v[208:211], v[136:139], a[72:75], v[208:211]
    ds_read_b64_tr_b16 v[162:163], v3 offset:1024
    v_mfma_f32_16x16x32_bf16 v[212:215], v[136:139], a[76:79], v[212:215]
    ds_read_b64_tr_b16 v[164:165], v3 offset:8192
    v_mfma_f32_16x16x32_bf16 v[212:215], v[104:107], a[68:71], v[212:215]
    s_waitcnt lgkmcnt(7)
    ds_read_b64_tr_b16 v[166:167], v3 offset:9216
    v_mfma_f32_16x16x32_bf16 v[216:219], v[52:55], a[64:67], v[216:219]
    ds_read_b64_tr_b16 v[40:41], v3 offset:16384
    v_mfma_f32_16x16x32_bf16 v[216:219], v[84:87], a[72:75], v[216:219]
    ds_read_b64_tr_b16 v[42:43], v3 offset:17408
    v_mfma_f32_16x16x32_bf16 v[220:223], v[84:87], a[76:79], v[220:223]
    ds_read_b64_tr_b16 v[72:73], v3 offset:24576
    v_mfma_f32_16x16x32_bf16 v[220:223], v[52:55], a[68:71], v[220:223]
    s_waitcnt lgkmcnt(7)
    ds_read_b64_tr_b16 v[74:75], v3 offset:25600
    v_mfma_f32_16x16x32_bf16 v[224:227], v[116:119], a[64:67], v[224:227]
    ds_read_b64_tr_b16 v[104:105], v4
    v_mfma_f32_16x16x32_bf16 v[224:227], v[148:151], a[72:75], v[224:227]
    ds_read_b64_tr_b16 v[106:107], v4 offset:1024
    v_mfma_f32_16x16x32_bf16 v[228:231], v[148:151], a[76:79], v[228:231]
    s_waitcnt vmcnt(4)
    ds_read_b64_tr_b16 v[136:137], v4 offset:8192
    v_bfe_u32 v32, v17, 4, 4
    v_mfma_f32_16x16x32_bf16 v[228:231], v[116:119], a[68:71], v[228:231]
    s_waitcnt lgkmcnt(7)
    ds_read_b64_tr_b16 v[138:139], v4 offset:9216
    v_lshlrev_b32 v32, 10, v32
    v_mfma_f32_16x16x32_bf16 v[184:187], v[160:163], a[80:83], v[184:187]
    ds_read_b64_tr_b16 v[52:53], v4 offset:16384
    v_bfe_u32 v33, v17, 8, 1
    v_mfma_f32_16x16x32_bf16 v[184:187], v[164:167], a[88:91], v[184:187]
    ds_read_b64_tr_b16 v[54:55], v4 offset:17408
    v_lshl_add_u32 v32, v33, 5, v32
    v_mfma_f32_16x16x32_bf16 v[188:191], v[164:167], a[92:95], v[188:191]
    s_waitcnt vmcnt(0)
    ds_read_b64_tr_b16 v[84:85], v4 offset:24576
    v_bfe_u32 v33, v17, 9, 1
    v_mfma_f32_16x16x32_bf16 v[188:191], v[160:163], a[84:87], v[188:191]
    s_waitcnt lgkmcnt(7)
    ds_read_b64_tr_b16 v[86:87], v4 offset:25600
    v_lshl_add_u32 v32, v33, 4, v32
    v_mfma_f32_16x16x32_bf16 v[184:187], v[40:43], a[128:131], v[184:187]
    ds_read_b64_tr_b16 v[116:117], v5
    v_mfma_f32_16x16x32_bf16 v[184:187], v[72:75], a[136:139], v[184:187]
    ds_read_b64_tr_b16 v[118:119], v5 offset:1024
    v_mfma_f32_16x16x32_bf16 v[188:191], v[72:75], a[140:143], v[188:191]
    ds_read_b64_tr_b16 v[148:149], v5 offset:8192
    v_mfma_f32_16x16x32_bf16 v[188:191], v[40:43], a[132:135], v[188:191]
    s_waitcnt lgkmcnt(7)
    ds_read_b64_tr_b16 v[150:151], v5 offset:9216
    v_mfma_f32_16x16x32_bf16 v[192:195], v[104:107], a[80:83], v[192:195]
    ds_read_b64_tr_b16 v[160:161], v5 offset:16384
    v_mfma_f32_16x16x32_bf16 v[192:195], v[136:139], a[88:91], v[192:195]
    ds_read_b64_tr_b16 v[162:163], v5 offset:17408
    v_cvt_pk_bf16_f32 v184, v184, v185
    v_mfma_f32_16x16x32_bf16 v[196:199], v[136:139], a[92:95], v[196:199]
    ds_read_b64_tr_b16 v[164:165], v5 offset:24576
    v_cvt_pk_bf16_f32 v185, v186, v187
    v_mfma_f32_16x16x32_bf16 v[196:199], v[104:107], a[84:87], v[196:199]
    s_waitcnt lgkmcnt(7)
    ds_read_b64_tr_b16 v[166:167], v5 offset:25600
    v_min_u32 v184, -2, v184
    v_mfma_f32_16x16x32_bf16 v[192:195], v[52:55], a[128:131], v[192:195]
    ds_read_b64_tr_b16 v[40:41], v6
    v_min_u32 v185, -2, v185
    v_mfma_f32_16x16x32_bf16 v[192:195], v[84:87], a[136:139], v[192:195]
    ds_read_b64_tr_b16 v[42:43], v6 offset:1024
    v_cvt_pk_bf16_f32 v186, v188, v189
    v_mfma_f32_16x16x32_bf16 v[196:199], v[84:87], a[140:143], v[196:199]
    ds_read_b64_tr_b16 v[72:73], v6 offset:8192
    v_cvt_pk_bf16_f32 v187, v190, v191
    v_mfma_f32_16x16x32_bf16 v[196:199], v[52:55], a[132:135], v[196:199]
    s_waitcnt lgkmcnt(7)
    ds_read_b64_tr_b16 v[74:75], v6 offset:9216
    v_min_u32 v186, -2, v186
    v_mfma_f32_16x16x32_bf16 v[200:203], v[116:119], a[80:83], v[200:203]
    ds_read_b64_tr_b16 v[104:105], v6 offset:16384
    v_min_u32 v187, -2, v187
    v_mfma_f32_16x16x32_bf16 v[200:203], v[148:151], a[88:91], v[200:203]
    ds_read_b64_tr_b16 v[106:107], v6 offset:17408
    buffer_store_dwordx4 v[184:187], v17, s[52:55], s13 offen sc1
    v_mfma_f32_16x16x32_bf16 v[204:207], v[148:151], a[92:95], v[204:207]
    ds_read_b64_tr_b16 v[136:137], v6 offset:24576
    v_cvt_pk_bf16_f32 v192, v192, v193
    v_mfma_f32_16x16x32_bf16 v[204:207], v[116:119], a[84:87], v[204:207]
    s_waitcnt lgkmcnt(7)
    ds_read_b64_tr_b16 v[138:139], v6 offset:25600
    v_cvt_pk_bf16_f32 v193, v194, v195
    v_mfma_f32_16x16x32_bf16 v[200:203], v[160:163], a[128:131], v[200:203]
    ds_read_b64_tr_b16 v[52:53], v7
    v_min_u32 v192, -2, v192
    v_mfma_f32_16x16x32_bf16 v[200:203], v[164:167], a[136:139], v[200:203]
    ds_read_b64_tr_b16 v[54:55], v7 offset:1024
    v_min_u32 v193, -2, v193
    v_mfma_f32_16x16x32_bf16 v[204:207], v[164:167], a[140:143], v[204:207]
    ds_read_b64_tr_b16 v[84:85], v7 offset:8192
    v_cvt_pk_bf16_f32 v194, v196, v197
    v_mfma_f32_16x16x32_bf16 v[204:207], v[160:163], a[132:135], v[204:207]
    s_waitcnt lgkmcnt(7)
    ds_read_b64_tr_b16 v[86:87], v7 offset:9216
    v_cvt_pk_bf16_f32 v195, v198, v199
    v_mfma_f32_16x16x32_bf16 v[208:211], v[40:43], a[80:83], v[208:211]
    ds_read_b64_tr_b16 v[116:117], v7 offset:16384
    v_min_u32 v194, -2, v194
    v_mfma_f32_16x16x32_bf16 v[208:211], v[72:75], a[88:91], v[208:211]
    ds_read_b64_tr_b16 v[118:119], v7 offset:17408
    v_min_u32 v195, -2, v195
    v_mfma_f32_16x16x32_bf16 v[212:215], v[72:75], a[92:95], v[212:215]
    ds_read_b64_tr_b16 v[148:149], v7 offset:24576
    buffer_store_dwordx4 v[192:195], v17, s[52:55], s13 offen offset:1024 sc1
    v_mfma_f32_16x16x32_bf16 v[212:215], v[40:43], a[84:87], v[212:215]
    s_waitcnt lgkmcnt(7)
    ds_read_b64_tr_b16 v[150:151], v7 offset:25600
    v_cvt_pk_bf16_f32 v200, v200, v201
    v_mfma_f32_16x16x32_bf16 v[208:211], v[104:107], a[128:131], v[208:211]
    ds_read_b64_tr_b16 v[160:161], v8
    v_cvt_pk_bf16_f32 v201, v202, v203
    v_mfma_f32_16x16x32_bf16 v[208:211], v[136:139], a[136:139], v[208:211]
    ds_read_b64_tr_b16 v[162:163], v8 offset:1024
    v_min_u32 v200, -2, v200
    v_mfma_f32_16x16x32_bf16 v[212:215], v[136:139], a[140:143], v[212:215]
    ds_read_b64_tr_b16 v[164:165], v8 offset:8192
    v_min_u32 v201, -2, v201
    v_mfma_f32_16x16x32_bf16 v[212:215], v[104:107], a[132:135], v[212:215]
    s_waitcnt lgkmcnt(7)
    ds_read_b64_tr_b16 v[166:167], v8 offset:9216
    v_cvt_pk_bf16_f32 v202, v204, v205
    v_mfma_f32_16x16x32_bf16 v[216:219], v[52:55], a[80:83], v[216:219]
    ds_read_b64_tr_b16 v[40:41], v8 offset:16384
    v_cvt_pk_bf16_f32 v203, v206, v207
    v_mfma_f32_16x16x32_bf16 v[216:219], v[84:87], a[88:91], v[216:219]
    ds_read_b64_tr_b16 v[42:43], v8 offset:17408
    v_min_u32 v202, -2, v202
    v_mfma_f32_16x16x32_bf16 v[220:223], v[84:87], a[92:95], v[220:223]
    ds_read_b64_tr_b16 v[72:73], v8 offset:24576
    v_min_u32 v203, -2, v203
    v_mfma_f32_16x16x32_bf16 v[220:223], v[52:55], a[84:87], v[220:223]
    s_waitcnt lgkmcnt(7)
    ds_read_b64_tr_b16 v[74:75], v8 offset:25600
    v_cvt_pk_bf16_f32 v208, v208, v209
    v_mfma_f32_16x16x32_bf16 v[216:219], v[116:119], a[128:131], v[216:219]
    ds_read_b64_tr_b16 v[104:105], v1
    buffer_store_dwordx4 v[200:203], v17, s[52:55], s14 offen sc1
    v_mfma_f32_16x16x32_bf16 v[216:219], v[148:151], a[136:139], v[216:219]
L_hop15:
    s_cbranch_execz L_hop_ret1
    ds_read_b64_tr_b16 v[106:107], v1 offset:1024
    v_cvt_pk_bf16_f32 v209, v210, v211
    v_mfma_f32_16x16x32_bf16 v[220:223], v[148:151], a[140:143], v[220:223]
    ds_read_b64_tr_b16 v[136:137], v1 offset:8192
    v_min_u32 v208, -2, v208
    v_mfma_f32_16x16x32_bf16 v[220:223], v[116:119], a[132:135], v[220:223]
    s_waitcnt lgkmcnt(7)
    ds_read_b64_tr_b16 v[138:139], v1 offset:9216
    v_min_u32 v209, -2, v209
    v_mfma_f32_16x16x32_bf16 v[224:227], v[160:163], a[80:83], v[224:227]
    ds_read_b64_tr_b16 v[52:53], v2
    v_cvt_pk_bf16_f32 v210, v212, v213
    v_mfma_f32_16x16x32_bf16 v[224:227], v[164:167], a[88:91], v[224:227]
    ds_read_b64_tr_b16 v[54:55], v2 offset:1024
    v_cvt_pk_bf16_f32 v211, v214, v215
    v_mfma_f32_16x16x32_bf16 v[228:231], v[164:167], a[92:95], v[228:231]
    ds_read_b64_tr_b16 v[84:85], v2 offset:8192
    v_min_u32 v210, -2, v210
    v_mfma_f32_16x16x32_bf16 v[228:231], v[160:163], a[84:87], v[228:231]
    s_waitcnt lgkmcnt(7)
    ds_read_b64_tr_b16 v[86:87], v2 offset:9216
    v_min_u32 v211, -2, v211
    v_mfma_f32_16x16x32_bf16 v[224:227], v[40:43], a[128:131], v[224:227]
    ds_read_b64_tr_b16 v[116:117], v1 offset:16384
    buffer_store_dwordx4 v[208:211], v17, s[52:55], s14 offen offset:1024 sc1
    v_mfma_f32_16x16x32_bf16 v[224:227], v[72:75], a[136:139], v[224:227]
    ds_read_b64_tr_b16 v[118:119], v1 offset:17408
    v_cvt_pk_bf16_f32 v216, v216, v217
    v_cvt_pk_bf16_f32 v217, v218, v219
    v_mfma_f32_16x16x32_bf16 v[228:231], v[72:75], a[140:143], v[228:231]
    ds_read_b64_tr_b16 v[148:149], v1 offset:24576
    v_min_u32 v216, -2, v216
    v_min_u32 v217, -2, v217
    v_mfma_f32_16x16x32_bf16 v[228:231], v[40:43], a[132:135], v[228:231]
    s_waitcnt lgkmcnt(7)
    ds_read_b64_tr_b16 v[150:151], v1 offset:25600
    v_add_u32 v1, s20, v1
    v_cvt_pk_bf16_f32 v218, v220, v221
    v_mfma_f32_16x16x32_bf16 v[168:171], v[104:107], a[96:99], v[168:171]
    ds_read_b64_tr_b16 v[160:161], v2 offset:16384
    v_cvt_pk_bf16_f32 v219, v222, v223
    v_min_u32 v218, -2, v218
    v_mfma_f32_16x16x32_bf16 v[168:171], v[136:139], a[104:107], v[168:171]
    ds_read_b64_tr_b16 v[162:163], v2 offset:17408
    v_min_u32 v219, -2, v219
    v_mfma_f32_16x16x32_bf16 v[172:175], v[136:139], a[108:111], v[172:175]
    ds_read_b64_tr_b16 v[164:165], v2 offset:24576
    buffer_store_dwordx4 v[216:219], v17, s[52:55], s15 offen sc1
    v_mfma_f32_16x16x32_bf16 v[172:175], v[104:107], a[100:103], v[172:175]
    s_waitcnt lgkmcnt(7)
    ds_read_b64_tr_b16 v[166:167], v2 offset:25600
    v_add_u32 v2, s20, v2
    v_cvt_pk_bf16_f32 v224, v224, v225
    v_mfma_f32_16x16x32_bf16 v[176:179], v[52:55], a[96:99], v[176:179]
    ds_read_b64_tr_b16 v[40:41], v1
    v_cvt_pk_bf16_f32 v225, v226, v227
    v_min_u32 v224, -2, v224
    v_mfma_f32_16x16x32_bf16 v[176:179], v[84:87], a[104:107], v[176:179]
    ds_read_b64_tr_b16 v[42:43], v1 offset:1024
    v_min_u32 v225, -2, v225
    v_cvt_pk_bf16_f32 v226, v228, v229
    v_mfma_f32_16x16x32_bf16 v[180:183], v[84:87], a[108:111], v[180:183]
    ds_read_b64_tr_b16 v[72:73], v1 offset:8192
    v_cvt_pk_bf16_f32 v227, v230, v231
    v_min_u32 v226, -2, v226
    v_mfma_f32_16x16x32_bf16 v[180:183], v[52:55], a[100:103], v[180:183]
    s_waitcnt lgkmcnt(7)
    ds_read_b64_tr_b16 v[74:75], v1 offset:9216
    v_min_u32 v227, -2, v227
    v_mfma_f32_16x16x32_bf16 v[168:171], v[116:119], a[112:115], v[168:171]
    ds_read_b64_tr_b16 v[104:105], v2
    buffer_store_dwordx4 v[224:227], v17, s[52:55], s15 offen offset:1024 sc1
    v_mfma_f32_16x16x32_bf16 v[168:171], v[148:151], a[120:123], v[168:171]
    ds_read_b64_tr_b16 v[106:107], v2 offset:1024
    v_mov_b32 v156, 0x3f80
    v_mfma_f32_16x16x32_bf16 v[172:175], v[148:151], a[124:127], v[172:175]
    ds_read_b64_tr_b16 v[136:137], v2 offset:8192
    v_mov_b32 v157, 0x3f800000
    v_mfma_f32_16x16x32_bf16 v[172:175], v[116:119], a[116:119], v[172:175]
    s_waitcnt lgkmcnt(7)
    ds_read_b64_tr_b16 v[138:139], v2 offset:9216
    v_mfma_f32_16x16x32_bf16 v[176:179], v[160:163], a[112:115], v[176:179]
    ds_read_b64_tr_b16 v[52:53], v1 offset:16384
    v_mfma_f32_16x16x32_bf16 v[176:179], v[164:167], a[120:123], v[176:179]
    ds_read_b64_tr_b16 v[54:55], v1 offset:17408
    v_mfma_f32_16x16x32_bf16 v[180:183], v[164:167], a[124:127], v[180:183]
    ds_read_b64_tr_b16 v[84:85], v1 offset:24576
    v_mfma_f32_16x16x32_bf16 v[180:183], v[160:163], a[116:119], v[180:183]
    s_waitcnt lgkmcnt(7)
    ds_read_b64_tr_b16 v[86:87], v1 offset:25600
    v_add_u32 v1, s21, v1
    v_mfma_f32_16x16x32_bf16 v[168:171], v[40:43], a[0:3], v[168:171]
    ds_read_b64_tr_b16 v[116:117], v2 offset:16384
    v_mfma_f32_16x16x32_bf16 v[168:171], v[72:75], a[8:11], v[168:171]
    ds_read_b64_tr_b16 v[118:119], v2 offset:17408
    v_mfma_f32_16x16x32_bf16 v[172:175], v[72:75], a[12:15], v[172:175]
    ds_read_b64_tr_b16 v[148:149], v2 offset:24576
    v_mfma_f32_16x16x32_bf16 v[172:175], v[40:43], a[4:7], v[172:175]
    s_waitcnt lgkmcnt(7)
    ds_read_b64_tr_b16 v[150:151], v2 offset:25600
    v_add_u32 v2, s21, v2
    v_mfma_f32_16x16x32_bf16 v[176:179], v[104:107], a[0:3], v[176:179]
    ds_read_b64_tr_b16 v[160:161], v1
    v_mfma_f32_16x16x32_bf16 v[176:179], v[136:139], a[8:11], v[176:179]
    ds_read_b64_tr_b16 v[162:163], v1 offset:1024
    v_mfma_f32_16x16x32_bf16 v[180:183], v[136:139], a[12:15], v[180:183]
    ds_read_b64_tr_b16 v[164:165], v1 offset:8192
    v_mfma_f32_16x16x32_bf16 v[180:183], v[104:107], a[4:7], v[180:183]
    s_waitcnt lgkmcnt(7)
    ds_read_b64_tr_b16 v[166:167], v1 offset:9216
    v_mfma_f32_16x16x32_bf16 v[168:171], v[52:55], a[16:19], v[168:171]
    ds_read_b64_tr_b16 v[40:41], v2
    v_mfma_f32_16x16x32_bf16 v[168:171], v[84:87], a[24:27], v[168:171]
    ds_read_b64_tr_b16 v[42:43], v2 offset:1024
    v_mfma_f32_16x16x32_bf16 v[172:175], v[84:87], a[28:31], v[172:175]
    ds_read_b64_tr_b16 v[72:73], v2 offset:8192
    v_mfma_f32_16x16x32_bf16 v[172:175], v[52:55], a[20:23], v[172:175]
    s_waitcnt lgkmcnt(7)
    ds_read_b64_tr_b16 v[74:75], v2 offset:9216
    v_mfma_f32_16x16x32_bf16 v[176:179], v[116:119], a[16:19], v[176:179]
    ds_read_b64_tr_b16 v[104:105], v1 offset:16384
    v_mfma_f32_16x16x32_bf16 v[176:179], v[148:151], a[24:27], v[176:179]
    ds_read_b64_tr_b16 v[106:107], v1 offset:17408
    v_mfma_f32_16x16x32_bf16 v[180:183], v[148:151], a[28:31], v[180:183]
    ds_read_b64_tr_b16 v[136:137], v1 offset:24576
    v_mfma_f32_16x16x32_bf16 v[180:183], v[116:119], a[20:23], v[180:183]
    s_waitcnt lgkmcnt(7)
    ds_read_b64_tr_b16 v[138:139], v1 offset:25600
    v_add_u32 v1, s22, v1
    v_mfma_f32_16x16x32_bf16 v[168:171], v[160:163], a[176:179], v[168:171]
    ds_read_b64_tr_b16 v[52:53], v2 offset:16384
    v_mfma_f32_16x16x32_bf16 v[168:171], v[164:167], a[184:187], v[168:171]
    ds_read_b64_tr_b16 v[54:55], v2 offset:17408
    v_mfma_f32_16x16x32_bf16 v[172:175], v[164:167], a[188:191], v[172:175]
    ds_read_b64_tr_b16 v[84:85], v2 offset:24576
    v_mfma_f32_16x16x32_bf16 v[172:175], v[160:163], a[180:183], v[172:175]
    s_waitcnt lgkmcnt(7)
    ds_read_b64_tr_b16 v[86:87], v2 offset:25600
    v_add_u32 v2, s22, v2
    v_mfma_f32_16x16x32_bf16 v[176:179], v[40:43], a[176:179], v[176:179]
    ds_read_b64_tr_b16 v[116:117], v1
    v_mfma_f32_16x16x32_bf16 v[176:179], v[72:75], a[184:187], v[176:179]
    ds_read_b64_tr_b16 v[118:119], v1 offset:1024
    v_mfma_f32_16x16x32_bf16 v[180:183], v[72:75], a[188:191], v[180:183]
    ds_read_b64_tr_b16 v[148:149], v1 offset:8192
    v_mfma_f32_16x16x32_bf16 v[180:183], v[40:43], a[180:183], v[180:183]
    s_waitcnt lgkmcnt(7)
    ds_read_b64_tr_b16 v[150:151], v1 offset:9216
    v_mfma_f32_16x16x32_bf16 v[168:171], v[104:107], a[32:35], v[168:171]
    ds_read_b64_tr_b16 v[160:161], v2
    v_mfma_f32_16x16x32_bf16 v[168:171], v[136:139], a[40:43], v[168:171]
    ds_read_b64_tr_b16 v[162:163], v2 offset:1024
    v_mfma_f32_16x16x32_bf16 v[172:175], v[136:139], a[44:47], v[172:175]
    ds_read_b64_tr_b16 v[164:165], v2 offset:8192
    v_mfma_f32_16x16x32_bf16 v[172:175], v[104:107], a[36:39], v[172:175]
    s_waitcnt lgkmcnt(7)
    ds_read_b64_tr_b16 v[166:167], v2 offset:9216
    v_mfma_f32_16x16x32_bf16 v[176:179], v[52:55], a[32:35], v[176:179]
    ds_read_b64_tr_b16 v[40:41], v1 offset:16384
    v_mfma_f32_16x16x32_bf16 v[176:179], v[84:87], a[40:43], v[176:179]
    ds_read_b64_tr_b16 v[42:43], v1 offset:17408
    v_mfma_f32_16x16x32_bf16 v[180:183], v[84:87], a[44:47], v[180:183]
    ds_read_b64_tr_b16 v[72:73], v1 offset:24576
    v_mfma_f32_16x16x32_bf16 v[180:183], v[52:55], a[36:39], v[180:183]
    s_waitcnt lgkmcnt(7)
    ds_read_b64_tr_b16 v[74:75], v1 offset:25600
    v_add_u32 v1, s23, v1
    v_mfma_f32_16x16x32_bf16 v[168:171], v[116:119], a[48:51], v[168:171]
    ds_read_b64_tr_b16 v[104:105], v2 offset:16384
    v_mfma_f32_16x16x32_bf16 v[168:171], v[148:151], a[56:59], v[168:171]
    ds_read_b64_tr_b16 v[106:107], v2 offset:17408
    v_mfma_f32_16x16x32_bf16 v[172:175], v[148:151], a[60:63], v[172:175]
    ds_read_b64_tr_b16 v[136:137], v2 offset:24576
    v_mfma_f32_16x16x32_bf16 v[172:175], v[116:119], a[52:55], v[172:175]
    s_waitcnt lgkmcnt(7)
    ds_read_b64_tr_b16 v[138:139], v2 offset:25600
    v_add_u32 v2, s23, v2
    v_mfma_f32_16x16x32_bf16 v[176:179], v[160:163], a[48:51], v[176:179]
    ds_read_b64_tr_b16 v[52:53], v1
    v_mfma_f32_16x16x32_bf16 v[176:179], v[164:167], a[56:59], v[176:179]
    ds_read_b64_tr_b16 v[54:55], v1 offset:1024
    v_mfma_f32_16x16x32_bf16 v[180:183], v[164:167], a[60:63], v[180:183]
    ds_read_b64_tr_b16 v[84:85], v1 offset:8192
    v_mfma_f32_16x16x32_bf16 v[180:183], v[160:163], a[52:55], v[180:183]
    s_waitcnt lgkmcnt(7)
    ds_read_b64_tr_b16 v[86:87], v1 offset:9216
    v_mfma_f32_16x16x32_bf16 v[168:171], v[40:43], a[64:67], v[168:171]
    ds_read_b64_tr_b16 v[116:117], v2
    v_mfma_f32_16x16x32_bf16 v[168:171], v[72:75], a[72:75], v[168:171]
    ds_read_b64_tr_b16 v[118:119], v2 offset:1024
    v_mfma_f32_16x16x32_bf16 v[172:175], v[72:75], a[76:79], v[172:175]
    ds_read_b64_tr_b16 v[148:149], v2 offset:8192
    v_mfma_f32_16x16x32_bf16 v[172:175], v[40:43], a[68:71], v[172:175]
    s_waitcnt lgkmcnt(7)
    ds_read_b64_tr_b16 v[150:151], v2 offset:9216
    v_mfma_f32_16x16x32_bf16 v[176:179], v[104:107], a[64:67], v[176:179]
    ds_read_b64_tr_b16 v[160:161], v1 offset:16384
    buffer_load_dwordx4 v[88:91], v17, s[52:55], s12 offen sc1
    v_mfma_f32_16x16x32_bf16 v[176:179], v[136:139], a[72:75], v[176:179]
    ds_read_b64_tr_b16 v[162:163], v1 offset:17408
    v_mfma_f32_16x16x32_bf16 v[180:183], v[136:139], a[76:79], v[180:183]
    ds_read_b64_tr_b16 v[164:165], v1 offset:24576
    buffer_load_dwordx4 v[92:95], v17, s[52:55], s12 offen offset:1024 sc1
    v_mfma_f32_16x16x32_bf16 v[180:183], v[104:107], a[68:71], v[180:183]
    s_waitcnt lgkmcnt(7)
    ds_read_b64_tr_b16 v[166:167], v1 offset:25600
    v_mfma_f32_16x16x32_bf16 v[168:171], v[52:55], a[80:83], v[168:171]
    ds_read_b64_tr_b16 v[40:41], v2 offset:16384
    buffer_load_dwordx4 v[96:99], v17, s[52:55], s12 offen offset:2048 sc1
    v_mfma_f32_16x16x32_bf16 v[168:171], v[84:87], a[88:91], v[168:171]
    ds_read_b64_tr_b16 v[42:43], v2 offset:17408
    v_mfma_f32_16x16x32_bf16 v[172:175], v[84:87], a[92:95], v[172:175]
    ds_read_b64_tr_b16 v[72:73], v2 offset:24576
    buffer_load_dwordx4 v[100:103], v17, s[52:55], s12 offen offset:3072 sc1
    v_mfma_f32_16x16x32_bf16 v[172:175], v[52:55], a[84:87], v[172:175]
    s_waitcnt lgkmcnt(7)
    ds_read_b64_tr_b16 v[74:75], v2 offset:25600
    v_mfma_f32_16x16x32_bf16 v[176:179], v[116:119], a[80:83], v[176:179]
    buffer_load_dwordx4 v[120:123], v17, s[52:55], s16 offen sc1
    v_mfma_f32_16x16x32_bf16 v[176:179], v[148:151], a[88:91], v[176:179]
    v_mfma_f32_16x16x32_bf16 v[180:183], v[148:151], a[92:95], v[180:183]
    buffer_load_dwordx4 v[124:127], v17, s[52:55], s16 offen offset:1024 sc1
    v_mfma_f32_16x16x32_bf16 v[180:183], v[116:119], a[84:87], v[180:183]
    s_waitcnt lgkmcnt(4)
    v_mfma_f32_16x16x32_bf16 v[168:171], v[160:163], a[128:131], v[168:171]
    v_mfma_f32_16x16x32_bf16 v[168:171], v[164:167], a[136:139], v[168:171]
    v_mfma_f32_16x16x32_bf16 v[172:175], v[164:167], a[140:143], v[172:175]
    v_mfma_f32_16x16x32_bf16 v[172:175], v[160:163], a[132:135], v[172:175]
    s_waitcnt lgkmcnt(0)
    v_mfma_f32_16x16x32_bf16 v[176:179], v[40:43], a[128:131], v[176:179]
    v_mfma_f32_16x16x32_bf16 v[176:179], v[72:75], a[136:139], v[176:179]
    v_mfma_f32_16x16x32_bf16 v[180:183], v[72:75], a[140:143], v[180:183]
    v_mfma_f32_16x16x32_bf16 v[180:183], v[40:43], a[132:135], v[180:183]
L_spin_p:
    s_waitcnt vmcnt(4)
    v_max3_u32 v152, v88, v89, v88
    v_max3_u32 v152, v90, v91, v152
    v_max3_u32 v153, v92, v93, v92
    v_max3_u32 v153, v94, v95, v153
    s_waitcnt vmcnt(2)
    v_max3_u32 v152, v96, v97, v152
    v_max3_u32 v152, v98, v99, v152
    v_max3_u32 v153, v100, v101, v153
    v_max3_u32 v153, v102, v103, v153
    s_waitcnt vmcnt(0)
    v_max3_u32 v152, v120, v121, v152
    v_max3_u32 v152, v122, v123, v152
    v_max3_u32 v153, v124, v125, v153
    v_max3_u32 v153, v126, v127, v153
    v_max_u32 v152, v152, v153
    v_cmp_eq_u32 vcc, -1, v152
    s_nop 4
    s_cbranch_vccz L_spin_p_ret
    buffer_load_dwordx4 v[88:91], v17, s[52:55], s12 offen sc1
    buffer_load_dwordx4 v[92:95], v17, s[52:55], s12 offen offset:1024 sc1
    buffer_load_dwordx4 v[96:99], v17, s[52:55], s12 offen offset:2048 sc1
    buffer_load_dwordx4 v[100:103], v17, s[52:55], s12 offen offset:3072 sc1
    buffer_load_dwordx4 v[120:123], v17, s[52:55], s16 offen sc1
    buffer_load_dwordx4 v[124:127], v17, s[52:55], s16 offen offset:1024 sc1
    s_branch L_spin_p
L_spin_p_ret:
    v_dot2c_f32_bf16 v168, v88, v156
    v_dot2c_f32_bf16 v169, v88, v157
    v_dot2c_f32_bf16 v170, v89, v156
    v_dot2c_f32_bf16 v171, v89, v157
    v_dot2c_f32_bf16 v176, v92, v156
    v_dot2c_f32_bf16 v177, v92, v157
    v_dot2c_f32_bf16 v178, v93, v156
    v_dot2c_f32_bf16 v179, v93, v157
    v_dot2c_f32_bf16 v168, v96, v156
    v_dot2c_f32_bf16 v169, v96, v157
    v_dot2c_f32_bf16 v170, v97, v156
    v_dot2c_f32_bf16 v171, v97, v157
    v_dot2c_f32_bf16 v176, v100, v156
    v_dot2c_f32_bf16 v177, v100, v157
    v_dot2c_f32_bf16 v178, v101, v156
    v_dot2c_f32_bf16 v179, v101, v157
    v_dot2c_f32_bf16 v168, v120, v156
    v_dot2c_f32_bf16 v169, v120, v157
    v_dot2c_f32_bf16 v170, v121, v156
    v_dot2c_f32_bf16 v171, v121, v157
    v_dot2c_f32_bf16 v176, v124, v156
    v_dot2c_f32_bf16 v177, v124, v157
    v_dot2c_f32_bf16 v178, v125, v156
    v_dot2c_f32_bf16 v179, v125, v157
    s_nop 2
    v_cvt_pk_bf16_f32 v128, v168, v169
    v_cvt_pk_bf16_f32 v129, v170, v171
    v_cvt_pk_bf16_f32 v130, v176, v177
    v_cvt_pk_bf16_f32 v131, v178, v179
    s_nop 1
    v_permlane16_swap_b32 v128, v130
    v_permlane16_swap_b32 v129, v131
    buffer_store_dwordx4 v[128:131], v32, s[48:51], s74 offen sc1
    v_dot2c_f32_bf16 v172, v90, v156
    v_dot2c_f32_bf16 v173, v90, v157
    v_dot2c_f32_bf16 v174, v91, v156
    v_dot2c_f32_bf16 v175, v91, v157
    v_dot2c_f32_bf16 v180, v94, v156
    v_dot2c_f32_bf16 v181, v94, v157
    v_dot2c_f32_bf16 v182, v95, v156
    v_dot2c_f32_bf16 v183, v95, v157
    v_dot2c_f32_bf16 v172, v98, v156
    v_dot2c_f32_bf16 v173, v98, v157
    v_dot2c_f32_bf16 v174, v99, v156
    v_dot2c_f32_bf16 v175, v99, v157
    v_dot2c_f32_bf16 v180, v102, v156
    v_dot2c_f32_bf16 v181, v102, v157
    v_dot2c_f32_bf16 v182, v103, v156
    v_dot2c_f32_bf16 v183, v103, v157
    v_dot2c_f32_bf16 v172, v122, v156
    v_dot2c_f32_bf16 v173, v122, v157
    v_dot2c_f32_bf16 v174, v123, v156
    v_dot2c_f32_bf16 v175, v123, v157
    v_dot2c_f32_bf16 v180, v126, v156
    v_dot2c_f32_bf16 v181, v126, v157
    v_dot2c_f32_bf16 v182, v127, v156
    v_dot2c_f32_bf16 v183, v127, v157
    s_nop 2
    v_cvt_pk_bf16_f32 v132, v172, v173
    v_cvt_pk_bf16_f32 v133, v174, v175
    v_cvt_pk_bf16_f32 v134, v180, v181
    v_cvt_pk_bf16_f32 v135, v182, v183
    s_nop 1
    v_permlane16_swap_b32 v132, v134
    v_permlane16_swap_b32 v133, v135
    buffer_store_dwordx4 v[132:135], v32, s[48:51], s75 offen sc1
L_end:
    s_endpgm
L_z7:
    s_add_u32 s72, s94, 0
    buffer_load_dwordx4 a[32:35], v17, s[32:35], s72 offen sc1
    s_add_u32 s73, s95, 0
    buffer_load_dwordx4 a[36:39], v17, s[32:35], s73 offen sc1
    buffer_load_dwordx4 a[40:43], v17, s[32:35], s72 offen offset:1024 sc1
    buffer_load_dwordx4 a[44:47], v17, s[32:35], s73 offen offset:1024 sc1
    buffer_load_dwordx4 a[48:51], v17, s[32:35], s72 offen offset:2048 sc1
    buffer_load_dwordx4 a[52:55], v17, s[32:35], s73 offen offset:2048 sc1
    buffer_load_dwordx4 a[56:59], v17, s[32:35], s72 offen offset:3072 sc1
    buffer_load_dwordx4 a[60:63], v17, s[32:35], s73 offen offset:3072 sc1
    s_add_u32 s72, s94, 4096
    buffer_load_dwordx4 a[64:67], v17, s[32:35], s72 offen sc1
    s_add_u32 s73, s95, 4096
    buffer_load_dwordx4 a[68:71], v17, s[32:35], s73 offen sc1
    buffer_load_dwordx4 a[72:75], v17, s[32:35], s72 offen offset:1024 sc1
    buffer_load_dwordx4 a[76:79], v17, s[32:35], s73 offen offset:1024 sc1
    buffer_load_dwordx4 a[80:83], v17, s[32:35], s72 offen offset:2048 sc1
    buffer_load_dwordx4 a[84:87], v17, s[32:35], s73 offen offset:2048 sc1
    buffer_load_dwordx4 a[88:91], v17, s[32:35], s72 offen offset:3072 sc1
    buffer_load_dwordx4 a[92:95], v17, s[32:35], s73 offen offset:3072 sc1
    s_branch L_e0
L_spin_z:
    buffer_load_dword v38, v36, s[56:59], 0 offen sc1
    s_waitcnt vmcnt(0)
    v_cmp_eq_u32 vcc, 0, v38
    s_nop 4
    s_cbranch_vccz L_spin_z_ret
    s_sleep 2
    s_branch L_spin_z
L_spin_kv:
    buffer_load_dword v38, v36, s[60:63], s0 offen sc1
    s_waitcnt vmcnt(0)
    v_cmp_eq_u32 vcc, 0, v38
    s_nop 4
    s_cbranch_vccz L_spin_kv_ret
    s_sleep 2
    s_branch L_spin_kv
L_spin_h:
    buffer_load_dword v38, v36, s[60:63], s1 offen sc1
    s_waitcnt vmcnt(0)
    v_cmp_eq_u32 vcc, 0, v38
    s_nop 4
    s_cbranch_vccz L_spin_h_ret
    s_sleep 2
    s_branch L_spin_h
L_fb1:
    s_nop 15
    s_lshl_b32 s20, s65, 3
    s_add_u32 s20, s20, s66
    s_lshr_b32 s21, s20, 1
    s_add_u32 s21, s21, 1
    s_lshl_b32 s20, s20, 4
    v_bfe_u32 v133, v17, 4, 4
    v_bfe_u32 v134, v17, 8, 2
    v_lshlrev_b32 v134, 2, v134
    v_sub_u32 v133, v133, v134
    v_add_u32 v133, s20, v133
    v_mov_b32 v135, 0xff800000
    v_mov_b32 v132, v135
    s_mov_b32 s22, 0
L_fb1_a:
    s_lshr_b32 s23, s22, 1
    s_lshl_b32 s23, s23, 15
    s_and_b32 s24, s22, 1
    s_lshl_b32 s24, s24, 13
    s_add_u32 s24, s24, s23
    s_lshl_b32 s20, s22, 5
    v_subrev_u32 v134, s20, v133
    buffer_load_dwordx4 v[88:91], v17, s[28:31], s24 offen sc1
    buffer_load_dwordx4 v[92:95], v17, s[28:31], s24 offen offset:1024 sc1
    buffer_load_dwordx4 v[96:99], v17, s[28:31], s24 offen offset:2048 sc1
    buffer_load_dwordx4 v[100:103], v17, s[28:31], s24 offen offset:3072 sc1
    s_add_u32 s24, s24, 4096
    s_waitcnt vmcnt(0)
    v_mfma_f32_16x16x32_bf16 v[120:123], v[88:91], v[44:47], 0
    v_mfma_f32_16x16x32_bf16 v[120:123], v[92:95], v[76:79], v[120:123]
    v_mfma_f32_16x16x32_bf16 v[120:123], v[96:99], v[108:111], v[120:123]
    v_mfma_f32_16x16x32_bf16 v[120:123], v[100:103], v[140:143], v[120:123]
    s_nop 7
    buffer_load_dwordx4 v[88:91], v17, s[28:31], s24 offen sc1
    buffer_load_dwordx4 v[92:95], v17, s[28:31], s24 offen offset:1024 sc1
    buffer_load_dwordx4 v[96:99], v17, s[28:31], s24 offen offset:2048 sc1
    buffer_load_dwordx4 v[100:103], v17, s[28:31], s24 offen offset:3072 sc1
    s_add_u32 s24, s24, 4096
    s_waitcnt vmcnt(0)
    v_mfma_f32_16x16x32_bf16 v[124:127], v[88:91], v[44:47], 0
    v_mfma_f32_16x16x32_bf16 v[124:127], v[92:95], v[76:79], v[124:127]
    v_mfma_f32_16x16x32_bf16 v[124:127], v[96:99], v[108:111], v[124:127]
    v_mfma_f32_16x16x32_bf16 v[124:127], v[100:103], v[140:143], v[124:127]
    s_nop 7
    v_cmp_le_i32 vcc, 0, v134
    s_nop 1
    v_cndmask_b32 v120, v135, v120, vcc
    v_cmp_le_i32 vcc, 1, v134
    s_nop 1
    v_cndmask_b32 v121, v135, v121, vcc
    v_cmp_le_i32 vcc, 2, v134
    s_nop 1
    v_cndmask_b32 v122, v135, v122, vcc
    v_cmp_le_i32 vcc, 3, v134
    s_nop 1
    v_cndmask_b32 v123, v135, v123, vcc
    v_cmp_le_i32 vcc, 16, v134
    s_nop 1
    v_cndmask_b32 v124, v135, v124, vcc
    v_cmp_le_i32 vcc, 17, v134
    s_nop 1
    v_cndmask_b32 v125, v135, v125, vcc
    v_cmp_le_i32 vcc, 18, v134
    s_nop 1
    v_cndmask_b32 v126, v135, v126, vcc
    v_cmp_le_i32 vcc, 19, v134
    s_nop 1
    v_cndmask_b32 v127, v135, v127, vcc
    v_max3_f32 v132, v132, v120, v121
    v_max3_f32 v132, v132, v122, v123
    v_max3_f32 v132, v132, v124, v125
    v_max3_f32 v132, v132, v126, v127
    s_add_u32 s22, s22, 1
    s_cmp_lt_u32 s22, s21
    s_cbranch_scc1 L_fb1_a
    v_mov_b32 v134, v132
    s_nop 1
    v_permlane32_swap_b32 v134, v132
    s_nop 1
    v_max_f32 v132, v132, v134
    v_mov_b32 v134, v132
    s_nop 1
    v_permlane16_swap_b32 v134, v132
    s_nop 1
    v_max_f32 v132, v132, v134
    v_accvgpr_write_b32 a32, 0
    v_accvgpr_write_b32 a33, 0
    v_accvgpr_write_b32 a34, 0
    v_accvgpr_write_b32 a35, 0
    v_accvgpr_write_b32 a36, 0
    v_accvgpr_write_b32 a37, 0
    v_accvgpr_write_b32 a38, 0
    v_accvgpr_write_b32 a39, 0
    v_accvgpr_write_b32 a40, 0
    v_accvgpr_write_b32 a41, 0
    v_accvgpr_write_b32 a42, 0
    v_accvgpr_write_b32 a43, 0
    v_accvgpr_write_b32 a44, 0
    v_accvgpr_write_b32 a45, 0
    v_accvgpr_write_b32 a46, 0
    v_accvgpr_write_b32 a47, 0
    v_accvgpr_write_b32 a48, 0
    v_accvgpr_write_b32 a49, 0
    v_accvgpr_write_b32 a50, 0
    v_accvgpr_write_b32 a51, 0
    v_accvgpr_write_b32 a52, 0
    v_accvgpr_write_b32 a53, 0
    v_accvgpr_write_b32 a54, 0
    v_accvgpr_write_b32 a55, 0
    v_accvgpr_write_b32 a56, 0
    v_accvgpr_write_b32 a57, 0
    v_accvgpr_write_b32 a58, 0
    v_accvgpr_write_b32 a59, 0
    v_accvgpr_write_b32 a60, 0
    v_accvgpr_write_b32 a61, 0
    v_accvgpr_write_b32 a62, 0
    v_accvgpr_write_b32 a63, 0
    v_mov_b32 v60, 0
    v_mov_b32 v61, 0
    v_mov_b32 v62, 0
    v_mov_b32 v63, 0
    s_mov_b32 s22, 0
L_fb1_b:
    s_lshr_b32 s23, s22, 1
    s_lshl_b32 s23, s23, 15
    s_and_b32 s24, s22, 1
    s_lshl_b32 s24, s24, 13
    s_add_u32 s24, s24, s23
    s_lshl_b32 s20, s22, 5
    v_subrev_u32 v134, s20, v133
    buffer_load_dwordx4 v[88:91], v17, s[28:31], s24 offen sc1
    buffer_load_dwordx4 v[92:95], v17, s[28:31], s24 offen offset:1024 sc1
    buffer_load_dwordx4 v[96:99], v17, s[28:31], s24 offen offset:2048 sc1
    buffer_load_dwordx4 v[100:103], v17, s[28:31], s24 offen offset:3072 sc1
    s_add_u32 s24, s24, 4096
    s_waitcnt vmcnt(0)
    v_mfma_f32_16x16x32_bf16 v[120:123], v[88:91], v[44:47], 0
    v_mfma_f32_16x16x32_bf16 v[120:123], v[92:95], v[76:79], v[120:123]
    v_mfma_f32_16x16x32_bf16 v[120:123], v[96:99], v[108:111], v[120:123]
    v_mfma_f32_16x16x32_bf16 v[120:123], v[100:103], v[140:143], v[120:123]
    s_nop 7
    buffer_load_dwordx4 v[88:91], v17, s[28:31], s24 offen sc1
    buffer_load_dwordx4 v[92:95], v17, s[28:31], s24 offen offset:1024 sc1
    buffer_load_dwordx4 v[96:99], v17, s[28:31], s24 offen offset:2048 sc1
    buffer_load_dwordx4 v[100:103], v17, s[28:31], s24 offen offset:3072 sc1
    s_add_u32 s24, s24, 4096
    s_waitcnt vmcnt(0)
    v_mfma_f32_16x16x32_bf16 v[124:127], v[88:91], v[44:47], 0
    v_mfma_f32_16x16x32_bf16 v[124:127], v[92:95], v[76:79], v[124:127]
    v_mfma_f32_16x16x32_bf16 v[124:127], v[96:99], v[108:111], v[124:127]
    v_mfma_f32_16x16x32_bf16 v[124:127], v[100:103], v[140:143], v[124:127]
    s_nop 7
    v_cmp_le_i32 vcc, 0, v134
    s_nop 1
    v_cndmask_b32 v120, v135, v120, vcc
    v_cmp_le_i32 vcc, 1, v134
    s_nop 1
    v_cndmask_b32 v121, v135, v121, vcc
    v_cmp_le_i32 vcc, 2, v134
    s_nop 1
    v_cndmask_b32 v122, v135, v122, vcc
    v_cmp_le_i32 vcc, 3, v134
    s_nop 1
    v_cndmask_b32 v123, v135, v123, vcc
    v_cmp_le_i32 vcc, 16, v134
    s_nop 1
    v_cndmask_b32 v124, v135, v124, vcc
    v_cmp_le_i32 vcc, 17, v134
    s_nop 1
    v_cndmask_b32 v125, v135, v125, vcc
    v_cmp_le_i32 vcc, 18, v134
    s_nop 1
    v_cndmask_b32 v126, v135, v126, vcc
    v_cmp_le_i32 vcc, 19, v134
    s_nop 1
    v_cndmask_b32 v127, v135, v127, vcc
    v_sub_f32 v120, v120, v132
    v_sub_f32 v121, v121, v132
    v_sub_f32 v122, v122, v132
    v_sub_f32 v123, v123, v132
    v_sub_f32 v124, v124, v132
    v_sub_f32 v125, v125, v132
    v_sub_f32 v126, v126, v132
    v_sub_f32 v127, v127, v132
    v_exp_f32 v120, v120
    v_exp_f32 v121, v121
    v_exp_f32 v122, v122
    v_exp_f32 v123, v123
    v_exp_f32 v124, v124
    v_exp_f32 v125, v125
    v_exp_f32 v126, v126
    v_exp_f32 v127, v127
    s_nop 0
    v_cvt_pk_bf16_f32 v128, v120, v121
    v_cvt_pk_bf16_f32 v129, v122, v123
    v_cvt_pk_bf16_f32 v130, v124, v125
    v_cvt_pk_bf16_f32 v131, v126, v127
    s_and_b32 s24, s22, 1
    s_lshl_b32 s24, s24, 10
    s_add_u32 s24, s24, s23
    s_add_u32 s24, s24, 16384
    v_mfma_f32_16x16x32_bf16 v[60:63], v[248:251], v[128:131], v[60:63]
    buffer_load_dwordx4 v[88:91], v17, s[28:31], s24 offen sc1
    buffer_load_dwordx4 v[92:95], v17, s[28:31], s24 offen offset:2048 sc1
    s_add_u32 s24, s24, 4096
    buffer_load_dwordx4 v[96:99], v17, s[28:31], s24 offen sc1
    buffer_load_dwordx4 v[100:103], v17, s[28:31], s24 offen offset:2048 sc1
    s_add_u32 s24, s24, 4096
    s_waitcnt vmcnt(0)
    v_mfma_f32_16x16x32_bf16 a[32:35], v[88:91], v[128:131], a[32:35]
    v_mfma_f32_16x16x32_bf16 a[36:39], v[92:95], v[128:131], a[36:39]
    v_mfma_f32_16x16x32_bf16 a[40:43], v[96:99], v[128:131], a[40:43]
    v_mfma_f32_16x16x32_bf16 a[44:47], v[100:103], v[128:131], a[44:47]
    s_nop 7
    buffer_load_dwordx4 v[88:91], v17, s[28:31], s24 offen sc1
    buffer_load_dwordx4 v[92:95], v17, s[28:31], s24 offen offset:2048 sc1
    s_add_u32 s24, s24, 4096
    buffer_load_dwordx4 v[96:99], v17, s[28:31], s24 offen sc1
    buffer_load_dwordx4 v[100:103], v17, s[28:31], s24 offen offset:2048 sc1
    s_add_u32 s24, s24, 4096
    s_waitcnt vmcnt(0)
    v_mfma_f32_16x16x32_bf16 a[48:51], v[88:91], v[128:131], a[48:51]
    v_mfma_f32_16x16x32_bf16 a[52:55], v[92:95], v[128:131], a[52:55]
    v_mfma_f32_16x16x32_bf16 a[56:59], v[96:99], v[128:131], a[56:59]
    v_mfma_f32_16x16x32_bf16 a[60:63], v[100:103], v[128:131], a[60:63]
    s_nop 7
    s_add_u32 s22, s22, 1
    s_cmp_lt_u32 s22, s21
    s_cbranch_scc1 L_fb1_b
    s_nop 15
    s_branch L_fb1_ret
L_fb2:
    s_nop 15
    s_lshl_b32 s20, s65, 3
    s_add_u32 s20, s20, 7
    s_sub_u32 s20, s20, s66
    s_lshr_b32 s21, s20, 1
    s_add_u32 s21, s21, 1
    s_lshl_b32 s20, s20, 4
    v_bfe_u32 v133, v17, 4, 4
    v_bfe_u32 v134, v17, 8, 2
    v_lshlrev_b32 v134, 2, v134
    v_sub_u32 v133, v133, v134
    v_add_u32 v133, s20, v133
    v_mov_b32 v135, 0xff800000
    v_mov_b32 v132, v135
    s_mov_b32 s22, 0
L_fb2_a:
    s_lshr_b32 s23, s22, 1
    s_lshl_b32 s23, s23, 15
    s_and_b32 s24, s22, 1
    s_lshl_b32 s24, s24, 13
    s_add_u32 s24, s24, s23
    s_lshl_b32 s20, s22, 5
    v_subrev_u32 v134, s20, v133
    buffer_load_dwordx4 v[88:91], v17, s[28:31], s24 offen sc1
    buffer_load_dwordx4 v[92:95], v17, s[28:31], s24 offen offset:1024 sc1
    buffer_load_dwordx4 v[96:99], v17, s[28:31], s24 offen offset:2048 sc1
    buffer_load_dwordx4 v[100:103], v17, s[28:31], s24 offen offset:3072 sc1
    s_add_u32 s24, s24, 4096
    s_waitcnt vmcnt(0)
    v_mfma_f32_16x16x32_bf16 v[120:123], v[88:91], v[48:51], 0
    v_mfma_f32_16x16x32_bf16 v[120:123], v[92:95], v[80:83], v[120:123]
    v_mfma_f32_16x16x32_bf16 v[120:123], v[96:99], v[112:115], v[120:123]
    v_mfma_f32_16x16x32_bf16 v[120:123], v[100:103], v[144:147], v[120:123]
    s_nop 7
    buffer_load_dwordx4 v[88:91], v17, s[28:31], s24 offen sc1
    buffer_load_dwordx4 v[92:95], v17, s[28:31], s24 offen offset:1024 sc1
    buffer_load_dwordx4 v[96:99], v17, s[28:31], s24 offen offset:2048 sc1
    buffer_load_dwordx4 v[100:103], v17, s[28:31], s24 offen offset:3072 sc1
    s_add_u32 s24, s24, 4096
    s_waitcnt vmcnt(0)
    v_mfma_f32_16x16x32_bf16 v[124:127], v[88:91], v[48:51], 0
    v_mfma_f32_16x16x32_bf16 v[124:127], v[92:95], v[80:83], v[124:127]
    v_mfma_f32_16x16x32_bf16 v[124:127], v[96:99], v[112:115], v[124:127]
    v_mfma_f32_16x16x32_bf16 v[124:127], v[100:103], v[144:147], v[124:127]
    s_nop 7
    v_cmp_le_i32 vcc, 0, v134
    s_nop 1
    v_cndmask_b32 v120, v135, v120, vcc
    v_cmp_le_i32 vcc, 1, v134
    s_nop 1
    v_cndmask_b32 v121, v135, v121, vcc
    v_cmp_le_i32 vcc, 2, v134
    s_nop 1
    v_cndmask_b32 v122, v135, v122, vcc
    v_cmp_le_i32 vcc, 3, v134
    s_nop 1
    v_cndmask_b32 v123, v135, v123, vcc
    v_cmp_le_i32 vcc, 16, v134
    s_nop 1
    v_cndmask_b32 v124, v135, v124, vcc
    v_cmp_le_i32 vcc, 17, v134
    s_nop 1
    v_cndmask_b32 v125, v135, v125, vcc
    v_cmp_le_i32 vcc, 18, v134
    s_nop 1
    v_cndmask_b32 v126, v135, v126, vcc
    v_cmp_le_i32 vcc, 19, v134
    s_nop 1
    v_cndmask_b32 v127, v135, v127, vcc
    v_max3_f32 v132, v132, v120, v121
    v_max3_f32 v132, v132, v122, v123
    v_max3_f32 v132, v132, v124, v125
    v_max3_f32 v132, v132, v126, v127
    s_add_u32 s22, s22, 1
    s_cmp_lt_u32 s22, s21
    s_cbranch_scc1 L_fb2_a
    v_mov_b32 v134, v132
    s_nop 1
    v_permlane32_swap_b32 v134, v132
    s_nop 1
    v_max_f32 v132, v132, v134
    v_mov_b32 v134, v132
    s_nop 1
    v_permlane16_swap_b32 v134, v132
    s_nop 1
    v_max_f32 v132, v132, v134
    v_accvgpr_write_b32 a64, 0
    v_accvgpr_write_b32 a65, 0
    v_accvgpr_write_b32 a66, 0
    v_accvgpr_write_b32 a67, 0
    v_accvgpr_write_b32 a68, 0
    v_accvgpr_write_b32 a69, 0
    v_accvgpr_write_b32 a70, 0
    v_accvgpr_write_b32 a71, 0
    v_accvgpr_write_b32 a72, 0
    v_accvgpr_write_b32 a73, 0
    v_accvgpr_write_b32 a74, 0
    v_accvgpr_write_b32 a75, 0
    v_accvgpr_write_b32 a76, 0
    v_accvgpr_write_b32 a77, 0
    v_accvgpr_write_b32 a78, 0
    v_accvgpr_write_b32 a79, 0
    v_accvgpr_write_b32 a80, 0
    v_accvgpr_write_b32 a81, 0
    v_accvgpr_write_b32 a82, 0
    v_accvgpr_write_b32 a83, 0
    v_accvgpr_write_b32 a84, 0
    v_accvgpr_write_b32 a85, 0
    v_accvgpr_write_b32 a86, 0
    v_accvgpr_write_b32 a87, 0
    v_accvgpr_write_b32 a88, 0
    v_accvgpr_write_b32 a89, 0
    v_accvgpr_write_b32 a90, 0
    v_accvgpr_write_b32 a91, 0
    v_accvgpr_write_b32 a92, 0
    v_accvgpr_write_b32 a93, 0
    v_accvgpr_write_b32 a94, 0
    v_accvgpr_write_b32 a95, 0
    v_mov_b32 v64, 0
    v_mov_b32 v65, 0
    v_mov_b32 v66, 0
    v_mov_b32 v67, 0
    s_mov_b32 s22, 0
L_fb2_b:
    s_lshr_b32 s23, s22, 1
    s_lshl_b32 s23, s23, 15
    s_and_b32 s24, s22, 1
    s_lshl_b32 s24, s24, 13
    s_add_u32 s24, s24, s23
    s_lshl_b32 s20, s22, 5
    v_subrev_u32 v134, s20, v133
    buffer_load_dwordx4 v[88:91], v17, s[28:31], s24 offen sc1
    buffer_load_dwordx4 v[92:95], v17, s[28:31], s24 offen offset:1024 sc1
    buffer_load_dwordx4 v[96:99], v17, s[28:31], s24 offen offset:2048 sc1
    buffer_load_dwordx4 v[100:103], v17, s[28:31], s24 offen offset:3072 sc1
    s_add_u32 s24, s24, 4096
    s_waitcnt vmcnt(0)
    v_mfma_f32_16x16x32_bf16 v[120:123], v[88:91], v[48:51], 0
    v_mfma_f32_16x16x32_bf16 v[120:123], v[92:95], v[80:83], v[120:123]
    v_mfma_f32_16x16x32_bf16 v[120:123], v[96:99], v[112:115], v[120:123]
    v_mfma_f32_16x16x32_bf16 v[120:123], v[100:103], v[144:147], v[120:123]
    s_nop 7
    buffer_load_dwordx4 v[88:91], v17, s[28:31], s24 offen sc1
    buffer_load_dwordx4 v[92:95], v17, s[28:31], s24 offen offset:1024 sc1
    buffer_load_dwordx4 v[96:99], v17, s[28:31], s24 offen offset:2048 sc1
    buffer_load_dwordx4 v[100:103], v17, s[28:31], s24 offen offset:3072 sc1
    s_add_u32 s24, s24, 4096
    s_waitcnt vmcnt(0)
    v_mfma_f32_16x16x32_bf16 v[124:127], v[88:91], v[48:51], 0
    v_mfma_f32_16x16x32_bf16 v[124:127], v[92:95], v[80:83], v[124:127]
    v_mfma_f32_16x16x32_bf16 v[124:127], v[96:99], v[112:115], v[124:127]
    v_mfma_f32_16x16x32_bf16 v[124:127], v[100:103], v[144:147], v[124:127]
    s_nop 7
    v_cmp_le_i32 vcc, 0, v134
    s_nop 1
    v_cndmask_b32 v120, v135, v120, vcc
    v_cmp_le_i32 vcc, 1, v134
    s_nop 1
    v_cndmask_b32 v121, v135, v121, vcc
    v_cmp_le_i32 vcc, 2, v134
    s_nop 1
    v_cndmask_b32 v122, v135, v122, vcc
    v_cmp_le_i32 vcc, 3, v134
    s_nop 1
    v_cndmask_b32 v123, v135, v123, vcc
    v_cmp_le_i32 vcc, 16, v134
    s_nop 1
    v_cndmask_b32 v124, v135, v124, vcc
    v_cmp_le_i32 vcc, 17, v134
    s_nop 1
    v_cndmask_b32 v125, v135, v125, vcc
    v_cmp_le_i32 vcc, 18, v134
    s_nop 1
    v_cndmask_b32 v126, v135, v126, vcc
    v_cmp_le_i32 vcc, 19, v134
    s_nop 1
    v_cndmask_b32 v127, v135, v127, vcc
    v_sub_f32 v120, v120, v132
    v_sub_f32 v121, v121, v132
    v_sub_f32 v122, v122, v132
    v_sub_f32 v123, v123, v132
    v_sub_f32 v124, v124, v132
    v_sub_f32 v125, v125, v132
    v_sub_f32 v126, v126, v132
    v_sub_f32 v127, v127, v132
    v_exp_f32 v120, v120
    v_exp_f32 v121, v121
    v_exp_f32 v122, v122
    v_exp_f32 v123, v123
    v_exp_f32 v124, v124
    v_exp_f32 v125, v125
    v_exp_f32 v126, v126
    v_exp_f32 v127, v127
    s_nop 0
    v_cvt_pk_bf16_f32 v128, v120, v121
    v_cvt_pk_bf16_f32 v129, v122, v123
    v_cvt_pk_bf16_f32 v130, v124, v125
    v_cvt_pk_bf16_f32 v131, v126, v127
    s_and_b32 s24, s22, 1
    s_lshl_b32 s24, s24, 10
    s_add_u32 s24, s24, s23
    s_add_u32 s24, s24, 16384
    v_mfma_f32_16x16x32_bf16 v[64:67], v[248:251], v[128:131], v[64:67]
    buffer_load_dwordx4 v[88:91], v17, s[28:31], s24 offen sc1
    buffer_load_dwordx4 v[92:95], v17, s[28:31], s24 offen offset:2048 sc1
    s_add_u32 s24, s24, 4096
    buffer_load_dwordx4 v[96:99], v17, s[28:31], s24 offen sc1
    buffer_load_dwordx4 v[100:103], v17, s[28:31], s24 offen offset:2048 sc1
    s_add_u32 s24, s24, 4096
    s_waitcnt vmcnt(0)
    v_mfma_f32_16x16x32_bf16 a[64:67], v[88:91], v[128:131], a[64:67]
    v_mfma_f32_16x16x32_bf16 a[68:71], v[92:95], v[128:131], a[68:71]
    v_mfma_f32_16x16x32_bf16 a[72:75], v[96:99], v[128:131], a[72:75]
    v_mfma_f32_16x16x32_bf16 a[76:79], v[100:103], v[128:131], a[76:79]
    s_nop 7
    buffer_load_dwordx4 v[88:91], v17, s[28:31], s24 offen sc1
    buffer_load_dwordx4 v[92:95], v17, s[28:31], s24 offen offset:2048 sc1
    s_add_u32 s24, s24, 4096
    buffer_load_dwordx4 v[96:99], v17, s[28:31], s24 offen sc1
    buffer_load_dwordx4 v[100:103], v17, s[28:31], s24 offen offset:2048 sc1
    s_add_u32 s24, s24, 4096
    s_waitcnt vmcnt(0)
    v_mfma_f32_16x16x32_bf16 a[80:83], v[88:91], v[128:131], a[80:83]
    v_mfma_f32_16x16x32_bf16 a[84:87], v[92:95], v[128:131], a[84:87]
    v_mfma_f32_16x16x32_bf16 a[88:91], v[96:99], v[128:131], a[88:91]
    v_mfma_f32_16x16x32_bf16 a[92:95], v[100:103], v[128:131], a[92:95]
    s_nop 7
    s_add_u32 s22, s22, 1
    s_cmp_lt_u32 s22, s21
    s_cbranch_scc1 L_fb2_b
    s_nop 15
    s_branch L_fb2_ret
L_fb3:
    s_nop 15
    s_lshl_b32 s20, s65, 3
    s_sub_u32 s20, 120, s20
    s_add_u32 s20, s20, s66
    s_lshr_b32 s21, s20, 1
    s_add_u32 s21, s21, 1
    s_lshl_b32 s20, s20, 4
    v_bfe_u32 v133, v17, 4, 4
    v_bfe_u32 v134, v17, 8, 2
    v_lshlrev_b32 v134, 2, v134
    v_sub_u32 v133, v133, v134
    v_add_u32 v133, s20, v133
    v_mov_b32 v135, 0xff800000
    v_mov_b32 v132, v135
    s_mov_b32 s22, 0
L_fb3_a:
    s_lshr_b32 s23, s22, 1
    s_lshl_b32 s23, s23, 15
    s_and_b32 s24, s22, 1
    s_lshl_b32 s24, s24, 13
    s_add_u32 s24, s24, s23
    s_lshl_b32 s20, s22, 5
    v_subrev_u32 v134, s20, v133
    buffer_load_dwordx4 v[88:91], v17, s[28:31], s24 offen sc1
    buffer_load_dwordx4 v[92:95], v17, s[28:31], s24 offen offset:1024 sc1
    buffer_load_dwordx4 v[96:99], v17, s[28:31], s24 offen offset:2048 sc1
    buffer_load_dwordx4 v[100:103], v17, s[28:31], s24 offen offset:3072 sc1
    s_add_u32 s24, s24, 4096
    s_waitcnt vmcnt(0)
    v_mfma_f32_16x16x32_bf16 v[120:123], v[88:91], v[52:55], 0
    v_mfma_f32_16x16x32_bf16 v[120:123], v[92:95], v[84:87], v[120:123]
    v_mfma_f32_16x16x32_bf16 v[120:123], v[96:99], v[116:119], v[120:123]
    v_mfma_f32_16x16x32_bf16 v[120:123], v[100:103], v[148:151], v[120:123]
    s_nop 7
    buffer_load_dwordx4 v[88:91], v17, s[28:31], s24 offen sc1
    buffer_load_dwordx4 v[92:95], v17, s[28:31], s24 offen offset:1024 sc1
    buffer_load_dwordx4 v[96:99], v17, s[28:31], s24 offen offset:2048 sc1
    buffer_load_dwordx4 v[100:103], v17, s[28:31], s24 offen offset:3072 sc1
    s_add_u32 s24, s24, 4096
    s_waitcnt vmcnt(0)
    v_mfma_f32_16x16x32_bf16 v[124:127], v[88:91], v[52:55], 0
    v_mfma_f32_16x16x32_bf16 v[124:127], v[92:95], v[84:87], v[124:127]
    v_mfma_f32_16x16x32_bf16 v[124:127], v[96:99], v[116:119], v[124:127]
    v_mfma_f32_16x16x32_bf16 v[124:127], v[100:103], v[148:151], v[124:127]
    s_nop 7
    v_cmp_le_i32 vcc, 0, v134
    s_nop 1
    v_cndmask_b32 v120, v135, v120, vcc
    v_cmp_le_i32 vcc, 1, v134
    s_nop 1
    v_cndmask_b32 v121, v135, v121, vcc
    v_cmp_le_i32 vcc, 2, v134
    s_nop 1
    v_cndmask_b32 v122, v135, v122, vcc
    v_cmp_le_i32 vcc, 3, v134
    s_nop 1
    v_cndmask_b32 v123, v135, v123, vcc
    v_cmp_le_i32 vcc, 16, v134
    s_nop 1
    v_cndmask_b32 v124, v135, v124, vcc
    v_cmp_le_i32 vcc, 17, v134
    s_nop 1
    v_cndmask_b32 v125, v135, v125, vcc
    v_cmp_le_i32 vcc, 18, v134
    s_nop 1
    v_cndmask_b32 v126, v135, v126, vcc
    v_cmp_le_i32 vcc, 19, v134
    s_nop 1
    v_cndmask_b32 v127, v135, v127, vcc
    v_max3_f32 v132, v132, v120, v121
    v_max3_f32 v132, v132, v122, v123
    v_max3_f32 v132, v132, v124, v125
    v_max3_f32 v132, v132, v126, v127
    s_add_u32 s22, s22, 1
    s_cmp_lt_u32 s22, s21
    s_cbranch_scc1 L_fb3_a
    v_mov_b32 v134, v132
    s_nop 1
    v_permlane32_swap_b32 v134, v132
    s_nop 1
    v_max_f32 v132, v132, v134
    v_mov_b32 v134, v132
    s_nop 1
    v_permlane16_swap_b32 v134, v132
    s_nop 1
    v_max_f32 v132, v132, v134
    v_accvgpr_write_b32 a96, 0
    v_accvgpr_write_b32 a97, 0
    v_accvgpr_write_b32 a98, 0
    v_accvgpr_write_b32 a99, 0
    v_accvgpr_write_b32 a100, 0
    v_accvgpr_write_b32 a101, 0
    v_accvgpr_write_b32 a102, 0
    v_accvgpr_write_b32 a103, 0
    v_accvgpr_write_b32 a104, 0
    v_accvgpr_write_b32 a105, 0
    v_accvgpr_write_b32 a106, 0
    v_accvgpr_write_b32 a107, 0
    v_accvgpr_write_b32 a108, 0
    v_accvgpr_write_b32 a109, 0
    v_accvgpr_write_b32 a110, 0
    v_accvgpr_write_b32 a111, 0
    v_accvgpr_write_b32 a112, 0
    v_accvgpr_write_b32 a113, 0
    v_accvgpr_write_b32 a114, 0
    v_accvgpr_write_b32 a115, 0
    v_accvgpr_write_b32 a116, 0
    v_accvgpr_write_b32 a117, 0
    v_accvgpr_write_b32 a118, 0
    v_accvgpr_write_b32 a119, 0
    v_accvgpr_write_b32 a120, 0
    v_accvgpr_write_b32 a121, 0
    v_accvgpr_write_b32 a122, 0
    v_accvgpr_write_b32 a123, 0
    v_accvgpr_write_b32 a124, 0
    v_accvgpr_write_b32 a125, 0
    v_accvgpr_write_b32 a126, 0
    v_accvgpr_write_b32 a127, 0
    v_mov_b32 v68, 0
    v_mov_b32 v69, 0
    v_mov_b32 v70, 0
    v_mov_b32 v71, 0
    s_mov_b32 s22, 0
L_fb3_b:
    s_lshr_b32 s23, s22, 1
    s_lshl_b32 s23, s23, 15
    s_and_b32 s24, s22, 1
    s_lshl_b32 s24, s24, 13
    s_add_u32 s24, s24, s23
    s_lshl_b32 s20, s22, 5
    v_subrev_u32 v134, s20, v133
    buffer_load_dwordx4 v[88:91], v17, s[28:31], s24 offen sc1
    buffer_load_dwordx4 v[92:95], v17, s[28:31], s24 offen offset:1024 sc1
    buffer_load_dwordx4 v[96:99], v17, s[28:31], s24 offen offset:2048 sc1
    buffer_load_dwordx4 v[100:103], v17, s[28:31], s24 offen offset:3072 sc1
    s_add_u32 s24, s24, 4096
    s_waitcnt vmcnt(0)
    v_mfma_f32_16x16x32_bf16 v[120:123], v[88:91], v[52:55], 0
    v_mfma_f32_16x16x32_bf16 v[120:123], v[92:95], v[84:87], v[120:123]
    v_mfma_f32_16x16x32_bf16 v[120:123], v[96:99], v[116:119], v[120:123]
    v_mfma_f32_16x16x32_bf16 v[120:123], v[100:103], v[148:151], v[120:123]
    s_nop 7
    buffer_load_dwordx4 v[88:91], v17, s[28:31], s24 offen sc1
    buffer_load_dwordx4 v[92:95], v17, s[28:31], s24 offen offset:1024 sc1
    buffer_load_dwordx4 v[96:99], v17, s[28:31], s24 offen offset:2048 sc1
    buffer_load_dwordx4 v[100:103], v17, s[28:31], s24 offen offset:3072 sc1
    s_add_u32 s24, s24, 4096
    s_waitcnt vmcnt(0)
    v_mfma_f32_16x16x32_bf16 v[124:127], v[88:91], v[52:55], 0
    v_mfma_f32_16x16x32_bf16 v[124:127], v[92:95], v[84:87], v[124:127]
    v_mfma_f32_16x16x32_bf16 v[124:127], v[96:99], v[116:119], v[124:127]
    v_mfma_f32_16x16x32_bf16 v[124:127], v[100:103], v[148:151], v[124:127]
    s_nop 7
    v_cmp_le_i32 vcc, 0, v134
    s_nop 1
    v_cndmask_b32 v120, v135, v120, vcc
    v_cmp_le_i32 vcc, 1, v134
    s_nop 1
    v_cndmask_b32 v121, v135, v121, vcc
    v_cmp_le_i32 vcc, 2, v134
    s_nop 1
    v_cndmask_b32 v122, v135, v122, vcc
    v_cmp_le_i32 vcc, 3, v134
    s_nop 1
    v_cndmask_b32 v123, v135, v123, vcc
    v_cmp_le_i32 vcc, 16, v134
    s_nop 1
    v_cndmask_b32 v124, v135, v124, vcc
    v_cmp_le_i32 vcc, 17, v134
    s_nop 1
    v_cndmask_b32 v125, v135, v125, vcc
    v_cmp_le_i32 vcc, 18, v134
    s_nop 1
    v_cndmask_b32 v126, v135, v126, vcc
    v_cmp_le_i32 vcc, 19, v134
    s_nop 1
    v_cndmask_b32 v127, v135, v127, vcc
    v_sub_f32 v120, v120, v132
    v_sub_f32 v121, v121, v132
    v_sub_f32 v122, v122, v132
    v_sub_f32 v123, v123, v132
    v_sub_f32 v124, v124, v132
    v_sub_f32 v125, v125, v132
    v_sub_f32 v126, v126, v132
    v_sub_f32 v127, v127, v132
    v_exp_f32 v120, v120
    v_exp_f32 v121, v121
    v_exp_f32 v122, v122
    v_exp_f32 v123, v123
    v_exp_f32 v124, v124
    v_exp_f32 v125, v125
    v_exp_f32 v126, v126
    v_exp_f32 v127, v127
    s_nop 0
    v_cvt_pk_bf16_f32 v128, v120, v121
    v_cvt_pk_bf16_f32 v129, v122, v123
    v_cvt_pk_bf16_f32 v130, v124, v125
    v_cvt_pk_bf16_f32 v131, v126, v127
    s_and_b32 s24, s22, 1
    s_lshl_b32 s24, s24, 10
    s_add_u32 s24, s24, s23
    s_add_u32 s24, s24, 16384
    v_mfma_f32_16x16x32_bf16 v[68:71], v[248:251], v[128:131], v[68:71]
    buffer_load_dwordx4 v[88:91], v17, s[28:31], s24 offen sc1
    buffer_load_dwordx4 v[92:95], v17, s[28:31], s24 offen offset:2048 sc1
    s_add_u32 s24, s24, 4096
    buffer_load_dwordx4 v[96:99], v17, s[28:31], s24 offen sc1
    buffer_load_dwordx4 v[100:103], v17, s[28:31], s24 offen offset:2048 sc1
    s_add_u32 s24, s24, 4096
    s_waitcnt vmcnt(0)
    v_mfma_f32_16x16x32_bf16 a[96:99], v[88:91], v[128:131], a[96:99]
    v_mfma_f32_16x16x32_bf16 a[100:103], v[92:95], v[128:131], a[100:103]
    v_mfma_f32_16x16x32_bf16 a[104:107], v[96:99], v[128:131], a[104:107]
    v_mfma_f32_16x16x32_bf16 a[108:111], v[100:103], v[128:131], a[108:111]
    s_nop 7
    buffer_load_dwordx4 v[88:91], v17, s[28:31], s24 offen sc1
    buffer_load_dwordx4 v[92:95], v17, s[28:31], s24 offen offset:2048 sc1
    s_add_u32 s24, s24, 4096
    buffer_load_dwordx4 v[96:99], v17, s[28:31], s24 offen sc1
    buffer_load_dwordx4 v[100:103], v17, s[28:31], s24 offen offset:2048 sc1
    s_add_u32 s24, s24, 4096
    s_waitcnt vmcnt(0)
    v_mfma_f32_16x16x32_bf16 a[112:115], v[88:91], v[128:131], a[112:115]
    v_mfma_f32_16x16x32_bf16 a[116:119], v[92:95], v[128:131], a[116:119]
    v_mfma_f32_16x16x32_bf16 a[120:123], v[96:99], v[128:131], a[120:123]
    v_mfma_f32_16x16x32_bf16 a[124:127], v[100:103], v[128:131], a[124:127]
    s_nop 7
    s_add_u32 s22, s22, 1
    s_cmp_lt_u32 s22, s21
    s_cbranch_scc1 L_fb3_b
    s_nop 15
    s_branch L_fb3_ret
L_fb0:
    s_nop 15
    s_lshl_b32 s20, s65, 3
    s_sub_u32 s20, 120, s20
    s_add_u32 s20, s20, 7
    s_sub_u32 s20, s20, s66
    s_lshr_b32 s21, s20, 1
    s_add_u32 s21, s21, 1
    s_lshl_b32 s20, s20, 4
    v_bfe_u32 v197, v17, 4, 4
    v_bfe_u32 v198, v17, 8, 2
    v_lshlrev_b32 v198, 2, v198
    v_sub_u32 v197, v197, v198
    v_add_u32 v197, s20, v197
    v_mov_b32 v199, 0xff800000
    v_mov_b32 v196, v199
    s_mov_b32 s22, 0
L_fb0_a:
    s_lshr_b32 s23, s22, 1
    s_lshl_b32 s23, s23, 15
    s_and_b32 s24, s22, 1
    s_lshl_b32 s24, s24, 13
    s_add_u32 s24, s24, s23
    s_lshl_b32 s20, s22, 5
    v_subrev_u32 v198, s20, v197
    buffer_load_dwordx4 v[168:171], v17, s[28:31], s24 offen sc1
    buffer_load_dwordx4 v[172:175], v17, s[28:31], s24 offen offset:1024 sc1
    buffer_load_dwordx4 v[176:179], v17, s[28:31], s24 offen offset:2048 sc1
    buffer_load_dwordx4 v[180:183], v17, s[28:31], s24 offen offset:3072 sc1
    s_add_u32 s24, s24, 4096
    s_waitcnt vmcnt(0)
    v_mfma_f32_16x16x32_bf16 v[184:187], v[168:171], v[40:43], 0
    v_mfma_f32_16x16x32_bf16 v[184:187], v[172:175], v[72:75], v[184:187]
    v_mfma_f32_16x16x32_bf16 v[184:187], v[176:179], v[104:107], v[184:187]
    v_mfma_f32_16x16x32_bf16 v[184:187], v[180:183], v[136:139], v[184:187]
    s_nop 7
    buffer_load_dwordx4 v[168:171], v17, s[28:31], s24 offen sc1
    buffer_load_dwordx4 v[172:175], v17, s[28:31], s24 offen offset:1024 sc1
    buffer_load_dwordx4 v[176:179], v17, s[28:31], s24 offen offset:2048 sc1
    buffer_load_dwordx4 v[180:183], v17, s[28:31], s24 offen offset:3072 sc1
    s_add_u32 s24, s24, 4096
    s_waitcnt vmcnt(0)
    v_mfma_f32_16x16x32_bf16 v[188:191], v[168:171], v[40:43], 0
    v_mfma_f32_16x16x32_bf16 v[188:191], v[172:175], v[72:75], v[188:191]
    v_mfma_f32_16x16x32_bf16 v[188:191], v[176:179], v[104:107], v[188:191]
    v_mfma_f32_16x16x32_bf16 v[188:191], v[180:183], v[136:139], v[188:191]
    s_nop 7
    v_cmp_le_i32 vcc, 0, v198
    s_nop 1
    v_cndmask_b32 v184, v199, v184, vcc
    v_cmp_le_i32 vcc, 1, v198
    s_nop 1
    v_cndmask_b32 v185, v199, v185, vcc
    v_cmp_le_i32 vcc, 2, v198
    s_nop 1
    v_cndmask_b32 v186, v199, v186, vcc
    v_cmp_le_i32 vcc, 3, v198
    s_nop 1
    v_cndmask_b32 v187, v199, v187, vcc
    v_cmp_le_i32 vcc, 16, v198
    s_nop 1
    v_cndmask_b32 v188, v199, v188, vcc
    v_cmp_le_i32 vcc, 17, v198
    s_nop 1
    v_cndmask_b32 v189, v199, v189, vcc
    v_cmp_le_i32 vcc, 18, v198
    s_nop 1
    v_cndmask_b32 v190, v199, v190, vcc
    v_cmp_le_i32 vcc, 19, v198
    s_nop 1
    v_cndmask_b32 v191, v199, v191, vcc
    v_max3_f32 v196, v196, v184, v185
    v_max3_f32 v196, v196, v186, v187
    v_max3_f32 v196, v196, v188, v189
    v_max3_f32 v196, v196, v190, v191
    s_add_u32 s22, s22, 1
    s_cmp_lt_u32 s22, s21
    s_cbranch_scc1 L_fb0_a
    v_mov_b32 v198, v196
    s_nop 1
    v_permlane32_swap_b32 v198, v196
    s_nop 1
    v_max_f32 v196, v196, v198
    v_mov_b32 v198, v196
    s_nop 1
    v_permlane16_swap_b32 v198, v196
    s_nop 1
    v_max_f32 v196, v196, v198
    v_accvgpr_write_b32 a0, 0
    v_accvgpr_write_b32 a1, 0
    v_accvgpr_write_b32 a2, 0
    v_accvgpr_write_b32 a3, 0
    v_accvgpr_write_b32 a4, 0
    v_accvgpr_write_b32 a5, 0
    v_accvgpr_write_b32 a6, 0
    v_accvgpr_write_b32 a7, 0
    v_accvgpr_write_b32 a8, 0
    v_accvgpr_write_b32 a9, 0
    v_accvgpr_write_b32 a10, 0
    v_accvgpr_write_b32 a11, 0
    v_accvgpr_write_b32 a12, 0
    v_accvgpr_write_b32 a13, 0
    v_accvgpr_write_b32 a14, 0
    v_accvgpr_write_b32 a15, 0
    v_accvgpr_write_b32 a16, 0
    v_accvgpr_write_b32 a17, 0
    v_accvgpr_write_b32 a18, 0
    v_accvgpr_write_b32 a19, 0
    v_accvgpr_write_b32 a20, 0
    v_accvgpr_write_b32 a21, 0
    v_accvgpr_write_b32 a22, 0
    v_accvgpr_write_b32 a23, 0
    v_accvgpr_write_b32 a24, 0
    v_accvgpr_write_b32 a25, 0
    v_accvgpr_write_b32 a26, 0
    v_accvgpr_write_b32 a27, 0
    v_accvgpr_write_b32 a28, 0
    v_accvgpr_write_b32 a29, 0
    v_accvgpr_write_b32 a30, 0
    v_accvgpr_write_b32 a31, 0
    v_mov_b32 v56, 0
    v_mov_b32 v57, 0
    v_mov_b32 v58, 0
    v_mov_b32 v59, 0
    s_mov_b32 s22, 0
L_fb0_b:
    s_lshr_b32 s23, s22, 1
    s_lshl_b32 s23, s23, 15
    s_and_b32 s24, s22, 1
    s_lshl_b32 s24, s24, 13
    s_add_u32 s24, s24, s23
    s_lshl_b32 s20, s22, 5
    v_subrev_u32 v198, s20, v197
    buffer_load_dwordx4 v[168:171], v17, s[28:31], s24 offen sc1
    buffer_load_dwordx4 v[172:175], v17, s[28:31], s24 offen offset:1024 sc1
    buffer_load_dwordx4 v[176:179], v17, s[28:31], s24 offen offset:2048 sc1
    buffer_load_dwordx4 v[180:183], v17, s[28:31], s24 offen offset:3072 sc1
    s_add_u32 s24, s24, 4096
    s_waitcnt vmcnt(0)
    v_mfma_f32_16x16x32_bf16 v[184:187], v[168:171], v[40:43], 0
    v_mfma_f32_16x16x32_bf16 v[184:187], v[172:175], v[72:75], v[184:187]
    v_mfma_f32_16x16x32_bf16 v[184:187], v[176:179], v[104:107], v[184:187]
    v_mfma_f32_16x16x32_bf16 v[184:187], v[180:183], v[136:139], v[184:187]
    s_nop 7
    buffer_load_dwordx4 v[168:171], v17, s[28:31], s24 offen sc1
    buffer_load_dwordx4 v[172:175], v17, s[28:31], s24 offen offset:1024 sc1
    buffer_load_dwordx4 v[176:179], v17, s[28:31], s24 offen offset:2048 sc1
    buffer_load_dwordx4 v[180:183], v17, s[28:31], s24 offen offset:3072 sc1
    s_add_u32 s24, s24, 4096
    s_waitcnt vmcnt(0)
    v_mfma_f32_16x16x32_bf16 v[188:191], v[168:171], v[40:43], 0
    v_mfma_f32_16x16x32_bf16 v[188:191], v[172:175], v[72:75], v[188:191]
    v_mfma_f32_16x16x32_bf16 v[188:191], v[176:179], v[104:107], v[188:191]
    v_mfma_f32_16x16x32_bf16 v[188:191], v[180:183], v[136:139], v[188:191]
    s_nop 7
    v_cmp_le_i32 vcc, 0, v198
    s_nop 1
    v_cndmask_b32 v184, v199, v184, vcc
    v_cmp_le_i32 vcc, 1, v198
    s_nop 1
    v_cndmask_b32 v185, v199, v185, vcc
    v_cmp_le_i32 vcc, 2, v198
    s_nop 1
    v_cndmask_b32 v186, v199, v186, vcc
    v_cmp_le_i32 vcc, 3, v198
    s_nop 1
    v_cndmask_b32 v187, v199, v187, vcc
    v_cmp_le_i32 vcc, 16, v198
    s_nop 1
    v_cndmask_b32 v188, v199, v188, vcc
    v_cmp_le_i32 vcc, 17, v198
    s_nop 1
    v_cndmask_b32 v189, v199, v189, vcc
    v_cmp_le_i32 vcc, 18, v198
    s_nop 1
    v_cndmask_b32 v190, v199, v190, vcc
    v_cmp_le_i32 vcc, 19, v198
    s_nop 1
    v_cndmask_b32 v191, v199, v191, vcc
    v_sub_f32 v184, v184, v196
    v_sub_f32 v185, v185, v196
    v_sub_f32 v186, v186, v196
    v_sub_f32 v187, v187, v196
    v_sub_f32 v188, v188, v196
    v_sub_f32 v189, v189, v196
    v_sub_f32 v190, v190, v196
    v_sub_f32 v191, v191, v196
    v_exp_f32 v184, v184
    v_exp_f32 v185, v185
    v_exp_f32 v186, v186
    v_exp_f32 v187, v187
    v_exp_f32 v188, v188
    v_exp_f32 v189, v189
    v_exp_f32 v190, v190
    v_exp_f32 v191, v191
    s_nop 0
    v_cvt_pk_bf16_f32 v192, v184, v185
    v_cvt_pk_bf16_f32 v193, v186, v187
    v_cvt_pk_bf16_f32 v194, v188, v189
    v_cvt_pk_bf16_f32 v195, v190, v191
    s_and_b32 s24, s22, 1
    s_lshl_b32 s24, s24, 10
    s_add_u32 s24, s24, s23
    s_add_u32 s24, s24, 16384
    v_mfma_f32_16x16x32_bf16 v[56:59], v[248:251], v[192:195], v[56:59]
    buffer_load_dwordx4 v[168:171], v17, s[28:31], s24 offen sc1
    buffer_load_dwordx4 v[172:175], v17, s[28:31], s24 offen offset:2048 sc1
    s_add_u32 s24, s24, 4096
    buffer_load_dwordx4 v[176:179], v17, s[28:31], s24 offen sc1
    buffer_load_dwordx4 v[180:183], v17, s[28:31], s24 offen offset:2048 sc1
    s_add_u32 s24, s24, 4096
    s_waitcnt vmcnt(0)
    v_mfma_f32_16x16x32_bf16 a[0:3], v[168:171], v[192:195], a[0:3]
    v_mfma_f32_16x16x32_bf16 a[4:7], v[172:175], v[192:195], a[4:7]
    v_mfma_f32_16x16x32_bf16 a[8:11], v[176:179], v[192:195], a[8:11]
    v_mfma_f32_16x16x32_bf16 a[12:15], v[180:183], v[192:195], a[12:15]
    s_nop 7
    buffer_load_dwordx4 v[168:171], v17, s[28:31], s24 offen sc1
    buffer_load_dwordx4 v[172:175], v17, s[28:31], s24 offen offset:2048 sc1
    s_add_u32 s24, s24, 4096
    buffer_load_dwordx4 v[176:179], v17, s[28:31], s24 offen sc1
    buffer_load_dwordx4 v[180:183], v17, s[28:31], s24 offen offset:2048 sc1
    s_add_u32 s24, s24, 4096
    s_waitcnt vmcnt(0)
    v_mfma_f32_16x16x32_bf16 a[16:19], v[168:171], v[192:195], a[16:19]
    v_mfma_f32_16x16x32_bf16 a[20:23], v[172:175], v[192:195], a[20:23]
    v_mfma_f32_16x16x32_bf16 a[24:27], v[176:179], v[192:195], a[24:27]
    v_mfma_f32_16x16x32_bf16 a[28:31], v[180:183], v[192:195], a[28:31]
    s_nop 7
    s_add_u32 s22, s22, 1
    s_cmp_lt_u32 s22, s21
    s_cbranch_scc1 L_fb0_b
    s_nop 15
    s_branch L_fb0_ret
L_spin_clr:
    buffer_load_dword v38, v36, s[60:63], s17 offen sc1
    s_waitcnt vmcnt(0)
    v_cmp_eq_u32 vcc, 0, v38
    s_nop 4
    s_cbranch_vccz L_spin_clr_ret
    s_sleep 2
    s_branch L_spin_clr
    .fill 2048, 4, 0xbf810000
.section .rodata,"a"
.p2align 6
.amdhsa_kernel gated_mix__compressed_kv_cla__dense_activation_relu__prompt_kernel
  .amdhsa_next_free_vgpr 512
  .amdhsa_next_free_sgpr 102
  .amdhsa_accum_offset 256
  .amdhsa_group_segment_fixed_size 0
  .amdhsa_kernarg_size 104
  .amdhsa_user_sgpr_count 2
  .amdhsa_user_sgpr_kernarg_segment_ptr 1
  .amdhsa_system_sgpr_workgroup_id_x 1
  .amdhsa_float_denorm_mode_32 3
.end_amdhsa_kernel
```
